```python
import torch

def _softmax(x, axis=-1):
    return torch.softmax(x, dim=axis)

def _gelu(x):
    return torch.nn.functional.gelu(x, approximate='tanh')

def _silu(x):
    return torch.nn.functional.silu(x)

def _sigmoid(x):
    return torch.sigmoid(x)

def _layernorm(x, axis=-1, eps=1e-05):
    m = x.mean(dim=axis, keepdim=True)
    v = x.var(dim=axis, keepdim=True, unbiased=False)
    return (x - m) / torch.sqrt(v + eps)

def _scatter_add(tgt, idx, src, axis=0):
    return tgt.clone().index_add_(axis, idx, src)

def _segment_sum(src, seg, n):
    out = torch.zeros((n,) + src.shape[1:], dtype=src.dtype)
    return out.index_add_(0, seg, src)

def _pad(x, pw):
    flat = tuple((v for pair in reversed(pw) for v in pair))
    return torch.nn.functional.pad(x, flat)
kernel_name = 'gated_mix__memory_aug_recurrent_mem_tr__dense_activation_relu__prompt'

def setup_inputs():

    _w = lambda a: (lambda t: t.to(torch.bfloat16) if t.is_floating_point() else t)(torch.as_tensor(a))

    def _A_setup():
        B, S, Dm = (1, 2048, 1024)
        H, Dh = (32, 128)
        M, seg = (8, 32)
        seg = min(seg, S)
        S = S // seg * seg
        return {'x': _w((lambda *s: torch.randn(*s, dtype=torch.bfloat16) * 0.05)(B, S, Dm)), 'mem0': _w((lambda *s: torch.randn(*s, dtype=torch.bfloat16) * 1.6)(B, M, Dm)), 'Wq': _w((lambda *s: torch.randn(*s, dtype=torch.bfloat16) * 0.8)(Dm, H, Dh) * Dm ** (-0.5)), 'Wk': _w((lambda *s: torch.randn(*s, dtype=torch.bfloat16) * 0.8)(Dm, H, Dh) * Dm ** (-0.5)), 'Wv': _w((lambda *s: torch.randn(*s, dtype=torch.bfloat16) * 1.6)(Dm, H, Dh) * Dm ** (-0.5)), 'Wo': _w((lambda *s: torch.randn(*s, dtype=torch.bfloat16) * 1.6)(H, Dh, Dm) * (H * Dh) ** (-0.5)), 'seg_len': seg}
    _A_in = _A_setup()

    def _B_setup():
        B, S, D, Dff = (1, 2048, 1024, 3584)
        return {'x': _w((lambda *s: torch.randn(*s, dtype=torch.bfloat16) * 0.05)(B, S, D)), 'w1': _w((lambda *s: torch.randn(*s, dtype=torch.bfloat16) * 0.05)(D, Dff)), 'w2': _w((lambda *s: torch.randn(*s, dtype=torch.bfloat16) * 0.05)(Dff, D))}
    _B_in = _B_setup()
    return {'A_x': _A_in['x'], 'A_mem0': _A_in['mem0'], 'A_Wq': _A_in['Wq'], 'A_Wk': _A_in['Wk'], 'A_Wv': _A_in['Wv'], 'A_Wo': _A_in['Wo'], 'A_seg_len': _A_in['seg_len'], 'B_x': _B_in['x'], 'B_w1': _B_in['w1'], 'B_w2': _B_in['w2'], 'gate_w': _w((lambda *s: torch.randn(*s, dtype=torch.bfloat16) * 0.05)(1024) * 16.0)}

def reference(A_x, A_mem0, A_Wq, A_Wk, A_Wv, A_Wo, A_seg_len, B_x, B_w1, B_w2, gate_w):

    def _A_ref(x, mem0, Wq, Wk, Wv, Wo, seg_len):
        B, S, Dm = x.shape
        H, Dh = (Wq.shape[1], Wq.shape[2])
        M = mem0.shape[1]
        scale = Dh ** (-0.5)
        n_seg = S // seg_len
        L = M + seg_len
        idx = torch.arange(L)
        mask = (idx[:, None] < M) | (idx[:, None] >= idx[None, :])
        mem = mem0
        outs = []
        for s in range(n_seg):
            xs = x[:, s * seg_len:(s + 1) * seg_len, :].clone()
            h = torch.concatenate([mem, xs], axis=1)
            q = torch.einsum('btd,dhe->bhte', h, Wq)
            k = torch.einsum('btd,dhe->bhte', h, Wk)
            v = torch.einsum('btd,dhe->bhte', h, Wv)
            scores = torch.einsum('bhqe,bhke->bhqk', q, k) * scale
            scores = torch.where(mask[None, None], scores, -1000000000.0)
            p = _softmax(scores, axis=-1)
            o = torch.einsum('bhqk,bhke->bhqe', p, v)
            o = torch.einsum('bhte,hed->btd', o, Wo)
            mem = o[:, :M, :].clone()
            outs.append(o[:, M:, :])
        return torch.concatenate(outs, axis=1)

    def _B_ref(x, w1, w2):
        h = torch.einsum('bsd,df->bsf', x, w1)
        zero = torch.zeros_like(h)
        h = torch.maximum(h, zero)
        return torch.einsum('bsf,fd->bsd', h, w2)
    x = A_x
    g = _sigmoid((x * gate_w).sum(-1, keepdims=True))
    a = _A_ref(x, A_mem0, A_Wq, A_Wk, A_Wv, A_Wo, A_seg_len)
    b = _B_ref(x, B_w1, B_w2)
    return g * a + (1 - g) * b
```

```asm
; @launch grid=(256,1,1) block=(256,1,1) lds=163840
.amdgcn_target "amdgcn-amd-amdhsa--gfx950"
.text
.globl gated_mix__memory_aug_recurrent_mem_tr__dense_activation_relu__prompt_kernel
.p2align 8
.type gated_mix__memory_aug_recurrent_mem_tr__dense_activation_relu__prompt_kernel,@function
gated_mix__memory_aug_recurrent_mem_tr__dense_activation_relu__prompt_kernel:
  s_cmp_ge_u32 s2, 256
  s_cbranch_scc1 L_exit
  s_load_dwordx16 s[64:79], s[0:1], 0
  s_load_dwordx8 s[80:87], s[0:1], 64
  s_load_dwordx4 s[88:91], s[0:1], 96
  s_getreg_b32 s39, hwreg(HW_REG_XCC_ID, 0, 3)
  v_lshrrev_b32 v1, 6, v0
  v_lshlrev_b32 v2, 4, v0
  v_readfirstlane_b32 s24, v1
  v_and_b32 v0, 63, v0
  s_mov_b32 s30, 0
  s_mov_b32 s36, 0
  s_mov_b32 s96, 0
  s_mov_b32 s97, 0
  s_lshr_b32 s26, s2, 3
  s_lshl_b32 s35, s39, 5
  s_add_u32 s35, s35, s26
  s_waitcnt lgkmcnt(0)
  s_mov_b32 s4, s90
  s_mov_b32 s5, s91
  s_mov_b32 s6, 0x10000000
  s_mov_b32 s7, 0x20000
  s_mov_b32 s8, s88
  s_mov_b32 s9, s89
  s_mov_b32 s10, 0x100
  s_mov_b32 s11, 0x20000
  s_sub_u32 s28, 0, s90
  s_and_b32 s28, s28, 0x1fffff
  s_cmp_lg_u32 s24, 1
  s_cbranch_scc1 L_probe_done
  s_cmp_lt_u32 s2, 240
  s_cbranch_scc1 L_probe_done
  s_and_b32 s31, s2, 15
  s_lshl_b32 s31, s31, 7
  s_add_u32 s31, s31, s28
  s_add_u32 s31, s31, 0x180000
  v_mov_b32 v3, 0
  s_mov_b64 exec, 1
  s_mov_b32 s40, 0xfffff
  s_mov_b32 s41, 0xfffff
  s_mov_b32 s45, 0
L_probe_next:
  s_mov_b32 s46, 0
  buffer_store_dword v3, off, s[4:7], s31 sc1
L_probe_wait:
  s_add_u32 s46, s46, 1
  s_getreg_b32 s44, hwreg(HW_REG_IB_STS, 0, 4)
  s_cmp_lg_u32 s44, 0
  s_cselect_b32 s44, 0x100000, 0
  s_cmp_lt_u32 s46, s44
  s_cbranch_scc1 L_probe_wait
  s_waitcnt vmcnt(0)
  s_add_u32 s31, s31, 8192
  s_min_u32 s46, s40, s46
  s_mov_b32 s40, s41
  s_mov_b32 s41, s46
  s_add_u32 s45, s45, 1
  s_cmp_lt_u32 s45, 6
  s_cbranch_scc1 L_probe_next
  s_sub_u32 s40, 0x100000, s40
  s_sub_u32 s41, 0x100000, s41
  s_and_b32 s32, s39, 4
  s_xor_b32 s33, s32, 4
  v_mov_b32 v3, s40
  v_mov_b32 v4, s41
  buffer_atomic_umax v3, off, s[8:11], s32 offset:136 sc1
  buffer_atomic_umax v4, off, s[8:11], s33 offset:136 sc1
  s_mov_b64 exec, -1
L_probe_done:
  s_mul_i32 s31, s2, 5120
  s_add_u32 s31, s31, s28
  v_mov_b32 v8, -1
  v_mov_b32 v9, -1
  v_mov_b32 v10, -1
  v_mov_b32 v11, -1
  buffer_store_dwordx4 v[8:11], v2, s[4:7], s31 offen sc1
  s_cmp_lg_u32 s24, 3
  s_cbranch_scc1 L_init_done
  s_add_u32 s31, s31, 1024
  buffer_store_dwordx4 v[8:11], v2, s[4:7], s31 offen sc1
  s_lshl_b32 s32, s2, 7
  s_add_u32 s32, s32, 0x400000
  v_mov_b32 v4, 0
  v_mov_b32 v5, 0
  v_mov_b32 v6, 0
  v_mov_b32 v7, 0
  s_mov_b64 exec, 1
  buffer_store_dwordx4 v[4:7], off, s[4:7], s32 sc1
  s_mov_b64 exec, -1
L_init_done:
  s_cmp_lg_u32 s24, 2
  s_cbranch_scc1 L_init_done2
  s_lshr_b32 s31, s2, 3
  s_mul_i32 s31, s31, 524288
  s_and_b32 s32, s2, 7
  s_lshl_b32 s32, s32, 10
  s_add_u32 s31, s31, s32
  s_add_u32 s31, s31, 0x487d800
  buffer_store_dwordx4 v[8:11], v2, s[4:7], s31 offen sc1
L_init_done2:
  s_lshl_b32 s63, s39, 7
  s_add_u32 s63, s63, 0x408000
  buffer_load_dword v30, off, s[4:7], s63 sc1
L_dispatch:
  s_lshr_b32 s27, s35, 5
  s_and_b32 s26, s35, 31
  s_cmp_ge_u32 s27, 4
  s_cbranch_scc1 L_mapHi
  s_cmp_lt_u32 s26, 8
  s_cbranch_scc1 L_mapA
  s_cmp_lt_u32 s26, 24
  s_cbranch_scc1 L_mapB
  s_mul_i32 s31, s27, 7
  s_add_u32 s31, s31, s26
  s_sub_u32 s31, s31, 24
  s_add_u32 s32, s27, 28
  s_cmp_eq_u32 s26, 31
  s_cselect_b32 s26, s32, s31
  s_mov_b32 s27, 6
  s_branch L_mapped
L_mapHi:
  s_cmp_eq_u32 s27, 6
  s_cselect_b32 s27, 3, s27
  s_branch L_mapped
L_mapA:
  s_lshl_b32 s31, s27, 3
  s_add_u32 s26, s26, s31
  s_mov_b32 s27, 0
  s_branch L_mapped
L_mapB:
  s_and_b32 s31, s27, 1
  s_lshl_b32 s31, s31, 4
  s_add_u32 s26, s26, s31
  s_sub_u32 s26, s26, 8
  s_lshr_b32 s27, s27, 1
  s_add_u32 s27, s27, 1
L_mapped:
  s_lshl_b32 s25, s27, 5
  s_add_u32 s25, s25, s26
  s_cmp_eq_u32 s27, 0
  s_cbranch_scc1 L_roleA
  s_cmp_le_u32 s27, 2
  s_cbranch_scc1 L_roleB
  s_cmp_eq_u32 s27, 7
  s_cbranch_scc1 L_roleF2
  s_cmp_ge_u32 s25, 220
  s_cbranch_scc1 L_roleX
  s_branch L_roleG1
L_roleA:
  s_mov_b32 s12, s68
  s_mov_b32 s13, s69
  s_mov_b32 s14, 0x800000
  s_mov_b32 s15, 0x20000
  s_mov_b32 s16, s70
  s_mov_b32 s17, s71
  s_mov_b32 s18, 0x800000
  s_mov_b32 s19, 0x20000
  s_lshl_b32 s32, s26, 8
  s_lshl_b32 s33, s24, 4
  v_mov_b32 v1, 0x0
  v_bfe_u32 v18, v0, 4, 2
  v_lshl_add_u32 v1, v18, 0, v1
  v_add_u32 v1, s33, v1
  v_lshlrev_b32 v1, 13, v1
  v_mov_b32 v2, 0x0
  v_bfe_u32 v18, v0, 0, 4
  v_lshl_add_u32 v2, v18, 4, v2
  v_bfe_u32 v18, v0, 4, 2
  v_lshlrev_b32 v18, 5, v18
  v_xor_b32 v2, v2, v18
  v_add3_u32 v1, v1, v2, s32
  v_xor_b32 v2, 128, v1
  s_lshl_b32 s33, s24, 6
  v_mov_b32 v3, 0x0
  v_bfe_u32 v18, v0, 2, 2
  v_lshl_add_u32 v3, v18, 5, v3
  v_bfe_u32 v18, v0, 4, 1
  v_lshl_add_u32 v3, v18, 7, v3
  v_xor_b32 v3, s33, v3
  v_mov_b32 v4, 0x0
  v_bfe_u32 v18, v0, 4, 2
  v_lshl_add_u32 v4, v18, 11, v4
  v_bfe_u32 v18, v0, 2, 2
  v_lshl_add_u32 v4, v18, 8, v4
  v_bfe_u32 v18, v0, 0, 2
  v_lshl_add_u32 v4, v18, 3, v4
  v_add_u32 v3, v3, v4
  v_xor_b32 v4, 32, v3
  v_add_u32 v5, 0x10000, v3
  v_add_u32 v16, 0x20000, v3
  v_add_u32 v6, 0x10000, v4
  v_add_u32 v17, 0x20000, v4
  s_lshl_b32 s44, s24, 12
  v_mov_b32 v7, 0x10000
  v_bfe_u32 v18, v0, 0, 6
  v_lshl_add_u32 v7, v18, 4, v7
  v_add_u32 v7, s44, v7
  s_cmp_eq_u32 s24, 1
  s_cbranch_scc1 L_A_ld1
  s_cmp_eq_u32 s24, 2
  s_cbranch_scc1 L_A_ld2
  s_cmp_eq_u32 s24, 3
  s_cbranch_scc1 L_A_ld3
L_A_ld0:
  s_mov_b32 s31, 0x0
  s_add_u32 m0, s44, 0
  s_nop 0
  buffer_load_dwordx4 v1, s[12:15], s31 offen lds
  s_mov_b32 s31, 0x8000
  s_add_u32 m0, s44, 1024
  s_nop 0
  buffer_load_dwordx4 v1, s[12:15], s31 offen lds
  s_mov_b32 s31, 0x10000
  s_add_u32 m0, s44, 2048
  s_nop 0
  buffer_load_dwordx4 v2, s[12:15], s31 offen lds
  s_mov_b32 s31, 0x18000
  s_add_u32 m0, s44, 3072
  s_nop 0
  buffer_load_dwordx4 v2, s[12:15], s31 offen lds
  s_mov_b32 s31, 0x0
  s_add_u32 m0, s44, 16384
  s_nop 0
  buffer_load_dwordx4 v1, s[16:19], s31 offen lds
  s_mov_b32 s31, 0x8000
  s_add_u32 m0, s44, 17408
  s_nop 0
  buffer_load_dwordx4 v1, s[16:19], s31 offen lds
  s_mov_b32 s31, 0x10000
  s_add_u32 m0, s44, 18432
  s_nop 0
  buffer_load_dwordx4 v2, s[16:19], s31 offen lds
  s_mov_b32 s31, 0x18000
  s_add_u32 m0, s44, 19456
  s_nop 0
  buffer_load_dwordx4 v2, s[16:19], s31 offen lds
  s_mov_b32 s31, 0x80000
  s_add_u32 m0, s44, 32768
  s_nop 0
  buffer_load_dwordx4 v1, s[12:15], s31 offen lds
  s_mov_b32 s31, 0x88000
  s_add_u32 m0, s44, 33792
  s_nop 0
  buffer_load_dwordx4 v1, s[12:15], s31 offen lds
  s_mov_b32 s31, 0x90000
  s_add_u32 m0, s44, 34816
  s_nop 0
  buffer_load_dwordx4 v2, s[12:15], s31 offen lds
  s_mov_b32 s31, 0x98000
  s_add_u32 m0, s44, 35840
  s_nop 0
  buffer_load_dwordx4 v2, s[12:15], s31 offen lds
  s_mov_b32 s31, 0x80000
  s_add_u32 m0, s44, 49152
  s_nop 0
  buffer_load_dwordx4 v1, s[16:19], s31 offen lds
  s_mov_b32 s31, 0x88000
  s_add_u32 m0, s44, 50176
  s_nop 0
  buffer_load_dwordx4 v1, s[16:19], s31 offen lds
  s_mov_b32 s31, 0x90000
  s_add_u32 m0, s44, 51200
  s_nop 0
  buffer_load_dwordx4 v2, s[16:19], s31 offen lds
  s_mov_b32 s31, 0x98000
  s_add_u32 m0, s44, 52224
  s_nop 0
  buffer_load_dwordx4 v2, s[16:19], s31 offen lds
  s_mov_b32 s31, 0x100000
  s_add_u32 m0, s44, 65536
  s_nop 0
  buffer_load_dwordx4 v1, s[12:15], s31 offen lds
  s_mov_b32 s31, 0x108000
  s_add_u32 m0, s44, 66560
  s_nop 0
  buffer_load_dwordx4 v1, s[12:15], s31 offen lds
  s_mov_b32 s31, 0x110000
  s_add_u32 m0, s44, 67584
  s_nop 0
  buffer_load_dwordx4 v2, s[12:15], s31 offen lds
  s_mov_b32 s31, 0x118000
  s_add_u32 m0, s44, 68608
  s_nop 0
  buffer_load_dwordx4 v2, s[12:15], s31 offen lds
  s_mov_b32 s31, 0x100000
  s_add_u32 m0, s44, 114688
  s_nop 0
  buffer_load_dwordx4 v1, s[16:19], s31 offen lds
  s_mov_b32 s31, 0x108000
  s_add_u32 m0, s44, 115712
  s_nop 0
  buffer_load_dwordx4 v1, s[16:19], s31 offen lds
  s_mov_b32 s31, 0x110000
  s_add_u32 m0, s44, 116736
  s_nop 0
  buffer_load_dwordx4 v2, s[16:19], s31 offen lds
  s_mov_b32 s31, 0x118000
  s_add_u32 m0, s44, 117760
  s_nop 0
  buffer_load_dwordx4 v2, s[16:19], s31 offen lds
  s_cmp_lg_u32 s36, 0
  s_cbranch_scc1 L_ci_1
  s_waitcnt vmcnt(24)
  v_readfirstlane_b32 s62, v30
  s_barrier
  s_cmp_lg_u32 s24, 0
  s_cbranch_scc1 L_ci_1
  s_lshr_b32 s32, s2, 3
  s_lshl_b32 s31, 1, s32
  s_lshl_b32 s32, s39, 2
  v_mov_b32 v22, s31
  s_mov_b64 exec, 1
  buffer_atomic_or v22, off, s[8:11], s32 sc0 sc1
  s_mov_b64 exec, -1
L_ci_1:
  s_waitcnt vmcnt(20)
  s_barrier
  s_mov_b32 s31, 0x180000
  s_add_u32 m0, s44, 131072
  s_nop 0
  buffer_load_dwordx4 v1, s[12:15], s31 offen lds
  s_mov_b32 s31, 0x188000
  s_add_u32 m0, s44, 132096
  s_nop 0
  buffer_load_dwordx4 v1, s[12:15], s31 offen lds
  s_mov_b32 s31, 0x190000
  s_add_u32 m0, s44, 133120
  s_nop 0
  buffer_load_dwordx4 v2, s[12:15], s31 offen lds
  s_mov_b32 s31, 0x198000
  s_add_u32 m0, s44, 134144
  s_nop 0
  buffer_load_dwordx4 v2, s[12:15], s31 offen lds
  ds_read_b64_tr_b16 v[32:33], v3 offset:0
  ds_read_b64_tr_b16 v[34:35], v3 offset:1024
  ds_read_b64_tr_b16 v[36:37], v3 offset:8192
  ds_read_b64_tr_b16 v[38:39], v3 offset:9216
  ds_read_b64_tr_b16 v[40:41], v4 offset:0
  ds_read_b64_tr_b16 v[42:43], v4 offset:1024
  ds_read_b64_tr_b16 v[44:45], v4 offset:8192
  ds_read_b64_tr_b16 v[46:47], v4 offset:9216
  s_waitcnt lgkmcnt(0)
  s_waitcnt vmcnt(20)
  s_barrier
  s_mov_b32 s31, 0x180000
  s_add_u32 m0, s44, 0
  s_nop 0
  buffer_load_dwordx4 v1, s[16:19], s31 offen lds
  s_mov_b32 s31, 0x188000
  s_add_u32 m0, s44, 1024
  s_nop 0
  buffer_load_dwordx4 v1, s[16:19], s31 offen lds
  s_mov_b32 s31, 0x190000
  s_add_u32 m0, s44, 2048
  s_nop 0
  buffer_load_dwordx4 v2, s[16:19], s31 offen lds
  s_mov_b32 s31, 0x198000
  s_add_u32 m0, s44, 3072
  s_nop 0
  buffer_load_dwordx4 v2, s[16:19], s31 offen lds
  ds_read_b64_tr_b16 v[48:49], v3 offset:16384
  ds_read_b64_tr_b16 v[50:51], v3 offset:17408
  ds_read_b64_tr_b16 v[52:53], v3 offset:24576
  ds_read_b64_tr_b16 v[54:55], v3 offset:25600
  ds_read_b64_tr_b16 v[56:57], v4 offset:16384
  ds_read_b64_tr_b16 v[58:59], v4 offset:17408
  ds_read_b64_tr_b16 v[60:61], v4 offset:24576
  ds_read_b64_tr_b16 v[62:63], v4 offset:25600
  s_waitcnt lgkmcnt(0)
  s_waitcnt vmcnt(20)
  s_barrier
  s_mov_b32 s31, 0x200000
  s_add_u32 m0, s44, 16384
  s_nop 0
  buffer_load_dwordx4 v1, s[12:15], s31 offen lds
  s_mov_b32 s31, 0x208000
  s_add_u32 m0, s44, 17408
  s_nop 0
  buffer_load_dwordx4 v1, s[12:15], s31 offen lds
  s_mov_b32 s31, 0x210000
  s_add_u32 m0, s44, 18432
  s_nop 0
  buffer_load_dwordx4 v2, s[12:15], s31 offen lds
  s_mov_b32 s31, 0x218000
  s_add_u32 m0, s44, 19456
  s_nop 0
  buffer_load_dwordx4 v2, s[12:15], s31 offen lds
  ds_read_b64_tr_b16 v[64:65], v3 offset:32768
  ds_read_b64_tr_b16 v[66:67], v3 offset:33792
  ds_read_b64_tr_b16 v[68:69], v3 offset:40960
  ds_read_b64_tr_b16 v[70:71], v3 offset:41984
  ds_read_b64_tr_b16 v[72:73], v4 offset:32768
  ds_read_b64_tr_b16 v[74:75], v4 offset:33792
  ds_read_b64_tr_b16 v[76:77], v4 offset:40960
  ds_read_b64_tr_b16 v[78:79], v4 offset:41984
  s_waitcnt lgkmcnt(0)
  s_waitcnt vmcnt(20)
  s_barrier
  s_mov_b32 s31, 0x200000
  s_add_u32 m0, s44, 32768
  s_nop 0
  buffer_load_dwordx4 v1, s[16:19], s31 offen lds
  s_mov_b32 s31, 0x208000
  s_add_u32 m0, s44, 33792
  s_nop 0
  buffer_load_dwordx4 v1, s[16:19], s31 offen lds
  s_mov_b32 s31, 0x210000
  s_add_u32 m0, s44, 34816
  s_nop 0
  buffer_load_dwordx4 v2, s[16:19], s31 offen lds
  s_mov_b32 s31, 0x218000
  s_add_u32 m0, s44, 35840
  s_nop 0
  buffer_load_dwordx4 v2, s[16:19], s31 offen lds
  ds_read_b64_tr_b16 v[80:81], v3 offset:49152
  ds_read_b64_tr_b16 v[82:83], v3 offset:50176
  ds_read_b64_tr_b16 v[84:85], v3 offset:57344
  ds_read_b64_tr_b16 v[86:87], v3 offset:58368
  ds_read_b64_tr_b16 v[88:89], v4 offset:49152
  ds_read_b64_tr_b16 v[90:91], v4 offset:50176
  ds_read_b64_tr_b16 v[92:93], v4 offset:57344
  ds_read_b64_tr_b16 v[94:95], v4 offset:58368
  s_waitcnt lgkmcnt(0)
  s_waitcnt vmcnt(20)
  s_barrier
  s_mov_b32 s31, 0x280000
  s_add_u32 m0, s44, 49152
  s_nop 0
  buffer_load_dwordx4 v1, s[12:15], s31 offen lds
  s_mov_b32 s31, 0x288000
  s_add_u32 m0, s44, 50176
  s_nop 0
  buffer_load_dwordx4 v1, s[12:15], s31 offen lds
  s_mov_b32 s31, 0x290000
  s_add_u32 m0, s44, 51200
  s_nop 0
  buffer_load_dwordx4 v2, s[12:15], s31 offen lds
  s_mov_b32 s31, 0x298000
  s_add_u32 m0, s44, 52224
  s_nop 0
  buffer_load_dwordx4 v2, s[12:15], s31 offen lds
  ds_read_b64_tr_b16 v[112:113], v5 offset:0
  ds_read_b64_tr_b16 v[114:115], v5 offset:1024
  ds_read_b64_tr_b16 v[116:117], v5 offset:8192
  ds_read_b64_tr_b16 v[118:119], v5 offset:9216
  ds_read_b64_tr_b16 v[120:121], v6 offset:0
  ds_read_b64_tr_b16 v[122:123], v6 offset:1024
  ds_read_b64_tr_b16 v[124:125], v6 offset:8192
  ds_read_b64_tr_b16 v[126:127], v6 offset:9216
  s_waitcnt lgkmcnt(0)
  s_waitcnt vmcnt(20)
  s_barrier
  s_mov_b32 s31, 0x280000
  s_add_u32 m0, s44, 65536
  s_nop 0
  buffer_load_dwordx4 v1, s[16:19], s31 offen lds
  s_mov_b32 s31, 0x288000
  s_add_u32 m0, s44, 66560
  s_nop 0
  buffer_load_dwordx4 v1, s[16:19], s31 offen lds
  s_mov_b32 s31, 0x290000
  s_add_u32 m0, s44, 67584
  s_nop 0
  buffer_load_dwordx4 v2, s[16:19], s31 offen lds
  s_mov_b32 s31, 0x298000
  s_add_u32 m0, s44, 68608
  s_nop 0
  buffer_load_dwordx4 v2, s[16:19], s31 offen lds
  ds_read_b64_tr_b16 v[128:129], v5 offset:49152
  ds_read_b64_tr_b16 v[130:131], v5 offset:50176
  ds_read_b64_tr_b16 v[132:133], v5 offset:57344
  ds_read_b64_tr_b16 v[134:135], v5 offset:58368
  ds_read_b64_tr_b16 v[136:137], v6 offset:49152
  ds_read_b64_tr_b16 v[138:139], v6 offset:50176
  ds_read_b64_tr_b16 v[140:141], v6 offset:57344
  ds_read_b64_tr_b16 v[142:143], v6 offset:58368
  s_waitcnt lgkmcnt(0)
  s_waitcnt vmcnt(20)
  s_barrier
  s_mov_b32 s31, 0x300000
  s_add_u32 m0, s44, 114688
  s_nop 0
  buffer_load_dwordx4 v1, s[12:15], s31 offen lds
  s_mov_b32 s31, 0x308000
  s_add_u32 m0, s44, 115712
  s_nop 0
  buffer_load_dwordx4 v1, s[12:15], s31 offen lds
  s_mov_b32 s31, 0x310000
  s_add_u32 m0, s44, 116736
  s_nop 0
  buffer_load_dwordx4 v2, s[12:15], s31 offen lds
  s_mov_b32 s31, 0x318000
  s_add_u32 m0, s44, 117760
  s_nop 0
  buffer_load_dwordx4 v2, s[12:15], s31 offen lds
  ds_read_b64_tr_b16 v[144:145], v16 offset:0
  ds_read_b64_tr_b16 v[146:147], v16 offset:1024
  ds_read_b64_tr_b16 v[148:149], v16 offset:8192
  ds_read_b64_tr_b16 v[150:151], v16 offset:9216
  ds_read_b64_tr_b16 v[152:153], v17 offset:0
  ds_read_b64_tr_b16 v[154:155], v17 offset:1024
  ds_read_b64_tr_b16 v[156:157], v17 offset:8192
  ds_read_b64_tr_b16 v[158:159], v17 offset:9216
  s_waitcnt lgkmcnt(0)
  s_cmp_lg_u32 s36, 0
  s_cbranch_scc1 L_cf_2
  s_cmp_lg_u32 s24, 0
  s_cbranch_scc1 L_cf_3
  s_mov_b32 s37, s39
  s_lshr_b32 s38, s2, 3
  s_mov_b64 exec, 1
L_cf_4:
  v_readfirstlane_b32 s33, v22
  s_lshl_b32 s31, 1, s38
  s_and_b32 s34, s33, s31
  s_cbranch_scc0 L_cf_5
  s_not_b32 s33, s33
  s_cbranch_scc1 L_cf_7
  s_add_u32 s37, s37, 1
  s_and_b32 s37, s37, 7
  s_mov_b32 s31, 256
  s_cmp_eq_u32 s37, s39
  s_cbranch_scc1 L_cf_6
  s_lshl_b32 s33, 1, s38
L_cf_7:
  s_ff1_i32_b32 s38, s33
  s_lshl_b32 s31, 1, s38
  s_lshl_b32 s32, s37, 2
  v_mov_b32 v22, s31
  buffer_atomic_or v22, off, s[8:11], s32 sc0 sc1
  s_waitcnt vmcnt(0)
  s_branch L_cf_4
L_cf_5:
  s_or_b32 s33, s33, s31
  s_cmp_eq_u32 s33, -1
  s_cbranch_scc0 L_cf_8
  v_mov_b32 v22, 1
  buffer_atomic_add v22, off, s[8:11], 0 offset:128 sc0 sc1
  s_waitcnt vmcnt(0)
  v_readfirstlane_b32 s33, v22
  s_nop 0
  s_cmp_eq_u32 s33, 7
  s_cbranch_scc0 L_cf_8
  buffer_load_dwordx2 v[22:23], off, s[8:11], 0 offset:136 sc1
  s_waitcnt vmcnt(0)
  v_readfirstlane_b32 s33, v22
  v_readfirstlane_b32 s34, v23
  s_mov_b64 exec, 0xff
  s_mov_b32 s32, 0x408000
  v_lshlrev_b32 v23, 7, v0
  buffer_load_dword v22, v23, s[4:7], s32 offen sc1
  s_cmp_gt_u32 s34, s33
  s_cselect_b32 s33, 1, 0
  s_waitcnt vmcnt(0)
  v_add_u32 v22, 2, v22
  v_and_b32 v22, -2, v22
  v_or_b32 v22, s33, v22
  buffer_store_dword v22, v23, s[4:7], s32 offen sc1
  s_mov_b64 exec, 1
L_cf_8:
  s_lshl_b32 s31, s37, 5
  s_add_u32 s31, s31, s38
L_cf_6:
  v_mov_b32 v22, s31
  v_mov_b32 v23, 163836
  ds_write_b32 v23, v22
  s_waitcnt lgkmcnt(0)
  s_mov_b64 exec, -1
L_cf_3:
  s_barrier
  v_mov_b32 v23, 163836
  ds_read_b32 v22, v23
  s_mov_b32 s36, 1
  s_waitcnt lgkmcnt(0)
  v_readfirstlane_b32 s31, v22
  s_nop 0
  s_cmp_ge_u32 s31, 256
  s_cbranch_scc1 L_exit
  s_cmp_eq_u32 s31, s35
  s_cbranch_scc1 L_cf_2
  s_mov_b32 s35, s31
  s_waitcnt vmcnt(0)
  s_barrier
  s_branch L_dispatch
L_cf_2:
  s_waitcnt vmcnt(20)
  s_barrier
  s_mov_b32 s31, 0x300000
  s_add_u32 m0, s44, 131072
  s_nop 0
  buffer_load_dwordx4 v1, s[16:19], s31 offen lds
  s_mov_b32 s31, 0x308000
  s_add_u32 m0, s44, 132096
  s_nop 0
  buffer_load_dwordx4 v1, s[16:19], s31 offen lds
  s_mov_b32 s31, 0x310000
  s_add_u32 m0, s44, 133120
  s_nop 0
  buffer_load_dwordx4 v2, s[16:19], s31 offen lds
  s_mov_b32 s31, 0x318000
  s_add_u32 m0, s44, 134144
  s_nop 0
  buffer_load_dwordx4 v2, s[16:19], s31 offen lds
  ds_read_b64_tr_b16 v[160:161], v3 offset:0
  ds_read_b64_tr_b16 v[162:163], v3 offset:1024
  ds_read_b64_tr_b16 v[164:165], v3 offset:8192
  ds_read_b64_tr_b16 v[166:167], v3 offset:9216
  ds_read_b64_tr_b16 v[168:169], v4 offset:0
  ds_read_b64_tr_b16 v[170:171], v4 offset:1024
  ds_read_b64_tr_b16 v[172:173], v4 offset:8192
  ds_read_b64_tr_b16 v[174:175], v4 offset:9216
  s_waitcnt lgkmcnt(0)
  s_waitcnt vmcnt(20)
  s_barrier
  s_mov_b32 s31, 0x380000
  s_add_u32 m0, s44, 0
  s_nop 0
  buffer_load_dwordx4 v1, s[12:15], s31 offen lds
  s_mov_b32 s31, 0x388000
  s_add_u32 m0, s44, 1024
  s_nop 0
  buffer_load_dwordx4 v1, s[12:15], s31 offen lds
  s_mov_b32 s31, 0x390000
  s_add_u32 m0, s44, 2048
  s_nop 0
  buffer_load_dwordx4 v2, s[12:15], s31 offen lds
  s_mov_b32 s31, 0x398000
  s_add_u32 m0, s44, 3072
  s_nop 0
  buffer_load_dwordx4 v2, s[12:15], s31 offen lds
  ds_read_b64_tr_b16 v[176:177], v3 offset:16384
  ds_read_b64_tr_b16 v[178:179], v3 offset:17408
  ds_read_b64_tr_b16 v[180:181], v3 offset:24576
  ds_read_b64_tr_b16 v[182:183], v3 offset:25600
  ds_read_b64_tr_b16 v[184:185], v4 offset:16384
  ds_read_b64_tr_b16 v[186:187], v4 offset:17408
  ds_read_b64_tr_b16 v[188:189], v4 offset:24576
  ds_read_b64_tr_b16 v[190:191], v4 offset:25600
  s_waitcnt lgkmcnt(0)
  s_waitcnt vmcnt(20)
  s_barrier
  s_mov_b32 s31, 0x380000
  s_add_u32 m0, s44, 16384
  s_nop 0
  buffer_load_dwordx4 v1, s[16:19], s31 offen lds
  s_mov_b32 s31, 0x388000
  s_add_u32 m0, s44, 17408
  s_nop 0
  buffer_load_dwordx4 v1, s[16:19], s31 offen lds
  s_mov_b32 s31, 0x390000
  s_add_u32 m0, s44, 18432
  s_nop 0
  buffer_load_dwordx4 v2, s[16:19], s31 offen lds
  s_mov_b32 s31, 0x398000
  s_add_u32 m0, s44, 19456
  s_nop 0
  buffer_load_dwordx4 v2, s[16:19], s31 offen lds
  ds_read_b64_tr_b16 v[192:193], v3 offset:32768
  ds_read_b64_tr_b16 v[194:195], v3 offset:33792
  ds_read_b64_tr_b16 v[196:197], v3 offset:40960
  ds_read_b64_tr_b16 v[198:199], v3 offset:41984
  ds_read_b64_tr_b16 v[200:201], v4 offset:32768
  ds_read_b64_tr_b16 v[202:203], v4 offset:33792
  ds_read_b64_tr_b16 v[204:205], v4 offset:40960
  ds_read_b64_tr_b16 v[206:207], v4 offset:41984
  s_waitcnt lgkmcnt(0)
  s_waitcnt vmcnt(20)
  s_barrier
  s_mov_b32 s31, 0x400000
  s_add_u32 m0, s44, 32768
  s_nop 0
  buffer_load_dwordx4 v1, s[12:15], s31 offen lds
  s_mov_b32 s31, 0x408000
  s_add_u32 m0, s44, 33792
  s_nop 0
  buffer_load_dwordx4 v1, s[12:15], s31 offen lds
  s_mov_b32 s31, 0x410000
  s_add_u32 m0, s44, 34816
  s_nop 0
  buffer_load_dwordx4 v2, s[12:15], s31 offen lds
  s_mov_b32 s31, 0x418000
  s_add_u32 m0, s44, 35840
  s_nop 0
  buffer_load_dwordx4 v2, s[12:15], s31 offen lds
  ds_read_b64_tr_b16 v[208:209], v3 offset:49152
  ds_read_b64_tr_b16 v[210:211], v3 offset:50176
  ds_read_b64_tr_b16 v[212:213], v3 offset:57344
  ds_read_b64_tr_b16 v[214:215], v3 offset:58368
  ds_read_b64_tr_b16 v[216:217], v4 offset:49152
  ds_read_b64_tr_b16 v[218:219], v4 offset:50176
  ds_read_b64_tr_b16 v[220:221], v4 offset:57344
  ds_read_b64_tr_b16 v[222:223], v4 offset:58368
  s_waitcnt lgkmcnt(0)
  s_waitcnt vmcnt(20)
  s_barrier
  s_mov_b32 s31, 0x400000
  s_add_u32 m0, s44, 49152
  s_nop 0
  buffer_load_dwordx4 v1, s[16:19], s31 offen lds
  s_mov_b32 s31, 0x408000
  s_add_u32 m0, s44, 50176
  s_nop 0
  buffer_load_dwordx4 v1, s[16:19], s31 offen lds
  s_mov_b32 s31, 0x410000
  s_add_u32 m0, s44, 51200
  s_nop 0
  buffer_load_dwordx4 v2, s[16:19], s31 offen lds
  s_mov_b32 s31, 0x418000
  s_add_u32 m0, s44, 52224
  s_nop 0
  buffer_load_dwordx4 v2, s[16:19], s31 offen lds
  ds_read_b64_tr_b16 v[224:225], v5 offset:0
  ds_read_b64_tr_b16 v[226:227], v5 offset:1024
  ds_read_b64_tr_b16 v[228:229], v5 offset:8192
  ds_read_b64_tr_b16 v[230:231], v5 offset:9216
  ds_read_b64_tr_b16 v[232:233], v6 offset:0
  ds_read_b64_tr_b16 v[234:235], v6 offset:1024
  ds_read_b64_tr_b16 v[236:237], v6 offset:8192
  ds_read_b64_tr_b16 v[238:239], v6 offset:9216
  s_waitcnt lgkmcnt(0)
  s_waitcnt vmcnt(20)
  s_barrier
  s_mov_b32 s31, 0x480000
  s_add_u32 m0, s44, 65536
  s_nop 0
  buffer_load_dwordx4 v1, s[12:15], s31 offen lds
  s_mov_b32 s31, 0x488000
  s_add_u32 m0, s44, 66560
  s_nop 0
  buffer_load_dwordx4 v1, s[12:15], s31 offen lds
  s_mov_b32 s31, 0x490000
  s_add_u32 m0, s44, 67584
  s_nop 0
  buffer_load_dwordx4 v2, s[12:15], s31 offen lds
  s_mov_b32 s31, 0x498000
  s_add_u32 m0, s44, 68608
  s_nop 0
  buffer_load_dwordx4 v2, s[12:15], s31 offen lds
  ds_read_b64_tr_b16 v[240:241], v5 offset:49152
  ds_read_b64_tr_b16 v[242:243], v5 offset:50176
  ds_read_b64_tr_b16 v[244:245], v5 offset:57344
  ds_read_b64_tr_b16 v[246:247], v5 offset:58368
  ds_read_b64_tr_b16 v[248:249], v6 offset:49152
  ds_read_b64_tr_b16 v[250:251], v6 offset:50176
  ds_read_b64_tr_b16 v[252:253], v6 offset:57344
  ds_read_b64_tr_b16 v[254:255], v6 offset:58368
  s_waitcnt lgkmcnt(0)
  s_waitcnt vmcnt(20)
  s_barrier
  s_mov_b32 s31, 0x480000
  s_add_u32 m0, s44, 114688
  s_nop 0
  buffer_load_dwordx4 v1, s[16:19], s31 offen lds
  s_mov_b32 s31, 0x488000
  s_add_u32 m0, s44, 115712
  s_nop 0
  buffer_load_dwordx4 v1, s[16:19], s31 offen lds
  s_mov_b32 s31, 0x490000
  s_add_u32 m0, s44, 116736
  s_nop 0
  buffer_load_dwordx4 v2, s[16:19], s31 offen lds
  s_mov_b32 s31, 0x498000
  s_add_u32 m0, s44, 117760
  s_nop 0
  buffer_load_dwordx4 v2, s[16:19], s31 offen lds
  ds_read_b64_tr_b16 a[0:1], v16 offset:0
  ds_read_b64_tr_b16 a[2:3], v16 offset:1024
  ds_read_b64_tr_b16 a[4:5], v16 offset:8192
  ds_read_b64_tr_b16 a[6:7], v16 offset:9216
  ds_read_b64_tr_b16 a[8:9], v17 offset:0
  ds_read_b64_tr_b16 a[10:11], v17 offset:1024
  ds_read_b64_tr_b16 a[12:13], v17 offset:8192
  ds_read_b64_tr_b16 a[14:15], v17 offset:9216
  s_waitcnt lgkmcnt(0)
  s_waitcnt vmcnt(20)
  s_barrier
  s_mov_b32 s31, 0x500000
  s_add_u32 m0, s44, 131072
  s_nop 0
  buffer_load_dwordx4 v1, s[12:15], s31 offen lds
  s_mov_b32 s31, 0x508000
  s_add_u32 m0, s44, 132096
  s_nop 0
  buffer_load_dwordx4 v1, s[12:15], s31 offen lds
  s_mov_b32 s31, 0x510000
  s_add_u32 m0, s44, 133120
  s_nop 0
  buffer_load_dwordx4 v2, s[12:15], s31 offen lds
  s_mov_b32 s31, 0x518000
  s_add_u32 m0, s44, 134144
  s_nop 0
  buffer_load_dwordx4 v2, s[12:15], s31 offen lds
  ds_read_b64_tr_b16 a[16:17], v3 offset:0
  ds_read_b64_tr_b16 a[18:19], v3 offset:1024
  ds_read_b64_tr_b16 a[20:21], v3 offset:8192
  ds_read_b64_tr_b16 a[22:23], v3 offset:9216
  ds_read_b64_tr_b16 a[24:25], v4 offset:0
  ds_read_b64_tr_b16 a[26:27], v4 offset:1024
  ds_read_b64_tr_b16 a[28:29], v4 offset:8192
  ds_read_b64_tr_b16 a[30:31], v4 offset:9216
  s_waitcnt lgkmcnt(0)
  s_waitcnt vmcnt(20)
  s_barrier
  s_mov_b32 s31, 0x500000
  s_add_u32 m0, s44, 0
  s_nop 0
  buffer_load_dwordx4 v1, s[16:19], s31 offen lds
  s_mov_b32 s31, 0x508000
  s_add_u32 m0, s44, 1024
  s_nop 0
  buffer_load_dwordx4 v1, s[16:19], s31 offen lds
  s_mov_b32 s31, 0x510000
  s_add_u32 m0, s44, 2048
  s_nop 0
  buffer_load_dwordx4 v2, s[16:19], s31 offen lds
  s_mov_b32 s31, 0x518000
  s_add_u32 m0, s44, 3072
  s_nop 0
  buffer_load_dwordx4 v2, s[16:19], s31 offen lds
  ds_read_b64_tr_b16 v[8:9], v3 offset:16384
  ds_read_b64_tr_b16 v[10:11], v3 offset:17408
  ds_read_b64_tr_b16 v[12:13], v3 offset:24576
  ds_read_b64_tr_b16 v[14:15], v3 offset:25600
  ds_read_b64_tr_b16 v[24:25], v4 offset:16384
  ds_read_b64_tr_b16 v[26:27], v4 offset:17408
  ds_read_b64_tr_b16 v[28:29], v4 offset:24576
  ds_read_b64_tr_b16 v[30:31], v4 offset:25600
  s_waitcnt lgkmcnt(0)
  ds_write_b128 v7, v[8:11] offset:32768
  ds_write_b128 v7, v[12:15] offset:33792
  ds_write_b128 v7, v[24:27] offset:34816
  ds_write_b128 v7, v[28:31] offset:35840
  s_waitcnt lgkmcnt(0)
  s_waitcnt vmcnt(20)
  s_barrier
  s_mov_b32 s31, 0x580000
  s_add_u32 m0, s44, 16384
  s_nop 0
  buffer_load_dwordx4 v1, s[12:15], s31 offen lds
  s_mov_b32 s31, 0x588000
  s_add_u32 m0, s44, 17408
  s_nop 0
  buffer_load_dwordx4 v1, s[12:15], s31 offen lds
  s_mov_b32 s31, 0x590000
  s_add_u32 m0, s44, 18432
  s_nop 0
  buffer_load_dwordx4 v2, s[12:15], s31 offen lds
  s_mov_b32 s31, 0x598000
  s_add_u32 m0, s44, 19456
  s_nop 0
  buffer_load_dwordx4 v2, s[12:15], s31 offen lds
  ds_read_b64_tr_b16 a[32:33], v3 offset:32768
  ds_read_b64_tr_b16 a[34:35], v3 offset:33792
  ds_read_b64_tr_b16 a[36:37], v3 offset:40960
  ds_read_b64_tr_b16 a[38:39], v3 offset:41984
  ds_read_b64_tr_b16 a[40:41], v4 offset:32768
  ds_read_b64_tr_b16 a[42:43], v4 offset:33792
  ds_read_b64_tr_b16 a[44:45], v4 offset:40960
  ds_read_b64_tr_b16 a[46:47], v4 offset:41984
  s_waitcnt lgkmcnt(0)
  s_waitcnt vmcnt(20)
  s_barrier
  s_mov_b32 s31, 0x580000
  s_add_u32 m0, s44, 32768
  s_nop 0
  buffer_load_dwordx4 v1, s[16:19], s31 offen lds
  s_mov_b32 s31, 0x588000
  s_add_u32 m0, s44, 33792
  s_nop 0
  buffer_load_dwordx4 v1, s[16:19], s31 offen lds
  s_mov_b32 s31, 0x590000
  s_add_u32 m0, s44, 34816
  s_nop 0
  buffer_load_dwordx4 v2, s[16:19], s31 offen lds
  s_mov_b32 s31, 0x598000
  s_add_u32 m0, s44, 35840
  s_nop 0
  buffer_load_dwordx4 v2, s[16:19], s31 offen lds
  ds_read_b64_tr_b16 a[48:49], v3 offset:49152
  ds_read_b64_tr_b16 a[50:51], v3 offset:50176
  ds_read_b64_tr_b16 a[52:53], v3 offset:57344
  ds_read_b64_tr_b16 a[54:55], v3 offset:58368
  ds_read_b64_tr_b16 a[56:57], v4 offset:49152
  ds_read_b64_tr_b16 a[58:59], v4 offset:50176
  ds_read_b64_tr_b16 a[60:61], v4 offset:57344
  ds_read_b64_tr_b16 a[62:63], v4 offset:58368
  s_waitcnt lgkmcnt(0)
  s_waitcnt vmcnt(20)
  s_barrier
  s_mov_b32 s31, 0x600000
  s_add_u32 m0, s44, 49152
  s_nop 0
  buffer_load_dwordx4 v1, s[12:15], s31 offen lds
  s_mov_b32 s31, 0x608000
  s_add_u32 m0, s44, 50176
  s_nop 0
  buffer_load_dwordx4 v1, s[12:15], s31 offen lds
  s_mov_b32 s31, 0x610000
  s_add_u32 m0, s44, 51200
  s_nop 0
  buffer_load_dwordx4 v2, s[12:15], s31 offen lds
  s_mov_b32 s31, 0x618000
  s_add_u32 m0, s44, 52224
  s_nop 0
  buffer_load_dwordx4 v2, s[12:15], s31 offen lds
  ds_read_b64_tr_b16 a[64:65], v5 offset:0
  ds_read_b64_tr_b16 a[66:67], v5 offset:1024
  ds_read_b64_tr_b16 a[68:69], v5 offset:8192
  ds_read_b64_tr_b16 a[70:71], v5 offset:9216
  ds_read_b64_tr_b16 a[72:73], v6 offset:0
  ds_read_b64_tr_b16 a[74:75], v6 offset:1024
  ds_read_b64_tr_b16 a[76:77], v6 offset:8192
  ds_read_b64_tr_b16 a[78:79], v6 offset:9216
  s_waitcnt lgkmcnt(0)
  s_waitcnt vmcnt(20)
  s_barrier
  s_mov_b32 s31, 0x600000
  s_add_u32 m0, s44, 65536
  s_nop 0
  buffer_load_dwordx4 v1, s[16:19], s31 offen lds
  s_mov_b32 s31, 0x608000
  s_add_u32 m0, s44, 66560
  s_nop 0
  buffer_load_dwordx4 v1, s[16:19], s31 offen lds
  s_mov_b32 s31, 0x610000
  s_add_u32 m0, s44, 67584
  s_nop 0
  buffer_load_dwordx4 v2, s[16:19], s31 offen lds
  s_mov_b32 s31, 0x618000
  s_add_u32 m0, s44, 68608
  s_nop 0
  buffer_load_dwordx4 v2, s[16:19], s31 offen lds
  ds_read_b64_tr_b16 a[80:81], v5 offset:49152
  ds_read_b64_tr_b16 a[82:83], v5 offset:50176
  ds_read_b64_tr_b16 a[84:85], v5 offset:57344
  ds_read_b64_tr_b16 a[86:87], v5 offset:58368
  ds_read_b64_tr_b16 a[88:89], v6 offset:49152
  ds_read_b64_tr_b16 a[90:91], v6 offset:50176
  ds_read_b64_tr_b16 a[92:93], v6 offset:57344
  ds_read_b64_tr_b16 a[94:95], v6 offset:58368
  s_waitcnt lgkmcnt(0)
  s_waitcnt vmcnt(20)
  s_barrier
  s_mov_b32 s31, 0x680000
  s_add_u32 m0, s44, 114688
  s_nop 0
  buffer_load_dwordx4 v1, s[12:15], s31 offen lds
  s_mov_b32 s31, 0x688000
  s_add_u32 m0, s44, 115712
  s_nop 0
  buffer_load_dwordx4 v1, s[12:15], s31 offen lds
  s_mov_b32 s31, 0x690000
  s_add_u32 m0, s44, 116736
  s_nop 0
  buffer_load_dwordx4 v2, s[12:15], s31 offen lds
  s_mov_b32 s31, 0x698000
  s_add_u32 m0, s44, 117760
  s_nop 0
  buffer_load_dwordx4 v2, s[12:15], s31 offen lds
  ds_read_b64_tr_b16 a[96:97], v16 offset:0
  ds_read_b64_tr_b16 a[98:99], v16 offset:1024
  ds_read_b64_tr_b16 a[100:101], v16 offset:8192
  ds_read_b64_tr_b16 a[102:103], v16 offset:9216
  ds_read_b64_tr_b16 a[104:105], v17 offset:0
  ds_read_b64_tr_b16 a[106:107], v17 offset:1024
  ds_read_b64_tr_b16 a[108:109], v17 offset:8192
  ds_read_b64_tr_b16 a[110:111], v17 offset:9216
  s_waitcnt lgkmcnt(0)
  s_waitcnt vmcnt(20)
  s_barrier
  s_mov_b32 s31, 0x680000
  s_add_u32 m0, s44, 131072
  s_nop 0
  buffer_load_dwordx4 v1, s[16:19], s31 offen lds
  s_mov_b32 s31, 0x688000
  s_add_u32 m0, s44, 132096
  s_nop 0
  buffer_load_dwordx4 v1, s[16:19], s31 offen lds
  s_mov_b32 s31, 0x690000
  s_add_u32 m0, s44, 133120
  s_nop 0
  buffer_load_dwordx4 v2, s[16:19], s31 offen lds
  s_mov_b32 s31, 0x698000
  s_add_u32 m0, s44, 134144
  s_nop 0
  buffer_load_dwordx4 v2, s[16:19], s31 offen lds
  ds_read_b64_tr_b16 a[112:113], v3 offset:0
  ds_read_b64_tr_b16 a[114:115], v3 offset:1024
  ds_read_b64_tr_b16 a[116:117], v3 offset:8192
  ds_read_b64_tr_b16 a[118:119], v3 offset:9216
  ds_read_b64_tr_b16 a[120:121], v4 offset:0
  ds_read_b64_tr_b16 a[122:123], v4 offset:1024
  ds_read_b64_tr_b16 a[124:125], v4 offset:8192
  ds_read_b64_tr_b16 a[126:127], v4 offset:9216
  s_waitcnt lgkmcnt(0)
  s_waitcnt vmcnt(20)
  s_barrier
  s_mov_b32 s31, 0x700000
  s_add_u32 m0, s44, 0
  s_nop 0
  buffer_load_dwordx4 v1, s[12:15], s31 offen lds
  s_mov_b32 s31, 0x708000
  s_add_u32 m0, s44, 1024
  s_nop 0
  buffer_load_dwordx4 v1, s[12:15], s31 offen lds
  s_mov_b32 s31, 0x710000
  s_add_u32 m0, s44, 2048
  s_nop 0
  buffer_load_dwordx4 v2, s[12:15], s31 offen lds
  s_mov_b32 s31, 0x718000
  s_add_u32 m0, s44, 3072
  s_nop 0
  buffer_load_dwordx4 v2, s[12:15], s31 offen lds
  ds_read_b64_tr_b16 a[128:129], v3 offset:16384
  ds_read_b64_tr_b16 a[130:131], v3 offset:17408
  ds_read_b64_tr_b16 a[132:133], v3 offset:24576
  ds_read_b64_tr_b16 a[134:135], v3 offset:25600
  ds_read_b64_tr_b16 a[136:137], v4 offset:16384
  ds_read_b64_tr_b16 a[138:139], v4 offset:17408
  ds_read_b64_tr_b16 a[140:141], v4 offset:24576
  ds_read_b64_tr_b16 a[142:143], v4 offset:25600
  s_waitcnt lgkmcnt(0)
  s_waitcnt vmcnt(20)
  s_barrier
  s_mov_b32 s31, 0x700000
  s_add_u32 m0, s44, 16384
  s_nop 0
  buffer_load_dwordx4 v1, s[16:19], s31 offen lds
  s_mov_b32 s31, 0x708000
  s_add_u32 m0, s44, 17408
  s_nop 0
  buffer_load_dwordx4 v1, s[16:19], s31 offen lds
  s_mov_b32 s31, 0x710000
  s_add_u32 m0, s44, 18432
  s_nop 0
  buffer_load_dwordx4 v2, s[16:19], s31 offen lds
  s_mov_b32 s31, 0x718000
  s_add_u32 m0, s44, 19456
  s_nop 0
  buffer_load_dwordx4 v2, s[16:19], s31 offen lds
  ds_read_b64_tr_b16 a[144:145], v3 offset:32768
  ds_read_b64_tr_b16 a[146:147], v3 offset:33792
  ds_read_b64_tr_b16 a[148:149], v3 offset:40960
  ds_read_b64_tr_b16 a[150:151], v3 offset:41984
  ds_read_b64_tr_b16 a[152:153], v4 offset:32768
  ds_read_b64_tr_b16 a[154:155], v4 offset:33792
  ds_read_b64_tr_b16 a[156:157], v4 offset:40960
  ds_read_b64_tr_b16 a[158:159], v4 offset:41984
  s_waitcnt lgkmcnt(0)
  s_waitcnt vmcnt(20)
  s_barrier
  s_mov_b32 s31, 0x780000
  s_add_u32 m0, s44, 32768
  s_nop 0
  buffer_load_dwordx4 v1, s[12:15], s31 offen lds
  s_mov_b32 s31, 0x788000
  s_add_u32 m0, s44, 33792
  s_nop 0
  buffer_load_dwordx4 v1, s[12:15], s31 offen lds
  s_mov_b32 s31, 0x790000
  s_add_u32 m0, s44, 34816
  s_nop 0
  buffer_load_dwordx4 v2, s[12:15], s31 offen lds
  s_mov_b32 s31, 0x798000
  s_add_u32 m0, s44, 35840
  s_nop 0
  buffer_load_dwordx4 v2, s[12:15], s31 offen lds
  ds_read_b64_tr_b16 v[96:97], v3 offset:49152
  ds_read_b64_tr_b16 v[98:99], v3 offset:50176
  ds_read_b64_tr_b16 v[100:101], v3 offset:57344
  ds_read_b64_tr_b16 v[102:103], v3 offset:58368
  ds_read_b64_tr_b16 v[104:105], v4 offset:49152
  ds_read_b64_tr_b16 v[106:107], v4 offset:50176
  ds_read_b64_tr_b16 v[108:109], v4 offset:57344
  ds_read_b64_tr_b16 v[110:111], v4 offset:58368
  s_waitcnt lgkmcnt(0)
  s_waitcnt vmcnt(20)
  s_barrier
  s_mov_b32 s31, 0x780000
  s_add_u32 m0, s44, 49152
  s_nop 0
  buffer_load_dwordx4 v1, s[16:19], s31 offen lds
  s_mov_b32 s31, 0x788000
  s_add_u32 m0, s44, 50176
  s_nop 0
  buffer_load_dwordx4 v1, s[16:19], s31 offen lds
  s_mov_b32 s31, 0x790000
  s_add_u32 m0, s44, 51200
  s_nop 0
  buffer_load_dwordx4 v2, s[16:19], s31 offen lds
  s_mov_b32 s31, 0x798000
  s_add_u32 m0, s44, 52224
  s_nop 0
  buffer_load_dwordx4 v2, s[16:19], s31 offen lds
  ds_read_b64_tr_b16 a[160:161], v5 offset:0
  ds_read_b64_tr_b16 a[162:163], v5 offset:1024
  ds_read_b64_tr_b16 a[164:165], v5 offset:8192
  ds_read_b64_tr_b16 a[166:167], v5 offset:9216
  ds_read_b64_tr_b16 a[168:169], v6 offset:0
  ds_read_b64_tr_b16 a[170:171], v6 offset:1024
  ds_read_b64_tr_b16 a[172:173], v6 offset:8192
  ds_read_b64_tr_b16 a[174:175], v6 offset:9216
  s_waitcnt lgkmcnt(0)
  s_waitcnt vmcnt(20)
  s_barrier
  ds_read_b64_tr_b16 a[176:177], v5 offset:49152
  ds_read_b64_tr_b16 a[178:179], v5 offset:50176
  ds_read_b64_tr_b16 a[180:181], v5 offset:57344
  ds_read_b64_tr_b16 a[182:183], v5 offset:58368
  ds_read_b64_tr_b16 a[184:185], v6 offset:49152
  ds_read_b64_tr_b16 a[186:187], v6 offset:50176
  ds_read_b64_tr_b16 a[188:189], v6 offset:57344
  ds_read_b64_tr_b16 a[190:191], v6 offset:58368
  s_waitcnt lgkmcnt(0)
  s_waitcnt vmcnt(16)
  s_barrier
  ds_read_b64_tr_b16 a[192:193], v16 offset:0
  ds_read_b64_tr_b16 a[194:195], v16 offset:1024
  ds_read_b64_tr_b16 a[196:197], v16 offset:8192
  ds_read_b64_tr_b16 a[198:199], v16 offset:9216
  ds_read_b64_tr_b16 a[200:201], v17 offset:0
  ds_read_b64_tr_b16 a[202:203], v17 offset:1024
  ds_read_b64_tr_b16 a[204:205], v17 offset:8192
  ds_read_b64_tr_b16 a[206:207], v17 offset:9216
  s_waitcnt lgkmcnt(0)
  s_waitcnt vmcnt(12)
  s_barrier
  ds_read_b64_tr_b16 v[8:9], v3 offset:0
  ds_read_b64_tr_b16 v[10:11], v3 offset:1024
  ds_read_b64_tr_b16 v[12:13], v3 offset:8192
  ds_read_b64_tr_b16 v[14:15], v3 offset:9216
  ds_read_b64_tr_b16 v[24:25], v4 offset:0
  ds_read_b64_tr_b16 v[26:27], v4 offset:1024
  ds_read_b64_tr_b16 v[28:29], v4 offset:8192
  ds_read_b64_tr_b16 v[30:31], v4 offset:9216
  s_waitcnt lgkmcnt(0)
  ds_write_b128 v7, v[8:11] offset:16384
  ds_write_b128 v7, v[12:15] offset:17408
  ds_write_b128 v7, v[24:27] offset:18432
  ds_write_b128 v7, v[28:31] offset:19456
  s_waitcnt lgkmcnt(0)
  s_waitcnt vmcnt(8)
  s_barrier
  ds_read_b64_tr_b16 a[208:209], v3 offset:16384
  ds_read_b64_tr_b16 a[210:211], v3 offset:17408
  ds_read_b64_tr_b16 a[212:213], v3 offset:24576
  ds_read_b64_tr_b16 a[214:215], v3 offset:25600
  ds_read_b64_tr_b16 a[216:217], v4 offset:16384
  ds_read_b64_tr_b16 a[218:219], v4 offset:17408
  ds_read_b64_tr_b16 a[220:221], v4 offset:24576
  ds_read_b64_tr_b16 a[222:223], v4 offset:25600
  s_waitcnt lgkmcnt(0)
  s_waitcnt vmcnt(4)
  s_barrier
  ds_read_b64_tr_b16 a[224:225], v3 offset:32768
  ds_read_b64_tr_b16 a[226:227], v3 offset:33792
  ds_read_b64_tr_b16 a[228:229], v3 offset:40960
  ds_read_b64_tr_b16 a[230:231], v3 offset:41984
  ds_read_b64_tr_b16 a[232:233], v4 offset:32768
  ds_read_b64_tr_b16 a[234:235], v4 offset:33792
  ds_read_b64_tr_b16 a[236:237], v4 offset:40960
  ds_read_b64_tr_b16 a[238:239], v4 offset:41984
  s_waitcnt lgkmcnt(0)
  s_waitcnt vmcnt(0)
  s_barrier
  ds_read_b64_tr_b16 a[240:241], v3 offset:49152
  ds_read_b64_tr_b16 a[242:243], v3 offset:50176
  ds_read_b64_tr_b16 a[244:245], v3 offset:57344
  ds_read_b64_tr_b16 a[246:247], v3 offset:58368
  ds_read_b64_tr_b16 a[248:249], v4 offset:49152
  ds_read_b64_tr_b16 a[250:251], v4 offset:50176
  ds_read_b64_tr_b16 a[252:253], v4 offset:57344
  ds_read_b64_tr_b16 a[254:255], v4 offset:58368
  s_waitcnt lgkmcnt(0)
  s_branch L_A_lddone
L_A_ld1:
  s_mov_b32 s31, 0x0
  s_add_u32 m0, s44, 0
  s_nop 0
  buffer_load_dwordx4 v1, s[12:15], s31 offen lds
  s_mov_b32 s31, 0x8000
  s_add_u32 m0, s44, 1024
  s_nop 0
  buffer_load_dwordx4 v1, s[12:15], s31 offen lds
  s_mov_b32 s31, 0x10000
  s_add_u32 m0, s44, 2048
  s_nop 0
  buffer_load_dwordx4 v2, s[12:15], s31 offen lds
  s_mov_b32 s31, 0x18000
  s_add_u32 m0, s44, 3072
  s_nop 0
  buffer_load_dwordx4 v2, s[12:15], s31 offen lds
  s_mov_b32 s31, 0x0
  s_add_u32 m0, s44, 16384
  s_nop 0
  buffer_load_dwordx4 v1, s[16:19], s31 offen lds
  s_mov_b32 s31, 0x8000
  s_add_u32 m0, s44, 17408
  s_nop 0
  buffer_load_dwordx4 v1, s[16:19], s31 offen lds
  s_mov_b32 s31, 0x10000
  s_add_u32 m0, s44, 18432
  s_nop 0
  buffer_load_dwordx4 v2, s[16:19], s31 offen lds
  s_mov_b32 s31, 0x18000
  s_add_u32 m0, s44, 19456
  s_nop 0
  buffer_load_dwordx4 v2, s[16:19], s31 offen lds
  s_mov_b32 s31, 0x80000
  s_add_u32 m0, s44, 32768
  s_nop 0
  buffer_load_dwordx4 v1, s[12:15], s31 offen lds
  s_mov_b32 s31, 0x88000
  s_add_u32 m0, s44, 33792
  s_nop 0
  buffer_load_dwordx4 v1, s[12:15], s31 offen lds
  s_mov_b32 s31, 0x90000
  s_add_u32 m0, s44, 34816
  s_nop 0
  buffer_load_dwordx4 v2, s[12:15], s31 offen lds
  s_mov_b32 s31, 0x98000
  s_add_u32 m0, s44, 35840
  s_nop 0
  buffer_load_dwordx4 v2, s[12:15], s31 offen lds
  s_mov_b32 s31, 0x80000
  s_add_u32 m0, s44, 49152
  s_nop 0
  buffer_load_dwordx4 v1, s[16:19], s31 offen lds
  s_mov_b32 s31, 0x88000
  s_add_u32 m0, s44, 50176
  s_nop 0
  buffer_load_dwordx4 v1, s[16:19], s31 offen lds
  s_mov_b32 s31, 0x90000
  s_add_u32 m0, s44, 51200
  s_nop 0
  buffer_load_dwordx4 v2, s[16:19], s31 offen lds
  s_mov_b32 s31, 0x98000
  s_add_u32 m0, s44, 52224
  s_nop 0
  buffer_load_dwordx4 v2, s[16:19], s31 offen lds
  s_mov_b32 s31, 0x100000
  s_add_u32 m0, s44, 65536
  s_nop 0
  buffer_load_dwordx4 v1, s[12:15], s31 offen lds
  s_mov_b32 s31, 0x108000
  s_add_u32 m0, s44, 66560
  s_nop 0
  buffer_load_dwordx4 v1, s[12:15], s31 offen lds
  s_mov_b32 s31, 0x110000
  s_add_u32 m0, s44, 67584
  s_nop 0
  buffer_load_dwordx4 v2, s[12:15], s31 offen lds
  s_mov_b32 s31, 0x118000
  s_add_u32 m0, s44, 68608
  s_nop 0
  buffer_load_dwordx4 v2, s[12:15], s31 offen lds
  s_mov_b32 s31, 0x100000
  s_add_u32 m0, s44, 114688
  s_nop 0
  buffer_load_dwordx4 v1, s[16:19], s31 offen lds
  s_mov_b32 s31, 0x108000
  s_add_u32 m0, s44, 115712
  s_nop 0
  buffer_load_dwordx4 v1, s[16:19], s31 offen lds
  s_mov_b32 s31, 0x110000
  s_add_u32 m0, s44, 116736
  s_nop 0
  buffer_load_dwordx4 v2, s[16:19], s31 offen lds
  s_mov_b32 s31, 0x118000
  s_add_u32 m0, s44, 117760
  s_nop 0
  buffer_load_dwordx4 v2, s[16:19], s31 offen lds
  s_cmp_lg_u32 s36, 0
  s_cbranch_scc1 L_ci_9
  s_waitcnt vmcnt(24)
  v_readfirstlane_b32 s62, v30
  s_barrier
  s_cmp_lg_u32 s24, 0
  s_cbranch_scc1 L_ci_9
  s_lshr_b32 s32, s2, 3
  s_lshl_b32 s31, 1, s32
  s_lshl_b32 s32, s39, 2
  v_mov_b32 v22, s31
  s_mov_b64 exec, 1
  buffer_atomic_or v22, off, s[8:11], s32 sc0 sc1
  s_mov_b64 exec, -1
L_ci_9:
  s_waitcnt vmcnt(20)
  s_barrier
  s_mov_b32 s31, 0x180000
  s_add_u32 m0, s44, 131072
  s_nop 0
  buffer_load_dwordx4 v1, s[12:15], s31 offen lds
  s_mov_b32 s31, 0x188000
  s_add_u32 m0, s44, 132096
  s_nop 0
  buffer_load_dwordx4 v1, s[12:15], s31 offen lds
  s_mov_b32 s31, 0x190000
  s_add_u32 m0, s44, 133120
  s_nop 0
  buffer_load_dwordx4 v2, s[12:15], s31 offen lds
  s_mov_b32 s31, 0x198000
  s_add_u32 m0, s44, 134144
  s_nop 0
  buffer_load_dwordx4 v2, s[12:15], s31 offen lds
  ds_read_b64_tr_b16 v[96:97], v3 offset:0
  ds_read_b64_tr_b16 v[98:99], v3 offset:1024
  ds_read_b64_tr_b16 v[100:101], v3 offset:8192
  ds_read_b64_tr_b16 v[102:103], v3 offset:9216
  ds_read_b64_tr_b16 v[104:105], v4 offset:0
  ds_read_b64_tr_b16 v[106:107], v4 offset:1024
  ds_read_b64_tr_b16 v[108:109], v4 offset:8192
  ds_read_b64_tr_b16 v[110:111], v4 offset:9216
  s_waitcnt lgkmcnt(0)
  s_waitcnt vmcnt(20)
  s_barrier
  s_mov_b32 s31, 0x180000
  s_add_u32 m0, s44, 0
  s_nop 0
  buffer_load_dwordx4 v1, s[16:19], s31 offen lds
  s_mov_b32 s31, 0x188000
  s_add_u32 m0, s44, 1024
  s_nop 0
  buffer_load_dwordx4 v1, s[16:19], s31 offen lds
  s_mov_b32 s31, 0x190000
  s_add_u32 m0, s44, 2048
  s_nop 0
  buffer_load_dwordx4 v2, s[16:19], s31 offen lds
  s_mov_b32 s31, 0x198000
  s_add_u32 m0, s44, 3072
  s_nop 0
  buffer_load_dwordx4 v2, s[16:19], s31 offen lds
  ds_read_b64_tr_b16 a[160:161], v3 offset:16384
  ds_read_b64_tr_b16 a[162:163], v3 offset:17408
  ds_read_b64_tr_b16 a[164:165], v3 offset:24576
  ds_read_b64_tr_b16 a[166:167], v3 offset:25600
  ds_read_b64_tr_b16 a[168:169], v4 offset:16384
  ds_read_b64_tr_b16 a[170:171], v4 offset:17408
  ds_read_b64_tr_b16 a[172:173], v4 offset:24576
  ds_read_b64_tr_b16 a[174:175], v4 offset:25600
  s_waitcnt lgkmcnt(0)
  s_waitcnt vmcnt(20)
  s_barrier
  s_mov_b32 s31, 0x200000
  s_add_u32 m0, s44, 16384
  s_nop 0
  buffer_load_dwordx4 v1, s[12:15], s31 offen lds
  s_mov_b32 s31, 0x208000
  s_add_u32 m0, s44, 17408
  s_nop 0
  buffer_load_dwordx4 v1, s[12:15], s31 offen lds
  s_mov_b32 s31, 0x210000
  s_add_u32 m0, s44, 18432
  s_nop 0
  buffer_load_dwordx4 v2, s[12:15], s31 offen lds
  s_mov_b32 s31, 0x218000
  s_add_u32 m0, s44, 19456
  s_nop 0
  buffer_load_dwordx4 v2, s[12:15], s31 offen lds
  ds_read_b64_tr_b16 a[176:177], v3 offset:32768
  ds_read_b64_tr_b16 a[178:179], v3 offset:33792
  ds_read_b64_tr_b16 a[180:181], v3 offset:40960
  ds_read_b64_tr_b16 a[182:183], v3 offset:41984
  ds_read_b64_tr_b16 a[184:185], v4 offset:32768
  ds_read_b64_tr_b16 a[186:187], v4 offset:33792
  ds_read_b64_tr_b16 a[188:189], v4 offset:40960
  ds_read_b64_tr_b16 a[190:191], v4 offset:41984
  s_waitcnt lgkmcnt(0)
  s_waitcnt vmcnt(20)
  s_barrier
  s_mov_b32 s31, 0x200000
  s_add_u32 m0, s44, 32768
  s_nop 0
  buffer_load_dwordx4 v1, s[16:19], s31 offen lds
  s_mov_b32 s31, 0x208000
  s_add_u32 m0, s44, 33792
  s_nop 0
  buffer_load_dwordx4 v1, s[16:19], s31 offen lds
  s_mov_b32 s31, 0x210000
  s_add_u32 m0, s44, 34816
  s_nop 0
  buffer_load_dwordx4 v2, s[16:19], s31 offen lds
  s_mov_b32 s31, 0x218000
  s_add_u32 m0, s44, 35840
  s_nop 0
  buffer_load_dwordx4 v2, s[16:19], s31 offen lds
  ds_read_b64_tr_b16 a[192:193], v3 offset:49152
  ds_read_b64_tr_b16 a[194:195], v3 offset:50176
  ds_read_b64_tr_b16 a[196:197], v3 offset:57344
  ds_read_b64_tr_b16 a[198:199], v3 offset:58368
  ds_read_b64_tr_b16 a[200:201], v4 offset:49152
  ds_read_b64_tr_b16 a[202:203], v4 offset:50176
  ds_read_b64_tr_b16 a[204:205], v4 offset:57344
  ds_read_b64_tr_b16 a[206:207], v4 offset:58368
  s_waitcnt lgkmcnt(0)
  s_waitcnt vmcnt(20)
  s_barrier
  s_mov_b32 s31, 0x280000
  s_add_u32 m0, s44, 49152
  s_nop 0
  buffer_load_dwordx4 v1, s[12:15], s31 offen lds
  s_mov_b32 s31, 0x288000
  s_add_u32 m0, s44, 50176
  s_nop 0
  buffer_load_dwordx4 v1, s[12:15], s31 offen lds
  s_mov_b32 s31, 0x290000
  s_add_u32 m0, s44, 51200
  s_nop 0
  buffer_load_dwordx4 v2, s[12:15], s31 offen lds
  s_mov_b32 s31, 0x298000
  s_add_u32 m0, s44, 52224
  s_nop 0
  buffer_load_dwordx4 v2, s[12:15], s31 offen lds
  ds_read_b64_tr_b16 v[8:9], v5 offset:0
  ds_read_b64_tr_b16 v[10:11], v5 offset:1024
  ds_read_b64_tr_b16 v[12:13], v5 offset:8192
  ds_read_b64_tr_b16 v[14:15], v5 offset:9216
  ds_read_b64_tr_b16 v[24:25], v6 offset:0
  ds_read_b64_tr_b16 v[26:27], v6 offset:1024
  ds_read_b64_tr_b16 v[28:29], v6 offset:8192
  ds_read_b64_tr_b16 v[30:31], v6 offset:9216
  s_waitcnt lgkmcnt(0)
  ds_write_b128 v7, v[8:11] offset:16384
  ds_write_b128 v7, v[12:15] offset:17408
  ds_write_b128 v7, v[24:27] offset:18432
  ds_write_b128 v7, v[28:31] offset:19456
  s_waitcnt lgkmcnt(0)
  s_waitcnt vmcnt(20)
  s_barrier
  s_mov_b32 s31, 0x280000
  s_add_u32 m0, s44, 65536
  s_nop 0
  buffer_load_dwordx4 v1, s[16:19], s31 offen lds
  s_mov_b32 s31, 0x288000
  s_add_u32 m0, s44, 66560
  s_nop 0
  buffer_load_dwordx4 v1, s[16:19], s31 offen lds
  s_mov_b32 s31, 0x290000
  s_add_u32 m0, s44, 67584
  s_nop 0
  buffer_load_dwordx4 v2, s[16:19], s31 offen lds
  s_mov_b32 s31, 0x298000
  s_add_u32 m0, s44, 68608
  s_nop 0
  buffer_load_dwordx4 v2, s[16:19], s31 offen lds
  ds_read_b64_tr_b16 a[208:209], v5 offset:49152
  ds_read_b64_tr_b16 a[210:211], v5 offset:50176
  ds_read_b64_tr_b16 a[212:213], v5 offset:57344
  ds_read_b64_tr_b16 a[214:215], v5 offset:58368
  ds_read_b64_tr_b16 a[216:217], v6 offset:49152
  ds_read_b64_tr_b16 a[218:219], v6 offset:50176
  ds_read_b64_tr_b16 a[220:221], v6 offset:57344
  ds_read_b64_tr_b16 a[222:223], v6 offset:58368
  s_waitcnt lgkmcnt(0)
  s_waitcnt vmcnt(20)
  s_barrier
  s_mov_b32 s31, 0x300000
  s_add_u32 m0, s44, 114688
  s_nop 0
  buffer_load_dwordx4 v1, s[12:15], s31 offen lds
  s_mov_b32 s31, 0x308000
  s_add_u32 m0, s44, 115712
  s_nop 0
  buffer_load_dwordx4 v1, s[12:15], s31 offen lds
  s_mov_b32 s31, 0x310000
  s_add_u32 m0, s44, 116736
  s_nop 0
  buffer_load_dwordx4 v2, s[12:15], s31 offen lds
  s_mov_b32 s31, 0x318000
  s_add_u32 m0, s44, 117760
  s_nop 0
  buffer_load_dwordx4 v2, s[12:15], s31 offen lds
  ds_read_b64_tr_b16 a[224:225], v16 offset:0
  ds_read_b64_tr_b16 a[226:227], v16 offset:1024
  ds_read_b64_tr_b16 a[228:229], v16 offset:8192
  ds_read_b64_tr_b16 a[230:231], v16 offset:9216
  ds_read_b64_tr_b16 a[232:233], v17 offset:0
  ds_read_b64_tr_b16 a[234:235], v17 offset:1024
  ds_read_b64_tr_b16 a[236:237], v17 offset:8192
  ds_read_b64_tr_b16 a[238:239], v17 offset:9216
  s_waitcnt lgkmcnt(0)
  s_cmp_lg_u32 s36, 0
  s_cbranch_scc1 L_cf_10
  s_cmp_lg_u32 s24, 0
  s_cbranch_scc1 L_cf_11
  s_mov_b32 s37, s39
  s_lshr_b32 s38, s2, 3
  s_mov_b64 exec, 1
L_cf_12:
  v_readfirstlane_b32 s33, v22
  s_lshl_b32 s31, 1, s38
  s_and_b32 s34, s33, s31
  s_cbranch_scc0 L_cf_13
  s_not_b32 s33, s33
  s_cbranch_scc1 L_cf_15
  s_add_u32 s37, s37, 1
  s_and_b32 s37, s37, 7
  s_mov_b32 s31, 256
  s_cmp_eq_u32 s37, s39
  s_cbranch_scc1 L_cf_14
  s_lshl_b32 s33, 1, s38
L_cf_15:
  s_ff1_i32_b32 s38, s33
  s_lshl_b32 s31, 1, s38
  s_lshl_b32 s32, s37, 2
  v_mov_b32 v22, s31
  buffer_atomic_or v22, off, s[8:11], s32 sc0 sc1
  s_waitcnt vmcnt(0)
  s_branch L_cf_12
L_cf_13:
  s_or_b32 s33, s33, s31
  s_cmp_eq_u32 s33, -1
  s_cbranch_scc0 L_cf_16
  v_mov_b32 v22, 1
  buffer_atomic_add v22, off, s[8:11], 0 offset:128 sc0 sc1
  s_waitcnt vmcnt(0)
  v_readfirstlane_b32 s33, v22
  s_nop 0
  s_cmp_eq_u32 s33, 7
  s_cbranch_scc0 L_cf_16
  buffer_load_dwordx2 v[22:23], off, s[8:11], 0 offset:136 sc1
  s_waitcnt vmcnt(0)
  v_readfirstlane_b32 s33, v22
  v_readfirstlane_b32 s34, v23
  s_mov_b64 exec, 0xff
  s_mov_b32 s32, 0x408000
  v_lshlrev_b32 v23, 7, v0
  buffer_load_dword v22, v23, s[4:7], s32 offen sc1
  s_cmp_gt_u32 s34, s33
  s_cselect_b32 s33, 1, 0
  s_waitcnt vmcnt(0)
  v_add_u32 v22, 2, v22
  v_and_b32 v22, -2, v22
  v_or_b32 v22, s33, v22
  buffer_store_dword v22, v23, s[4:7], s32 offen sc1
  s_mov_b64 exec, 1
L_cf_16:
  s_lshl_b32 s31, s37, 5
  s_add_u32 s31, s31, s38
L_cf_14:
  v_mov_b32 v22, s31
  v_mov_b32 v23, 163836
  ds_write_b32 v23, v22
  s_waitcnt lgkmcnt(0)
  s_mov_b64 exec, -1
L_cf_11:
  s_barrier
  v_mov_b32 v23, 163836
  ds_read_b32 v22, v23
  s_mov_b32 s36, 1
  s_waitcnt lgkmcnt(0)
  v_readfirstlane_b32 s31, v22
  s_nop 0
  s_cmp_ge_u32 s31, 256
  s_cbranch_scc1 L_exit
  s_cmp_eq_u32 s31, s35
  s_cbranch_scc1 L_cf_10
  s_mov_b32 s35, s31
  s_waitcnt vmcnt(0)
  s_barrier
  s_branch L_dispatch
L_cf_10:
  s_waitcnt vmcnt(20)
  s_barrier
  s_mov_b32 s31, 0x300000
  s_add_u32 m0, s44, 131072
  s_nop 0
  buffer_load_dwordx4 v1, s[16:19], s31 offen lds
  s_mov_b32 s31, 0x308000
  s_add_u32 m0, s44, 132096
  s_nop 0
  buffer_load_dwordx4 v1, s[16:19], s31 offen lds
  s_mov_b32 s31, 0x310000
  s_add_u32 m0, s44, 133120
  s_nop 0
  buffer_load_dwordx4 v2, s[16:19], s31 offen lds
  s_mov_b32 s31, 0x318000
  s_add_u32 m0, s44, 134144
  s_nop 0
  buffer_load_dwordx4 v2, s[16:19], s31 offen lds
  ds_read_b64_tr_b16 a[240:241], v3 offset:0
  ds_read_b64_tr_b16 a[242:243], v3 offset:1024
  ds_read_b64_tr_b16 a[244:245], v3 offset:8192
  ds_read_b64_tr_b16 a[246:247], v3 offset:9216
  ds_read_b64_tr_b16 a[248:249], v4 offset:0
  ds_read_b64_tr_b16 a[250:251], v4 offset:1024
  ds_read_b64_tr_b16 a[252:253], v4 offset:8192
  ds_read_b64_tr_b16 a[254:255], v4 offset:9216
  s_waitcnt lgkmcnt(0)
  s_waitcnt vmcnt(20)
  s_barrier
  s_mov_b32 s31, 0x380000
  s_add_u32 m0, s44, 0
  s_nop 0
  buffer_load_dwordx4 v1, s[12:15], s31 offen lds
  s_mov_b32 s31, 0x388000
  s_add_u32 m0, s44, 1024
  s_nop 0
  buffer_load_dwordx4 v1, s[12:15], s31 offen lds
  s_mov_b32 s31, 0x390000
  s_add_u32 m0, s44, 2048
  s_nop 0
  buffer_load_dwordx4 v2, s[12:15], s31 offen lds
  s_mov_b32 s31, 0x398000
  s_add_u32 m0, s44, 3072
  s_nop 0
  buffer_load_dwordx4 v2, s[12:15], s31 offen lds
  ds_read_b64_tr_b16 v[32:33], v3 offset:16384
  ds_read_b64_tr_b16 v[34:35], v3 offset:17408
  ds_read_b64_tr_b16 v[36:37], v3 offset:24576
  ds_read_b64_tr_b16 v[38:39], v3 offset:25600
  ds_read_b64_tr_b16 v[40:41], v4 offset:16384
  ds_read_b64_tr_b16 v[42:43], v4 offset:17408
  ds_read_b64_tr_b16 v[44:45], v4 offset:24576
  ds_read_b64_tr_b16 v[46:47], v4 offset:25600
  s_waitcnt lgkmcnt(0)
  s_waitcnt vmcnt(20)
  s_barrier
  s_mov_b32 s31, 0x380000
  s_add_u32 m0, s44, 16384
  s_nop 0
  buffer_load_dwordx4 v1, s[16:19], s31 offen lds
  s_mov_b32 s31, 0x388000
  s_add_u32 m0, s44, 17408
  s_nop 0
  buffer_load_dwordx4 v1, s[16:19], s31 offen lds
  s_mov_b32 s31, 0x390000
  s_add_u32 m0, s44, 18432
  s_nop 0
  buffer_load_dwordx4 v2, s[16:19], s31 offen lds
  s_mov_b32 s31, 0x398000
  s_add_u32 m0, s44, 19456
  s_nop 0
  buffer_load_dwordx4 v2, s[16:19], s31 offen lds
  ds_read_b64_tr_b16 v[48:49], v3 offset:32768
  ds_read_b64_tr_b16 v[50:51], v3 offset:33792
  ds_read_b64_tr_b16 v[52:53], v3 offset:40960
  ds_read_b64_tr_b16 v[54:55], v3 offset:41984
  ds_read_b64_tr_b16 v[56:57], v4 offset:32768
  ds_read_b64_tr_b16 v[58:59], v4 offset:33792
  ds_read_b64_tr_b16 v[60:61], v4 offset:40960
  ds_read_b64_tr_b16 v[62:63], v4 offset:41984
  s_waitcnt lgkmcnt(0)
  s_waitcnt vmcnt(20)
  s_barrier
  s_mov_b32 s31, 0x400000
  s_add_u32 m0, s44, 32768
  s_nop 0
  buffer_load_dwordx4 v1, s[12:15], s31 offen lds
  s_mov_b32 s31, 0x408000
  s_add_u32 m0, s44, 33792
  s_nop 0
  buffer_load_dwordx4 v1, s[12:15], s31 offen lds
  s_mov_b32 s31, 0x410000
  s_add_u32 m0, s44, 34816
  s_nop 0
  buffer_load_dwordx4 v2, s[12:15], s31 offen lds
  s_mov_b32 s31, 0x418000
  s_add_u32 m0, s44, 35840
  s_nop 0
  buffer_load_dwordx4 v2, s[12:15], s31 offen lds
  ds_read_b64_tr_b16 v[64:65], v3 offset:49152
  ds_read_b64_tr_b16 v[66:67], v3 offset:50176
  ds_read_b64_tr_b16 v[68:69], v3 offset:57344
  ds_read_b64_tr_b16 v[70:71], v3 offset:58368
  ds_read_b64_tr_b16 v[72:73], v4 offset:49152
  ds_read_b64_tr_b16 v[74:75], v4 offset:50176
  ds_read_b64_tr_b16 v[76:77], v4 offset:57344
  ds_read_b64_tr_b16 v[78:79], v4 offset:58368
  s_waitcnt lgkmcnt(0)
  s_waitcnt vmcnt(20)
  s_barrier
  s_mov_b32 s31, 0x400000
  s_add_u32 m0, s44, 49152
  s_nop 0
  buffer_load_dwordx4 v1, s[16:19], s31 offen lds
  s_mov_b32 s31, 0x408000
  s_add_u32 m0, s44, 50176
  s_nop 0
  buffer_load_dwordx4 v1, s[16:19], s31 offen lds
  s_mov_b32 s31, 0x410000
  s_add_u32 m0, s44, 51200
  s_nop 0
  buffer_load_dwordx4 v2, s[16:19], s31 offen lds
  s_mov_b32 s31, 0x418000
  s_add_u32 m0, s44, 52224
  s_nop 0
  buffer_load_dwordx4 v2, s[16:19], s31 offen lds
  ds_read_b64_tr_b16 v[80:81], v5 offset:0
  ds_read_b64_tr_b16 v[82:83], v5 offset:1024
  ds_read_b64_tr_b16 v[84:85], v5 offset:8192
  ds_read_b64_tr_b16 v[86:87], v5 offset:9216
  ds_read_b64_tr_b16 v[88:89], v6 offset:0
  ds_read_b64_tr_b16 v[90:91], v6 offset:1024
  ds_read_b64_tr_b16 v[92:93], v6 offset:8192
  ds_read_b64_tr_b16 v[94:95], v6 offset:9216
  s_waitcnt lgkmcnt(0)
  s_waitcnt vmcnt(20)
  s_barrier
  s_mov_b32 s31, 0x480000
  s_add_u32 m0, s44, 65536
  s_nop 0
  buffer_load_dwordx4 v1, s[12:15], s31 offen lds
  s_mov_b32 s31, 0x488000
  s_add_u32 m0, s44, 66560
  s_nop 0
  buffer_load_dwordx4 v1, s[12:15], s31 offen lds
  s_mov_b32 s31, 0x490000
  s_add_u32 m0, s44, 67584
  s_nop 0
  buffer_load_dwordx4 v2, s[12:15], s31 offen lds
  s_mov_b32 s31, 0x498000
  s_add_u32 m0, s44, 68608
  s_nop 0
  buffer_load_dwordx4 v2, s[12:15], s31 offen lds
  ds_read_b64_tr_b16 v[112:113], v5 offset:49152
  ds_read_b64_tr_b16 v[114:115], v5 offset:50176
  ds_read_b64_tr_b16 v[116:117], v5 offset:57344
  ds_read_b64_tr_b16 v[118:119], v5 offset:58368
  ds_read_b64_tr_b16 v[120:121], v6 offset:49152
  ds_read_b64_tr_b16 v[122:123], v6 offset:50176
  ds_read_b64_tr_b16 v[124:125], v6 offset:57344
  ds_read_b64_tr_b16 v[126:127], v6 offset:58368
  s_waitcnt lgkmcnt(0)
  s_waitcnt vmcnt(20)
  s_barrier
  s_mov_b32 s31, 0x480000
  s_add_u32 m0, s44, 114688
  s_nop 0
  buffer_load_dwordx4 v1, s[16:19], s31 offen lds
  s_mov_b32 s31, 0x488000
  s_add_u32 m0, s44, 115712
  s_nop 0
  buffer_load_dwordx4 v1, s[16:19], s31 offen lds
  s_mov_b32 s31, 0x490000
  s_add_u32 m0, s44, 116736
  s_nop 0
  buffer_load_dwordx4 v2, s[16:19], s31 offen lds
  s_mov_b32 s31, 0x498000
  s_add_u32 m0, s44, 117760
  s_nop 0
  buffer_load_dwordx4 v2, s[16:19], s31 offen lds
  ds_read_b64_tr_b16 v[128:129], v16 offset:0
  ds_read_b64_tr_b16 v[130:131], v16 offset:1024
  ds_read_b64_tr_b16 v[132:133], v16 offset:8192
  ds_read_b64_tr_b16 v[134:135], v16 offset:9216
  ds_read_b64_tr_b16 v[136:137], v17 offset:0
  ds_read_b64_tr_b16 v[138:139], v17 offset:1024
  ds_read_b64_tr_b16 v[140:141], v17 offset:8192
  ds_read_b64_tr_b16 v[142:143], v17 offset:9216
  s_waitcnt lgkmcnt(0)
  s_waitcnt vmcnt(20)
  s_barrier
  s_mov_b32 s31, 0x500000
  s_add_u32 m0, s44, 131072
  s_nop 0
  buffer_load_dwordx4 v1, s[12:15], s31 offen lds
  s_mov_b32 s31, 0x508000
  s_add_u32 m0, s44, 132096
  s_nop 0
  buffer_load_dwordx4 v1, s[12:15], s31 offen lds
  s_mov_b32 s31, 0x510000
  s_add_u32 m0, s44, 133120
  s_nop 0
  buffer_load_dwordx4 v2, s[12:15], s31 offen lds
  s_mov_b32 s31, 0x518000
  s_add_u32 m0, s44, 134144
  s_nop 0
  buffer_load_dwordx4 v2, s[12:15], s31 offen lds
  ds_read_b64_tr_b16 v[144:145], v3 offset:0
  ds_read_b64_tr_b16 v[146:147], v3 offset:1024
  ds_read_b64_tr_b16 v[148:149], v3 offset:8192
  ds_read_b64_tr_b16 v[150:151], v3 offset:9216
  ds_read_b64_tr_b16 v[152:153], v4 offset:0
  ds_read_b64_tr_b16 v[154:155], v4 offset:1024
  ds_read_b64_tr_b16 v[156:157], v4 offset:8192
  ds_read_b64_tr_b16 v[158:159], v4 offset:9216
  s_waitcnt lgkmcnt(0)
  s_waitcnt vmcnt(20)
  s_barrier
  s_mov_b32 s31, 0x500000
  s_add_u32 m0, s44, 0
  s_nop 0
  buffer_load_dwordx4 v1, s[16:19], s31 offen lds
  s_mov_b32 s31, 0x508000
  s_add_u32 m0, s44, 1024
  s_nop 0
  buffer_load_dwordx4 v1, s[16:19], s31 offen lds
  s_mov_b32 s31, 0x510000
  s_add_u32 m0, s44, 2048
  s_nop 0
  buffer_load_dwordx4 v2, s[16:19], s31 offen lds
  s_mov_b32 s31, 0x518000
  s_add_u32 m0, s44, 3072
  s_nop 0
  buffer_load_dwordx4 v2, s[16:19], s31 offen lds
  ds_read_b64_tr_b16 v[160:161], v3 offset:16384
  ds_read_b64_tr_b16 v[162:163], v3 offset:17408
  ds_read_b64_tr_b16 v[164:165], v3 offset:24576
  ds_read_b64_tr_b16 v[166:167], v3 offset:25600
  ds_read_b64_tr_b16 v[168:169], v4 offset:16384
  ds_read_b64_tr_b16 v[170:171], v4 offset:17408
  ds_read_b64_tr_b16 v[172:173], v4 offset:24576
  ds_read_b64_tr_b16 v[174:175], v4 offset:25600
  s_waitcnt lgkmcnt(0)
  s_waitcnt vmcnt(20)
  s_barrier
  s_mov_b32 s31, 0x580000
  s_add_u32 m0, s44, 16384
  s_nop 0
  buffer_load_dwordx4 v1, s[12:15], s31 offen lds
  s_mov_b32 s31, 0x588000
  s_add_u32 m0, s44, 17408
  s_nop 0
  buffer_load_dwordx4 v1, s[12:15], s31 offen lds
  s_mov_b32 s31, 0x590000
  s_add_u32 m0, s44, 18432
  s_nop 0
  buffer_load_dwordx4 v2, s[12:15], s31 offen lds
  s_mov_b32 s31, 0x598000
  s_add_u32 m0, s44, 19456
  s_nop 0
  buffer_load_dwordx4 v2, s[12:15], s31 offen lds
  ds_read_b64_tr_b16 v[176:177], v3 offset:32768
  ds_read_b64_tr_b16 v[178:179], v3 offset:33792
  ds_read_b64_tr_b16 v[180:181], v3 offset:40960
  ds_read_b64_tr_b16 v[182:183], v3 offset:41984
  ds_read_b64_tr_b16 v[184:185], v4 offset:32768
  ds_read_b64_tr_b16 v[186:187], v4 offset:33792
  ds_read_b64_tr_b16 v[188:189], v4 offset:40960
  ds_read_b64_tr_b16 v[190:191], v4 offset:41984
  s_waitcnt lgkmcnt(0)
  s_waitcnt vmcnt(20)
  s_barrier
  s_mov_b32 s31, 0x580000
  s_add_u32 m0, s44, 32768
  s_nop 0
  buffer_load_dwordx4 v1, s[16:19], s31 offen lds
  s_mov_b32 s31, 0x588000
  s_add_u32 m0, s44, 33792
  s_nop 0
  buffer_load_dwordx4 v1, s[16:19], s31 offen lds
  s_mov_b32 s31, 0x590000
  s_add_u32 m0, s44, 34816
  s_nop 0
  buffer_load_dwordx4 v2, s[16:19], s31 offen lds
  s_mov_b32 s31, 0x598000
  s_add_u32 m0, s44, 35840
  s_nop 0
  buffer_load_dwordx4 v2, s[16:19], s31 offen lds
  ds_read_b64_tr_b16 v[192:193], v3 offset:49152
  ds_read_b64_tr_b16 v[194:195], v3 offset:50176
  ds_read_b64_tr_b16 v[196:197], v3 offset:57344
  ds_read_b64_tr_b16 v[198:199], v3 offset:58368
  ds_read_b64_tr_b16 v[200:201], v4 offset:49152
  ds_read_b64_tr_b16 v[202:203], v4 offset:50176
  ds_read_b64_tr_b16 v[204:205], v4 offset:57344
  ds_read_b64_tr_b16 v[206:207], v4 offset:58368
  s_waitcnt lgkmcnt(0)
  s_waitcnt vmcnt(20)
  s_barrier
  s_mov_b32 s31, 0x600000
  s_add_u32 m0, s44, 49152
  s_nop 0
  buffer_load_dwordx4 v1, s[12:15], s31 offen lds
  s_mov_b32 s31, 0x608000
  s_add_u32 m0, s44, 50176
  s_nop 0
  buffer_load_dwordx4 v1, s[12:15], s31 offen lds
  s_mov_b32 s31, 0x610000
  s_add_u32 m0, s44, 51200
  s_nop 0
  buffer_load_dwordx4 v2, s[12:15], s31 offen lds
  s_mov_b32 s31, 0x618000
  s_add_u32 m0, s44, 52224
  s_nop 0
  buffer_load_dwordx4 v2, s[12:15], s31 offen lds
  ds_read_b64_tr_b16 v[208:209], v5 offset:0
  ds_read_b64_tr_b16 v[210:211], v5 offset:1024
  ds_read_b64_tr_b16 v[212:213], v5 offset:8192
  ds_read_b64_tr_b16 v[214:215], v5 offset:9216
  ds_read_b64_tr_b16 v[216:217], v6 offset:0
  ds_read_b64_tr_b16 v[218:219], v6 offset:1024
  ds_read_b64_tr_b16 v[220:221], v6 offset:8192
  ds_read_b64_tr_b16 v[222:223], v6 offset:9216
  s_waitcnt lgkmcnt(0)
  s_waitcnt vmcnt(20)
  s_barrier
  s_mov_b32 s31, 0x600000
  s_add_u32 m0, s44, 65536
  s_nop 0
  buffer_load_dwordx4 v1, s[16:19], s31 offen lds
  s_mov_b32 s31, 0x608000
  s_add_u32 m0, s44, 66560
  s_nop 0
  buffer_load_dwordx4 v1, s[16:19], s31 offen lds
  s_mov_b32 s31, 0x610000
  s_add_u32 m0, s44, 67584
  s_nop 0
  buffer_load_dwordx4 v2, s[16:19], s31 offen lds
  s_mov_b32 s31, 0x618000
  s_add_u32 m0, s44, 68608
  s_nop 0
  buffer_load_dwordx4 v2, s[16:19], s31 offen lds
  ds_read_b64_tr_b16 v[224:225], v5 offset:49152
  ds_read_b64_tr_b16 v[226:227], v5 offset:50176
  ds_read_b64_tr_b16 v[228:229], v5 offset:57344
  ds_read_b64_tr_b16 v[230:231], v5 offset:58368
  ds_read_b64_tr_b16 v[232:233], v6 offset:49152
  ds_read_b64_tr_b16 v[234:235], v6 offset:50176
  ds_read_b64_tr_b16 v[236:237], v6 offset:57344
  ds_read_b64_tr_b16 v[238:239], v6 offset:58368
  s_waitcnt lgkmcnt(0)
  s_waitcnt vmcnt(20)
  s_barrier
  s_mov_b32 s31, 0x680000
  s_add_u32 m0, s44, 114688
  s_nop 0
  buffer_load_dwordx4 v1, s[12:15], s31 offen lds
  s_mov_b32 s31, 0x688000
  s_add_u32 m0, s44, 115712
  s_nop 0
  buffer_load_dwordx4 v1, s[12:15], s31 offen lds
  s_mov_b32 s31, 0x690000
  s_add_u32 m0, s44, 116736
  s_nop 0
  buffer_load_dwordx4 v2, s[12:15], s31 offen lds
  s_mov_b32 s31, 0x698000
  s_add_u32 m0, s44, 117760
  s_nop 0
  buffer_load_dwordx4 v2, s[12:15], s31 offen lds
  ds_read_b64_tr_b16 v[240:241], v16 offset:0
  ds_read_b64_tr_b16 v[242:243], v16 offset:1024
  ds_read_b64_tr_b16 v[244:245], v16 offset:8192
  ds_read_b64_tr_b16 v[246:247], v16 offset:9216
  ds_read_b64_tr_b16 v[248:249], v17 offset:0
  ds_read_b64_tr_b16 v[250:251], v17 offset:1024
  ds_read_b64_tr_b16 v[252:253], v17 offset:8192
  ds_read_b64_tr_b16 v[254:255], v17 offset:9216
  s_waitcnt lgkmcnt(0)
  s_waitcnt vmcnt(20)
  s_barrier
  s_mov_b32 s31, 0x680000
  s_add_u32 m0, s44, 131072
  s_nop 0
  buffer_load_dwordx4 v1, s[16:19], s31 offen lds
  s_mov_b32 s31, 0x688000
  s_add_u32 m0, s44, 132096
  s_nop 0
  buffer_load_dwordx4 v1, s[16:19], s31 offen lds
  s_mov_b32 s31, 0x690000
  s_add_u32 m0, s44, 133120
  s_nop 0
  buffer_load_dwordx4 v2, s[16:19], s31 offen lds
  s_mov_b32 s31, 0x698000
  s_add_u32 m0, s44, 134144
  s_nop 0
  buffer_load_dwordx4 v2, s[16:19], s31 offen lds
  ds_read_b64_tr_b16 a[0:1], v3 offset:0
  ds_read_b64_tr_b16 a[2:3], v3 offset:1024
  ds_read_b64_tr_b16 a[4:5], v3 offset:8192
  ds_read_b64_tr_b16 a[6:7], v3 offset:9216
  ds_read_b64_tr_b16 a[8:9], v4 offset:0
  ds_read_b64_tr_b16 a[10:11], v4 offset:1024
  ds_read_b64_tr_b16 a[12:13], v4 offset:8192
  ds_read_b64_tr_b16 a[14:15], v4 offset:9216
  s_waitcnt lgkmcnt(0)
  s_waitcnt vmcnt(20)
  s_barrier
  s_mov_b32 s31, 0x700000
  s_add_u32 m0, s44, 0
  s_nop 0
  buffer_load_dwordx4 v1, s[12:15], s31 offen lds
  s_mov_b32 s31, 0x708000
  s_add_u32 m0, s44, 1024
  s_nop 0
  buffer_load_dwordx4 v1, s[12:15], s31 offen lds
  s_mov_b32 s31, 0x710000
  s_add_u32 m0, s44, 2048
  s_nop 0
  buffer_load_dwordx4 v2, s[12:15], s31 offen lds
  s_mov_b32 s31, 0x718000
  s_add_u32 m0, s44, 3072
  s_nop 0
  buffer_load_dwordx4 v2, s[12:15], s31 offen lds
  ds_read_b64_tr_b16 a[16:17], v3 offset:16384
  ds_read_b64_tr_b16 a[18:19], v3 offset:17408
  ds_read_b64_tr_b16 a[20:21], v3 offset:24576
  ds_read_b64_tr_b16 a[22:23], v3 offset:25600
  ds_read_b64_tr_b16 a[24:25], v4 offset:16384
  ds_read_b64_tr_b16 a[26:27], v4 offset:17408
  ds_read_b64_tr_b16 a[28:29], v4 offset:24576
  ds_read_b64_tr_b16 a[30:31], v4 offset:25600
  s_waitcnt lgkmcnt(0)
  s_waitcnt vmcnt(20)
  s_barrier
  s_mov_b32 s31, 0x700000
  s_add_u32 m0, s44, 16384
  s_nop 0
  buffer_load_dwordx4 v1, s[16:19], s31 offen lds
  s_mov_b32 s31, 0x708000
  s_add_u32 m0, s44, 17408
  s_nop 0
  buffer_load_dwordx4 v1, s[16:19], s31 offen lds
  s_mov_b32 s31, 0x710000
  s_add_u32 m0, s44, 18432
  s_nop 0
  buffer_load_dwordx4 v2, s[16:19], s31 offen lds
  s_mov_b32 s31, 0x718000
  s_add_u32 m0, s44, 19456
  s_nop 0
  buffer_load_dwordx4 v2, s[16:19], s31 offen lds
  ds_read_b64_tr_b16 v[8:9], v3 offset:32768
  ds_read_b64_tr_b16 v[10:11], v3 offset:33792
  ds_read_b64_tr_b16 v[12:13], v3 offset:40960
  ds_read_b64_tr_b16 v[14:15], v3 offset:41984
  ds_read_b64_tr_b16 v[24:25], v4 offset:32768
  ds_read_b64_tr_b16 v[26:27], v4 offset:33792
  ds_read_b64_tr_b16 v[28:29], v4 offset:40960
  ds_read_b64_tr_b16 v[30:31], v4 offset:41984
  s_waitcnt lgkmcnt(0)
  ds_write_b128 v7, v[8:11] offset:32768
  ds_write_b128 v7, v[12:15] offset:33792
  ds_write_b128 v7, v[24:27] offset:34816
  ds_write_b128 v7, v[28:31] offset:35840
  s_waitcnt lgkmcnt(0)
  s_waitcnt vmcnt(20)
  s_barrier
  s_mov_b32 s31, 0x780000
  s_add_u32 m0, s44, 32768
  s_nop 0
  buffer_load_dwordx4 v1, s[12:15], s31 offen lds
  s_mov_b32 s31, 0x788000
  s_add_u32 m0, s44, 33792
  s_nop 0
  buffer_load_dwordx4 v1, s[12:15], s31 offen lds
  s_mov_b32 s31, 0x790000
  s_add_u32 m0, s44, 34816
  s_nop 0
  buffer_load_dwordx4 v2, s[12:15], s31 offen lds
  s_mov_b32 s31, 0x798000
  s_add_u32 m0, s44, 35840
  s_nop 0
  buffer_load_dwordx4 v2, s[12:15], s31 offen lds
  ds_read_b64_tr_b16 a[32:33], v3 offset:49152
  ds_read_b64_tr_b16 a[34:35], v3 offset:50176
  ds_read_b64_tr_b16 a[36:37], v3 offset:57344
  ds_read_b64_tr_b16 a[38:39], v3 offset:58368
  ds_read_b64_tr_b16 a[40:41], v4 offset:49152
  ds_read_b64_tr_b16 a[42:43], v4 offset:50176
  ds_read_b64_tr_b16 a[44:45], v4 offset:57344
  ds_read_b64_tr_b16 a[46:47], v4 offset:58368
  s_waitcnt lgkmcnt(0)
  s_waitcnt vmcnt(20)
  s_barrier
  s_mov_b32 s31, 0x780000
  s_add_u32 m0, s44, 49152
  s_nop 0
  buffer_load_dwordx4 v1, s[16:19], s31 offen lds
  s_mov_b32 s31, 0x788000
  s_add_u32 m0, s44, 50176
  s_nop 0
  buffer_load_dwordx4 v1, s[16:19], s31 offen lds
  s_mov_b32 s31, 0x790000
  s_add_u32 m0, s44, 51200
  s_nop 0
  buffer_load_dwordx4 v2, s[16:19], s31 offen lds
  s_mov_b32 s31, 0x798000
  s_add_u32 m0, s44, 52224
  s_nop 0
  buffer_load_dwordx4 v2, s[16:19], s31 offen lds
  ds_read_b64_tr_b16 a[48:49], v5 offset:0
  ds_read_b64_tr_b16 a[50:51], v5 offset:1024
  ds_read_b64_tr_b16 a[52:53], v5 offset:8192
  ds_read_b64_tr_b16 a[54:55], v5 offset:9216
  ds_read_b64_tr_b16 a[56:57], v6 offset:0
  ds_read_b64_tr_b16 a[58:59], v6 offset:1024
  ds_read_b64_tr_b16 a[60:61], v6 offset:8192
  ds_read_b64_tr_b16 a[62:63], v6 offset:9216
  s_waitcnt lgkmcnt(0)
  s_waitcnt vmcnt(20)
  s_barrier
  ds_read_b64_tr_b16 a[64:65], v5 offset:49152
  ds_read_b64_tr_b16 a[66:67], v5 offset:50176
  ds_read_b64_tr_b16 a[68:69], v5 offset:57344
  ds_read_b64_tr_b16 a[70:71], v5 offset:58368
  ds_read_b64_tr_b16 a[72:73], v6 offset:49152
  ds_read_b64_tr_b16 a[74:75], v6 offset:50176
  ds_read_b64_tr_b16 a[76:77], v6 offset:57344
  ds_read_b64_tr_b16 a[78:79], v6 offset:58368
  s_waitcnt lgkmcnt(0)
  s_waitcnt vmcnt(16)
  s_barrier
  ds_read_b64_tr_b16 a[80:81], v16 offset:0
  ds_read_b64_tr_b16 a[82:83], v16 offset:1024
  ds_read_b64_tr_b16 a[84:85], v16 offset:8192
  ds_read_b64_tr_b16 a[86:87], v16 offset:9216
  ds_read_b64_tr_b16 a[88:89], v17 offset:0
  ds_read_b64_tr_b16 a[90:91], v17 offset:1024
  ds_read_b64_tr_b16 a[92:93], v17 offset:8192
  ds_read_b64_tr_b16 a[94:95], v17 offset:9216
  s_waitcnt lgkmcnt(0)
  s_waitcnt vmcnt(12)
  s_barrier
  ds_read_b64_tr_b16 a[96:97], v3 offset:0
  ds_read_b64_tr_b16 a[98:99], v3 offset:1024
  ds_read_b64_tr_b16 a[100:101], v3 offset:8192
  ds_read_b64_tr_b16 a[102:103], v3 offset:9216
  ds_read_b64_tr_b16 a[104:105], v4 offset:0
  ds_read_b64_tr_b16 a[106:107], v4 offset:1024
  ds_read_b64_tr_b16 a[108:109], v4 offset:8192
  ds_read_b64_tr_b16 a[110:111], v4 offset:9216
  s_waitcnt lgkmcnt(0)
  s_waitcnt vmcnt(8)
  s_barrier
  ds_read_b64_tr_b16 a[112:113], v3 offset:16384
  ds_read_b64_tr_b16 a[114:115], v3 offset:17408
  ds_read_b64_tr_b16 a[116:117], v3 offset:24576
  ds_read_b64_tr_b16 a[118:119], v3 offset:25600
  ds_read_b64_tr_b16 a[120:121], v4 offset:16384
  ds_read_b64_tr_b16 a[122:123], v4 offset:17408
  ds_read_b64_tr_b16 a[124:125], v4 offset:24576
  ds_read_b64_tr_b16 a[126:127], v4 offset:25600
  s_waitcnt lgkmcnt(0)
  s_waitcnt vmcnt(4)
  s_barrier
  ds_read_b64_tr_b16 a[128:129], v3 offset:32768
  ds_read_b64_tr_b16 a[130:131], v3 offset:33792
  ds_read_b64_tr_b16 a[132:133], v3 offset:40960
  ds_read_b64_tr_b16 a[134:135], v3 offset:41984
  ds_read_b64_tr_b16 a[136:137], v4 offset:32768
  ds_read_b64_tr_b16 a[138:139], v4 offset:33792
  ds_read_b64_tr_b16 a[140:141], v4 offset:40960
  ds_read_b64_tr_b16 a[142:143], v4 offset:41984
  s_waitcnt lgkmcnt(0)
  s_waitcnt vmcnt(0)
  s_barrier
  ds_read_b64_tr_b16 a[144:145], v3 offset:49152
  ds_read_b64_tr_b16 a[146:147], v3 offset:50176
  ds_read_b64_tr_b16 a[148:149], v3 offset:57344
  ds_read_b64_tr_b16 a[150:151], v3 offset:58368
  ds_read_b64_tr_b16 a[152:153], v4 offset:49152
  ds_read_b64_tr_b16 a[154:155], v4 offset:50176
  ds_read_b64_tr_b16 a[156:157], v4 offset:57344
  ds_read_b64_tr_b16 a[158:159], v4 offset:58368
  s_waitcnt lgkmcnt(0)
  s_branch L_A_lddone
L_A_ld2:
  s_mov_b32 s31, 0x0
  s_add_u32 m0, s44, 0
  s_nop 0
  buffer_load_dwordx4 v1, s[12:15], s31 offen lds
  s_mov_b32 s31, 0x8000
  s_add_u32 m0, s44, 1024
  s_nop 0
  buffer_load_dwordx4 v1, s[12:15], s31 offen lds
  s_mov_b32 s31, 0x10000
  s_add_u32 m0, s44, 2048
  s_nop 0
  buffer_load_dwordx4 v2, s[12:15], s31 offen lds
  s_mov_b32 s31, 0x18000
  s_add_u32 m0, s44, 3072
  s_nop 0
  buffer_load_dwordx4 v2, s[12:15], s31 offen lds
  s_mov_b32 s31, 0x0
  s_add_u32 m0, s44, 16384
  s_nop 0
  buffer_load_dwordx4 v1, s[16:19], s31 offen lds
  s_mov_b32 s31, 0x8000
  s_add_u32 m0, s44, 17408
  s_nop 0
  buffer_load_dwordx4 v1, s[16:19], s31 offen lds
  s_mov_b32 s31, 0x10000
  s_add_u32 m0, s44, 18432
  s_nop 0
  buffer_load_dwordx4 v2, s[16:19], s31 offen lds
  s_mov_b32 s31, 0x18000
  s_add_u32 m0, s44, 19456
  s_nop 0
  buffer_load_dwordx4 v2, s[16:19], s31 offen lds
  s_mov_b32 s31, 0x80000
  s_add_u32 m0, s44, 32768
  s_nop 0
  buffer_load_dwordx4 v1, s[12:15], s31 offen lds
  s_mov_b32 s31, 0x88000
  s_add_u32 m0, s44, 33792
  s_nop 0
  buffer_load_dwordx4 v1, s[12:15], s31 offen lds
  s_mov_b32 s31, 0x90000
  s_add_u32 m0, s44, 34816
  s_nop 0
  buffer_load_dwordx4 v2, s[12:15], s31 offen lds
  s_mov_b32 s31, 0x98000
  s_add_u32 m0, s44, 35840
  s_nop 0
  buffer_load_dwordx4 v2, s[12:15], s31 offen lds
  s_mov_b32 s31, 0x80000
  s_add_u32 m0, s44, 49152
  s_nop 0
  buffer_load_dwordx4 v1, s[16:19], s31 offen lds
  s_mov_b32 s31, 0x88000
  s_add_u32 m0, s44, 50176
  s_nop 0
  buffer_load_dwordx4 v1, s[16:19], s31 offen lds
  s_mov_b32 s31, 0x90000
  s_add_u32 m0, s44, 51200
  s_nop 0
  buffer_load_dwordx4 v2, s[16:19], s31 offen lds
  s_mov_b32 s31, 0x98000
  s_add_u32 m0, s44, 52224
  s_nop 0
  buffer_load_dwordx4 v2, s[16:19], s31 offen lds
  s_mov_b32 s31, 0x100000
  s_add_u32 m0, s44, 65536
  s_nop 0
  buffer_load_dwordx4 v1, s[12:15], s31 offen lds
  s_mov_b32 s31, 0x108000
  s_add_u32 m0, s44, 66560
  s_nop 0
  buffer_load_dwordx4 v1, s[12:15], s31 offen lds
  s_mov_b32 s31, 0x110000
  s_add_u32 m0, s44, 67584
  s_nop 0
  buffer_load_dwordx4 v2, s[12:15], s31 offen lds
  s_mov_b32 s31, 0x118000
  s_add_u32 m0, s44, 68608
  s_nop 0
  buffer_load_dwordx4 v2, s[12:15], s31 offen lds
  s_mov_b32 s31, 0x100000
  s_add_u32 m0, s44, 114688
  s_nop 0
  buffer_load_dwordx4 v1, s[16:19], s31 offen lds
  s_mov_b32 s31, 0x108000
  s_add_u32 m0, s44, 115712
  s_nop 0
  buffer_load_dwordx4 v1, s[16:19], s31 offen lds
  s_mov_b32 s31, 0x110000
  s_add_u32 m0, s44, 116736
  s_nop 0
  buffer_load_dwordx4 v2, s[16:19], s31 offen lds
  s_mov_b32 s31, 0x118000
  s_add_u32 m0, s44, 117760
  s_nop 0
  buffer_load_dwordx4 v2, s[16:19], s31 offen lds
  s_cmp_lg_u32 s36, 0
  s_cbranch_scc1 L_ci_17
  s_waitcnt vmcnt(24)
  v_readfirstlane_b32 s62, v30
  s_barrier
  s_cmp_lg_u32 s24, 0
  s_cbranch_scc1 L_ci_17
  s_lshr_b32 s32, s2, 3
  s_lshl_b32 s31, 1, s32
  s_lshl_b32 s32, s39, 2
  v_mov_b32 v22, s31
  s_mov_b64 exec, 1
  buffer_atomic_or v22, off, s[8:11], s32 sc0 sc1
  s_mov_b64 exec, -1
L_ci_17:
  s_waitcnt vmcnt(20)
  s_barrier
  s_mov_b32 s31, 0x180000
  s_add_u32 m0, s44, 131072
  s_nop 0
  buffer_load_dwordx4 v1, s[12:15], s31 offen lds
  s_mov_b32 s31, 0x188000
  s_add_u32 m0, s44, 132096
  s_nop 0
  buffer_load_dwordx4 v1, s[12:15], s31 offen lds
  s_mov_b32 s31, 0x190000
  s_add_u32 m0, s44, 133120
  s_nop 0
  buffer_load_dwordx4 v2, s[12:15], s31 offen lds
  s_mov_b32 s31, 0x198000
  s_add_u32 m0, s44, 134144
  s_nop 0
  buffer_load_dwordx4 v2, s[12:15], s31 offen lds
  ds_read_b64_tr_b16 a[32:33], v3 offset:0
  ds_read_b64_tr_b16 a[34:35], v3 offset:1024
  ds_read_b64_tr_b16 a[36:37], v3 offset:8192
  ds_read_b64_tr_b16 a[38:39], v3 offset:9216
  ds_read_b64_tr_b16 a[40:41], v4 offset:0
  ds_read_b64_tr_b16 a[42:43], v4 offset:1024
  ds_read_b64_tr_b16 a[44:45], v4 offset:8192
  ds_read_b64_tr_b16 a[46:47], v4 offset:9216
  s_waitcnt lgkmcnt(0)
  s_waitcnt vmcnt(20)
  s_barrier
  s_mov_b32 s31, 0x180000
  s_add_u32 m0, s44, 0
  s_nop 0
  buffer_load_dwordx4 v1, s[16:19], s31 offen lds
  s_mov_b32 s31, 0x188000
  s_add_u32 m0, s44, 1024
  s_nop 0
  buffer_load_dwordx4 v1, s[16:19], s31 offen lds
  s_mov_b32 s31, 0x190000
  s_add_u32 m0, s44, 2048
  s_nop 0
  buffer_load_dwordx4 v2, s[16:19], s31 offen lds
  s_mov_b32 s31, 0x198000
  s_add_u32 m0, s44, 3072
  s_nop 0
  buffer_load_dwordx4 v2, s[16:19], s31 offen lds
  ds_read_b64_tr_b16 a[48:49], v3 offset:16384
  ds_read_b64_tr_b16 a[50:51], v3 offset:17408
  ds_read_b64_tr_b16 a[52:53], v3 offset:24576
  ds_read_b64_tr_b16 a[54:55], v3 offset:25600
  ds_read_b64_tr_b16 a[56:57], v4 offset:16384
  ds_read_b64_tr_b16 a[58:59], v4 offset:17408
  ds_read_b64_tr_b16 a[60:61], v4 offset:24576
  ds_read_b64_tr_b16 a[62:63], v4 offset:25600
  s_waitcnt lgkmcnt(0)
  s_waitcnt vmcnt(20)
  s_barrier
  s_mov_b32 s31, 0x200000
  s_add_u32 m0, s44, 16384
  s_nop 0
  buffer_load_dwordx4 v1, s[12:15], s31 offen lds
  s_mov_b32 s31, 0x208000
  s_add_u32 m0, s44, 17408
  s_nop 0
  buffer_load_dwordx4 v1, s[12:15], s31 offen lds
  s_mov_b32 s31, 0x210000
  s_add_u32 m0, s44, 18432
  s_nop 0
  buffer_load_dwordx4 v2, s[12:15], s31 offen lds
  s_mov_b32 s31, 0x218000
  s_add_u32 m0, s44, 19456
  s_nop 0
  buffer_load_dwordx4 v2, s[12:15], s31 offen lds
  ds_read_b64_tr_b16 a[64:65], v3 offset:32768
  ds_read_b64_tr_b16 a[66:67], v3 offset:33792
  ds_read_b64_tr_b16 a[68:69], v3 offset:40960
  ds_read_b64_tr_b16 a[70:71], v3 offset:41984
  ds_read_b64_tr_b16 a[72:73], v4 offset:32768
  ds_read_b64_tr_b16 a[74:75], v4 offset:33792
  ds_read_b64_tr_b16 a[76:77], v4 offset:40960
  ds_read_b64_tr_b16 a[78:79], v4 offset:41984
  s_waitcnt lgkmcnt(0)
  s_waitcnt vmcnt(20)
  s_barrier
  s_mov_b32 s31, 0x200000
  s_add_u32 m0, s44, 32768
  s_nop 0
  buffer_load_dwordx4 v1, s[16:19], s31 offen lds
  s_mov_b32 s31, 0x208000
  s_add_u32 m0, s44, 33792
  s_nop 0
  buffer_load_dwordx4 v1, s[16:19], s31 offen lds
  s_mov_b32 s31, 0x210000
  s_add_u32 m0, s44, 34816
  s_nop 0
  buffer_load_dwordx4 v2, s[16:19], s31 offen lds
  s_mov_b32 s31, 0x218000
  s_add_u32 m0, s44, 35840
  s_nop 0
  buffer_load_dwordx4 v2, s[16:19], s31 offen lds
  ds_read_b64_tr_b16 a[80:81], v3 offset:49152
  ds_read_b64_tr_b16 a[82:83], v3 offset:50176
  ds_read_b64_tr_b16 a[84:85], v3 offset:57344
  ds_read_b64_tr_b16 a[86:87], v3 offset:58368
  ds_read_b64_tr_b16 a[88:89], v4 offset:49152
  ds_read_b64_tr_b16 a[90:91], v4 offset:50176
  ds_read_b64_tr_b16 a[92:93], v4 offset:57344
  ds_read_b64_tr_b16 a[94:95], v4 offset:58368
  s_waitcnt lgkmcnt(0)
  s_waitcnt vmcnt(20)
  s_barrier
  s_mov_b32 s31, 0x280000
  s_add_u32 m0, s44, 49152
  s_nop 0
  buffer_load_dwordx4 v1, s[12:15], s31 offen lds
  s_mov_b32 s31, 0x288000
  s_add_u32 m0, s44, 50176
  s_nop 0
  buffer_load_dwordx4 v1, s[12:15], s31 offen lds
  s_mov_b32 s31, 0x290000
  s_add_u32 m0, s44, 51200
  s_nop 0
  buffer_load_dwordx4 v2, s[12:15], s31 offen lds
  s_mov_b32 s31, 0x298000
  s_add_u32 m0, s44, 52224
  s_nop 0
  buffer_load_dwordx4 v2, s[12:15], s31 offen lds
  ds_read_b64_tr_b16 a[96:97], v5 offset:0
  ds_read_b64_tr_b16 a[98:99], v5 offset:1024
  ds_read_b64_tr_b16 a[100:101], v5 offset:8192
  ds_read_b64_tr_b16 a[102:103], v5 offset:9216
  ds_read_b64_tr_b16 a[104:105], v6 offset:0
  ds_read_b64_tr_b16 a[106:107], v6 offset:1024
  ds_read_b64_tr_b16 a[108:109], v6 offset:8192
  ds_read_b64_tr_b16 a[110:111], v6 offset:9216
  s_waitcnt lgkmcnt(0)
  s_waitcnt vmcnt(20)
  s_barrier
  s_mov_b32 s31, 0x280000
  s_add_u32 m0, s44, 65536
  s_nop 0
  buffer_load_dwordx4 v1, s[16:19], s31 offen lds
  s_mov_b32 s31, 0x288000
  s_add_u32 m0, s44, 66560
  s_nop 0
  buffer_load_dwordx4 v1, s[16:19], s31 offen lds
  s_mov_b32 s31, 0x290000
  s_add_u32 m0, s44, 67584
  s_nop 0
  buffer_load_dwordx4 v2, s[16:19], s31 offen lds
  s_mov_b32 s31, 0x298000
  s_add_u32 m0, s44, 68608
  s_nop 0
  buffer_load_dwordx4 v2, s[16:19], s31 offen lds
  ds_read_b64_tr_b16 a[112:113], v5 offset:49152
  ds_read_b64_tr_b16 a[114:115], v5 offset:50176
  ds_read_b64_tr_b16 a[116:117], v5 offset:57344
  ds_read_b64_tr_b16 a[118:119], v5 offset:58368
  ds_read_b64_tr_b16 a[120:121], v6 offset:49152
  ds_read_b64_tr_b16 a[122:123], v6 offset:50176
  ds_read_b64_tr_b16 a[124:125], v6 offset:57344
  ds_read_b64_tr_b16 a[126:127], v6 offset:58368
  s_waitcnt lgkmcnt(0)
  s_waitcnt vmcnt(20)
  s_barrier
  s_mov_b32 s31, 0x300000
  s_add_u32 m0, s44, 114688
  s_nop 0
  buffer_load_dwordx4 v1, s[12:15], s31 offen lds
  s_mov_b32 s31, 0x308000
  s_add_u32 m0, s44, 115712
  s_nop 0
  buffer_load_dwordx4 v1, s[12:15], s31 offen lds
  s_mov_b32 s31, 0x310000
  s_add_u32 m0, s44, 116736
  s_nop 0
  buffer_load_dwordx4 v2, s[12:15], s31 offen lds
  s_mov_b32 s31, 0x318000
  s_add_u32 m0, s44, 117760
  s_nop 0
  buffer_load_dwordx4 v2, s[12:15], s31 offen lds
  ds_read_b64_tr_b16 a[128:129], v16 offset:0
  ds_read_b64_tr_b16 a[130:131], v16 offset:1024
  ds_read_b64_tr_b16 a[132:133], v16 offset:8192
  ds_read_b64_tr_b16 a[134:135], v16 offset:9216
  ds_read_b64_tr_b16 a[136:137], v17 offset:0
  ds_read_b64_tr_b16 a[138:139], v17 offset:1024
  ds_read_b64_tr_b16 a[140:141], v17 offset:8192
  ds_read_b64_tr_b16 a[142:143], v17 offset:9216
  s_waitcnt lgkmcnt(0)
  s_cmp_lg_u32 s36, 0
  s_cbranch_scc1 L_cf_18
  s_cmp_lg_u32 s24, 0
  s_cbranch_scc1 L_cf_19
  s_mov_b32 s37, s39
  s_lshr_b32 s38, s2, 3
  s_mov_b64 exec, 1
L_cf_20:
  v_readfirstlane_b32 s33, v22
  s_lshl_b32 s31, 1, s38
  s_and_b32 s34, s33, s31
  s_cbranch_scc0 L_cf_21
  s_not_b32 s33, s33
  s_cbranch_scc1 L_cf_23
  s_add_u32 s37, s37, 1
  s_and_b32 s37, s37, 7
  s_mov_b32 s31, 256
  s_cmp_eq_u32 s37, s39
  s_cbranch_scc1 L_cf_22
  s_lshl_b32 s33, 1, s38
L_cf_23:
  s_ff1_i32_b32 s38, s33
  s_lshl_b32 s31, 1, s38
  s_lshl_b32 s32, s37, 2
  v_mov_b32 v22, s31
  buffer_atomic_or v22, off, s[8:11], s32 sc0 sc1
  s_waitcnt vmcnt(0)
  s_branch L_cf_20
L_cf_21:
  s_or_b32 s33, s33, s31
  s_cmp_eq_u32 s33, -1
  s_cbranch_scc0 L_cf_24
  v_mov_b32 v22, 1
  buffer_atomic_add v22, off, s[8:11], 0 offset:128 sc0 sc1
  s_waitcnt vmcnt(0)
  v_readfirstlane_b32 s33, v22
  s_nop 0
  s_cmp_eq_u32 s33, 7
  s_cbranch_scc0 L_cf_24
  buffer_load_dwordx2 v[22:23], off, s[8:11], 0 offset:136 sc1
  s_waitcnt vmcnt(0)
  v_readfirstlane_b32 s33, v22
  v_readfirstlane_b32 s34, v23
  s_mov_b64 exec, 0xff
  s_mov_b32 s32, 0x408000
  v_lshlrev_b32 v23, 7, v0
  buffer_load_dword v22, v23, s[4:7], s32 offen sc1
  s_cmp_gt_u32 s34, s33
  s_cselect_b32 s33, 1, 0
  s_waitcnt vmcnt(0)
  v_add_u32 v22, 2, v22
  v_and_b32 v22, -2, v22
  v_or_b32 v22, s33, v22
  buffer_store_dword v22, v23, s[4:7], s32 offen sc1
  s_mov_b64 exec, 1
L_cf_24:
  s_lshl_b32 s31, s37, 5
  s_add_u32 s31, s31, s38
L_cf_22:
  v_mov_b32 v22, s31
  v_mov_b32 v23, 163836
  ds_write_b32 v23, v22
  s_waitcnt lgkmcnt(0)
  s_mov_b64 exec, -1
L_cf_19:
  s_barrier
  v_mov_b32 v23, 163836
  ds_read_b32 v22, v23
  s_mov_b32 s36, 1
  s_waitcnt lgkmcnt(0)
  v_readfirstlane_b32 s31, v22
  s_nop 0
  s_cmp_ge_u32 s31, 256
  s_cbranch_scc1 L_exit
  s_cmp_eq_u32 s31, s35
  s_cbranch_scc1 L_cf_18
  s_mov_b32 s35, s31
  s_waitcnt vmcnt(0)
  s_barrier
  s_branch L_dispatch
L_cf_18:
  s_waitcnt vmcnt(20)
  s_barrier
  s_mov_b32 s31, 0x300000
  s_add_u32 m0, s44, 131072
  s_nop 0
  buffer_load_dwordx4 v1, s[16:19], s31 offen lds
  s_mov_b32 s31, 0x308000
  s_add_u32 m0, s44, 132096
  s_nop 0
  buffer_load_dwordx4 v1, s[16:19], s31 offen lds
  s_mov_b32 s31, 0x310000
  s_add_u32 m0, s44, 133120
  s_nop 0
  buffer_load_dwordx4 v2, s[16:19], s31 offen lds
  s_mov_b32 s31, 0x318000
  s_add_u32 m0, s44, 134144
  s_nop 0
  buffer_load_dwordx4 v2, s[16:19], s31 offen lds
  ds_read_b64_tr_b16 a[144:145], v3 offset:0
  ds_read_b64_tr_b16 a[146:147], v3 offset:1024
  ds_read_b64_tr_b16 a[148:149], v3 offset:8192
  ds_read_b64_tr_b16 a[150:151], v3 offset:9216
  ds_read_b64_tr_b16 a[152:153], v4 offset:0
  ds_read_b64_tr_b16 a[154:155], v4 offset:1024
  ds_read_b64_tr_b16 a[156:157], v4 offset:8192
  ds_read_b64_tr_b16 a[158:159], v4 offset:9216
  s_waitcnt lgkmcnt(0)
  s_waitcnt vmcnt(20)
  s_barrier
  s_mov_b32 s31, 0x380000
  s_add_u32 m0, s44, 0
  s_nop 0
  buffer_load_dwordx4 v1, s[12:15], s31 offen lds
  s_mov_b32 s31, 0x388000
  s_add_u32 m0, s44, 1024
  s_nop 0
  buffer_load_dwordx4 v1, s[12:15], s31 offen lds
  s_mov_b32 s31, 0x390000
  s_add_u32 m0, s44, 2048
  s_nop 0
  buffer_load_dwordx4 v2, s[12:15], s31 offen lds
  s_mov_b32 s31, 0x398000
  s_add_u32 m0, s44, 3072
  s_nop 0
  buffer_load_dwordx4 v2, s[12:15], s31 offen lds
  ds_read_b64_tr_b16 v[96:97], v3 offset:16384
  ds_read_b64_tr_b16 v[98:99], v3 offset:17408
  ds_read_b64_tr_b16 v[100:101], v3 offset:24576
  ds_read_b64_tr_b16 v[102:103], v3 offset:25600
  ds_read_b64_tr_b16 v[104:105], v4 offset:16384
  ds_read_b64_tr_b16 v[106:107], v4 offset:17408
  ds_read_b64_tr_b16 v[108:109], v4 offset:24576
  ds_read_b64_tr_b16 v[110:111], v4 offset:25600
  s_waitcnt lgkmcnt(0)
  s_waitcnt vmcnt(20)
  s_barrier
  s_mov_b32 s31, 0x380000
  s_add_u32 m0, s44, 16384
  s_nop 0
  buffer_load_dwordx4 v1, s[16:19], s31 offen lds
  s_mov_b32 s31, 0x388000
  s_add_u32 m0, s44, 17408
  s_nop 0
  buffer_load_dwordx4 v1, s[16:19], s31 offen lds
  s_mov_b32 s31, 0x390000
  s_add_u32 m0, s44, 18432
  s_nop 0
  buffer_load_dwordx4 v2, s[16:19], s31 offen lds
  s_mov_b32 s31, 0x398000
  s_add_u32 m0, s44, 19456
  s_nop 0
  buffer_load_dwordx4 v2, s[16:19], s31 offen lds
  ds_read_b64_tr_b16 a[160:161], v3 offset:32768
  ds_read_b64_tr_b16 a[162:163], v3 offset:33792
  ds_read_b64_tr_b16 a[164:165], v3 offset:40960
  ds_read_b64_tr_b16 a[166:167], v3 offset:41984
  ds_read_b64_tr_b16 a[168:169], v4 offset:32768
  ds_read_b64_tr_b16 a[170:171], v4 offset:33792
  ds_read_b64_tr_b16 a[172:173], v4 offset:40960
  ds_read_b64_tr_b16 a[174:175], v4 offset:41984
  s_waitcnt lgkmcnt(0)
  s_waitcnt vmcnt(20)
  s_barrier
  s_mov_b32 s31, 0x400000
  s_add_u32 m0, s44, 32768
  s_nop 0
  buffer_load_dwordx4 v1, s[12:15], s31 offen lds
  s_mov_b32 s31, 0x408000
  s_add_u32 m0, s44, 33792
  s_nop 0
  buffer_load_dwordx4 v1, s[12:15], s31 offen lds
  s_mov_b32 s31, 0x410000
  s_add_u32 m0, s44, 34816
  s_nop 0
  buffer_load_dwordx4 v2, s[12:15], s31 offen lds
  s_mov_b32 s31, 0x418000
  s_add_u32 m0, s44, 35840
  s_nop 0
  buffer_load_dwordx4 v2, s[12:15], s31 offen lds
  ds_read_b64_tr_b16 a[176:177], v3 offset:49152
  ds_read_b64_tr_b16 a[178:179], v3 offset:50176
  ds_read_b64_tr_b16 a[180:181], v3 offset:57344
  ds_read_b64_tr_b16 a[182:183], v3 offset:58368
  ds_read_b64_tr_b16 a[184:185], v4 offset:49152
  ds_read_b64_tr_b16 a[186:187], v4 offset:50176
  ds_read_b64_tr_b16 a[188:189], v4 offset:57344
  ds_read_b64_tr_b16 a[190:191], v4 offset:58368
  s_waitcnt lgkmcnt(0)
  s_waitcnt vmcnt(20)
  s_barrier
  s_mov_b32 s31, 0x400000
  s_add_u32 m0, s44, 49152
  s_nop 0
  buffer_load_dwordx4 v1, s[16:19], s31 offen lds
  s_mov_b32 s31, 0x408000
  s_add_u32 m0, s44, 50176
  s_nop 0
  buffer_load_dwordx4 v1, s[16:19], s31 offen lds
  s_mov_b32 s31, 0x410000
  s_add_u32 m0, s44, 51200
  s_nop 0
  buffer_load_dwordx4 v2, s[16:19], s31 offen lds
  s_mov_b32 s31, 0x418000
  s_add_u32 m0, s44, 52224
  s_nop 0
  buffer_load_dwordx4 v2, s[16:19], s31 offen lds
  ds_read_b64_tr_b16 a[192:193], v5 offset:0
  ds_read_b64_tr_b16 a[194:195], v5 offset:1024
  ds_read_b64_tr_b16 a[196:197], v5 offset:8192
  ds_read_b64_tr_b16 a[198:199], v5 offset:9216
  ds_read_b64_tr_b16 a[200:201], v6 offset:0
  ds_read_b64_tr_b16 a[202:203], v6 offset:1024
  ds_read_b64_tr_b16 a[204:205], v6 offset:8192
  ds_read_b64_tr_b16 a[206:207], v6 offset:9216
  s_waitcnt lgkmcnt(0)
  s_waitcnt vmcnt(20)
  s_barrier
  s_mov_b32 s31, 0x480000
  s_add_u32 m0, s44, 65536
  s_nop 0
  buffer_load_dwordx4 v1, s[12:15], s31 offen lds
  s_mov_b32 s31, 0x488000
  s_add_u32 m0, s44, 66560
  s_nop 0
  buffer_load_dwordx4 v1, s[12:15], s31 offen lds
  s_mov_b32 s31, 0x490000
  s_add_u32 m0, s44, 67584
  s_nop 0
  buffer_load_dwordx4 v2, s[12:15], s31 offen lds
  s_mov_b32 s31, 0x498000
  s_add_u32 m0, s44, 68608
  s_nop 0
  buffer_load_dwordx4 v2, s[12:15], s31 offen lds
  ds_read_b64_tr_b16 v[8:9], v5 offset:49152
  ds_read_b64_tr_b16 v[10:11], v5 offset:50176
  ds_read_b64_tr_b16 v[12:13], v5 offset:57344
  ds_read_b64_tr_b16 v[14:15], v5 offset:58368
  ds_read_b64_tr_b16 v[24:25], v6 offset:49152
  ds_read_b64_tr_b16 v[26:27], v6 offset:50176
  ds_read_b64_tr_b16 v[28:29], v6 offset:57344
  ds_read_b64_tr_b16 v[30:31], v6 offset:58368
  s_waitcnt lgkmcnt(0)
  ds_write_b128 v7, v[8:11] offset:16384
  ds_write_b128 v7, v[12:15] offset:17408
  ds_write_b128 v7, v[24:27] offset:18432
  ds_write_b128 v7, v[28:31] offset:19456
  s_waitcnt lgkmcnt(0)
  s_waitcnt vmcnt(20)
  s_barrier
  s_mov_b32 s31, 0x480000
  s_add_u32 m0, s44, 114688
  s_nop 0
  buffer_load_dwordx4 v1, s[16:19], s31 offen lds
  s_mov_b32 s31, 0x488000
  s_add_u32 m0, s44, 115712
  s_nop 0
  buffer_load_dwordx4 v1, s[16:19], s31 offen lds
  s_mov_b32 s31, 0x490000
  s_add_u32 m0, s44, 116736
  s_nop 0
  buffer_load_dwordx4 v2, s[16:19], s31 offen lds
  s_mov_b32 s31, 0x498000
  s_add_u32 m0, s44, 117760
  s_nop 0
  buffer_load_dwordx4 v2, s[16:19], s31 offen lds
  ds_read_b64_tr_b16 a[208:209], v16 offset:0
  ds_read_b64_tr_b16 a[210:211], v16 offset:1024
  ds_read_b64_tr_b16 a[212:213], v16 offset:8192
  ds_read_b64_tr_b16 a[214:215], v16 offset:9216
  ds_read_b64_tr_b16 a[216:217], v17 offset:0
  ds_read_b64_tr_b16 a[218:219], v17 offset:1024
  ds_read_b64_tr_b16 a[220:221], v17 offset:8192
  ds_read_b64_tr_b16 a[222:223], v17 offset:9216
  s_waitcnt lgkmcnt(0)
  s_waitcnt vmcnt(20)
  s_barrier
  s_mov_b32 s31, 0x500000
  s_add_u32 m0, s44, 131072
  s_nop 0
  buffer_load_dwordx4 v1, s[12:15], s31 offen lds
  s_mov_b32 s31, 0x508000
  s_add_u32 m0, s44, 132096
  s_nop 0
  buffer_load_dwordx4 v1, s[12:15], s31 offen lds
  s_mov_b32 s31, 0x510000
  s_add_u32 m0, s44, 133120
  s_nop 0
  buffer_load_dwordx4 v2, s[12:15], s31 offen lds
  s_mov_b32 s31, 0x518000
  s_add_u32 m0, s44, 134144
  s_nop 0
  buffer_load_dwordx4 v2, s[12:15], s31 offen lds
  ds_read_b64_tr_b16 a[224:225], v3 offset:0
  ds_read_b64_tr_b16 a[226:227], v3 offset:1024
  ds_read_b64_tr_b16 a[228:229], v3 offset:8192
  ds_read_b64_tr_b16 a[230:231], v3 offset:9216
  ds_read_b64_tr_b16 a[232:233], v4 offset:0
  ds_read_b64_tr_b16 a[234:235], v4 offset:1024
  ds_read_b64_tr_b16 a[236:237], v4 offset:8192
  ds_read_b64_tr_b16 a[238:239], v4 offset:9216
  s_waitcnt lgkmcnt(0)
  s_waitcnt vmcnt(20)
  s_barrier
  s_mov_b32 s31, 0x500000
  s_add_u32 m0, s44, 0
  s_nop 0
  buffer_load_dwordx4 v1, s[16:19], s31 offen lds
  s_mov_b32 s31, 0x508000
  s_add_u32 m0, s44, 1024
  s_nop 0
  buffer_load_dwordx4 v1, s[16:19], s31 offen lds
  s_mov_b32 s31, 0x510000
  s_add_u32 m0, s44, 2048
  s_nop 0
  buffer_load_dwordx4 v2, s[16:19], s31 offen lds
  s_mov_b32 s31, 0x518000
  s_add_u32 m0, s44, 3072
  s_nop 0
  buffer_load_dwordx4 v2, s[16:19], s31 offen lds
  ds_read_b64_tr_b16 a[240:241], v3 offset:16384
  ds_read_b64_tr_b16 a[242:243], v3 offset:17408
  ds_read_b64_tr_b16 a[244:245], v3 offset:24576
  ds_read_b64_tr_b16 a[246:247], v3 offset:25600
  ds_read_b64_tr_b16 a[248:249], v4 offset:16384
  ds_read_b64_tr_b16 a[250:251], v4 offset:17408
  ds_read_b64_tr_b16 a[252:253], v4 offset:24576
  ds_read_b64_tr_b16 a[254:255], v4 offset:25600
  s_waitcnt lgkmcnt(0)
  s_waitcnt vmcnt(20)
  s_barrier
  s_mov_b32 s31, 0x580000
  s_add_u32 m0, s44, 16384
  s_nop 0
  buffer_load_dwordx4 v1, s[12:15], s31 offen lds
  s_mov_b32 s31, 0x588000
  s_add_u32 m0, s44, 17408
  s_nop 0
  buffer_load_dwordx4 v1, s[12:15], s31 offen lds
  s_mov_b32 s31, 0x590000
  s_add_u32 m0, s44, 18432
  s_nop 0
  buffer_load_dwordx4 v2, s[12:15], s31 offen lds
  s_mov_b32 s31, 0x598000
  s_add_u32 m0, s44, 19456
  s_nop 0
  buffer_load_dwordx4 v2, s[12:15], s31 offen lds
  ds_read_b64_tr_b16 v[32:33], v3 offset:32768
  ds_read_b64_tr_b16 v[34:35], v3 offset:33792
  ds_read_b64_tr_b16 v[36:37], v3 offset:40960
  ds_read_b64_tr_b16 v[38:39], v3 offset:41984
  ds_read_b64_tr_b16 v[40:41], v4 offset:32768
  ds_read_b64_tr_b16 v[42:43], v4 offset:33792
  ds_read_b64_tr_b16 v[44:45], v4 offset:40960
  ds_read_b64_tr_b16 v[46:47], v4 offset:41984
  s_waitcnt lgkmcnt(0)
  s_waitcnt vmcnt(20)
  s_barrier
  s_mov_b32 s31, 0x580000
  s_add_u32 m0, s44, 32768
  s_nop 0
  buffer_load_dwordx4 v1, s[16:19], s31 offen lds
  s_mov_b32 s31, 0x588000
  s_add_u32 m0, s44, 33792
  s_nop 0
  buffer_load_dwordx4 v1, s[16:19], s31 offen lds
  s_mov_b32 s31, 0x590000
  s_add_u32 m0, s44, 34816
  s_nop 0
  buffer_load_dwordx4 v2, s[16:19], s31 offen lds
  s_mov_b32 s31, 0x598000
  s_add_u32 m0, s44, 35840
  s_nop 0
  buffer_load_dwordx4 v2, s[16:19], s31 offen lds
  ds_read_b64_tr_b16 v[48:49], v3 offset:49152
  ds_read_b64_tr_b16 v[50:51], v3 offset:50176
  ds_read_b64_tr_b16 v[52:53], v3 offset:57344
  ds_read_b64_tr_b16 v[54:55], v3 offset:58368
  ds_read_b64_tr_b16 v[56:57], v4 offset:49152
  ds_read_b64_tr_b16 v[58:59], v4 offset:50176
  ds_read_b64_tr_b16 v[60:61], v4 offset:57344
  ds_read_b64_tr_b16 v[62:63], v4 offset:58368
  s_waitcnt lgkmcnt(0)
  s_waitcnt vmcnt(20)
  s_barrier
  s_mov_b32 s31, 0x600000
  s_add_u32 m0, s44, 49152
  s_nop 0
  buffer_load_dwordx4 v1, s[12:15], s31 offen lds
  s_mov_b32 s31, 0x608000
  s_add_u32 m0, s44, 50176
  s_nop 0
  buffer_load_dwordx4 v1, s[12:15], s31 offen lds
  s_mov_b32 s31, 0x610000
  s_add_u32 m0, s44, 51200
  s_nop 0
  buffer_load_dwordx4 v2, s[12:15], s31 offen lds
  s_mov_b32 s31, 0x618000
  s_add_u32 m0, s44, 52224
  s_nop 0
  buffer_load_dwordx4 v2, s[12:15], s31 offen lds
  ds_read_b64_tr_b16 v[64:65], v5 offset:0
  ds_read_b64_tr_b16 v[66:67], v5 offset:1024
  ds_read_b64_tr_b16 v[68:69], v5 offset:8192
  ds_read_b64_tr_b16 v[70:71], v5 offset:9216
  ds_read_b64_tr_b16 v[72:73], v6 offset:0
  ds_read_b64_tr_b16 v[74:75], v6 offset:1024
  ds_read_b64_tr_b16 v[76:77], v6 offset:8192
  ds_read_b64_tr_b16 v[78:79], v6 offset:9216
  s_waitcnt lgkmcnt(0)
  s_waitcnt vmcnt(20)
  s_barrier
  s_mov_b32 s31, 0x600000
  s_add_u32 m0, s44, 65536
  s_nop 0
  buffer_load_dwordx4 v1, s[16:19], s31 offen lds
  s_mov_b32 s31, 0x608000
  s_add_u32 m0, s44, 66560
  s_nop 0
  buffer_load_dwordx4 v1, s[16:19], s31 offen lds
  s_mov_b32 s31, 0x610000
  s_add_u32 m0, s44, 67584
  s_nop 0
  buffer_load_dwordx4 v2, s[16:19], s31 offen lds
  s_mov_b32 s31, 0x618000
  s_add_u32 m0, s44, 68608
  s_nop 0
  buffer_load_dwordx4 v2, s[16:19], s31 offen lds
  ds_read_b64_tr_b16 v[80:81], v5 offset:49152
  ds_read_b64_tr_b16 v[82:83], v5 offset:50176
  ds_read_b64_tr_b16 v[84:85], v5 offset:57344
  ds_read_b64_tr_b16 v[86:87], v5 offset:58368
  ds_read_b64_tr_b16 v[88:89], v6 offset:49152
  ds_read_b64_tr_b16 v[90:91], v6 offset:50176
  ds_read_b64_tr_b16 v[92:93], v6 offset:57344
  ds_read_b64_tr_b16 v[94:95], v6 offset:58368
  s_waitcnt lgkmcnt(0)
  s_waitcnt vmcnt(20)
  s_barrier
  s_mov_b32 s31, 0x680000
  s_add_u32 m0, s44, 114688
  s_nop 0
  buffer_load_dwordx4 v1, s[12:15], s31 offen lds
  s_mov_b32 s31, 0x688000
  s_add_u32 m0, s44, 115712
  s_nop 0
  buffer_load_dwordx4 v1, s[12:15], s31 offen lds
  s_mov_b32 s31, 0x690000
  s_add_u32 m0, s44, 116736
  s_nop 0
  buffer_load_dwordx4 v2, s[12:15], s31 offen lds
  s_mov_b32 s31, 0x698000
  s_add_u32 m0, s44, 117760
  s_nop 0
  buffer_load_dwordx4 v2, s[12:15], s31 offen lds
  ds_read_b64_tr_b16 v[112:113], v16 offset:0
  ds_read_b64_tr_b16 v[114:115], v16 offset:1024
  ds_read_b64_tr_b16 v[116:117], v16 offset:8192
  ds_read_b64_tr_b16 v[118:119], v16 offset:9216
  ds_read_b64_tr_b16 v[120:121], v17 offset:0
  ds_read_b64_tr_b16 v[122:123], v17 offset:1024
  ds_read_b64_tr_b16 v[124:125], v17 offset:8192
  ds_read_b64_tr_b16 v[126:127], v17 offset:9216
  s_waitcnt lgkmcnt(0)
  s_waitcnt vmcnt(20)
  s_barrier
  s_mov_b32 s31, 0x680000
  s_add_u32 m0, s44, 131072
  s_nop 0
  buffer_load_dwordx4 v1, s[16:19], s31 offen lds
  s_mov_b32 s31, 0x688000
  s_add_u32 m0, s44, 132096
  s_nop 0
  buffer_load_dwordx4 v1, s[16:19], s31 offen lds
  s_mov_b32 s31, 0x690000
  s_add_u32 m0, s44, 133120
  s_nop 0
  buffer_load_dwordx4 v2, s[16:19], s31 offen lds
  s_mov_b32 s31, 0x698000
  s_add_u32 m0, s44, 134144
  s_nop 0
  buffer_load_dwordx4 v2, s[16:19], s31 offen lds
  ds_read_b64_tr_b16 v[128:129], v3 offset:0
  ds_read_b64_tr_b16 v[130:131], v3 offset:1024
  ds_read_b64_tr_b16 v[132:133], v3 offset:8192
  ds_read_b64_tr_b16 v[134:135], v3 offset:9216
  ds_read_b64_tr_b16 v[136:137], v4 offset:0
  ds_read_b64_tr_b16 v[138:139], v4 offset:1024
  ds_read_b64_tr_b16 v[140:141], v4 offset:8192
  ds_read_b64_tr_b16 v[142:143], v4 offset:9216
  s_waitcnt lgkmcnt(0)
  s_waitcnt vmcnt(20)
  s_barrier
  s_mov_b32 s31, 0x700000
  s_add_u32 m0, s44, 0
  s_nop 0
  buffer_load_dwordx4 v1, s[12:15], s31 offen lds
  s_mov_b32 s31, 0x708000
  s_add_u32 m0, s44, 1024
  s_nop 0
  buffer_load_dwordx4 v1, s[12:15], s31 offen lds
  s_mov_b32 s31, 0x710000
  s_add_u32 m0, s44, 2048
  s_nop 0
  buffer_load_dwordx4 v2, s[12:15], s31 offen lds
  s_mov_b32 s31, 0x718000
  s_add_u32 m0, s44, 3072
  s_nop 0
  buffer_load_dwordx4 v2, s[12:15], s31 offen lds
  ds_read_b64_tr_b16 v[144:145], v3 offset:16384
  ds_read_b64_tr_b16 v[146:147], v3 offset:17408
  ds_read_b64_tr_b16 v[148:149], v3 offset:24576
  ds_read_b64_tr_b16 v[150:151], v3 offset:25600
  ds_read_b64_tr_b16 v[152:153], v4 offset:16384
  ds_read_b64_tr_b16 v[154:155], v4 offset:17408
  ds_read_b64_tr_b16 v[156:157], v4 offset:24576
  ds_read_b64_tr_b16 v[158:159], v4 offset:25600
  s_waitcnt lgkmcnt(0)
  s_waitcnt vmcnt(20)
  s_barrier
  s_mov_b32 s31, 0x700000
  s_add_u32 m0, s44, 16384
  s_nop 0
  buffer_load_dwordx4 v1, s[16:19], s31 offen lds
  s_mov_b32 s31, 0x708000
  s_add_u32 m0, s44, 17408
  s_nop 0
  buffer_load_dwordx4 v1, s[16:19], s31 offen lds
  s_mov_b32 s31, 0x710000
  s_add_u32 m0, s44, 18432
  s_nop 0
  buffer_load_dwordx4 v2, s[16:19], s31 offen lds
  s_mov_b32 s31, 0x718000
  s_add_u32 m0, s44, 19456
  s_nop 0
  buffer_load_dwordx4 v2, s[16:19], s31 offen lds
  ds_read_b64_tr_b16 v[160:161], v3 offset:32768
  ds_read_b64_tr_b16 v[162:163], v3 offset:33792
  ds_read_b64_tr_b16 v[164:165], v3 offset:40960
  ds_read_b64_tr_b16 v[166:167], v3 offset:41984
  ds_read_b64_tr_b16 v[168:169], v4 offset:32768
  ds_read_b64_tr_b16 v[170:171], v4 offset:33792
  ds_read_b64_tr_b16 v[172:173], v4 offset:40960
  ds_read_b64_tr_b16 v[174:175], v4 offset:41984
  s_waitcnt lgkmcnt(0)
  s_waitcnt vmcnt(20)
  s_barrier
  s_mov_b32 s31, 0x780000
  s_add_u32 m0, s44, 32768
  s_nop 0
  buffer_load_dwordx4 v1, s[12:15], s31 offen lds
  s_mov_b32 s31, 0x788000
  s_add_u32 m0, s44, 33792
  s_nop 0
  buffer_load_dwordx4 v1, s[12:15], s31 offen lds
  s_mov_b32 s31, 0x790000
  s_add_u32 m0, s44, 34816
  s_nop 0
  buffer_load_dwordx4 v2, s[12:15], s31 offen lds
  s_mov_b32 s31, 0x798000
  s_add_u32 m0, s44, 35840
  s_nop 0
  buffer_load_dwordx4 v2, s[12:15], s31 offen lds
  ds_read_b64_tr_b16 v[176:177], v3 offset:49152
  ds_read_b64_tr_b16 v[178:179], v3 offset:50176
  ds_read_b64_tr_b16 v[180:181], v3 offset:57344
  ds_read_b64_tr_b16 v[182:183], v3 offset:58368
  ds_read_b64_tr_b16 v[184:185], v4 offset:49152
  ds_read_b64_tr_b16 v[186:187], v4 offset:50176
  ds_read_b64_tr_b16 v[188:189], v4 offset:57344
  ds_read_b64_tr_b16 v[190:191], v4 offset:58368
  s_waitcnt lgkmcnt(0)
  s_waitcnt vmcnt(20)
  s_barrier
  s_mov_b32 s31, 0x780000
  s_add_u32 m0, s44, 49152
  s_nop 0
  buffer_load_dwordx4 v1, s[16:19], s31 offen lds
  s_mov_b32 s31, 0x788000
  s_add_u32 m0, s44, 50176
  s_nop 0
  buffer_load_dwordx4 v1, s[16:19], s31 offen lds
  s_mov_b32 s31, 0x790000
  s_add_u32 m0, s44, 51200
  s_nop 0
  buffer_load_dwordx4 v2, s[16:19], s31 offen lds
  s_mov_b32 s31, 0x798000
  s_add_u32 m0, s44, 52224
  s_nop 0
  buffer_load_dwordx4 v2, s[16:19], s31 offen lds
  ds_read_b64_tr_b16 v[192:193], v5 offset:0
  ds_read_b64_tr_b16 v[194:195], v5 offset:1024
  ds_read_b64_tr_b16 v[196:197], v5 offset:8192
  ds_read_b64_tr_b16 v[198:199], v5 offset:9216
  ds_read_b64_tr_b16 v[200:201], v6 offset:0
  ds_read_b64_tr_b16 v[202:203], v6 offset:1024
  ds_read_b64_tr_b16 v[204:205], v6 offset:8192
  ds_read_b64_tr_b16 v[206:207], v6 offset:9216
  s_waitcnt lgkmcnt(0)
  s_waitcnt vmcnt(20)
  s_barrier
  ds_read_b64_tr_b16 v[208:209], v5 offset:49152
  ds_read_b64_tr_b16 v[210:211], v5 offset:50176
  ds_read_b64_tr_b16 v[212:213], v5 offset:57344
  ds_read_b64_tr_b16 v[214:215], v5 offset:58368
  ds_read_b64_tr_b16 v[216:217], v6 offset:49152
  ds_read_b64_tr_b16 v[218:219], v6 offset:50176
  ds_read_b64_tr_b16 v[220:221], v6 offset:57344
  ds_read_b64_tr_b16 v[222:223], v6 offset:58368
  s_waitcnt lgkmcnt(0)
  s_waitcnt vmcnt(16)
  s_barrier
  ds_read_b64_tr_b16 v[224:225], v16 offset:0
  ds_read_b64_tr_b16 v[226:227], v16 offset:1024
  ds_read_b64_tr_b16 v[228:229], v16 offset:8192
  ds_read_b64_tr_b16 v[230:231], v16 offset:9216
  ds_read_b64_tr_b16 v[232:233], v17 offset:0
  ds_read_b64_tr_b16 v[234:235], v17 offset:1024
  ds_read_b64_tr_b16 v[236:237], v17 offset:8192
  ds_read_b64_tr_b16 v[238:239], v17 offset:9216
  s_waitcnt lgkmcnt(0)
  s_waitcnt vmcnt(12)
  s_barrier
  ds_read_b64_tr_b16 v[240:241], v3 offset:0
  ds_read_b64_tr_b16 v[242:243], v3 offset:1024
  ds_read_b64_tr_b16 v[244:245], v3 offset:8192
  ds_read_b64_tr_b16 v[246:247], v3 offset:9216
  ds_read_b64_tr_b16 v[248:249], v4 offset:0
  ds_read_b64_tr_b16 v[250:251], v4 offset:1024
  ds_read_b64_tr_b16 v[252:253], v4 offset:8192
  ds_read_b64_tr_b16 v[254:255], v4 offset:9216
  s_waitcnt lgkmcnt(0)
  s_waitcnt vmcnt(8)
  s_barrier
  ds_read_b64_tr_b16 a[0:1], v3 offset:16384
  ds_read_b64_tr_b16 a[2:3], v3 offset:17408
  ds_read_b64_tr_b16 a[4:5], v3 offset:24576
  ds_read_b64_tr_b16 a[6:7], v3 offset:25600
  ds_read_b64_tr_b16 a[8:9], v4 offset:16384
  ds_read_b64_tr_b16 a[10:11], v4 offset:17408
  ds_read_b64_tr_b16 a[12:13], v4 offset:24576
  ds_read_b64_tr_b16 a[14:15], v4 offset:25600
  s_waitcnt lgkmcnt(0)
  s_waitcnt vmcnt(4)
  s_barrier
  ds_read_b64_tr_b16 a[16:17], v3 offset:32768
  ds_read_b64_tr_b16 a[18:19], v3 offset:33792
  ds_read_b64_tr_b16 a[20:21], v3 offset:40960
  ds_read_b64_tr_b16 a[22:23], v3 offset:41984
  ds_read_b64_tr_b16 a[24:25], v4 offset:32768
  ds_read_b64_tr_b16 a[26:27], v4 offset:33792
  ds_read_b64_tr_b16 a[28:29], v4 offset:40960
  ds_read_b64_tr_b16 a[30:31], v4 offset:41984
  s_waitcnt lgkmcnt(0)
  s_waitcnt vmcnt(0)
  s_barrier
  ds_read_b64_tr_b16 v[8:9], v3 offset:49152
  ds_read_b64_tr_b16 v[10:11], v3 offset:50176
  ds_read_b64_tr_b16 v[12:13], v3 offset:57344
  ds_read_b64_tr_b16 v[14:15], v3 offset:58368
  ds_read_b64_tr_b16 v[24:25], v4 offset:49152
  ds_read_b64_tr_b16 v[26:27], v4 offset:50176
  ds_read_b64_tr_b16 v[28:29], v4 offset:57344
  ds_read_b64_tr_b16 v[30:31], v4 offset:58368
  s_waitcnt lgkmcnt(0)
  ds_write_b128 v7, v[8:11] offset:32768
  ds_write_b128 v7, v[12:15] offset:33792
  ds_write_b128 v7, v[24:27] offset:34816
  ds_write_b128 v7, v[28:31] offset:35840
  s_waitcnt lgkmcnt(0)
  s_branch L_A_lddone
L_A_ld3:
  s_mov_b32 s31, 0x0
  s_add_u32 m0, s44, 0
  s_nop 0
  buffer_load_dwordx4 v1, s[12:15], s31 offen lds
  s_mov_b32 s31, 0x8000
  s_add_u32 m0, s44, 1024
  s_nop 0
  buffer_load_dwordx4 v1, s[12:15], s31 offen lds
  s_mov_b32 s31, 0x10000
  s_add_u32 m0, s44, 2048
  s_nop 0
  buffer_load_dwordx4 v2, s[12:15], s31 offen lds
  s_mov_b32 s31, 0x18000
  s_add_u32 m0, s44, 3072
  s_nop 0
  buffer_load_dwordx4 v2, s[12:15], s31 offen lds
  s_mov_b32 s31, 0x0
  s_add_u32 m0, s44, 16384
  s_nop 0
  buffer_load_dwordx4 v1, s[16:19], s31 offen lds
  s_mov_b32 s31, 0x8000
  s_add_u32 m0, s44, 17408
  s_nop 0
  buffer_load_dwordx4 v1, s[16:19], s31 offen lds
  s_mov_b32 s31, 0x10000
  s_add_u32 m0, s44, 18432
  s_nop 0
  buffer_load_dwordx4 v2, s[16:19], s31 offen lds
  s_mov_b32 s31, 0x18000
  s_add_u32 m0, s44, 19456
  s_nop 0
  buffer_load_dwordx4 v2, s[16:19], s31 offen lds
  s_mov_b32 s31, 0x80000
  s_add_u32 m0, s44, 32768
  s_nop 0
  buffer_load_dwordx4 v1, s[12:15], s31 offen lds
  s_mov_b32 s31, 0x88000
  s_add_u32 m0, s44, 33792
  s_nop 0
  buffer_load_dwordx4 v1, s[12:15], s31 offen lds
  s_mov_b32 s31, 0x90000
  s_add_u32 m0, s44, 34816
  s_nop 0
  buffer_load_dwordx4 v2, s[12:15], s31 offen lds
  s_mov_b32 s31, 0x98000
  s_add_u32 m0, s44, 35840
  s_nop 0
  buffer_load_dwordx4 v2, s[12:15], s31 offen lds
  s_mov_b32 s31, 0x80000
  s_add_u32 m0, s44, 49152
  s_nop 0
  buffer_load_dwordx4 v1, s[16:19], s31 offen lds
  s_mov_b32 s31, 0x88000
  s_add_u32 m0, s44, 50176
  s_nop 0
  buffer_load_dwordx4 v1, s[16:19], s31 offen lds
  s_mov_b32 s31, 0x90000
  s_add_u32 m0, s44, 51200
  s_nop 0
  buffer_load_dwordx4 v2, s[16:19], s31 offen lds
  s_mov_b32 s31, 0x98000
  s_add_u32 m0, s44, 52224
  s_nop 0
  buffer_load_dwordx4 v2, s[16:19], s31 offen lds
  s_mov_b32 s31, 0x100000
  s_add_u32 m0, s44, 65536
  s_nop 0
  buffer_load_dwordx4 v1, s[12:15], s31 offen lds
  s_mov_b32 s31, 0x108000
  s_add_u32 m0, s44, 66560
  s_nop 0
  buffer_load_dwordx4 v1, s[12:15], s31 offen lds
  s_mov_b32 s31, 0x110000
  s_add_u32 m0, s44, 67584
  s_nop 0
  buffer_load_dwordx4 v2, s[12:15], s31 offen lds
  s_mov_b32 s31, 0x118000
  s_add_u32 m0, s44, 68608
  s_nop 0
  buffer_load_dwordx4 v2, s[12:15], s31 offen lds
  s_mov_b32 s31, 0x100000
  s_add_u32 m0, s44, 114688
  s_nop 0
  buffer_load_dwordx4 v1, s[16:19], s31 offen lds
  s_mov_b32 s31, 0x108000
  s_add_u32 m0, s44, 115712
  s_nop 0
  buffer_load_dwordx4 v1, s[16:19], s31 offen lds
  s_mov_b32 s31, 0x110000
  s_add_u32 m0, s44, 116736
  s_nop 0
  buffer_load_dwordx4 v2, s[16:19], s31 offen lds
  s_mov_b32 s31, 0x118000
  s_add_u32 m0, s44, 117760
  s_nop 0
  buffer_load_dwordx4 v2, s[16:19], s31 offen lds
  s_cmp_lg_u32 s36, 0
  s_cbranch_scc1 L_ci_25
  s_waitcnt vmcnt(24)
  v_readfirstlane_b32 s62, v30
  s_barrier
  s_cmp_lg_u32 s24, 0
  s_cbranch_scc1 L_ci_25
  s_lshr_b32 s32, s2, 3
  s_lshl_b32 s31, 1, s32
  s_lshl_b32 s32, s39, 2
  v_mov_b32 v22, s31
  s_mov_b64 exec, 1
  buffer_atomic_or v22, off, s[8:11], s32 sc0 sc1
  s_mov_b64 exec, -1
L_ci_25:
  s_waitcnt vmcnt(20)
  s_barrier
  s_mov_b32 s31, 0x180000
  s_add_u32 m0, s44, 131072
  s_nop 0
  buffer_load_dwordx4 v1, s[12:15], s31 offen lds
  s_mov_b32 s31, 0x188000
  s_add_u32 m0, s44, 132096
  s_nop 0
  buffer_load_dwordx4 v1, s[12:15], s31 offen lds
  s_mov_b32 s31, 0x190000
  s_add_u32 m0, s44, 133120
  s_nop 0
  buffer_load_dwordx4 v2, s[12:15], s31 offen lds
  s_mov_b32 s31, 0x198000
  s_add_u32 m0, s44, 134144
  s_nop 0
  buffer_load_dwordx4 v2, s[12:15], s31 offen lds
  ds_read_b64_tr_b16 v[176:177], v3 offset:0
  ds_read_b64_tr_b16 v[178:179], v3 offset:1024
  ds_read_b64_tr_b16 v[180:181], v3 offset:8192
  ds_read_b64_tr_b16 v[182:183], v3 offset:9216
  ds_read_b64_tr_b16 v[184:185], v4 offset:0
  ds_read_b64_tr_b16 v[186:187], v4 offset:1024
  ds_read_b64_tr_b16 v[188:189], v4 offset:8192
  ds_read_b64_tr_b16 v[190:191], v4 offset:9216
  s_waitcnt lgkmcnt(0)
  s_waitcnt vmcnt(20)
  s_barrier
  s_mov_b32 s31, 0x180000
  s_add_u32 m0, s44, 0
  s_nop 0
  buffer_load_dwordx4 v1, s[16:19], s31 offen lds
  s_mov_b32 s31, 0x188000
  s_add_u32 m0, s44, 1024
  s_nop 0
  buffer_load_dwordx4 v1, s[16:19], s31 offen lds
  s_mov_b32 s31, 0x190000
  s_add_u32 m0, s44, 2048
  s_nop 0
  buffer_load_dwordx4 v2, s[16:19], s31 offen lds
  s_mov_b32 s31, 0x198000
  s_add_u32 m0, s44, 3072
  s_nop 0
  buffer_load_dwordx4 v2, s[16:19], s31 offen lds
  ds_read_b64_tr_b16 v[192:193], v3 offset:16384
  ds_read_b64_tr_b16 v[194:195], v3 offset:17408
  ds_read_b64_tr_b16 v[196:197], v3 offset:24576
  ds_read_b64_tr_b16 v[198:199], v3 offset:25600
  ds_read_b64_tr_b16 v[200:201], v4 offset:16384
  ds_read_b64_tr_b16 v[202:203], v4 offset:17408
  ds_read_b64_tr_b16 v[204:205], v4 offset:24576
  ds_read_b64_tr_b16 v[206:207], v4 offset:25600
  s_waitcnt lgkmcnt(0)
  s_waitcnt vmcnt(20)
  s_barrier
  s_mov_b32 s31, 0x200000
  s_add_u32 m0, s44, 16384
  s_nop 0
  buffer_load_dwordx4 v1, s[12:15], s31 offen lds
  s_mov_b32 s31, 0x208000
  s_add_u32 m0, s44, 17408
  s_nop 0
  buffer_load_dwordx4 v1, s[12:15], s31 offen lds
  s_mov_b32 s31, 0x210000
  s_add_u32 m0, s44, 18432
  s_nop 0
  buffer_load_dwordx4 v2, s[12:15], s31 offen lds
  s_mov_b32 s31, 0x218000
  s_add_u32 m0, s44, 19456
  s_nop 0
  buffer_load_dwordx4 v2, s[12:15], s31 offen lds
  ds_read_b64_tr_b16 v[208:209], v3 offset:32768
  ds_read_b64_tr_b16 v[210:211], v3 offset:33792
  ds_read_b64_tr_b16 v[212:213], v3 offset:40960
  ds_read_b64_tr_b16 v[214:215], v3 offset:41984
  ds_read_b64_tr_b16 v[216:217], v4 offset:32768
  ds_read_b64_tr_b16 v[218:219], v4 offset:33792
  ds_read_b64_tr_b16 v[220:221], v4 offset:40960
  ds_read_b64_tr_b16 v[222:223], v4 offset:41984
  s_waitcnt lgkmcnt(0)
  s_waitcnt vmcnt(20)
  s_barrier
  s_mov_b32 s31, 0x200000
  s_add_u32 m0, s44, 32768
  s_nop 0
  buffer_load_dwordx4 v1, s[16:19], s31 offen lds
  s_mov_b32 s31, 0x208000
  s_add_u32 m0, s44, 33792
  s_nop 0
  buffer_load_dwordx4 v1, s[16:19], s31 offen lds
  s_mov_b32 s31, 0x210000
  s_add_u32 m0, s44, 34816
  s_nop 0
  buffer_load_dwordx4 v2, s[16:19], s31 offen lds
  s_mov_b32 s31, 0x218000
  s_add_u32 m0, s44, 35840
  s_nop 0
  buffer_load_dwordx4 v2, s[16:19], s31 offen lds
  ds_read_b64_tr_b16 v[224:225], v3 offset:49152
  ds_read_b64_tr_b16 v[226:227], v3 offset:50176
  ds_read_b64_tr_b16 v[228:229], v3 offset:57344
  ds_read_b64_tr_b16 v[230:231], v3 offset:58368
  ds_read_b64_tr_b16 v[232:233], v4 offset:49152
  ds_read_b64_tr_b16 v[234:235], v4 offset:50176
  ds_read_b64_tr_b16 v[236:237], v4 offset:57344
  ds_read_b64_tr_b16 v[238:239], v4 offset:58368
  s_waitcnt lgkmcnt(0)
  s_waitcnt vmcnt(20)
  s_barrier
  s_mov_b32 s31, 0x280000
  s_add_u32 m0, s44, 49152
  s_nop 0
  buffer_load_dwordx4 v1, s[12:15], s31 offen lds
  s_mov_b32 s31, 0x288000
  s_add_u32 m0, s44, 50176
  s_nop 0
  buffer_load_dwordx4 v1, s[12:15], s31 offen lds
  s_mov_b32 s31, 0x290000
  s_add_u32 m0, s44, 51200
  s_nop 0
  buffer_load_dwordx4 v2, s[12:15], s31 offen lds
  s_mov_b32 s31, 0x298000
  s_add_u32 m0, s44, 52224
  s_nop 0
  buffer_load_dwordx4 v2, s[12:15], s31 offen lds
  ds_read_b64_tr_b16 v[240:241], v5 offset:0
  ds_read_b64_tr_b16 v[242:243], v5 offset:1024
  ds_read_b64_tr_b16 v[244:245], v5 offset:8192
  ds_read_b64_tr_b16 v[246:247], v5 offset:9216
  ds_read_b64_tr_b16 v[248:249], v6 offset:0
  ds_read_b64_tr_b16 v[250:251], v6 offset:1024
  ds_read_b64_tr_b16 v[252:253], v6 offset:8192
  ds_read_b64_tr_b16 v[254:255], v6 offset:9216
  s_waitcnt lgkmcnt(0)
  s_waitcnt vmcnt(20)
  s_barrier
  s_mov_b32 s31, 0x280000
  s_add_u32 m0, s44, 65536
  s_nop 0
  buffer_load_dwordx4 v1, s[16:19], s31 offen lds
  s_mov_b32 s31, 0x288000
  s_add_u32 m0, s44, 66560
  s_nop 0
  buffer_load_dwordx4 v1, s[16:19], s31 offen lds
  s_mov_b32 s31, 0x290000
  s_add_u32 m0, s44, 67584
  s_nop 0
  buffer_load_dwordx4 v2, s[16:19], s31 offen lds
  s_mov_b32 s31, 0x298000
  s_add_u32 m0, s44, 68608
  s_nop 0
  buffer_load_dwordx4 v2, s[16:19], s31 offen lds
  ds_read_b64_tr_b16 a[0:1], v5 offset:49152
  ds_read_b64_tr_b16 a[2:3], v5 offset:50176
  ds_read_b64_tr_b16 a[4:5], v5 offset:57344
  ds_read_b64_tr_b16 a[6:7], v5 offset:58368
  ds_read_b64_tr_b16 a[8:9], v6 offset:49152
  ds_read_b64_tr_b16 a[10:11], v6 offset:50176
  ds_read_b64_tr_b16 a[12:13], v6 offset:57344
  ds_read_b64_tr_b16 a[14:15], v6 offset:58368
  s_waitcnt lgkmcnt(0)
  s_waitcnt vmcnt(20)
  s_barrier
  s_mov_b32 s31, 0x300000
  s_add_u32 m0, s44, 114688
  s_nop 0
  buffer_load_dwordx4 v1, s[12:15], s31 offen lds
  s_mov_b32 s31, 0x308000
  s_add_u32 m0, s44, 115712
  s_nop 0
  buffer_load_dwordx4 v1, s[12:15], s31 offen lds
  s_mov_b32 s31, 0x310000
  s_add_u32 m0, s44, 116736
  s_nop 0
  buffer_load_dwordx4 v2, s[12:15], s31 offen lds
  s_mov_b32 s31, 0x318000
  s_add_u32 m0, s44, 117760
  s_nop 0
  buffer_load_dwordx4 v2, s[12:15], s31 offen lds
  ds_read_b64_tr_b16 a[16:17], v16 offset:0
  ds_read_b64_tr_b16 a[18:19], v16 offset:1024
  ds_read_b64_tr_b16 a[20:21], v16 offset:8192
  ds_read_b64_tr_b16 a[22:23], v16 offset:9216
  ds_read_b64_tr_b16 a[24:25], v17 offset:0
  ds_read_b64_tr_b16 a[26:27], v17 offset:1024
  ds_read_b64_tr_b16 a[28:29], v17 offset:8192
  ds_read_b64_tr_b16 a[30:31], v17 offset:9216
  s_waitcnt lgkmcnt(0)
  s_cmp_lg_u32 s36, 0
  s_cbranch_scc1 L_cf_26
  s_cmp_lg_u32 s24, 0
  s_cbranch_scc1 L_cf_27
  s_mov_b32 s37, s39
  s_lshr_b32 s38, s2, 3
  s_mov_b64 exec, 1
L_cf_28:
  v_readfirstlane_b32 s33, v22
  s_lshl_b32 s31, 1, s38
  s_and_b32 s34, s33, s31
  s_cbranch_scc0 L_cf_29
  s_not_b32 s33, s33
  s_cbranch_scc1 L_cf_31
  s_add_u32 s37, s37, 1
  s_and_b32 s37, s37, 7
  s_mov_b32 s31, 256
  s_cmp_eq_u32 s37, s39
  s_cbranch_scc1 L_cf_30
  s_lshl_b32 s33, 1, s38
L_cf_31:
  s_ff1_i32_b32 s38, s33
  s_lshl_b32 s31, 1, s38
  s_lshl_b32 s32, s37, 2
  v_mov_b32 v22, s31
  buffer_atomic_or v22, off, s[8:11], s32 sc0 sc1
  s_waitcnt vmcnt(0)
  s_branch L_cf_28
L_cf_29:
  s_or_b32 s33, s33, s31
  s_cmp_eq_u32 s33, -1
  s_cbranch_scc0 L_cf_32
  v_mov_b32 v22, 1
  buffer_atomic_add v22, off, s[8:11], 0 offset:128 sc0 sc1
  s_waitcnt vmcnt(0)
  v_readfirstlane_b32 s33, v22
  s_nop 0
  s_cmp_eq_u32 s33, 7
  s_cbranch_scc0 L_cf_32
  buffer_load_dwordx2 v[22:23], off, s[8:11], 0 offset:136 sc1
  s_waitcnt vmcnt(0)
  v_readfirstlane_b32 s33, v22
  v_readfirstlane_b32 s34, v23
  s_mov_b64 exec, 0xff
  s_mov_b32 s32, 0x408000
  v_lshlrev_b32 v23, 7, v0
  buffer_load_dword v22, v23, s[4:7], s32 offen sc1
  s_cmp_gt_u32 s34, s33
  s_cselect_b32 s33, 1, 0
  s_waitcnt vmcnt(0)
  v_add_u32 v22, 2, v22
  v_and_b32 v22, -2, v22
  v_or_b32 v22, s33, v22
  buffer_store_dword v22, v23, s[4:7], s32 offen sc1
  s_mov_b64 exec, 1
L_cf_32:
  s_lshl_b32 s31, s37, 5
  s_add_u32 s31, s31, s38
L_cf_30:
  v_mov_b32 v22, s31
  v_mov_b32 v23, 163836
  ds_write_b32 v23, v22
  s_waitcnt lgkmcnt(0)
  s_mov_b64 exec, -1
L_cf_27:
  s_barrier
  v_mov_b32 v23, 163836
  ds_read_b32 v22, v23
  s_mov_b32 s36, 1
  s_waitcnt lgkmcnt(0)
  v_readfirstlane_b32 s31, v22
  s_nop 0
  s_cmp_ge_u32 s31, 256
  s_cbranch_scc1 L_exit
  s_cmp_eq_u32 s31, s35
  s_cbranch_scc1 L_cf_26
  s_mov_b32 s35, s31
  s_waitcnt vmcnt(0)
  s_barrier
  s_branch L_dispatch
L_cf_26:
  s_waitcnt vmcnt(20)
  s_barrier
  s_mov_b32 s31, 0x300000
  s_add_u32 m0, s44, 131072
  s_nop 0
  buffer_load_dwordx4 v1, s[16:19], s31 offen lds
  s_mov_b32 s31, 0x308000
  s_add_u32 m0, s44, 132096
  s_nop 0
  buffer_load_dwordx4 v1, s[16:19], s31 offen lds
  s_mov_b32 s31, 0x310000
  s_add_u32 m0, s44, 133120
  s_nop 0
  buffer_load_dwordx4 v2, s[16:19], s31 offen lds
  s_mov_b32 s31, 0x318000
  s_add_u32 m0, s44, 134144
  s_nop 0
  buffer_load_dwordx4 v2, s[16:19], s31 offen lds
  ds_read_b64_tr_b16 v[8:9], v3 offset:0
  ds_read_b64_tr_b16 v[10:11], v3 offset:1024
  ds_read_b64_tr_b16 v[12:13], v3 offset:8192
  ds_read_b64_tr_b16 v[14:15], v3 offset:9216
  ds_read_b64_tr_b16 v[24:25], v4 offset:0
  ds_read_b64_tr_b16 v[26:27], v4 offset:1024
  ds_read_b64_tr_b16 v[28:29], v4 offset:8192
  ds_read_b64_tr_b16 v[30:31], v4 offset:9216
  s_waitcnt lgkmcnt(0)
  ds_write_b128 v7, v[8:11] offset:32768
  ds_write_b128 v7, v[12:15] offset:33792
  ds_write_b128 v7, v[24:27] offset:34816
  ds_write_b128 v7, v[28:31] offset:35840
  s_waitcnt lgkmcnt(0)
  s_waitcnt vmcnt(20)
  s_barrier
  s_mov_b32 s31, 0x380000
  s_add_u32 m0, s44, 0
  s_nop 0
  buffer_load_dwordx4 v1, s[12:15], s31 offen lds
  s_mov_b32 s31, 0x388000
  s_add_u32 m0, s44, 1024
  s_nop 0
  buffer_load_dwordx4 v1, s[12:15], s31 offen lds
  s_mov_b32 s31, 0x390000
  s_add_u32 m0, s44, 2048
  s_nop 0
  buffer_load_dwordx4 v2, s[12:15], s31 offen lds
  s_mov_b32 s31, 0x398000
  s_add_u32 m0, s44, 3072
  s_nop 0
  buffer_load_dwordx4 v2, s[12:15], s31 offen lds
  ds_read_b64_tr_b16 a[32:33], v3 offset:16384
  ds_read_b64_tr_b16 a[34:35], v3 offset:17408
  ds_read_b64_tr_b16 a[36:37], v3 offset:24576
  ds_read_b64_tr_b16 a[38:39], v3 offset:25600
  ds_read_b64_tr_b16 a[40:41], v4 offset:16384
  ds_read_b64_tr_b16 a[42:43], v4 offset:17408
  ds_read_b64_tr_b16 a[44:45], v4 offset:24576
  ds_read_b64_tr_b16 a[46:47], v4 offset:25600
  s_waitcnt lgkmcnt(0)
  s_waitcnt vmcnt(20)
  s_barrier
  s_mov_b32 s31, 0x380000
  s_add_u32 m0, s44, 16384
  s_nop 0
  buffer_load_dwordx4 v1, s[16:19], s31 offen lds
  s_mov_b32 s31, 0x388000
  s_add_u32 m0, s44, 17408
  s_nop 0
  buffer_load_dwordx4 v1, s[16:19], s31 offen lds
  s_mov_b32 s31, 0x390000
  s_add_u32 m0, s44, 18432
  s_nop 0
  buffer_load_dwordx4 v2, s[16:19], s31 offen lds
  s_mov_b32 s31, 0x398000
  s_add_u32 m0, s44, 19456
  s_nop 0
  buffer_load_dwordx4 v2, s[16:19], s31 offen lds
  ds_read_b64_tr_b16 a[48:49], v3 offset:32768
  ds_read_b64_tr_b16 a[50:51], v3 offset:33792
  ds_read_b64_tr_b16 a[52:53], v3 offset:40960
  ds_read_b64_tr_b16 a[54:55], v3 offset:41984
  ds_read_b64_tr_b16 a[56:57], v4 offset:32768
  ds_read_b64_tr_b16 a[58:59], v4 offset:33792
  ds_read_b64_tr_b16 a[60:61], v4 offset:40960
  ds_read_b64_tr_b16 a[62:63], v4 offset:41984
  s_waitcnt lgkmcnt(0)
  s_waitcnt vmcnt(20)
  s_barrier
  s_mov_b32 s31, 0x400000
  s_add_u32 m0, s44, 32768
  s_nop 0
  buffer_load_dwordx4 v1, s[12:15], s31 offen lds
  s_mov_b32 s31, 0x408000
  s_add_u32 m0, s44, 33792
  s_nop 0
  buffer_load_dwordx4 v1, s[12:15], s31 offen lds
  s_mov_b32 s31, 0x410000
  s_add_u32 m0, s44, 34816
  s_nop 0
  buffer_load_dwordx4 v2, s[12:15], s31 offen lds
  s_mov_b32 s31, 0x418000
  s_add_u32 m0, s44, 35840
  s_nop 0
  buffer_load_dwordx4 v2, s[12:15], s31 offen lds
  ds_read_b64_tr_b16 a[64:65], v3 offset:49152
  ds_read_b64_tr_b16 a[66:67], v3 offset:50176
  ds_read_b64_tr_b16 a[68:69], v3 offset:57344
  ds_read_b64_tr_b16 a[70:71], v3 offset:58368
  ds_read_b64_tr_b16 a[72:73], v4 offset:49152
  ds_read_b64_tr_b16 a[74:75], v4 offset:50176
  ds_read_b64_tr_b16 a[76:77], v4 offset:57344
  ds_read_b64_tr_b16 a[78:79], v4 offset:58368
  s_waitcnt lgkmcnt(0)
  s_waitcnt vmcnt(20)
  s_barrier
  s_mov_b32 s31, 0x400000
  s_add_u32 m0, s44, 49152
  s_nop 0
  buffer_load_dwordx4 v1, s[16:19], s31 offen lds
  s_mov_b32 s31, 0x408000
  s_add_u32 m0, s44, 50176
  s_nop 0
  buffer_load_dwordx4 v1, s[16:19], s31 offen lds
  s_mov_b32 s31, 0x410000
  s_add_u32 m0, s44, 51200
  s_nop 0
  buffer_load_dwordx4 v2, s[16:19], s31 offen lds
  s_mov_b32 s31, 0x418000
  s_add_u32 m0, s44, 52224
  s_nop 0
  buffer_load_dwordx4 v2, s[16:19], s31 offen lds
  ds_read_b64_tr_b16 a[80:81], v5 offset:0
  ds_read_b64_tr_b16 a[82:83], v5 offset:1024
  ds_read_b64_tr_b16 a[84:85], v5 offset:8192
  ds_read_b64_tr_b16 a[86:87], v5 offset:9216
  ds_read_b64_tr_b16 a[88:89], v6 offset:0
  ds_read_b64_tr_b16 a[90:91], v6 offset:1024
  ds_read_b64_tr_b16 a[92:93], v6 offset:8192
  ds_read_b64_tr_b16 a[94:95], v6 offset:9216
  s_waitcnt lgkmcnt(0)
  s_waitcnt vmcnt(20)
  s_barrier
  s_mov_b32 s31, 0x480000
  s_add_u32 m0, s44, 65536
  s_nop 0
  buffer_load_dwordx4 v1, s[12:15], s31 offen lds
  s_mov_b32 s31, 0x488000
  s_add_u32 m0, s44, 66560
  s_nop 0
  buffer_load_dwordx4 v1, s[12:15], s31 offen lds
  s_mov_b32 s31, 0x490000
  s_add_u32 m0, s44, 67584
  s_nop 0
  buffer_load_dwordx4 v2, s[12:15], s31 offen lds
  s_mov_b32 s31, 0x498000
  s_add_u32 m0, s44, 68608
  s_nop 0
  buffer_load_dwordx4 v2, s[12:15], s31 offen lds
  ds_read_b64_tr_b16 a[96:97], v5 offset:49152
  ds_read_b64_tr_b16 a[98:99], v5 offset:50176
  ds_read_b64_tr_b16 a[100:101], v5 offset:57344
  ds_read_b64_tr_b16 a[102:103], v5 offset:58368
  ds_read_b64_tr_b16 a[104:105], v6 offset:49152
  ds_read_b64_tr_b16 a[106:107], v6 offset:50176
  ds_read_b64_tr_b16 a[108:109], v6 offset:57344
  ds_read_b64_tr_b16 a[110:111], v6 offset:58368
  s_waitcnt lgkmcnt(0)
  s_waitcnt vmcnt(20)
  s_barrier
  s_mov_b32 s31, 0x480000
  s_add_u32 m0, s44, 114688
  s_nop 0
  buffer_load_dwordx4 v1, s[16:19], s31 offen lds
  s_mov_b32 s31, 0x488000
  s_add_u32 m0, s44, 115712
  s_nop 0
  buffer_load_dwordx4 v1, s[16:19], s31 offen lds
  s_mov_b32 s31, 0x490000
  s_add_u32 m0, s44, 116736
  s_nop 0
  buffer_load_dwordx4 v2, s[16:19], s31 offen lds
  s_mov_b32 s31, 0x498000
  s_add_u32 m0, s44, 117760
  s_nop 0
  buffer_load_dwordx4 v2, s[16:19], s31 offen lds
  ds_read_b64_tr_b16 a[112:113], v16 offset:0
  ds_read_b64_tr_b16 a[114:115], v16 offset:1024
  ds_read_b64_tr_b16 a[116:117], v16 offset:8192
  ds_read_b64_tr_b16 a[118:119], v16 offset:9216
  ds_read_b64_tr_b16 a[120:121], v17 offset:0
  ds_read_b64_tr_b16 a[122:123], v17 offset:1024
  ds_read_b64_tr_b16 a[124:125], v17 offset:8192
  ds_read_b64_tr_b16 a[126:127], v17 offset:9216
  s_waitcnt lgkmcnt(0)
  s_waitcnt vmcnt(20)
  s_barrier
  s_mov_b32 s31, 0x500000
  s_add_u32 m0, s44, 131072
  s_nop 0
  buffer_load_dwordx4 v1, s[12:15], s31 offen lds
  s_mov_b32 s31, 0x508000
  s_add_u32 m0, s44, 132096
  s_nop 0
  buffer_load_dwordx4 v1, s[12:15], s31 offen lds
  s_mov_b32 s31, 0x510000
  s_add_u32 m0, s44, 133120
  s_nop 0
  buffer_load_dwordx4 v2, s[12:15], s31 offen lds
  s_mov_b32 s31, 0x518000
  s_add_u32 m0, s44, 134144
  s_nop 0
  buffer_load_dwordx4 v2, s[12:15], s31 offen lds
  ds_read_b64_tr_b16 a[128:129], v3 offset:0
  ds_read_b64_tr_b16 a[130:131], v3 offset:1024
  ds_read_b64_tr_b16 a[132:133], v3 offset:8192
  ds_read_b64_tr_b16 a[134:135], v3 offset:9216
  ds_read_b64_tr_b16 a[136:137], v4 offset:0
  ds_read_b64_tr_b16 a[138:139], v4 offset:1024
  ds_read_b64_tr_b16 a[140:141], v4 offset:8192
  ds_read_b64_tr_b16 a[142:143], v4 offset:9216
  s_waitcnt lgkmcnt(0)
  s_waitcnt vmcnt(20)
  s_barrier
  s_mov_b32 s31, 0x500000
  s_add_u32 m0, s44, 0
  s_nop 0
  buffer_load_dwordx4 v1, s[16:19], s31 offen lds
  s_mov_b32 s31, 0x508000
  s_add_u32 m0, s44, 1024
  s_nop 0
  buffer_load_dwordx4 v1, s[16:19], s31 offen lds
  s_mov_b32 s31, 0x510000
  s_add_u32 m0, s44, 2048
  s_nop 0
  buffer_load_dwordx4 v2, s[16:19], s31 offen lds
  s_mov_b32 s31, 0x518000
  s_add_u32 m0, s44, 3072
  s_nop 0
  buffer_load_dwordx4 v2, s[16:19], s31 offen lds
  ds_read_b64_tr_b16 a[144:145], v3 offset:16384
  ds_read_b64_tr_b16 a[146:147], v3 offset:17408
  ds_read_b64_tr_b16 a[148:149], v3 offset:24576
  ds_read_b64_tr_b16 a[150:151], v3 offset:25600
  ds_read_b64_tr_b16 a[152:153], v4 offset:16384
  ds_read_b64_tr_b16 a[154:155], v4 offset:17408
  ds_read_b64_tr_b16 a[156:157], v4 offset:24576
  ds_read_b64_tr_b16 a[158:159], v4 offset:25600
  s_waitcnt lgkmcnt(0)
  s_waitcnt vmcnt(20)
  s_barrier
  s_mov_b32 s31, 0x580000
  s_add_u32 m0, s44, 16384
  s_nop 0
  buffer_load_dwordx4 v1, s[12:15], s31 offen lds
  s_mov_b32 s31, 0x588000
  s_add_u32 m0, s44, 17408
  s_nop 0
  buffer_load_dwordx4 v1, s[12:15], s31 offen lds
  s_mov_b32 s31, 0x590000
  s_add_u32 m0, s44, 18432
  s_nop 0
  buffer_load_dwordx4 v2, s[12:15], s31 offen lds
  s_mov_b32 s31, 0x598000
  s_add_u32 m0, s44, 19456
  s_nop 0
  buffer_load_dwordx4 v2, s[12:15], s31 offen lds
  ds_read_b64_tr_b16 v[96:97], v3 offset:32768
  ds_read_b64_tr_b16 v[98:99], v3 offset:33792
  ds_read_b64_tr_b16 v[100:101], v3 offset:40960
  ds_read_b64_tr_b16 v[102:103], v3 offset:41984
  ds_read_b64_tr_b16 v[104:105], v4 offset:32768
  ds_read_b64_tr_b16 v[106:107], v4 offset:33792
  ds_read_b64_tr_b16 v[108:109], v4 offset:40960
  ds_read_b64_tr_b16 v[110:111], v4 offset:41984
  s_waitcnt lgkmcnt(0)
  s_waitcnt vmcnt(20)
  s_barrier
  s_mov_b32 s31, 0x580000
  s_add_u32 m0, s44, 32768
  s_nop 0
  buffer_load_dwordx4 v1, s[16:19], s31 offen lds
  s_mov_b32 s31, 0x588000
  s_add_u32 m0, s44, 33792
  s_nop 0
  buffer_load_dwordx4 v1, s[16:19], s31 offen lds
  s_mov_b32 s31, 0x590000
  s_add_u32 m0, s44, 34816
  s_nop 0
  buffer_load_dwordx4 v2, s[16:19], s31 offen lds
  s_mov_b32 s31, 0x598000
  s_add_u32 m0, s44, 35840
  s_nop 0
  buffer_load_dwordx4 v2, s[16:19], s31 offen lds
  ds_read_b64_tr_b16 a[160:161], v3 offset:49152
  ds_read_b64_tr_b16 a[162:163], v3 offset:50176
  ds_read_b64_tr_b16 a[164:165], v3 offset:57344
  ds_read_b64_tr_b16 a[166:167], v3 offset:58368
  ds_read_b64_tr_b16 a[168:169], v4 offset:49152
  ds_read_b64_tr_b16 a[170:171], v4 offset:50176
  ds_read_b64_tr_b16 a[172:173], v4 offset:57344
  ds_read_b64_tr_b16 a[174:175], v4 offset:58368
  s_waitcnt lgkmcnt(0)
  s_waitcnt vmcnt(20)
  s_barrier
  s_mov_b32 s31, 0x600000
  s_add_u32 m0, s44, 49152
  s_nop 0
  buffer_load_dwordx4 v1, s[12:15], s31 offen lds
  s_mov_b32 s31, 0x608000
  s_add_u32 m0, s44, 50176
  s_nop 0
  buffer_load_dwordx4 v1, s[12:15], s31 offen lds
  s_mov_b32 s31, 0x610000
  s_add_u32 m0, s44, 51200
  s_nop 0
  buffer_load_dwordx4 v2, s[12:15], s31 offen lds
  s_mov_b32 s31, 0x618000
  s_add_u32 m0, s44, 52224
  s_nop 0
  buffer_load_dwordx4 v2, s[12:15], s31 offen lds
  ds_read_b64_tr_b16 a[176:177], v5 offset:0
  ds_read_b64_tr_b16 a[178:179], v5 offset:1024
  ds_read_b64_tr_b16 a[180:181], v5 offset:8192
  ds_read_b64_tr_b16 a[182:183], v5 offset:9216
  ds_read_b64_tr_b16 a[184:185], v6 offset:0
  ds_read_b64_tr_b16 a[186:187], v6 offset:1024
  ds_read_b64_tr_b16 a[188:189], v6 offset:8192
  ds_read_b64_tr_b16 a[190:191], v6 offset:9216
  s_waitcnt lgkmcnt(0)
  s_waitcnt vmcnt(20)
  s_barrier
  s_mov_b32 s31, 0x600000
  s_add_u32 m0, s44, 65536
  s_nop 0
  buffer_load_dwordx4 v1, s[16:19], s31 offen lds
  s_mov_b32 s31, 0x608000
  s_add_u32 m0, s44, 66560
  s_nop 0
  buffer_load_dwordx4 v1, s[16:19], s31 offen lds
  s_mov_b32 s31, 0x610000
  s_add_u32 m0, s44, 67584
  s_nop 0
  buffer_load_dwordx4 v2, s[16:19], s31 offen lds
  s_mov_b32 s31, 0x618000
  s_add_u32 m0, s44, 68608
  s_nop 0
  buffer_load_dwordx4 v2, s[16:19], s31 offen lds
  ds_read_b64_tr_b16 a[192:193], v5 offset:49152
  ds_read_b64_tr_b16 a[194:195], v5 offset:50176
  ds_read_b64_tr_b16 a[196:197], v5 offset:57344
  ds_read_b64_tr_b16 a[198:199], v5 offset:58368
  ds_read_b64_tr_b16 a[200:201], v6 offset:49152
  ds_read_b64_tr_b16 a[202:203], v6 offset:50176
  ds_read_b64_tr_b16 a[204:205], v6 offset:57344
  ds_read_b64_tr_b16 a[206:207], v6 offset:58368
  s_waitcnt lgkmcnt(0)
  s_waitcnt vmcnt(20)
  s_barrier
  s_mov_b32 s31, 0x680000
  s_add_u32 m0, s44, 114688
  s_nop 0
  buffer_load_dwordx4 v1, s[12:15], s31 offen lds
  s_mov_b32 s31, 0x688000
  s_add_u32 m0, s44, 115712
  s_nop 0
  buffer_load_dwordx4 v1, s[12:15], s31 offen lds
  s_mov_b32 s31, 0x690000
  s_add_u32 m0, s44, 116736
  s_nop 0
  buffer_load_dwordx4 v2, s[12:15], s31 offen lds
  s_mov_b32 s31, 0x698000
  s_add_u32 m0, s44, 117760
  s_nop 0
  buffer_load_dwordx4 v2, s[12:15], s31 offen lds
  ds_read_b64_tr_b16 v[8:9], v16 offset:0
  ds_read_b64_tr_b16 v[10:11], v16 offset:1024
  ds_read_b64_tr_b16 v[12:13], v16 offset:8192
  ds_read_b64_tr_b16 v[14:15], v16 offset:9216
  ds_read_b64_tr_b16 v[24:25], v17 offset:0
  ds_read_b64_tr_b16 v[26:27], v17 offset:1024
  ds_read_b64_tr_b16 v[28:29], v17 offset:8192
  ds_read_b64_tr_b16 v[30:31], v17 offset:9216
  s_waitcnt lgkmcnt(0)
  ds_write_b128 v7, v[8:11] offset:16384
  ds_write_b128 v7, v[12:15] offset:17408
  ds_write_b128 v7, v[24:27] offset:18432
  ds_write_b128 v7, v[28:31] offset:19456
  s_waitcnt lgkmcnt(0)
  s_waitcnt vmcnt(20)
  s_barrier
  s_mov_b32 s31, 0x680000
  s_add_u32 m0, s44, 131072
  s_nop 0
  buffer_load_dwordx4 v1, s[16:19], s31 offen lds
  s_mov_b32 s31, 0x688000
  s_add_u32 m0, s44, 132096
  s_nop 0
  buffer_load_dwordx4 v1, s[16:19], s31 offen lds
  s_mov_b32 s31, 0x690000
  s_add_u32 m0, s44, 133120
  s_nop 0
  buffer_load_dwordx4 v2, s[16:19], s31 offen lds
  s_mov_b32 s31, 0x698000
  s_add_u32 m0, s44, 134144
  s_nop 0
  buffer_load_dwordx4 v2, s[16:19], s31 offen lds
  ds_read_b64_tr_b16 a[208:209], v3 offset:0
  ds_read_b64_tr_b16 a[210:211], v3 offset:1024
  ds_read_b64_tr_b16 a[212:213], v3 offset:8192
  ds_read_b64_tr_b16 a[214:215], v3 offset:9216
  ds_read_b64_tr_b16 a[216:217], v4 offset:0
  ds_read_b64_tr_b16 a[218:219], v4 offset:1024
  ds_read_b64_tr_b16 a[220:221], v4 offset:8192
  ds_read_b64_tr_b16 a[222:223], v4 offset:9216
  s_waitcnt lgkmcnt(0)
  s_waitcnt vmcnt(20)
  s_barrier
  s_mov_b32 s31, 0x700000
  s_add_u32 m0, s44, 0
  s_nop 0
  buffer_load_dwordx4 v1, s[12:15], s31 offen lds
  s_mov_b32 s31, 0x708000
  s_add_u32 m0, s44, 1024
  s_nop 0
  buffer_load_dwordx4 v1, s[12:15], s31 offen lds
  s_mov_b32 s31, 0x710000
  s_add_u32 m0, s44, 2048
  s_nop 0
  buffer_load_dwordx4 v2, s[12:15], s31 offen lds
  s_mov_b32 s31, 0x718000
  s_add_u32 m0, s44, 3072
  s_nop 0
  buffer_load_dwordx4 v2, s[12:15], s31 offen lds
  ds_read_b64_tr_b16 a[224:225], v3 offset:16384
  ds_read_b64_tr_b16 a[226:227], v3 offset:17408
  ds_read_b64_tr_b16 a[228:229], v3 offset:24576
  ds_read_b64_tr_b16 a[230:231], v3 offset:25600
  ds_read_b64_tr_b16 a[232:233], v4 offset:16384
  ds_read_b64_tr_b16 a[234:235], v4 offset:17408
  ds_read_b64_tr_b16 a[236:237], v4 offset:24576
  ds_read_b64_tr_b16 a[238:239], v4 offset:25600
  s_waitcnt lgkmcnt(0)
  s_waitcnt vmcnt(20)
  s_barrier
  s_mov_b32 s31, 0x700000
  s_add_u32 m0, s44, 16384
  s_nop 0
  buffer_load_dwordx4 v1, s[16:19], s31 offen lds
  s_mov_b32 s31, 0x708000
  s_add_u32 m0, s44, 17408
  s_nop 0
  buffer_load_dwordx4 v1, s[16:19], s31 offen lds
  s_mov_b32 s31, 0x710000
  s_add_u32 m0, s44, 18432
  s_nop 0
  buffer_load_dwordx4 v2, s[16:19], s31 offen lds
  s_mov_b32 s31, 0x718000
  s_add_u32 m0, s44, 19456
  s_nop 0
  buffer_load_dwordx4 v2, s[16:19], s31 offen lds
  ds_read_b64_tr_b16 a[240:241], v3 offset:32768
  ds_read_b64_tr_b16 a[242:243], v3 offset:33792
  ds_read_b64_tr_b16 a[244:245], v3 offset:40960
  ds_read_b64_tr_b16 a[246:247], v3 offset:41984
  ds_read_b64_tr_b16 a[248:249], v4 offset:32768
  ds_read_b64_tr_b16 a[250:251], v4 offset:33792
  ds_read_b64_tr_b16 a[252:253], v4 offset:40960
  ds_read_b64_tr_b16 a[254:255], v4 offset:41984
  s_waitcnt lgkmcnt(0)
  s_waitcnt vmcnt(20)
  s_barrier
  s_mov_b32 s31, 0x780000
  s_add_u32 m0, s44, 32768
  s_nop 0
  buffer_load_dwordx4 v1, s[12:15], s31 offen lds
  s_mov_b32 s31, 0x788000
  s_add_u32 m0, s44, 33792
  s_nop 0
  buffer_load_dwordx4 v1, s[12:15], s31 offen lds
  s_mov_b32 s31, 0x790000
  s_add_u32 m0, s44, 34816
  s_nop 0
  buffer_load_dwordx4 v2, s[12:15], s31 offen lds
  s_mov_b32 s31, 0x798000
  s_add_u32 m0, s44, 35840
  s_nop 0
  buffer_load_dwordx4 v2, s[12:15], s31 offen lds
  ds_read_b64_tr_b16 v[32:33], v3 offset:49152
  ds_read_b64_tr_b16 v[34:35], v3 offset:50176
  ds_read_b64_tr_b16 v[36:37], v3 offset:57344
  ds_read_b64_tr_b16 v[38:39], v3 offset:58368
  ds_read_b64_tr_b16 v[40:41], v4 offset:49152
  ds_read_b64_tr_b16 v[42:43], v4 offset:50176
  ds_read_b64_tr_b16 v[44:45], v4 offset:57344
  ds_read_b64_tr_b16 v[46:47], v4 offset:58368
  s_waitcnt lgkmcnt(0)
  s_waitcnt vmcnt(20)
  s_barrier
  s_mov_b32 s31, 0x780000
  s_add_u32 m0, s44, 49152
  s_nop 0
  buffer_load_dwordx4 v1, s[16:19], s31 offen lds
  s_mov_b32 s31, 0x788000
  s_add_u32 m0, s44, 50176
  s_nop 0
  buffer_load_dwordx4 v1, s[16:19], s31 offen lds
  s_mov_b32 s31, 0x790000
  s_add_u32 m0, s44, 51200
  s_nop 0
  buffer_load_dwordx4 v2, s[16:19], s31 offen lds
  s_mov_b32 s31, 0x798000
  s_add_u32 m0, s44, 52224
  s_nop 0
  buffer_load_dwordx4 v2, s[16:19], s31 offen lds
  ds_read_b64_tr_b16 v[48:49], v5 offset:0
  ds_read_b64_tr_b16 v[50:51], v5 offset:1024
  ds_read_b64_tr_b16 v[52:53], v5 offset:8192
  ds_read_b64_tr_b16 v[54:55], v5 offset:9216
  ds_read_b64_tr_b16 v[56:57], v6 offset:0
  ds_read_b64_tr_b16 v[58:59], v6 offset:1024
  ds_read_b64_tr_b16 v[60:61], v6 offset:8192
  ds_read_b64_tr_b16 v[62:63], v6 offset:9216
  s_waitcnt lgkmcnt(0)
  s_waitcnt vmcnt(20)
  s_barrier
  ds_read_b64_tr_b16 v[64:65], v5 offset:49152
  ds_read_b64_tr_b16 v[66:67], v5 offset:50176
  ds_read_b64_tr_b16 v[68:69], v5 offset:57344
  ds_read_b64_tr_b16 v[70:71], v5 offset:58368
  ds_read_b64_tr_b16 v[72:73], v6 offset:49152
  ds_read_b64_tr_b16 v[74:75], v6 offset:50176
  ds_read_b64_tr_b16 v[76:77], v6 offset:57344
  ds_read_b64_tr_b16 v[78:79], v6 offset:58368
  s_waitcnt lgkmcnt(0)
  s_waitcnt vmcnt(16)
  s_barrier
  ds_read_b64_tr_b16 v[80:81], v16 offset:0
  ds_read_b64_tr_b16 v[82:83], v16 offset:1024
  ds_read_b64_tr_b16 v[84:85], v16 offset:8192
  ds_read_b64_tr_b16 v[86:87], v16 offset:9216
  ds_read_b64_tr_b16 v[88:89], v17 offset:0
  ds_read_b64_tr_b16 v[90:91], v17 offset:1024
  ds_read_b64_tr_b16 v[92:93], v17 offset:8192
  ds_read_b64_tr_b16 v[94:95], v17 offset:9216
  s_waitcnt lgkmcnt(0)
  s_waitcnt vmcnt(12)
  s_barrier
  ds_read_b64_tr_b16 v[112:113], v3 offset:0
  ds_read_b64_tr_b16 v[114:115], v3 offset:1024
  ds_read_b64_tr_b16 v[116:117], v3 offset:8192
  ds_read_b64_tr_b16 v[118:119], v3 offset:9216
  ds_read_b64_tr_b16 v[120:121], v4 offset:0
  ds_read_b64_tr_b16 v[122:123], v4 offset:1024
  ds_read_b64_tr_b16 v[124:125], v4 offset:8192
  ds_read_b64_tr_b16 v[126:127], v4 offset:9216
  s_waitcnt lgkmcnt(0)
  s_waitcnt vmcnt(8)
  s_barrier
  ds_read_b64_tr_b16 v[128:129], v3 offset:16384
  ds_read_b64_tr_b16 v[130:131], v3 offset:17408
  ds_read_b64_tr_b16 v[132:133], v3 offset:24576
  ds_read_b64_tr_b16 v[134:135], v3 offset:25600
  ds_read_b64_tr_b16 v[136:137], v4 offset:16384
  ds_read_b64_tr_b16 v[138:139], v4 offset:17408
  ds_read_b64_tr_b16 v[140:141], v4 offset:24576
  ds_read_b64_tr_b16 v[142:143], v4 offset:25600
  s_waitcnt lgkmcnt(0)
  s_waitcnt vmcnt(4)
  s_barrier
  ds_read_b64_tr_b16 v[144:145], v3 offset:32768
  ds_read_b64_tr_b16 v[146:147], v3 offset:33792
  ds_read_b64_tr_b16 v[148:149], v3 offset:40960
  ds_read_b64_tr_b16 v[150:151], v3 offset:41984
  ds_read_b64_tr_b16 v[152:153], v4 offset:32768
  ds_read_b64_tr_b16 v[154:155], v4 offset:33792
  ds_read_b64_tr_b16 v[156:157], v4 offset:40960
  ds_read_b64_tr_b16 v[158:159], v4 offset:41984
  s_waitcnt lgkmcnt(0)
  s_waitcnt vmcnt(0)
  s_barrier
  ds_read_b64_tr_b16 v[160:161], v3 offset:49152
  ds_read_b64_tr_b16 v[162:163], v3 offset:50176
  ds_read_b64_tr_b16 v[164:165], v3 offset:57344
  ds_read_b64_tr_b16 v[166:167], v3 offset:58368
  ds_read_b64_tr_b16 v[168:169], v4 offset:49152
  ds_read_b64_tr_b16 v[170:171], v4 offset:50176
  ds_read_b64_tr_b16 v[172:173], v4 offset:57344
  ds_read_b64_tr_b16 v[174:175], v4 offset:58368
  s_waitcnt lgkmcnt(0)
L_A_lddone:
  s_barrier
  v_add_u32 v1, 0xffff0000, v7
  ds_write_b128 v1, v[32:35] offset:0
  ds_write_b128 v1, v[36:39] offset:1024
  ds_write_b128 v1, v[40:43] offset:2048
  ds_write_b128 v1, v[44:47] offset:3072
  s_waitcnt lgkmcnt(0)
  ds_write_b128 v1, v[48:51] offset:16384
  ds_write_b128 v1, v[52:55] offset:17408
  ds_write_b128 v1, v[56:59] offset:18432
  ds_write_b128 v1, v[60:63] offset:19456
  s_waitcnt lgkmcnt(0)
  ds_write_b128 v1, v[64:67] offset:32768
  ds_write_b128 v1, v[68:71] offset:33792
  ds_write_b128 v1, v[72:75] offset:34816
  ds_write_b128 v1, v[76:79] offset:35840
  s_waitcnt lgkmcnt(0)
  ds_write_b128 v1, v[80:83] offset:49152
  ds_write_b128 v1, v[84:87] offset:50176
  ds_write_b128 v1, v[88:91] offset:51200
  ds_write_b128 v1, v[92:95] offset:52224
  s_waitcnt lgkmcnt(0)
  ds_write_b128 v7, v[96:99] offset:0
  ds_write_b128 v7, v[100:103] offset:1024
  ds_write_b128 v7, v[104:107] offset:2048
  ds_write_b128 v7, v[108:111] offset:3072
  s_waitcnt lgkmcnt(0)
L_wi_33:
  buffer_load_dword v32, off, s[4:7], s63 sc1
  s_waitcnt vmcnt(0)
  v_readfirstlane_b32 s32, v32
  s_nop 0
  s_cmp_lg_u32 s32, s62
  s_cbranch_scc1 L_wi_ok_34
  s_sleep 8
  s_add_u32 s30, s30, 1
  s_cmp_lt_u32 s30, 0x100000
  s_cbranch_scc1 L_wi_33
  s_branch L_abort
L_wi_ok_34:
  s_and_b32 s32, s32, 1
  s_lshl_b32 s32, s32, 13
  s_add_u32 s28, s28, s32
  v_bfe_u32 v47, v0, 0, 1
  v_mul_u32_u24 v47, 0xaaaa, v47
  v_add_u32 v1, 0x4444, v47
  s_lshr_b32 s31, s24, 1
  s_lshl_b32 s31, s31, 14
  s_and_b32 s32, s24, 1
  s_lshl_b32 s32, s32, 12
  s_add_u32 s31, s31, s32
  v_mov_b32 v2, 0x0
  v_bfe_u32 v47, v0, 5, 1
  v_lshl_add_u32 v2, v47, 9, v2
  v_bfe_u32 v47, v0, 3, 1
  v_lshl_add_u32 v2, v47, 8, v2
  v_bfe_u32 v47, v0, 4, 1
  v_lshl_add_u32 v2, v47, 7, v2
  v_bfe_u32 v47, v0, 0, 3
  v_lshl_add_u32 v2, v47, 4, v2
  v_add_u32 v2, s31, v2
  s_add_u32 s31, s24, 0
  s_and_b32 s31, s31, 3
  s_lshl_b32 s31, s31, 12
  v_mov_b32 v3, 0x1c000
  v_bfe_u32 v47, v0, 0, 6
  v_lshl_add_u32 v3, v47, 4, v3
  v_add_u32 v3, s31, v3
  s_add_u32 s31, s24, 1
  s_and_b32 s31, s31, 3
  s_lshl_b32 s31, s31, 12
  v_mov_b32 v4, 0x1c000
  v_bfe_u32 v47, v0, 0, 6
  v_lshl_add_u32 v4, v47, 4, v4
  v_add_u32 v4, s31, v4
  s_add_u32 s31, s24, 2
  s_and_b32 s31, s31, 3
  s_lshl_b32 s31, s31, 12
  v_mov_b32 v5, 0x1c000
  v_bfe_u32 v47, v0, 0, 6
  v_lshl_add_u32 v5, v47, 4, v5
  v_add_u32 v5, s31, v5
  s_add_u32 s31, s24, 3
  s_and_b32 s31, s31, 3
  s_lshl_b32 s31, s31, 12
  v_mov_b32 v6, 0x1c000
  v_bfe_u32 v47, v0, 0, 6
  v_lshl_add_u32 v6, v47, 4, v6
  v_add_u32 v6, s31, v6
  s_lshl_b32 s31, s24, 10
  v_mov_b32 v8, 0x26000
  v_bfe_u32 v47, v0, 0, 4
  v_lshl_add_u32 v8, v47, 5, v8
  v_bfe_u32 v47, v0, 4, 2
  v_lshl_add_u32 v8, v47, 3, v8
  v_add_u32 v8, s31, v8
  v_mov_b32 v9, 0x26000
  v_bfe_u32 v47, v0, 0, 6
  v_lshl_add_u32 v9, v47, 3, v9
  v_mov_b32 v10, 0x20000
  v_bfe_u32 v47, v0, 0, 6
  v_lshl_add_u32 v10, v47, 4, v10
  s_lshl_b32 s31, s24, 11
  v_mov_b32 v11, 0x22000
  v_bfe_u32 v47, v0, 0, 6
  v_lshl_add_u32 v11, v47, 4, v11
  v_add_u32 v11, s31, v11
  s_lshr_b32 s31, s26, 2
  s_lshl_b32 s31, s31, 14
  s_and_b32 s32, s26, 3
  s_lshl_b32 s32, s32, 11
  s_add_u32 s31, s31, s32
  s_lshl_b32 s32, s24, 9
  s_add_u32 s31, s31, s32
  v_mov_b32 v12, 0x0
  v_bfe_u32 v47, v0, 0, 6
  v_lshl_add_u32 v12, v47, 2, v12
  v_add_u32 v12, s31, v12
  s_lshr_b32 s31, s26, 3
  s_lshl_b32 s31, s31, 14
  s_and_b32 s32, s26, 7
  s_lshl_b32 s32, s32, 10
  s_add_u32 s31, s31, s32
  s_lshl_b32 s32, s24, 8
  s_add_u32 s31, s31, s32
  v_mov_b32 v13, 0x0
  v_bfe_u32 v47, v0, 3, 1
  v_lshl_add_u32 v13, v47, 16, v13
  v_bfe_u32 v47, v0, 2, 1
  v_lshl_add_u32 v13, v47, 7, v13
  v_bfe_u32 v47, v0, 0, 1
  v_lshl_add_u32 v13, v47, 6, v13
  v_bfe_u32 v47, v0, 4, 2
  v_lshl_add_u32 v13, v47, 4, v13
  v_bfe_u32 v47, v0, 1, 1
  v_lshl_add_u32 v13, v47, 30, v13
  v_add_u32 v13, s31, v13
  s_mul_i32 s98, s26, 524288
  s_lshl_b32 s32, s24, 11
  s_add_u32 s98, s98, s32
  s_and_b32 s32, s24, 1
  s_lshl_b32 s32, s32, 10
  s_add_u32 s98, s98, s32
  s_add_u32 s98, s98, 0x47e0000
  v_cmp_gt_u32 vcc, 4, v0
  v_mov_b32 v15, 0x40000000
  v_lshlrev_b32 v47, 14, v0
  v_cndmask_b32 v15, v15, v47, vcc
  s_and_b32 s31, s24, 1
  s_lshl_b32 s31, s31, 4
  v_mov_b32 v46, 0x0
  v_bfe_u32 v47, v0, 0, 4
  v_lshl_add_u32 v46, v47, 0, v46
  v_add_u32 v46, s31, v46
  v_mov_b32 v45, 0x0
  v_bfe_u32 v47, v0, 4, 2
  v_lshl_add_u32 v45, v47, 2, v45
  v_sub_u32 v46, v46, v45
  v_cmp_le_i32 s[48:49], 0, v46
  v_cmp_le_i32 s[50:51], 1, v46
  v_cmp_le_i32 s[52:53], 2, v46
  v_cmp_le_i32 s[54:55], 3, v46
  v_cmp_le_i32 s[56:57], 16, v46
  v_cmp_le_i32 s[58:59], 17, v46
  v_cmp_le_i32 s[60:61], 18, v46
  v_cmp_le_i32 s[62:63], 19, v46
  s_mov_b32 s40, 0x3e0293ee
  s_mul_i32 s45, s26, 1572864
  s_mul_i32 s31, s24, 6144
  s_add_u32 s45, s45, s31
  s_add_u32 s45, s45, 0x7e0000
  s_add_u32 s47, s26, 192
  s_lshl_b32 s47, s47, 7
  s_add_u32 s47, s47, 0x400000
  s_cmp_eq_u32 s24, 0
  s_cselect_b32 s47, s47, 0x40000000
  s_mov_b32 s46, 0
  s_mov_b32 s29, 0
  s_lshr_b32 s31, s25, 3
  s_lshl_b32 s31, s31, 2
  s_add_u32 s31, s31, s24
  s_lshl_b32 s31, s31, 9
  s_add_u32 s94, s31, s28
  s_add_u32 s94, s94, 0x130000
  s_and_b32 s32, s39, 3
  s_lshl_b32 s32, s32, 14
  s_add_u32 s94, s94, s32
  s_lshl_b32 s31, s26, 7
  s_add_u32 s95, s31, s28
  s_add_u32 s95, s95, 0x120000
  s_cmp_eq_u32 s24, 0
  s_cselect_b32 s95, s95, 0x40000000
  s_sub_u32 s31, s26, 0
  s_and_b32 s31, s31, 7
  s_cmp_lt_u32 s31, 2
  s_cselect_b32 s95, s95, 0x40000000
  s_barrier
  s_add_u32 s32, s29, 1
  s_min_u32 s32, s32, 64
  s_cmp_ge_u32 s46, s32
  s_cbranch_scc1 L_kv_ok_35
  v_min_u32 v43, 2, v0
  v_lshlrev_b32 v43, 12, v43
  s_lshl_b32 s31, s26, 7
  s_add_u32 s31, s31, 0x400000
L_kv_36:
  buffer_load_dwordx4 v[44:47], v43, s[4:7], s31 offen sc1
  s_waitcnt vmcnt(0)
  v_min3_u32 v44, v44, v45, v46
  v_min_u32 v44, v44, v47
  s_nop 0
  v_readlane_b32 s33, v44, 0
  v_readlane_b32 s34, v44, 1
  v_readlane_b32 s46, v44, 2
  s_min_u32 s33, s33, s34
  s_min_u32 s46, s46, s33
  s_cmp_ge_u32 s46, s32
  s_cbranch_scc1 L_kv_ok_35
  s_add_u32 s30, s30, 1
  s_cmp_lt_u32 s30, 0x100000
  s_cbranch_scc1 L_kv_36
  s_branch L_abort
L_kv_ok_35:
  s_mul_i32 s33, s24, 6144
  s_add_u32 m0, s33, 131072
  s_nop 0
  buffer_load_dwordx4 v10, s[4:7], s45 offen offset:0 sc1 lds
  buffer_load_dwordx4 v10, s[4:7], s45 offen offset:1024 sc1 lds
  buffer_load_dwordx4 v10, s[4:7], s45 offen offset:2048 sc1 lds
  buffer_load_dwordx4 v10, s[4:7], s45 offen offset:3072 sc1 lds
  s_add_u32 m0, s33, 135168
  s_add_u32 s34, s45, 4096
  buffer_load_dwordx4 v10, s[4:7], s34 offen offset:0 sc1 lds
  buffer_load_dwordx4 v10, s[4:7], s34 offen offset:1024 sc1 lds
  s_add_u32 s45, s45, 24576
  s_mov_b32 s100, 0x40000000
  s_mov_b32 s99, 0
.p2align 6
L_A_loop:
  s_and_b32 s31, s29, 3
  s_lshl_b32 s41, s31, 15
  s_add_u32 s41, s41, s28
  s_add_u32 s41, s41, 0x100000
  s_lshl_b32 s43, s31, 17
  s_add_u32 s43, s43, s28
  s_add_u32 s42, s43, 0x80000
  v_add_u32 v31, 0xffff0000, v7
  ds_read_b128 v[48:51], v31 offset:0
  ds_read_b128 v[52:55], v31 offset:1024
  v_mov_b32 v32, 0
  v_mov_b32 v33, 0
  ds_read_b128 v[56:59], v31 offset:2048
  ds_read_b128 v[60:63], v31 offset:3072
  v_mov_b32 v34, 0
  v_mov_b32 v35, 0
  ds_read_b128 v[64:67], v31 offset:16384
  ds_read_b128 v[68:71], v31 offset:17408
  v_mov_b32 v36, 0
  v_mov_b32 v37, 0
  ds_read_b128 v[72:75], v31 offset:18432
  ds_read_b128 v[76:79], v31 offset:19456
  v_mov_b32 v38, 0
  v_mov_b32 v39, 0
  ds_read_b128 v[80:83], v31 offset:32768
  ds_read_b128 v[84:87], v31 offset:33792
  v_mov_b32 v40, 0
  v_mov_b32 v41, 0
  ds_read_b128 v[88:91], v31 offset:34816
  ds_read_b128 v[92:95], v31 offset:35840
  s_waitcnt lgkmcnt(8)
  v_mov_b32 v42, 0
  v_mov_b32 v43, 0
  ds_read_b128 v[96:99], v31 offset:49152
  ds_read_b128 v[100:103], v31 offset:50176
  v_mov_b32 v44, 0
  v_mov_b32 v45, 0
  ds_read_b128 v[104:107], v31 offset:51200
  ds_read_b128 v[108:111], v31 offset:52224
  v_mov_b32 v46, 0
  v_mov_b32 v47, 0
  v_lshlrev_b32 v18, 7, v0
  v_mov_b32 v14, s29
  s_waitcnt lgkmcnt(0)
  s_cmp_eq_u32 s99, 0
  s_cbranch_scc1 L_pt_37
  s_waitcnt vmcnt(0)
  v_min3_u32 v20, v20, v21, v22
  v_min_u32 v20, v20, v23
  s_nop 0
  v_readlane_b32 s33, v20, 0
  v_readlane_b32 s34, v20, 1
  v_readlane_b32 s46, v20, 2
  s_min_u32 s33, s33, s34
  s_min_u32 s46, s46, s33
L_pt_37:
  s_cmp_lt_u32 s24, 3
  s_cbranch_scc1 L_hu_ok_39
  s_mov_b64 exec, 0x1
L_hu_38:
  buffer_load_dword v16, v18, s[4:7], s94 offen sc1
  s_waitcnt vmcnt(0)
  v_cmp_gt_i32 vcc, s29, v16
  s_cbranch_vccz L_hu_ok_39
  s_add_u32 s30, s30, 1
  s_cmp_lt_u32 s30, 0x100000
  s_cbranch_scc1 L_hu_38
  s_branch L_abort
L_hu_ok_39:
  s_mov_b64 exec, -1
  s_barrier
  buffer_load_dwordx4 v[16:19], v2, s[4:7], s41 offen offset:0 sc1
  s_barrier
  buffer_load_dwordx4 v[20:23], v2, s[4:7], s41 offen offset:1024 sc1
  s_barrier
  buffer_load_dwordx4 v[24:27], v2, s[4:7], s41 offen offset:2048 sc1
  s_barrier
  buffer_load_dwordx4 v[28:31], v2, s[4:7], s41 offen offset:3072 sc1
L_A_mproc:
  s_waitcnt vmcnt(3)
  ds_write_b128 v3, v[16:19] offset:0
  v_cmp_eq_u32 vcc, -1, v19
  s_cbranch_vccnz L_A_slow0
L_A_back0:
  v_smfmac_f32_16x16x64_bf16 v[32:35], v[16:19], v[48:55], v1
  v_smfmac_f32_16x16x64_bf16 v[36:39], v[16:19], v[56:63], v1
  v_max3_u32 v0, v16, v17, v18
  s_waitcnt vmcnt(2)
  ds_write_b128 v3, v[20:23] offset:1024
  v_cmp_eq_u32 vcc, -1, v23
  v_smfmac_f32_16x16x64_bf16 v[40:43], v[16:19], v[64:71], v1
  v_smfmac_f32_16x16x64_bf16 v[44:47], v[16:19], v[72:79], v1
  s_cbranch_vccnz L_A_slow1
L_A_back1:
  v_max3_u32 v0, v0, v19, v20
  v_max3_u32 v0, v0, v21, v22
  s_waitcnt vmcnt(1)
  ds_write_b128 v3, v[24:27] offset:2048
  v_cmp_eq_u32 vcc, -1, v27
  v_smfmac_f32_16x16x64_bf16 v[32:35], v[20:23], v[80:87], v1
  v_smfmac_f32_16x16x64_bf16 v[36:39], v[20:23], v[88:95], v1
  s_cbranch_vccnz L_A_slow2
L_A_back2:
  v_max3_u32 v0, v0, v23, v24
  v_max3_u32 v0, v0, v25, v26
  s_waitcnt vmcnt(0)
  ds_write_b128 v3, v[28:31] offset:3072
  v_max3_u32 v0, v0, v27, v28
  v_max3_u32 v0, v0, v29, v30
  v_max_u32 v0, v0, v31
  v_cmp_eq_u32 vcc, -1, v0
  v_smfmac_f32_16x16x64_bf16 v[40:43], v[20:23], v[96:103], v1
  v_smfmac_f32_16x16x64_bf16 v[44:47], v[20:23], v[104:111], v1
  v_smfmac_f32_16x16x64_bf16 v[32:35], v[24:27], v[112:119], v1
  v_smfmac_f32_16x16x64_bf16 v[36:39], v[24:27], v[120:127], v1
  s_cbranch_vccnz L_A_slow3
L_A_back3:
  s_waitcnt lgkmcnt(0)
  s_barrier
  ds_read_b128 v[48:51], v4 offset:0
  v_smfmac_f32_16x16x64_bf16 v[40:43], v[24:27], v[128:135], v1
  ds_read_b128 v[52:55], v4 offset:1024
  v_smfmac_f32_16x16x64_bf16 v[44:47], v[24:27], v[136:143], v1
  ds_read_b128 v[56:59], v4 offset:2048
  v_smfmac_f32_16x16x64_bf16 v[32:35], v[28:31], v[144:151], v1
  ds_read_b128 v[60:63], v4 offset:3072
  v_smfmac_f32_16x16x64_bf16 v[36:39], v[28:31], v[152:159], v1
  ds_read_b128 v[64:67], v5 offset:0
  v_smfmac_f32_16x16x64_bf16 v[40:43], v[28:31], v[160:167], v1
  ds_read_b128 v[68:71], v5 offset:1024
  v_smfmac_f32_16x16x64_bf16 v[44:47], v[28:31], v[168:175], v1
  s_waitcnt lgkmcnt(5)
  v_smfmac_f32_16x16x64_bf16 v[32:35], v[48:51], v[176:183], v1
  ds_read_b128 v[72:75], v5 offset:2048
  v_smfmac_f32_16x16x64_bf16 v[36:39], v[48:51], v[184:191], v1
  ds_read_b128 v[76:79], v5 offset:3072
  s_waitcnt lgkmcnt(6)
  v_smfmac_f32_16x16x64_bf16 v[32:35], v[52:55], v[208:215], v1
  ds_read_b128 v[80:83], v6 offset:0
  v_smfmac_f32_16x16x64_bf16 v[36:39], v[52:55], v[216:223], v1
  ds_read_b128 v[84:87], v6 offset:1024
  s_waitcnt lgkmcnt(7)
  v_smfmac_f32_16x16x64_bf16 v[32:35], v[56:59], v[240:247], v1
  ds_read_b128 v[88:91], v6 offset:2048
  v_smfmac_f32_16x16x64_bf16 v[36:39], v[56:59], v[248:255], v1
  ds_read_b128 v[92:95], v6 offset:3072
  s_waitcnt lgkmcnt(8)
  v_smfmac_f32_16x16x64_bf16 v[32:35], v[60:63], a[16:23], v1
  ds_read_b128 v[96:99], v7 offset:0
  v_smfmac_f32_16x16x64_bf16 v[36:39], v[60:63], a[24:31], v1
  ds_read_b128 v[100:103], v7 offset:1024
  s_waitcnt lgkmcnt(9)
  v_smfmac_f32_16x16x64_bf16 v[32:35], v[64:67], a[32:39], v1
  ds_read_b128 v[104:107], v7 offset:2048
  v_smfmac_f32_16x16x64_bf16 v[36:39], v[64:67], a[40:47], v1
  ds_read_b128 v[108:111], v7 offset:3072
  s_waitcnt lgkmcnt(10)
  v_smfmac_f32_16x16x64_bf16 v[32:35], v[68:71], a[64:71], v1
  ds_read_b128 v[16:19], v7 offset:16384
  v_smfmac_f32_16x16x64_bf16 v[36:39], v[68:71], a[72:79], v1
  ds_read_b128 v[20:23], v7 offset:17408
  s_waitcnt lgkmcnt(11)
  v_smfmac_f32_16x16x64_bf16 v[32:35], v[72:75], a[96:103], v1
  ds_read_b128 v[24:27], v7 offset:18432
  v_smfmac_f32_16x16x64_bf16 v[36:39], v[72:75], a[104:111], v1
  ds_read_b128 v[28:31], v7 offset:19456
  s_waitcnt lgkmcnt(12)
  v_smfmac_f32_16x16x64_bf16 v[32:35], v[76:79], a[128:135], v1
  v_smfmac_f32_16x16x64_bf16 v[36:39], v[76:79], a[136:143], v1
  s_waitcnt lgkmcnt(11)
  s_waitcnt lgkmcnt(6)
  v_smfmac_f32_16x16x64_bf16 v[32:35], v[80:83], v[96:103], v1
  s_waitcnt lgkmcnt(4)
  v_smfmac_f32_16x16x64_bf16 v[36:39], v[80:83], v[104:111], v1
  v_smfmac_f32_16x16x64_bf16 v[32:35], v[84:87], a[176:183], v1
  ds_read_b128 v[96:99], v7 offset:32768
  v_smfmac_f32_16x16x64_bf16 v[36:39], v[84:87], a[184:191], v1
  ds_read_b128 v[100:103], v7 offset:33792
  s_waitcnt lgkmcnt(4)
  v_smfmac_f32_16x16x64_bf16 v[32:35], v[88:91], v[16:23], v1
  ds_read_b128 v[104:107], v7 offset:34816
  s_waitcnt lgkmcnt(3)
  v_smfmac_f32_16x16x64_bf16 v[36:39], v[88:91], v[24:31], v1
  ds_read_b128 v[108:111], v7 offset:35840
  v_smfmac_f32_16x16x64_bf16 v[32:35], v[92:95], a[224:231], v1
  ds_read_b128 v[16:19], v10 offset:0
  v_smfmac_f32_16x16x64_bf16 v[36:39], v[92:95], a[232:239], v1
  ds_read_b128 v[20:23], v10 offset:1024
  v_smfmac_f32_16x16x64_bf16 v[40:43], v[48:51], v[192:199], v1
  ds_read_b128 v[24:27], v10 offset:2048
  v_smfmac_f32_16x16x64_bf16 v[44:47], v[48:51], v[200:207], v1
  ds_read_b128 v[28:31], v10 offset:3072
  v_smfmac_f32_16x16x64_bf16 v[40:43], v[52:55], v[224:231], v1
  v_add_f32 v32, v32, v33
  v_add_f32 v34, v34, v35
  v_smfmac_f32_16x16x64_bf16 v[44:47], v[52:55], v[232:239], v1
  v_add_f32 v36, v36, v37
  v_add_f32 v38, v38, v39
  v_smfmac_f32_16x16x64_bf16 v[40:43], v[56:59], a[0:7], v1
  v_cvt_pk_bf16_f32 v33, v32, v34
  v_cvt_pk_bf16_f32 v37, v36, v38
  v_smfmac_f32_16x16x64_bf16 v[44:47], v[56:59], a[8:15], v1
  ds_write2st64_b32 v8, v33, v37 offset0:0 offset1:2
  s_waitcnt lgkmcnt(7)
  v_smfmac_f32_16x16x64_bf16 v[40:43], v[60:63], v[96:103], v1
  s_waitcnt lgkmcnt(5)
  v_smfmac_f32_16x16x64_bf16 v[44:47], v[60:63], v[104:111], v1
  v_smfmac_f32_16x16x64_bf16 v[40:43], v[64:67], a[48:55], v1
  ds_read_b128 v[48:51], v10 offset:4096
  v_smfmac_f32_16x16x64_bf16 v[44:47], v[64:67], a[56:63], v1
  ds_read_b128 v[52:55], v10 offset:5120
  v_smfmac_f32_16x16x64_bf16 v[40:43], v[68:71], a[80:87], v1
  ds_read_b128 v[56:59], v10 offset:6144
  v_smfmac_f32_16x16x64_bf16 v[44:47], v[68:71], a[88:95], v1
  ds_read_b128 v[60:63], v10 offset:7168
  s_waitcnt lgkmcnt(4)
  s_barrier
  v_smfmac_f32_16x16x64_bf16 v[40:43], v[72:75], a[112:119], v1
  ds_read_b64_tr_b16 v[96:97], v9 offset:0
  v_smfmac_f32_16x16x64_bf16 v[44:47], v[72:75], a[120:127], v1
  ds_read_b64_tr_b16 v[98:99], v9 offset:512
  v_smfmac_f32_16x16x64_bf16 v[40:43], v[76:79], a[144:151], v1
  ds_read_b64_tr_b16 v[100:101], v9 offset:1024
  v_smfmac_f32_16x16x64_bf16 v[44:47], v[76:79], a[152:159], v1
  ds_read_b64_tr_b16 v[102:103], v9 offset:1536
  v_smfmac_f32_16x16x64_bf16 v[40:43], v[80:83], a[160:167], v1
  ds_read_b64_tr_b16 v[104:105], v9 offset:2048
  v_smfmac_f32_16x16x64_bf16 v[44:47], v[80:83], a[168:175], v1
  ds_read_b64_tr_b16 v[106:107], v9 offset:2560
  v_smfmac_f32_16x16x64_bf16 v[40:43], v[84:87], a[192:199], v1
  ds_read_b64_tr_b16 v[108:109], v9 offset:3072
  v_smfmac_f32_16x16x64_bf16 v[44:47], v[84:87], a[200:207], v1
  ds_read_b64_tr_b16 v[110:111], v9 offset:3584
  v_smfmac_f32_16x16x64_bf16 v[40:43], v[88:91], a[208:215], v1
  v_smfmac_f32_16x16x64_bf16 v[44:47], v[88:91], a[216:223], v1
  v_smfmac_f32_16x16x64_bf16 v[40:43], v[92:95], a[240:247], v1
  v_smfmac_f32_16x16x64_bf16 v[44:47], v[92:95], a[248:255], v1
  s_waitcnt lgkmcnt(6)
  v_mfma_f32_16x16x32_bf16 v[32:35], v[16:19], v[96:99], 0
  v_mfma_f32_16x16x32_bf16 v[36:39], v[20:23], v[96:99], 0
  s_nop 3
  v_add_f32 v40, v40, v41
  v_add_f32 v42, v42, v43
  v_add_f32 v44, v44, v45
  v_add_f32 v46, v46, v47
  v_cvt_pk_bf16_f32 v41, v40, v42
  v_cvt_pk_bf16_f32 v45, v44, v46
  ds_write2st64_b32 v8, v41, v45 offset0:16 offset1:18
  s_waitcnt lgkmcnt(5)
  v_mfma_f32_16x16x32_bf16 v[32:35], v[24:27], v[100:103], v[32:35]
  buffer_load_dword v80, v12, s[4:7], s42 offen offset:0 sc1
  v_mfma_f32_16x16x32_bf16 v[36:39], v[28:31], v[100:103], v[36:39]
  buffer_load_dword v82, v12, s[4:7], s42 offen offset:256 sc1
  s_waitcnt lgkmcnt(3)
  v_mfma_f32_16x16x32_bf16 v[32:35], v[48:51], v[104:107], v[32:35]
  v_mfma_f32_16x16x32_bf16 v[36:39], v[52:55], v[104:107], v[36:39]
  s_waitcnt lgkmcnt(0)
  s_barrier
  ds_read_b64_tr_b16 v[64:65], v9 offset:4096
  ds_read_b64_tr_b16 v[66:67], v9 offset:4608
  v_mfma_f32_16x16x32_bf16 v[32:35], v[56:59], v[108:111], v[32:35]
  buffer_store_dword v14, v15, s[4:7], s95 offen sc1
  ds_read_b64_tr_b16 v[68:69], v9 offset:5120
  ds_read_b64_tr_b16 v[70:71], v9 offset:5632
  v_mfma_f32_16x16x32_bf16 v[36:39], v[60:63], v[108:111], v[36:39]
  ds_read_b64_tr_b16 v[72:73], v9 offset:6144
  ds_read_b64_tr_b16 v[74:75], v9 offset:6656
  ds_read_b64_tr_b16 v[76:77], v9 offset:7168
  ds_read_b64_tr_b16 v[78:79], v9 offset:7680
  ds_read_b128 v[88:91], v11
  ds_read_b128 v[92:95], v11 offset:1024
  v_mov_b32 v84, 0x3f803f80
  v_mov_b32 v85, 0x3f803f80
  s_waitcnt lgkmcnt(8)
  v_mfma_f32_16x16x32_bf16 v[40:43], v[64:67], v[96:99], 0
  v_mov_b32 v86, 0x3f803f80
  v_mov_b32 v87, 0x3f803f80
  s_waitcnt lgkmcnt(6)
  v_mfma_f32_16x16x32_bf16 v[40:43], v[68:71], v[100:103], v[40:43]
  v_mov_b32 v47, 0
  v_max3_f32 v44, v32, v33, v34
  s_waitcnt lgkmcnt(4)
  v_mfma_f32_16x16x32_bf16 v[40:43], v[72:75], v[104:107], v[40:43]
  v_max3_f32 v44, v44, v35, v36
  s_waitcnt lgkmcnt(2)
  v_mfma_f32_16x16x32_bf16 v[40:43], v[76:79], v[108:111], v[40:43]
  v_max3_f32 v44, v44, v37, v38
  v_max_f32 v44, v44, v39
  s_nop 5
  v_max3_f32 v44, v44, v40, v41
  v_mov_b32 v45, v44
  s_nop 1
  v_permlane16_swap_b32 v44, v45
  v_max_f32 v44, v44, v45
  v_mov_b32 v45, v44
  s_nop 1
  v_permlane32_swap_b32 v44, v45
  v_max_f32 v44, v44, v45
  v_mul_f32 v44, s40, v44
  v_pk_fma_f32 v[32:33], v[32:33], s[40:41], v[44:45] op_sel_hi:[1,0,0] neg_lo:[0,0,1] neg_hi:[0,0,1]
  v_pk_fma_f32 v[34:35], v[34:35], s[40:41], v[44:45] op_sel_hi:[1,0,0] neg_lo:[0,0,1] neg_hi:[0,0,1]
  v_pk_fma_f32 v[36:37], v[36:37], s[40:41], v[44:45] op_sel_hi:[1,0,0] neg_lo:[0,0,1] neg_hi:[0,0,1]
  v_pk_fma_f32 v[38:39], v[38:39], s[40:41], v[44:45] op_sel_hi:[1,0,0] neg_lo:[0,0,1] neg_hi:[0,0,1]
  v_pk_fma_f32 v[40:41], v[40:41], s[40:41], v[44:45] op_sel_hi:[1,0,0] neg_lo:[0,0,1] neg_hi:[0,0,1]
  v_exp_f32 v32, v32
  v_exp_f32 v33, v33
  v_exp_f32 v34, v34
  v_exp_f32 v35, v35
  v_exp_f32 v36, v36
  v_exp_f32 v37, v37
  v_exp_f32 v38, v38
  v_exp_f32 v39, v39
  v_cvt_pk_bf16_f32 v96, v32, v33
  v_cvt_pk_bf16_f32 v97, v34, v35
  v_cvt_pk_bf16_f32 v98, v36, v37
  v_cvt_pk_bf16_f32 v99, v38, v39
  v_exp_f32 v42, v40
  s_waitcnt lgkmcnt(0)
L_A_pv:
  v_mfma_f32_16x16x32_bf16 v[108:111], v[84:87], v[96:99], 0
  v_exp_f32 v43, v41
  v_mfma_f32_16x16x32_bf16 v[100:103], v[88:91], v[96:99], 0
  v_cvt_pk_bf16_f32 v46, v42, v43
  v_mfma_f32_16x16x32_bf16 v[104:107], v[92:95], v[96:99], 0
  s_nop 1
  v_mfma_f32_16x16x16_bf16 v[108:111], v[84:85], v[46:47], v[108:111]
  s_waitcnt vmcnt(1)
  v_max_u32 v45, v80, v82
  v_mfma_f32_16x16x16_bf16 v[100:103], v[80:81], v[46:47], v[100:103]
  v_cmp_eq_u32 vcc, -1, v45
  v_mfma_f32_16x16x16_bf16 v[104:107], v[82:83], v[46:47], v[104:107]
  s_nop 2
  v_rcp_f32 v108, v108
  s_cbranch_vccnz L_A_vretry
  s_nop 0
  v_pk_mul_f32 v[100:101], v[100:101], v[108:109] op_sel_hi:[1,0]
  v_pk_mul_f32 v[102:103], v[102:103], v[108:109] op_sel_hi:[1,0]
  v_pk_mul_f32 v[104:105], v[104:105], v[108:109] op_sel_hi:[1,0]
  v_pk_mul_f32 v[106:107], v[106:107], v[108:109] op_sel_hi:[1,0]
  v_cvt_pk_bf16_f32 v96, v100, v101
  v_cvt_pk_bf16_f32 v97, v102, v103
  v_cvt_pk_bf16_f32 v98, v104, v105
  v_cvt_pk_bf16_f32 v99, v106, v107
  buffer_store_dwordx4 v[96:99], v13, s[4:7], s43 offen sc1
  v_xor_b32 v0, 512, v12
  buffer_load_dword v84, v0, s[4:7], s42 offen offset:0 sc1
  buffer_load_dword v86, v0, s[4:7], s42 offen offset:256 sc1
  s_and_b32 s31, s24, 1
  s_lshl_b32 s31, s31, 10
  v_add_u32 v0, s31, v10
  ds_read_b128 v[96:99], v0 offset:16384
  ds_read_b128 v[100:103], v0 offset:18432
  ds_read_b128 v[104:107], v0 offset:20480
  ds_read_b128 v[108:111], v0 offset:22528
  s_add_u32 s31, s29, 3
  s_and_b32 s31, s31, 3
  s_lshl_b32 s31, s31, 17
  s_add_u32 s31, s31, s28
  v_mov_b32 v44, -1
  v_mov_b32 v45, -1
  v_mov_b32 v46, -1
  v_mov_b32 v47, -1
  buffer_store_dwordx4 v[44:47], v13, s[4:7], s31 offen sc1
  s_waitcnt lgkmcnt(3)
  v_mfma_f32_16x16x32_bf16 v[40:43], v[64:67], v[96:99], 0
  s_waitcnt lgkmcnt(2)
  v_mfma_f32_16x16x32_bf16 v[40:43], v[68:71], v[100:103], v[40:43]
  s_waitcnt lgkmcnt(1)
  v_mfma_f32_16x16x32_bf16 v[40:43], v[72:75], v[104:107], v[40:43]
  s_waitcnt lgkmcnt(0)
  v_mfma_f32_16x16x32_bf16 v[40:43], v[76:79], v[108:111], v[40:43]
  v_xor_b32 v0, 2048, v11
  v_mfma_f32_16x16x32_bf16 v[32:35], v[16:19], v[96:99], 0
  ds_read_b128 v[64:67], v0
  v_mfma_f32_16x16x32_bf16 v[36:39], v[20:23], v[96:99], 0
  ds_read_b128 v[68:71], v0 offset:1024
  v_mfma_f32_16x16x32_bf16 v[32:35], v[24:27], v[100:103], v[32:35]
  v_mfma_f32_16x16x32_bf16 v[36:39], v[28:31], v[100:103], v[36:39]
  v_mfma_f32_16x16x32_bf16 v[32:35], v[48:51], v[104:107], v[32:35]
  v_mfma_f32_16x16x32_bf16 v[36:39], v[52:55], v[104:107], v[36:39]
  v_mfma_f32_16x16x32_bf16 v[32:35], v[56:59], v[108:111], v[32:35]
  v_mfma_f32_16x16x32_bf16 v[36:39], v[60:63], v[108:111], v[36:39]
  v_mbcnt_lo_u32_b32 v0, -1, 0
  v_mbcnt_hi_u32_b32 v0, -1, v0
  s_waitcnt lgkmcnt(0)
  s_barrier
  s_mov_b64 exec, 1
  buffer_store_dword v14, off, s[4:7], s47 sc1
  s_mov_b64 exec, -1
  s_add_u32 s32, s29, 2
  s_min_u32 s32, s32, 64
  s_cmp_ge_u32 s46, s32
  s_cbranch_scc1 L_kv_ok_40
  v_min_u32 v43, 2, v0
  v_lshlrev_b32 v43, 12, v43
  s_lshl_b32 s31, s26, 7
  s_add_u32 s31, s31, 0x400000
L_kv_41:
  buffer_load_dwordx4 v[44:47], v43, s[4:7], s31 offen sc1
  s_waitcnt vmcnt(0)
  v_min3_u32 v44, v44, v45, v46
  v_min_u32 v44, v44, v47
  s_nop 0
  v_readlane_b32 s33, v44, 0
  v_readlane_b32 s34, v44, 1
  v_readlane_b32 s46, v44, 2
  s_min_u32 s33, s33, s34
  s_min_u32 s46, s46, s33
  s_cmp_ge_u32 s46, s32
  s_cbranch_scc1 L_kv_ok_40
  s_add_u32 s30, s30, 1
  s_cmp_lt_u32 s30, 0x100000
  s_cbranch_scc1 L_kv_41
  s_branch L_abort
L_kv_ok_40:
  s_cmp_lt_u32 s29, 63
  s_cselect_b32 s101, s45, 0x40000000
  s_add_u32 s45, s45, 24576
  s_mul_i32 s33, s24, 6144
  s_add_u32 m0, s33, 131072
  v_mov_b32 v44, 0xf149f2ca
  s_add_u32 s32, s29, 6
  s_min_u32 s32, s32, 64
  s_cmp_lt_u32 s46, s32
  s_cselect_b32 s99, 1, 0
  s_cbranch_scc0 L_pf_42
  v_bfe_u32 v24, v10, 4, 6
  v_min_u32 v24, 2, v24
  v_lshlrev_b32 v24, 12, v24
  s_lshl_b32 s31, s26, 7
  s_add_u32 s31, s31, 0x400000
  buffer_load_dwordx4 v[20:23], v24, s[4:7], s31 offen sc1
L_pf_42:
  buffer_load_dwordx4 v10, s[4:7], s101 offen offset:0 sc1 lds
  v_cndmask_b32 v32, v44, v32, s[48:49]
  v_cndmask_b32 v33, v44, v33, s[50:51]
  v_cndmask_b32 v34, v44, v34, s[52:53]
  v_cndmask_b32 v35, v44, v35, s[54:55]
  v_cndmask_b32 v36, v44, v36, s[56:57]
  v_cndmask_b32 v37, v44, v37, s[58:59]
  v_cndmask_b32 v38, v44, v38, s[60:61]
  v_cndmask_b32 v39, v44, v39, s[62:63]
  v_max3_f32 v45, v32, v33, v34
  v_max3_f32 v45, v45, v35, v36
  v_max3_f32 v45, v45, v37, v38
  v_max3_f32 v45, v45, v39, v40
  v_max_f32 v45, v45, v41
  buffer_load_dwordx4 v10, s[4:7], s101 offen offset:1024 sc1 lds
  v_mov_b32 v46, v45
  s_nop 1
  v_permlane16_swap_b32 v45, v46
  v_max_f32 v45, v45, v46
  v_mov_b32 v46, v45
  s_nop 1
  v_permlane32_swap_b32 v45, v46
  v_max_f32 v45, v45, v46
  v_mul_f32 v44, s40, v45
  buffer_load_dwordx4 v10, s[4:7], s101 offen offset:2048 sc1 lds
  v_pk_fma_f32 v[32:33], v[32:33], s[40:41], v[44:45] op_sel_hi:[1,0,0] neg_lo:[0,0,1] neg_hi:[0,0,1]
  v_pk_fma_f32 v[34:35], v[34:35], s[40:41], v[44:45] op_sel_hi:[1,0,0] neg_lo:[0,0,1] neg_hi:[0,0,1]
  v_pk_fma_f32 v[36:37], v[36:37], s[40:41], v[44:45] op_sel_hi:[1,0,0] neg_lo:[0,0,1] neg_hi:[0,0,1]
  v_pk_fma_f32 v[38:39], v[38:39], s[40:41], v[44:45] op_sel_hi:[1,0,0] neg_lo:[0,0,1] neg_hi:[0,0,1]
  v_pk_fma_f32 v[40:41], v[40:41], s[40:41], v[44:45] op_sel_hi:[1,0,0] neg_lo:[0,0,1] neg_hi:[0,0,1]
  v_exp_f32 v32, v32
  v_exp_f32 v33, v33
  v_exp_f32 v34, v34
  v_exp_f32 v35, v35
  v_exp_f32 v36, v36
  buffer_load_dwordx4 v10, s[4:7], s101 offen offset:3072 sc1 lds
  v_exp_f32 v37, v37
  v_exp_f32 v38, v38
  v_exp_f32 v39, v39
  v_exp_f32 v40, v40
  v_exp_f32 v41, v41
  s_add_u32 m0, s33, 135168
  s_add_u32 s101, s101, 4096
  buffer_load_dwordx4 v10, s[4:7], s101 offen offset:0 sc1 lds
  s_waitcnt vmcnt(7)
L_A_v2chk:
  v_max_u32 v45, v84, v86
  v_cmp_eq_u32 vcc, -1, v45
  v_mov_b32 v48, 0x3f803f80
  v_mov_b32 v49, 0x3f803f80
  v_mov_b32 v50, 0x3f803f80
  v_mov_b32 v51, 0x3f803f80
  v_cvt_pk_bf16_f32 v52, v32, v33
  v_cvt_pk_bf16_f32 v53, v34, v35
  v_cvt_pk_bf16_f32 v54, v36, v37
  v_cvt_pk_bf16_f32 v55, v38, v39
  v_cvt_pk_bf16_f32 v56, v40, v41
  v_mov_b32 v57, 0
  s_cbranch_vccnz L_A_v2retry
  v_mfma_f32_16x16x32_bf16 v[16:19], v[48:51], v[52:55], 0
  v_mfma_f32_16x16x32_bf16 v[96:99], v[88:91], v[52:55], 0
  v_mfma_f32_16x16x32_bf16 v[100:103], v[92:95], v[52:55], 0
  v_mfma_f32_16x16x32_bf16 v[104:107], v[64:67], v[52:55], 0
  v_mfma_f32_16x16x32_bf16 v[108:111], v[68:71], v[52:55], 0
  s_nop 1
  v_mfma_f32_16x16x16_bf16 v[16:19], v[48:49], v[56:57], v[16:19]
  buffer_load_dwordx4 v10, s[4:7], s101 offen offset:1024 sc1 lds
  v_mfma_f32_16x16x16_bf16 v[96:99], v[80:81], v[56:57], v[96:99]
  v_mfma_f32_16x16x16_bf16 v[100:103], v[82:83], v[56:57], v[100:103]
  v_mfma_f32_16x16x16_bf16 v[104:107], v[84:85], v[56:57], v[104:107]
  v_mfma_f32_16x16x16_bf16 v[108:111], v[86:87], v[56:57], v[108:111]
  s_nop 2
  v_rcp_f32 v16, v16
  s_mul_i32 s100, s29, 8192
  s_add_u32 s100, s100, s98
  v_pk_mul_f32 v[96:97], v[96:97], v[16:17] op_sel_hi:[1,0]
  v_pk_mul_f32 v[98:99], v[98:99], v[16:17] op_sel_hi:[1,0]
  v_pk_mul_f32 v[100:101], v[100:101], v[16:17] op_sel_hi:[1,0]
  v_pk_mul_f32 v[102:103], v[102:103], v[16:17] op_sel_hi:[1,0]
  v_pk_mul_f32 v[104:105], v[104:105], v[16:17] op_sel_hi:[1,0]
  v_pk_mul_f32 v[106:107], v[106:107], v[16:17] op_sel_hi:[1,0]
  v_pk_mul_f32 v[108:109], v[108:109], v[16:17] op_sel_hi:[1,0]
  v_pk_mul_f32 v[110:111], v[110:111], v[16:17] op_sel_hi:[1,0]
  v_cvt_pk_bf16_f32 v111, v110, v111
  v_cvt_pk_bf16_f32 v110, v108, v109
  v_cvt_pk_bf16_f32 v109, v106, v107
  v_cvt_pk_bf16_f32 v108, v104, v105
  v_cvt_pk_bf16_f32 v107, v102, v103
  v_cvt_pk_bf16_f32 v106, v100, v101
  v_cvt_pk_bf16_f32 v105, v98, v99
  v_cvt_pk_bf16_f32 v104, v96, v97
  buffer_store_dwordx4 v[104:107], v10, s[4:7], s100 offen sc1
  s_xor_b32 s100, s100, 2048
  buffer_store_dwordx4 v[108:111], v10, s[4:7], s100 offen sc1
  s_add_u32 s29, s29, 1
  s_cmp_lt_u32 s29, 64
  s_cbranch_scc1 L_A_loop
  v_mov_b32 v14, s29
  s_mov_b64 exec, 1
  buffer_store_dword v14, off, s[4:7], s47 sc1
  s_mov_b64 exec, -1
  v_mov_b32 v44, 65
  s_waitcnt vmcnt(0)
  s_barrier
  s_mov_b64 exec, 1
  buffer_store_dword v44, off, s[4:7], s47 sc1
  s_mov_b64 exec, -1
  s_branch L_exit
L_A_slow0:
  buffer_load_dwordx4 v[16:19], v2, s[4:7], s41 offen offset:0 sc1
  buffer_load_dwordx4 v[20:23], v2, s[4:7], s41 offen offset:1024 sc1
  buffer_load_dwordx4 v[24:27], v2, s[4:7], s41 offen offset:2048 sc1
  buffer_load_dwordx4 v[28:31], v2, s[4:7], s41 offen offset:3072 sc1
  s_waitcnt vmcnt(3)
  ds_write_b128 v3, v[16:19] offset:0
  v_cmp_eq_u32 vcc, -1, v19
  s_cbranch_vccz L_A_back0
  s_add_u32 s30, s30, 1
  s_cmp_lt_u32 s30, 0x100000
  s_cbranch_scc1 L_A_slow0
  s_branch L_abort
L_A_slow1:
  buffer_load_dwordx4 v[20:23], v2, s[4:7], s41 offen offset:1024 sc1
  buffer_load_dwordx4 v[24:27], v2, s[4:7], s41 offen offset:2048 sc1
  buffer_load_dwordx4 v[28:31], v2, s[4:7], s41 offen offset:3072 sc1
  s_waitcnt vmcnt(2)
  ds_write_b128 v3, v[20:23] offset:1024
  v_cmp_eq_u32 vcc, -1, v23
  s_cbranch_vccz L_A_back1
  s_add_u32 s30, s30, 1
  s_cmp_lt_u32 s30, 0x100000
  s_cbranch_scc1 L_A_slow1
  s_branch L_abort
L_A_slow2:
  buffer_load_dwordx4 v[24:27], v2, s[4:7], s41 offen offset:2048 sc1
  buffer_load_dwordx4 v[28:31], v2, s[4:7], s41 offen offset:3072 sc1
  s_waitcnt vmcnt(1)
  ds_write_b128 v3, v[24:27] offset:2048
  v_cmp_eq_u32 vcc, -1, v27
  s_cbranch_vccz L_A_back2
  s_add_u32 s30, s30, 1
  s_cmp_lt_u32 s30, 0x100000
  s_cbranch_scc1 L_A_slow2
  s_branch L_abort
L_A_slow3:
  v_cmp_eq_u32 vcc, -1, v31
  s_cbranch_vccz L_A_mretry
  buffer_load_dwordx4 v[28:31], v2, s[4:7], s41 offen offset:3072 sc1
  s_waitcnt vmcnt(0)
  ds_write_b128 v3, v[28:31] offset:3072
  v_max3_u32 v0, v16, v17, v18
  v_max3_u32 v0, v0, v19, v20
  v_max3_u32 v0, v0, v21, v22
  v_max3_u32 v0, v0, v23, v24
  v_max3_u32 v0, v0, v25, v26
  v_max3_u32 v0, v0, v27, v28
  v_max3_u32 v0, v0, v29, v30
  v_max_u32 v0, v0, v31
  v_cmp_eq_u32 vcc, -1, v0
  s_cbranch_vccz L_A_back3
  s_add_u32 s30, s30, 1
  s_cmp_lt_u32 s30, 0x100000
  s_cbranch_scc1 L_A_slow3
  s_branch L_abort
L_A_mretry:
  s_nop 7
  v_mov_b32 v32, 0
  v_mov_b32 v33, 0
  v_mov_b32 v34, 0
  v_mov_b32 v35, 0
  v_mov_b32 v36, 0
  v_mov_b32 v37, 0
  v_mov_b32 v38, 0
  v_mov_b32 v39, 0
  v_mov_b32 v40, 0
  v_mov_b32 v41, 0
  v_mov_b32 v42, 0
  v_mov_b32 v43, 0
  v_mov_b32 v44, 0
  v_mov_b32 v45, 0
  v_mov_b32 v46, 0
  v_mov_b32 v47, 0
  s_waitcnt lgkmcnt(0)
  s_waitcnt vmcnt(0)
  buffer_load_dwordx4 v[16:19], v2, s[4:7], s41 offen offset:0 sc1
  buffer_load_dwordx4 v[20:23], v2, s[4:7], s41 offen offset:1024 sc1
  buffer_load_dwordx4 v[24:27], v2, s[4:7], s41 offen offset:2048 sc1
  buffer_load_dwordx4 v[28:31], v2, s[4:7], s41 offen offset:3072 sc1
  s_add_u32 s30, s30, 1
  s_cmp_lt_u32 s30, 0x100000
  s_cbranch_scc1 L_A_mproc
  s_branch L_abort
L_A_v2retry:
  v_xor_b32 v45, 512, v12
  buffer_load_dword v84, v45, s[4:7], s42 offen offset:0 sc1
  buffer_load_dword v86, v45, s[4:7], s42 offen offset:256 sc1
  s_waitcnt vmcnt(0)
  s_add_u32 s30, s30, 1
  s_cmp_lt_u32 s30, 0x100000
  s_cbranch_scc1 L_A_v2chk
  s_branch L_abort
L_A_vretry:
  buffer_load_dword v80, v12, s[4:7], s42 offen offset:0 sc1
  buffer_load_dword v82, v12, s[4:7], s42 offen offset:256 sc1
  s_waitcnt vmcnt(0)
  s_add_u32 s30, s30, 1
  s_cmp_lt_u32 s30, 0x100000
  s_cbranch_scc1 L_A_pv
  s_branch L_abort
L_roleB:
  s_sub_u32 s40, s27, 1
  s_mov_b32 s51, s26
  s_mov_b32 s52, s40
  s_mov_b32 s12, s72
  s_mov_b32 s13, s73
  s_mov_b32 s14, 0x800000
  s_mov_b32 s15, 0x20000
  s_mov_b32 s16, s74
  s_mov_b32 s17, s75
  s_mov_b32 s18, 0x800000
  s_mov_b32 s19, 0x20000
  s_mov_b32 s20, s66
  s_mov_b32 s21, s67
  s_mov_b32 s22, 0x4000
  s_mov_b32 s23, 0x20000
  s_lshl_b32 s44, s24, 15
  s_lshl_b32 s32, s51, 8
  s_lshl_b32 s33, s52, 7
  s_add_u32 s32, s32, s33
  s_lshl_b32 s33, s24, 21
  s_add_u32 s32, s32, s33
  v_mov_b32 v16, 0x0
  v_bfe_u32 v21, v0, 3, 3
  v_lshl_add_u32 v16, v21, 13, v16
  v_bfe_u32 v21, v0, 0, 3
  v_lshl_add_u32 v16, v21, 4, v16
  v_add_u32 v16, s32, v16
  v_bfe_u32 v21, v0, 4, 1
  v_lshlrev_b32 v21, 5, v21
  v_xor_b32 v16, v16, v21
  v_xor_b32 v20, 64, v16
  s_lshl_b32 s32, s24, 5
  v_mov_b32 v28, 0x0
  v_bfe_u32 v21, v0, 4, 2
  v_lshl_add_u32 v28, v21, 10, v28
  v_bfe_u32 v21, v0, 2, 2
  v_lshl_add_u32 v28, v21, 7, v28
  v_bfe_u32 v21, v0, 0, 2
  v_lshl_add_u32 v28, v21, 3, v28
  v_add_u32 v28, s32, v28
  v_mov_b32 v29, 0x0
  v_bfe_u32 v21, v0, 3, 1
  v_lshl_add_u32 v29, v21, 5, v29
  v_bfe_u32 v21, v0, 4, 1
  v_lshl_add_u32 v29, v21, 6, v29
  v_xor_b32 v28, v28, v29
  v_add_u32 v29, 0x10000, v28
  s_lshl_b32 s32, s26, 6
  s_lshl_b32 s33, s24, 21
  s_add_u32 s32, s32, s33
  v_mov_b32 v17, 0x0
  v_bfe_u32 v21, v0, 4, 2
  v_lshl_add_u32 v17, v21, 15, v17
  v_bfe_u32 v21, v0, 3, 1
  v_lshl_add_u32 v17, v21, 13, v17
  v_bfe_u32 v21, v0, 2, 1
  v_lshl_add_u32 v17, v21, 11, v17
  v_bfe_u32 v21, v0, 0, 2
  v_lshl_add_u32 v17, v21, 4, v17
  v_add_u32 v17, s32, v17
  v_bfe_u32 v21, v0, 4, 1
  v_lshlrev_b32 v21, 5, v21
  v_xor_b32 v17, v17, v21
  v_mov_b32 v18, 0x0
  v_bfe_u32 v21, v0, 4, 2
  v_lshl_add_u32 v18, v21, 8, v18
  v_bfe_u32 v21, v0, 2, 2
  v_lshl_add_u32 v18, v21, 6, v18
  v_bfe_u32 v21, v0, 4, 1
  v_lshl_add_u32 v18, v21, 5, v18
  v_bfe_u32 v21, v0, 0, 2
  v_lshl_add_u32 v18, v21, 3, v18
  v_add_u32 v18, s44, v18
  v_xor_b32 v19, 32, v18
  v_cmp_gt_u32 vcc, 4, v0
  v_mov_b32 v2, 0x40000000
  v_lshlrev_b32 v21, 14, v0
  v_cndmask_b32 v2, v2, v21, vcc
  s_lshr_b32 s31, s26, 4
  s_lshl_b32 s31, s31, 14
  s_and_b32 s32, s26, 15
  s_lshl_b32 s32, s32, 9
  s_add_u32 s31, s31, s32
  s_lshl_b32 s32, s40, 8
  s_add_u32 s31, s31, s32
  v_mov_b32 v13, 0x0
  v_bfe_u32 v21, v0, 0, 6
  v_lshl_add_u32 v13, v21, 2, v13
  v_add_u32 v13, s31, v13
  s_lshl_b32 s31, s26, 6
  s_lshl_b32 s32, s40, 13
  s_add_u32 s31, s31, s32
  v_mov_b32 v26, 0x0
  v_bfe_u32 v21, v0, 3, 2
  v_lshl_add_u32 v26, v21, 11, v26
  v_bfe_u32 v21, v0, 5, 1
  v_lshl_add_u32 v26, v21, 5, v26
  v_bfe_u32 v21, v0, 0, 2
  v_lshl_add_u32 v26, v21, 3, v26
  v_bfe_u32 v21, v0, 2, 1
  v_lshl_add_u32 v26, v21, 2, v26
  v_add_u32 v26, s31, v26
  buffer_load_dword v27, v26, s[20:23], 0 offen
  s_mov_b32 s31, 0x0
  s_add_u32 m0, s44, 0
  s_nop 0
  buffer_load_dwordx4 v16, s[12:15], s31 offen lds
  s_mov_b32 s31, 0x10000
  s_add_u32 m0, s44, 1024
  s_nop 0
  buffer_load_dwordx4 v20, s[12:15], s31 offen lds
  s_mov_b32 s31, 0x20000
  s_add_u32 m0, s44, 2048
  s_nop 0
  buffer_load_dwordx4 v16, s[12:15], s31 offen lds
  s_mov_b32 s31, 0x30000
  s_add_u32 m0, s44, 3072
  s_nop 0
  buffer_load_dwordx4 v20, s[12:15], s31 offen lds
  s_mov_b32 s31, 0x40000
  s_add_u32 m0, s44, 4096
  s_nop 0
  buffer_load_dwordx4 v16, s[12:15], s31 offen lds
  s_mov_b32 s31, 0x50000
  s_add_u32 m0, s44, 5120
  s_nop 0
  buffer_load_dwordx4 v20, s[12:15], s31 offen lds
  s_mov_b32 s31, 0x60000
  s_add_u32 m0, s44, 6144
  s_nop 0
  buffer_load_dwordx4 v16, s[12:15], s31 offen lds
  s_mov_b32 s31, 0x70000
  s_add_u32 m0, s44, 7168
  s_nop 0
  buffer_load_dwordx4 v20, s[12:15], s31 offen lds
  s_mov_b32 s31, 0x80000
  s_add_u32 m0, s44, 8192
  s_nop 0
  buffer_load_dwordx4 v16, s[12:15], s31 offen lds
  s_mov_b32 s31, 0x90000
  s_add_u32 m0, s44, 9216
  s_nop 0
  buffer_load_dwordx4 v20, s[12:15], s31 offen lds
  s_mov_b32 s31, 0xa0000
  s_add_u32 m0, s44, 10240
  s_nop 0
  buffer_load_dwordx4 v16, s[12:15], s31 offen lds
  s_mov_b32 s31, 0xb0000
  s_add_u32 m0, s44, 11264
  s_nop 0
  buffer_load_dwordx4 v20, s[12:15], s31 offen lds
  s_mov_b32 s31, 0xc0000
  s_add_u32 m0, s44, 12288
  s_nop 0
  buffer_load_dwordx4 v16, s[12:15], s31 offen lds
  s_mov_b32 s31, 0xd0000
  s_add_u32 m0, s44, 13312
  s_nop 0
  buffer_load_dwordx4 v20, s[12:15], s31 offen lds
  s_mov_b32 s31, 0xe0000
  s_add_u32 m0, s44, 14336
  s_nop 0
  buffer_load_dwordx4 v16, s[12:15], s31 offen lds
  s_mov_b32 s31, 0xf0000
  s_add_u32 m0, s44, 15360
  s_nop 0
  buffer_load_dwordx4 v20, s[12:15], s31 offen lds
  s_mov_b32 s31, 0x100000
  s_add_u32 m0, s44, 16384
  s_nop 0
  buffer_load_dwordx4 v16, s[12:15], s31 offen lds
  s_mov_b32 s31, 0x110000
  s_add_u32 m0, s44, 17408
  s_nop 0
  buffer_load_dwordx4 v20, s[12:15], s31 offen lds
  s_mov_b32 s31, 0x120000
  s_add_u32 m0, s44, 18432
  s_nop 0
  buffer_load_dwordx4 v16, s[12:15], s31 offen lds
  s_mov_b32 s31, 0x130000
  s_add_u32 m0, s44, 19456
  s_nop 0
  buffer_load_dwordx4 v20, s[12:15], s31 offen lds
  s_mov_b32 s31, 0x140000
  s_add_u32 m0, s44, 20480
  s_nop 0
  buffer_load_dwordx4 v16, s[12:15], s31 offen lds
  s_mov_b32 s31, 0x150000
  s_add_u32 m0, s44, 21504
  s_nop 0
  buffer_load_dwordx4 v20, s[12:15], s31 offen lds
  s_mov_b32 s31, 0x160000
  s_add_u32 m0, s44, 22528
  s_nop 0
  buffer_load_dwordx4 v16, s[12:15], s31 offen lds
  s_mov_b32 s31, 0x170000
  s_add_u32 m0, s44, 23552
  s_nop 0
  buffer_load_dwordx4 v20, s[12:15], s31 offen lds
  s_mov_b32 s31, 0x180000
  s_add_u32 m0, s44, 24576
  s_nop 0
  buffer_load_dwordx4 v16, s[12:15], s31 offen lds
  s_mov_b32 s31, 0x190000
  s_add_u32 m0, s44, 25600
  s_nop 0
  buffer_load_dwordx4 v20, s[12:15], s31 offen lds
  s_mov_b32 s31, 0x1a0000
  s_add_u32 m0, s44, 26624
  s_nop 0
  buffer_load_dwordx4 v16, s[12:15], s31 offen lds
  s_mov_b32 s31, 0x1b0000
  s_add_u32 m0, s44, 27648
  s_nop 0
  buffer_load_dwordx4 v20, s[12:15], s31 offen lds
  s_mov_b32 s31, 0x1c0000
  s_add_u32 m0, s44, 28672
  s_nop 0
  buffer_load_dwordx4 v16, s[12:15], s31 offen lds
  s_mov_b32 s31, 0x1d0000
  s_add_u32 m0, s44, 29696
  s_nop 0
  buffer_load_dwordx4 v20, s[12:15], s31 offen lds
  s_mov_b32 s31, 0x1e0000
  s_add_u32 m0, s44, 30720
  s_nop 0
  buffer_load_dwordx4 v16, s[12:15], s31 offen lds
  s_mov_b32 s31, 0x1f0000
  s_add_u32 m0, s44, 31744
  s_nop 0
  buffer_load_dwordx4 v20, s[12:15], s31 offen lds
  s_cmp_lg_u32 s36, 0
  s_cbranch_scc1 L_ci_43
  s_waitcnt vmcnt(32)
  v_readfirstlane_b32 s62, v30
  s_barrier
  s_cmp_lg_u32 s24, 0
  s_cbranch_scc1 L_ci_43
  s_lshr_b32 s32, s2, 3
  s_lshl_b32 s31, 1, s32
  s_lshl_b32 s32, s39, 2
  v_mov_b32 v22, s31
  s_mov_b64 exec, 1
  buffer_atomic_or v22, off, s[8:11], s32 sc0 sc1
  s_mov_b64 exec, -1
L_ci_43:
  s_waitcnt vmcnt(0)
  s_cmp_lg_u32 s36, 0
  s_cbranch_scc1 L_cf_44
  s_cmp_lg_u32 s24, 0
  s_cbranch_scc1 L_cf_45
  s_mov_b32 s37, s39
  s_lshr_b32 s38, s2, 3
  s_mov_b64 exec, 1
L_cf_46:
  v_readfirstlane_b32 s33, v22
  s_lshl_b32 s31, 1, s38
  s_and_b32 s34, s33, s31
  s_cbranch_scc0 L_cf_47
  s_not_b32 s33, s33
  s_cbranch_scc1 L_cf_49
  s_add_u32 s37, s37, 1
  s_and_b32 s37, s37, 7
  s_mov_b32 s31, 256
  s_cmp_eq_u32 s37, s39
  s_cbranch_scc1 L_cf_48
  s_lshl_b32 s33, 1, s38
L_cf_49:
  s_ff1_i32_b32 s38, s33
  s_lshl_b32 s31, 1, s38
  s_lshl_b32 s32, s37, 2
  v_mov_b32 v22, s31
  buffer_atomic_or v22, off, s[8:11], s32 sc0 sc1
  s_waitcnt vmcnt(0)
  s_branch L_cf_46
L_cf_47:
  s_or_b32 s33, s33, s31
  s_cmp_eq_u32 s33, -1
  s_cbranch_scc0 L_cf_50
  v_mov_b32 v22, 1
  buffer_atomic_add v22, off, s[8:11], 0 offset:128 sc0 sc1
  s_waitcnt vmcnt(0)
  v_readfirstlane_b32 s33, v22
  s_nop 0
  s_cmp_eq_u32 s33, 7
  s_cbranch_scc0 L_cf_50
  buffer_load_dwordx2 v[22:23], off, s[8:11], 0 offset:136 sc1
  s_waitcnt vmcnt(0)
  v_readfirstlane_b32 s33, v22
  v_readfirstlane_b32 s34, v23
  s_mov_b64 exec, 0xff
  s_mov_b32 s32, 0x408000
  v_lshlrev_b32 v23, 7, v0
  buffer_load_dword v22, v23, s[4:7], s32 offen sc1
  s_cmp_gt_u32 s34, s33
  s_cselect_b32 s33, 1, 0
  s_waitcnt vmcnt(0)
  v_add_u32 v22, 2, v22
  v_and_b32 v22, -2, v22
  v_or_b32 v22, s33, v22
  buffer_store_dword v22, v23, s[4:7], s32 offen sc1
  s_mov_b64 exec, 1
L_cf_50:
  s_lshl_b32 s31, s37, 5
  s_add_u32 s31, s31, s38
L_cf_48:
  v_mov_b32 v22, s31
  v_mov_b32 v23, 163836
  ds_write_b32 v23, v22
  s_waitcnt lgkmcnt(0)
  s_mov_b64 exec, -1
L_cf_45:
  s_barrier
  v_mov_b32 v23, 163836
  ds_read_b32 v22, v23
  s_mov_b32 s36, 1
  s_waitcnt lgkmcnt(0)
  v_readfirstlane_b32 s31, v22
  s_nop 0
  s_cmp_ge_u32 s31, 256
  s_cbranch_scc1 L_exit
  s_cmp_eq_u32 s31, s35
  s_cbranch_scc1 L_cf_44
  s_mov_b32 s35, s31
  s_waitcnt vmcnt(0)
  s_barrier
  s_branch L_dispatch
L_cf_44:
  s_barrier
  ds_read_b64_tr_b16 v[128:129], v28 offset:0
  ds_read_b64_tr_b16 v[130:131], v28 offset:512
  ds_read_b64_tr_b16 v[132:133], v28 offset:4096
  ds_read_b64_tr_b16 v[134:135], v28 offset:4608
  ds_read_b64_tr_b16 v[136:137], v28 offset:8192
  ds_read_b64_tr_b16 v[138:139], v28 offset:8704
  ds_read_b64_tr_b16 v[140:141], v28 offset:12288
  ds_read_b64_tr_b16 v[142:143], v28 offset:12800
  ds_read_b64_tr_b16 v[144:145], v28 offset:16384
  ds_read_b64_tr_b16 v[146:147], v28 offset:16896
  ds_read_b64_tr_b16 v[148:149], v28 offset:20480
  ds_read_b64_tr_b16 v[150:151], v28 offset:20992
  s_waitcnt lgkmcnt(8)
  ds_read_b64_tr_b16 v[152:153], v28 offset:24576
  ds_read_b64_tr_b16 v[154:155], v28 offset:25088
  ds_read_b64_tr_b16 v[156:157], v28 offset:28672
  ds_read_b64_tr_b16 v[158:159], v28 offset:29184
  s_waitcnt lgkmcnt(8)
  ds_read_b64_tr_b16 v[160:161], v28 offset:32768
  ds_read_b64_tr_b16 v[162:163], v28 offset:33280
  ds_read_b64_tr_b16 v[164:165], v28 offset:36864
  ds_read_b64_tr_b16 v[166:167], v28 offset:37376
  s_waitcnt lgkmcnt(8)
  ds_read_b64_tr_b16 v[168:169], v28 offset:40960
  ds_read_b64_tr_b16 v[170:171], v28 offset:41472
  ds_read_b64_tr_b16 v[172:173], v28 offset:45056
  ds_read_b64_tr_b16 v[174:175], v28 offset:45568
  s_waitcnt lgkmcnt(8)
  ds_read_b64_tr_b16 v[176:177], v28 offset:49152
  ds_read_b64_tr_b16 v[178:179], v28 offset:49664
  ds_read_b64_tr_b16 v[180:181], v28 offset:53248
  ds_read_b64_tr_b16 v[182:183], v28 offset:53760
  s_waitcnt lgkmcnt(8)
  ds_read_b64_tr_b16 v[184:185], v28 offset:57344
  ds_read_b64_tr_b16 v[186:187], v28 offset:57856
  ds_read_b64_tr_b16 v[188:189], v28 offset:61440
  ds_read_b64_tr_b16 v[190:191], v28 offset:61952
  s_waitcnt lgkmcnt(8)
  ds_read_b64_tr_b16 v[192:193], v29 offset:0
  ds_read_b64_tr_b16 v[194:195], v29 offset:512
  ds_read_b64_tr_b16 v[196:197], v29 offset:4096
  ds_read_b64_tr_b16 v[198:199], v29 offset:4608
  s_waitcnt lgkmcnt(8)
  ds_read_b64_tr_b16 v[200:201], v29 offset:8192
  ds_read_b64_tr_b16 v[202:203], v29 offset:8704
  ds_read_b64_tr_b16 v[204:205], v29 offset:12288
  ds_read_b64_tr_b16 v[206:207], v29 offset:12800
  s_waitcnt lgkmcnt(8)
  ds_read_b64_tr_b16 v[208:209], v29 offset:16384
  ds_read_b64_tr_b16 v[210:211], v29 offset:16896
  ds_read_b64_tr_b16 v[212:213], v29 offset:20480
  ds_read_b64_tr_b16 v[214:215], v29 offset:20992
  s_waitcnt lgkmcnt(8)
  ds_read_b64_tr_b16 v[216:217], v29 offset:24576
  ds_read_b64_tr_b16 v[218:219], v29 offset:25088
  ds_read_b64_tr_b16 v[220:221], v29 offset:28672
  ds_read_b64_tr_b16 v[222:223], v29 offset:29184
  s_waitcnt lgkmcnt(8)
  ds_read_b64_tr_b16 v[224:225], v29 offset:32768
  ds_read_b64_tr_b16 v[226:227], v29 offset:33280
  ds_read_b64_tr_b16 v[228:229], v29 offset:36864
  ds_read_b64_tr_b16 v[230:231], v29 offset:37376
  s_waitcnt lgkmcnt(8)
  ds_read_b64_tr_b16 v[232:233], v29 offset:40960
  ds_read_b64_tr_b16 v[234:235], v29 offset:41472
  ds_read_b64_tr_b16 v[236:237], v29 offset:45056
  ds_read_b64_tr_b16 v[238:239], v29 offset:45568
  s_waitcnt lgkmcnt(8)
  ds_read_b64_tr_b16 v[240:241], v29 offset:49152
  ds_read_b64_tr_b16 v[242:243], v29 offset:49664
  ds_read_b64_tr_b16 v[244:245], v29 offset:53248
  ds_read_b64_tr_b16 v[246:247], v29 offset:53760
  s_waitcnt lgkmcnt(8)
  ds_read_b64_tr_b16 v[248:249], v29 offset:57344
  ds_read_b64_tr_b16 v[250:251], v29 offset:57856
  ds_read_b64_tr_b16 v[252:253], v29 offset:61440
  ds_read_b64_tr_b16 v[254:255], v29 offset:61952
  s_waitcnt lgkmcnt(8)
  s_waitcnt lgkmcnt(0)
  s_barrier
  s_mov_b32 s31, 0x0
  s_add_u32 m0, s44, 0
  s_nop 0
  buffer_load_dwordx4 v17, s[16:19], s31 offen lds
  s_mov_b32 s31, 0x1000
  s_add_u32 m0, s44, 1024
  s_nop 0
  buffer_load_dwordx4 v17, s[16:19], s31 offen lds
  s_mov_b32 s31, 0x20000
  s_add_u32 m0, s44, 2048
  s_nop 0
  buffer_load_dwordx4 v17, s[16:19], s31 offen lds
  s_mov_b32 s31, 0x21000
  s_add_u32 m0, s44, 3072
  s_nop 0
  buffer_load_dwordx4 v17, s[16:19], s31 offen lds
  s_mov_b32 s31, 0x4000
  s_add_u32 m0, s44, 4096
  s_nop 0
  buffer_load_dwordx4 v17, s[16:19], s31 offen lds
  s_mov_b32 s31, 0x5000
  s_add_u32 m0, s44, 5120
  s_nop 0
  buffer_load_dwordx4 v17, s[16:19], s31 offen lds
  s_mov_b32 s31, 0x24000
  s_add_u32 m0, s44, 6144
  s_nop 0
  buffer_load_dwordx4 v17, s[16:19], s31 offen lds
  s_mov_b32 s31, 0x25000
  s_add_u32 m0, s44, 7168
  s_nop 0
  buffer_load_dwordx4 v17, s[16:19], s31 offen lds
  s_mov_b32 s31, 0x40000
  s_add_u32 m0, s44, 8192
  s_nop 0
  buffer_load_dwordx4 v17, s[16:19], s31 offen lds
  s_mov_b32 s31, 0x41000
  s_add_u32 m0, s44, 9216
  s_nop 0
  buffer_load_dwordx4 v17, s[16:19], s31 offen lds
  s_mov_b32 s31, 0x60000
  s_add_u32 m0, s44, 10240
  s_nop 0
  buffer_load_dwordx4 v17, s[16:19], s31 offen lds
  s_mov_b32 s31, 0x61000
  s_add_u32 m0, s44, 11264
  s_nop 0
  buffer_load_dwordx4 v17, s[16:19], s31 offen lds
  s_mov_b32 s31, 0x44000
  s_add_u32 m0, s44, 12288
  s_nop 0
  buffer_load_dwordx4 v17, s[16:19], s31 offen lds
  s_mov_b32 s31, 0x45000
  s_add_u32 m0, s44, 13312
  s_nop 0
  buffer_load_dwordx4 v17, s[16:19], s31 offen lds
  s_mov_b32 s31, 0x64000
  s_add_u32 m0, s44, 14336
  s_nop 0
  buffer_load_dwordx4 v17, s[16:19], s31 offen lds
  s_mov_b32 s31, 0x65000
  s_add_u32 m0, s44, 15360
  s_nop 0
  buffer_load_dwordx4 v17, s[16:19], s31 offen lds
  s_mov_b32 s31, 0x80000
  s_add_u32 m0, s44, 16384
  s_nop 0
  buffer_load_dwordx4 v17, s[16:19], s31 offen lds
  s_mov_b32 s31, 0x81000
  s_add_u32 m0, s44, 17408
  s_nop 0
  buffer_load_dwordx4 v17, s[16:19], s31 offen lds
  s_mov_b32 s31, 0xa0000
  s_add_u32 m0, s44, 18432
  s_nop 0
  buffer_load_dwordx4 v17, s[16:19], s31 offen lds
  s_mov_b32 s31, 0xa1000
  s_add_u32 m0, s44, 19456
  s_nop 0
  buffer_load_dwordx4 v17, s[16:19], s31 offen lds
  s_mov_b32 s31, 0x84000
  s_add_u32 m0, s44, 20480
  s_nop 0
  buffer_load_dwordx4 v17, s[16:19], s31 offen lds
  s_mov_b32 s31, 0x85000
  s_add_u32 m0, s44, 21504
  s_nop 0
  buffer_load_dwordx4 v17, s[16:19], s31 offen lds
  s_mov_b32 s31, 0xa4000
  s_add_u32 m0, s44, 22528
  s_nop 0
  buffer_load_dwordx4 v17, s[16:19], s31 offen lds
  s_mov_b32 s31, 0xa5000
  s_add_u32 m0, s44, 23552
  s_nop 0
  buffer_load_dwordx4 v17, s[16:19], s31 offen lds
  s_mov_b32 s31, 0xc0000
  s_add_u32 m0, s44, 24576
  s_nop 0
  buffer_load_dwordx4 v17, s[16:19], s31 offen lds
  s_mov_b32 s31, 0xc1000
  s_add_u32 m0, s44, 25600
  s_nop 0
  buffer_load_dwordx4 v17, s[16:19], s31 offen lds
  s_mov_b32 s31, 0xe0000
  s_add_u32 m0, s44, 26624
  s_nop 0
  buffer_load_dwordx4 v17, s[16:19], s31 offen lds
  s_mov_b32 s31, 0xe1000
  s_add_u32 m0, s44, 27648
  s_nop 0
  buffer_load_dwordx4 v17, s[16:19], s31 offen lds
  s_mov_b32 s31, 0xc4000
  s_add_u32 m0, s44, 28672
  s_nop 0
  buffer_load_dwordx4 v17, s[16:19], s31 offen lds
  s_mov_b32 s31, 0xc5000
  s_add_u32 m0, s44, 29696
  s_nop 0
  buffer_load_dwordx4 v17, s[16:19], s31 offen lds
  s_mov_b32 s31, 0xe4000
  s_add_u32 m0, s44, 30720
  s_nop 0
  buffer_load_dwordx4 v17, s[16:19], s31 offen lds
  s_mov_b32 s31, 0xe5000
  s_add_u32 m0, s44, 31744
  s_nop 0
  buffer_load_dwordx4 v17, s[16:19], s31 offen lds
  s_waitcnt vmcnt(28)
  ds_read_b64_tr_b16 a[0:1], v18 offset:0
  ds_read_b64_tr_b16 a[2:3], v18 offset:1024
  ds_read_b64_tr_b16 a[4:5], v18 offset:2048
  ds_read_b64_tr_b16 a[6:7], v18 offset:3072
  ds_read_b64_tr_b16 a[8:9], v19 offset:0
  ds_read_b64_tr_b16 a[10:11], v19 offset:1024
  ds_read_b64_tr_b16 a[12:13], v19 offset:2048
  ds_read_b64_tr_b16 a[14:15], v19 offset:3072
  s_waitcnt lgkmcnt(0)
  s_mov_b32 s31, 0x100000
  s_add_u32 m0, s44, 0
  s_nop 0
  buffer_load_dwordx4 v17, s[16:19], s31 offen lds
  s_mov_b32 s31, 0x101000
  s_add_u32 m0, s44, 1024
  s_nop 0
  buffer_load_dwordx4 v17, s[16:19], s31 offen lds
  s_mov_b32 s31, 0x120000
  s_add_u32 m0, s44, 2048
  s_nop 0
  buffer_load_dwordx4 v17, s[16:19], s31 offen lds
  s_mov_b32 s31, 0x121000
  s_add_u32 m0, s44, 3072
  s_nop 0
  buffer_load_dwordx4 v17, s[16:19], s31 offen lds
  s_waitcnt vmcnt(28)
  ds_read_b64_tr_b16 a[16:17], v18 offset:4096
  ds_read_b64_tr_b16 a[18:19], v18 offset:5120
  ds_read_b64_tr_b16 a[20:21], v18 offset:6144
  ds_read_b64_tr_b16 a[22:23], v18 offset:7168
  ds_read_b64_tr_b16 a[24:25], v19 offset:4096
  ds_read_b64_tr_b16 a[26:27], v19 offset:5120
  ds_read_b64_tr_b16 a[28:29], v19 offset:6144
  ds_read_b64_tr_b16 a[30:31], v19 offset:7168
  s_waitcnt lgkmcnt(0)
  s_mov_b32 s31, 0x104000
  s_add_u32 m0, s44, 4096
  s_nop 0
  buffer_load_dwordx4 v17, s[16:19], s31 offen lds
  s_mov_b32 s31, 0x105000
  s_add_u32 m0, s44, 5120
  s_nop 0
  buffer_load_dwordx4 v17, s[16:19], s31 offen lds
  s_mov_b32 s31, 0x124000
  s_add_u32 m0, s44, 6144
  s_nop 0
  buffer_load_dwordx4 v17, s[16:19], s31 offen lds
  s_mov_b32 s31, 0x125000
  s_add_u32 m0, s44, 7168
  s_nop 0
  buffer_load_dwordx4 v17, s[16:19], s31 offen lds
  s_waitcnt vmcnt(28)
  ds_read_b64_tr_b16 a[32:33], v18 offset:8192
  ds_read_b64_tr_b16 a[34:35], v18 offset:9216
  ds_read_b64_tr_b16 a[36:37], v18 offset:10240
  ds_read_b64_tr_b16 a[38:39], v18 offset:11264
  ds_read_b64_tr_b16 a[40:41], v19 offset:8192
  ds_read_b64_tr_b16 a[42:43], v19 offset:9216
  ds_read_b64_tr_b16 a[44:45], v19 offset:10240
  ds_read_b64_tr_b16 a[46:47], v19 offset:11264
  s_waitcnt lgkmcnt(0)
  s_mov_b32 s31, 0x140000
  s_add_u32 m0, s44, 8192
  s_nop 0
  buffer_load_dwordx4 v17, s[16:19], s31 offen lds
  s_mov_b32 s31, 0x141000
  s_add_u32 m0, s44, 9216
  s_nop 0
  buffer_load_dwordx4 v17, s[16:19], s31 offen lds
  s_mov_b32 s31, 0x160000
  s_add_u32 m0, s44, 10240
  s_nop 0
  buffer_load_dwordx4 v17, s[16:19], s31 offen lds
  s_mov_b32 s31, 0x161000
  s_add_u32 m0, s44, 11264
  s_nop 0
  buffer_load_dwordx4 v17, s[16:19], s31 offen lds
  s_waitcnt vmcnt(28)
  ds_read_b64_tr_b16 a[48:49], v18 offset:12288
  ds_read_b64_tr_b16 a[50:51], v18 offset:13312
  ds_read_b64_tr_b16 a[52:53], v18 offset:14336
  ds_read_b64_tr_b16 a[54:55], v18 offset:15360
  ds_read_b64_tr_b16 a[56:57], v19 offset:12288
  ds_read_b64_tr_b16 a[58:59], v19 offset:13312
  ds_read_b64_tr_b16 a[60:61], v19 offset:14336
  ds_read_b64_tr_b16 a[62:63], v19 offset:15360
  s_waitcnt lgkmcnt(0)
  s_mov_b32 s31, 0x144000
  s_add_u32 m0, s44, 12288
  s_nop 0
  buffer_load_dwordx4 v17, s[16:19], s31 offen lds
  s_mov_b32 s31, 0x145000
  s_add_u32 m0, s44, 13312
  s_nop 0
  buffer_load_dwordx4 v17, s[16:19], s31 offen lds
  s_mov_b32 s31, 0x164000
  s_add_u32 m0, s44, 14336
  s_nop 0
  buffer_load_dwordx4 v17, s[16:19], s31 offen lds
  s_mov_b32 s31, 0x165000
  s_add_u32 m0, s44, 15360
  s_nop 0
  buffer_load_dwordx4 v17, s[16:19], s31 offen lds
  s_waitcnt vmcnt(28)
  ds_read_b64_tr_b16 a[64:65], v18 offset:16384
  ds_read_b64_tr_b16 a[66:67], v18 offset:17408
  ds_read_b64_tr_b16 a[68:69], v18 offset:18432
  ds_read_b64_tr_b16 a[70:71], v18 offset:19456
  ds_read_b64_tr_b16 a[72:73], v19 offset:16384
  ds_read_b64_tr_b16 a[74:75], v19 offset:17408
  ds_read_b64_tr_b16 a[76:77], v19 offset:18432
  ds_read_b64_tr_b16 a[78:79], v19 offset:19456
  s_waitcnt lgkmcnt(0)
  s_mov_b32 s31, 0x180000
  s_add_u32 m0, s44, 16384
  s_nop 0
  buffer_load_dwordx4 v17, s[16:19], s31 offen lds
  s_mov_b32 s31, 0x181000
  s_add_u32 m0, s44, 17408
  s_nop 0
  buffer_load_dwordx4 v17, s[16:19], s31 offen lds
  s_mov_b32 s31, 0x1a0000
  s_add_u32 m0, s44, 18432
  s_nop 0
  buffer_load_dwordx4 v17, s[16:19], s31 offen lds
  s_mov_b32 s31, 0x1a1000
  s_add_u32 m0, s44, 19456
  s_nop 0
  buffer_load_dwordx4 v17, s[16:19], s31 offen lds
L_wi_51:
  buffer_load_dword v24, off, s[4:7], s63 sc1
  s_waitcnt vmcnt(0)
  v_readfirstlane_b32 s32, v24
  s_nop 0
  s_cmp_lg_u32 s32, s62
  s_cbranch_scc1 L_wi_ok_52
  s_sleep 8
  s_add_u32 s30, s30, 1
  s_cmp_lt_u32 s30, 0x100000
  s_cbranch_scc1 L_wi_51
  s_branch L_abort
L_wi_ok_52:
  s_and_b32 s32, s32, 1
  s_lshl_b32 s32, s32, 13
  s_add_u32 s28, s28, s32
  s_lshl_b32 s31, s40, 5
  s_add_u32 s31, s31, s26
  s_lshl_b32 s31, s31, 7
  s_add_u32 s31, s31, s28
  s_add_u32 s48, s31, 0x130000
  s_cmp_eq_u32 s24, 0
  s_cselect_b32 s48, s48, 0x40000000
  s_and_b32 s31, s26, 15
  s_sub_u32 s31, s31, 12
  s_cmp_lt_u32 s31, 1
  s_cselect_b32 s48, s48, 0x40000000
  s_cmp_lg_u32 s24, 0
  s_cbranch_scc1 L_B_m0_53
  v_min_u32 v27, -2, v27
  s_add_u32 s31, s28, 0x100000
  buffer_store_dword v27, v13, s[4:7], s31 offen sc1
L_B_m0_53:
  v_mov_b32 v24, 0
  buffer_store_dword v24, v2, s[4:7], s48 offen sc1
  s_add_u32 s32, s26, 160
  s_lshl_b32 s32, s32, 7
  s_add_u32 s32, s32, 0x400000
  s_cmp_eq_u32 s24, 0
  s_cselect_b32 s32, s32, 0x40000000
  s_cmp_eq_u32 s40, 0
  s_cselect_b32 s32, s32, 0x40000000
  v_mov_b32 v25, 1
  s_mov_b64 exec, 1
  buffer_store_dword v25, off, s[4:7], s32 sc1
  s_mov_b64 exec, -1
  ds_read_b64_tr_b16 a[80:81], v18 offset:20480
  ds_read_b64_tr_b16 a[82:83], v18 offset:21504
  ds_read_b64_tr_b16 a[84:85], v18 offset:22528
  ds_read_b64_tr_b16 a[86:87], v18 offset:23552
  ds_read_b64_tr_b16 a[88:89], v19 offset:20480
  ds_read_b64_tr_b16 a[90:91], v19 offset:21504
  ds_read_b64_tr_b16 a[92:93], v19 offset:22528
  ds_read_b64_tr_b16 a[94:95], v19 offset:23552
  s_waitcnt lgkmcnt(0)
  s_mov_b32 s31, 0x184000
  s_add_u32 m0, s44, 20480
  s_nop 0
  buffer_load_dwordx4 v17, s[16:19], s31 offen lds
  s_mov_b32 s31, 0x185000
  s_add_u32 m0, s44, 21504
  s_nop 0
  buffer_load_dwordx4 v17, s[16:19], s31 offen lds
  s_mov_b32 s31, 0x1a4000
  s_add_u32 m0, s44, 22528
  s_nop 0
  buffer_load_dwordx4 v17, s[16:19], s31 offen lds
  s_mov_b32 s31, 0x1a5000
  s_add_u32 m0, s44, 23552
  s_nop 0
  buffer_load_dwordx4 v17, s[16:19], s31 offen lds
  ds_read_b64_tr_b16 a[96:97], v18 offset:24576
  ds_read_b64_tr_b16 a[98:99], v18 offset:25600
  ds_read_b64_tr_b16 a[100:101], v18 offset:26624
  ds_read_b64_tr_b16 a[102:103], v18 offset:27648
  ds_read_b64_tr_b16 a[104:105], v19 offset:24576
  ds_read_b64_tr_b16 a[106:107], v19 offset:25600
  ds_read_b64_tr_b16 a[108:109], v19 offset:26624
  ds_read_b64_tr_b16 a[110:111], v19 offset:27648
  s_waitcnt lgkmcnt(0)
  s_mov_b32 s31, 0x1c0000
  s_add_u32 m0, s44, 24576
  s_nop 0
  buffer_load_dwordx4 v17, s[16:19], s31 offen lds
  s_mov_b32 s31, 0x1c1000
  s_add_u32 m0, s44, 25600
  s_nop 0
  buffer_load_dwordx4 v17, s[16:19], s31 offen lds
  s_mov_b32 s31, 0x1e0000
  s_add_u32 m0, s44, 26624
  s_nop 0
  buffer_load_dwordx4 v17, s[16:19], s31 offen lds
  s_mov_b32 s31, 0x1e1000
  s_add_u32 m0, s44, 27648
  s_nop 0
  buffer_load_dwordx4 v17, s[16:19], s31 offen lds
  ds_read_b64_tr_b16 a[112:113], v18 offset:28672
  ds_read_b64_tr_b16 a[114:115], v18 offset:29696
  ds_read_b64_tr_b16 a[116:117], v18 offset:30720
  ds_read_b64_tr_b16 a[118:119], v18 offset:31744
  ds_read_b64_tr_b16 a[120:121], v19 offset:28672
  ds_read_b64_tr_b16 a[122:123], v19 offset:29696
  ds_read_b64_tr_b16 a[124:125], v19 offset:30720
  ds_read_b64_tr_b16 a[126:127], v19 offset:31744
  s_waitcnt lgkmcnt(0)
  s_mov_b32 s31, 0x1c4000
  s_add_u32 m0, s44, 28672
  s_nop 0
  buffer_load_dwordx4 v17, s[16:19], s31 offen lds
  s_mov_b32 s31, 0x1c5000
  s_add_u32 m0, s44, 29696
  s_nop 0
  buffer_load_dwordx4 v17, s[16:19], s31 offen lds
  s_mov_b32 s31, 0x1e4000
  s_add_u32 m0, s44, 30720
  s_nop 0
  buffer_load_dwordx4 v17, s[16:19], s31 offen lds
  s_mov_b32 s31, 0x1e5000
  s_add_u32 m0, s44, 31744
  s_nop 0
  buffer_load_dwordx4 v17, s[16:19], s31 offen lds
  ds_read_b64_tr_b16 a[128:129], v18 offset:0
  ds_read_b64_tr_b16 a[130:131], v18 offset:1024
  ds_read_b64_tr_b16 a[132:133], v18 offset:2048
  ds_read_b64_tr_b16 a[134:135], v18 offset:3072
  ds_read_b64_tr_b16 a[136:137], v19 offset:0
  ds_read_b64_tr_b16 a[138:139], v19 offset:1024
  ds_read_b64_tr_b16 a[140:141], v19 offset:2048
  ds_read_b64_tr_b16 a[142:143], v19 offset:3072
  s_waitcnt lgkmcnt(0)
  ds_read_b64_tr_b16 a[144:145], v18 offset:4096
  ds_read_b64_tr_b16 a[146:147], v18 offset:5120
  ds_read_b64_tr_b16 a[148:149], v18 offset:6144
  ds_read_b64_tr_b16 a[150:151], v18 offset:7168
  ds_read_b64_tr_b16 a[152:153], v19 offset:4096
  ds_read_b64_tr_b16 a[154:155], v19 offset:5120
  ds_read_b64_tr_b16 a[156:157], v19 offset:6144
  ds_read_b64_tr_b16 a[158:159], v19 offset:7168
  s_waitcnt lgkmcnt(0)
  ds_read_b64_tr_b16 a[160:161], v18 offset:8192
  ds_read_b64_tr_b16 a[162:163], v18 offset:9216
  ds_read_b64_tr_b16 a[164:165], v18 offset:10240
  ds_read_b64_tr_b16 a[166:167], v18 offset:11264
  ds_read_b64_tr_b16 a[168:169], v19 offset:8192
  ds_read_b64_tr_b16 a[170:171], v19 offset:9216
  ds_read_b64_tr_b16 a[172:173], v19 offset:10240
  ds_read_b64_tr_b16 a[174:175], v19 offset:11264
  s_waitcnt lgkmcnt(0)
  ds_read_b64_tr_b16 a[176:177], v18 offset:12288
  ds_read_b64_tr_b16 a[178:179], v18 offset:13312
  ds_read_b64_tr_b16 a[180:181], v18 offset:14336
  ds_read_b64_tr_b16 a[182:183], v18 offset:15360
  ds_read_b64_tr_b16 a[184:185], v19 offset:12288
  ds_read_b64_tr_b16 a[186:187], v19 offset:13312
  ds_read_b64_tr_b16 a[188:189], v19 offset:14336
  ds_read_b64_tr_b16 a[190:191], v19 offset:15360
  s_waitcnt lgkmcnt(0)
  ds_read_b64_tr_b16 a[192:193], v18 offset:16384
  ds_read_b64_tr_b16 a[194:195], v18 offset:17408
  ds_read_b64_tr_b16 a[196:197], v18 offset:18432
  ds_read_b64_tr_b16 a[198:199], v18 offset:19456
  ds_read_b64_tr_b16 a[200:201], v19 offset:16384
  ds_read_b64_tr_b16 a[202:203], v19 offset:17408
  ds_read_b64_tr_b16 a[204:205], v19 offset:18432
  ds_read_b64_tr_b16 a[206:207], v19 offset:19456
  s_waitcnt lgkmcnt(0)
  s_waitcnt vmcnt(8)
  ds_read_b64_tr_b16 a[208:209], v18 offset:20480
  ds_read_b64_tr_b16 a[210:211], v18 offset:21504
  ds_read_b64_tr_b16 a[212:213], v18 offset:22528
  ds_read_b64_tr_b16 a[214:215], v18 offset:23552
  ds_read_b64_tr_b16 a[216:217], v19 offset:20480
  ds_read_b64_tr_b16 a[218:219], v19 offset:21504
  ds_read_b64_tr_b16 a[220:221], v19 offset:22528
  ds_read_b64_tr_b16 a[222:223], v19 offset:23552
  s_waitcnt lgkmcnt(0)
  s_waitcnt vmcnt(4)
  ds_read_b64_tr_b16 a[224:225], v18 offset:24576
  ds_read_b64_tr_b16 a[226:227], v18 offset:25600
  ds_read_b64_tr_b16 a[228:229], v18 offset:26624
  ds_read_b64_tr_b16 a[230:231], v18 offset:27648
  ds_read_b64_tr_b16 a[232:233], v19 offset:24576
  ds_read_b64_tr_b16 a[234:235], v19 offset:25600
  ds_read_b64_tr_b16 a[236:237], v19 offset:26624
  ds_read_b64_tr_b16 a[238:239], v19 offset:27648
  s_waitcnt lgkmcnt(0)
  s_waitcnt vmcnt(0)
  ds_read_b64_tr_b16 a[240:241], v18 offset:28672
  ds_read_b64_tr_b16 a[242:243], v18 offset:29696
  ds_read_b64_tr_b16 a[244:245], v18 offset:30720
  ds_read_b64_tr_b16 a[246:247], v18 offset:31744
  ds_read_b64_tr_b16 a[248:249], v19 offset:28672
  ds_read_b64_tr_b16 a[250:251], v19 offset:29696
  ds_read_b64_tr_b16 a[252:253], v19 offset:30720
  ds_read_b64_tr_b16 a[254:255], v19 offset:31744
  s_waitcnt lgkmcnt(0)
  v_bfe_u32 v21, v0, 0, 1
  v_mul_u32_u24 v21, 0xaaaa, v21
  v_add_u32 v1, 0x4444, v21
  s_lshr_b32 s31, s24, 1
  s_lshl_b32 s31, s31, 14
  s_and_b32 s32, s24, 1
  s_lshl_b32 s32, s32, 12
  s_add_u32 s31, s31, s32
  v_mov_b32 v3, 0x0
  v_bfe_u32 v21, v0, 5, 1
  v_lshl_add_u32 v3, v21, 9, v3
  v_bfe_u32 v21, v0, 3, 1
  v_lshl_add_u32 v3, v21, 8, v3
  v_bfe_u32 v21, v0, 4, 1
  v_lshl_add_u32 v3, v21, 7, v3
  v_bfe_u32 v21, v0, 0, 3
  v_lshl_add_u32 v3, v21, 4, v3
  v_add_u32 v3, s31, v3
  s_add_u32 s31, s24, 0
  s_and_b32 s31, s31, 3
  s_lshl_b32 s31, s31, 12
  v_mov_b32 v4, 0x20000
  v_bfe_u32 v21, v0, 0, 6
  v_lshl_add_u32 v4, v21, 4, v4
  v_add_u32 v4, s31, v4
  v_mov_b32 v5, 0x20000
  v_bfe_u32 v21, v0, 0, 6
  v_lshl_add_u32 v5, v21, 4, v5
  s_lshl_b32 s31, s40, 2
  s_add_u32 s31, s31, s24
  s_lshl_b32 s31, s31, 14
  v_mov_b32 v8, 0x0
  v_bfe_u32 v21, v0, 0, 6
  v_lshl_add_u32 v8, v21, 4, v8
  v_add_u32 v8, s31, v8
  v_add_u32 v9, 4096, v8
  s_lshr_b32 s31, s51, 2
  s_lshl_b32 s31, s31, 14
  s_and_b32 s32, s51, 3
  s_lshl_b32 s32, s32, 11
  s_add_u32 s31, s31, s32
  s_lshl_b32 s32, s52, 10
  s_add_u32 s31, s31, s32
  s_lshl_b32 s32, s24, 8
  s_add_u32 s31, s31, s32
  v_mov_b32 v10, 0x0
  v_bfe_u32 v21, v0, 0, 6
  v_lshl_add_u32 v10, v21, 2, v10
  v_add_u32 v10, s31, v10
  s_lshl_b32 s31, s24, 9
  v_mov_b32 v11, 0x24000
  v_bfe_u32 v21, v0, 4, 2
  v_lshl_add_u32 v11, v21, 7, v11
  v_bfe_u32 v21, v0, 0, 4
  v_lshl_add_u32 v11, v21, 2, v11
  v_add_u32 v11, s31, v11
  v_mov_b32 v12, 0x24000
  v_bfe_u32 v21, v0, 3, 2
  v_lshl_add_u32 v12, v21, 7, v12
  v_bfe_u32 v21, v0, 5, 1
  v_lshl_add_u32 v12, v21, 6, v12
  v_bfe_u32 v21, v0, 0, 2
  v_lshl_add_u32 v12, v21, 4, v12
  v_bfe_u32 v21, v0, 2, 1
  v_lshl_add_u32 v12, v21, 3, v12
  v_mov_b32 v14, -1
  s_waitcnt vmcnt(0)
  s_lshr_b32 s33, s26, 4
  s_lshl_b32 s31, s40, 1
  s_add_u32 s33, s33, s31
  s_lshl_b32 s33, s33, 2
  s_add_u32 s33, s33, s24
  s_lshl_b32 s31, s33, 9
  s_add_u32 s46, s31, s28
  s_add_u32 s46, s46, 0x130000
  s_and_b32 s32, s39, 3
  s_lshl_b32 s32, s32, 14
  s_add_u32 s46, s46, s32
  s_add_u32 s47, s28, 0x120000
  s_and_b32 s32, s39, 3
  s_lshl_b32 s32, s32, 14
  s_add_u32 s47, s47, s32
  s_mov_b32 s29, 0
  s_barrier
.p2align 6
L_B_loop:
  s_and_b32 s31, s29, 3
  s_lshl_b32 s41, s31, 15
  s_add_u32 s41, s41, s28
  s_add_u32 s41, s41, 0x100000
  v_lshlrev_b32 v34, 7, v0
  v_mov_b32 v96, 0
  v_mov_b32 v97, 0
  v_mov_b32 v98, 0
  v_mov_b32 v99, 0
  s_cmp_lt_u32 s24, 3
  s_cbranch_scc1 L_hu_ok_55
  s_mov_b64 exec, 0x1
L_hu_54:
  buffer_load_dword v32, v34, s[4:7], s46 offen sc1
  s_waitcnt vmcnt(0)
  v_cmp_gt_i32 vcc, s29, v32
  s_cbranch_vccz L_hu_ok_55
  s_add_u32 s30, s30, 1
  s_cmp_lt_u32 s30, 0x100000
  s_cbranch_scc1 L_hu_54
  s_branch L_abort
L_hu_ok_55:
  s_mov_b64 exec, -1
  s_barrier
L_B_mload:
  buffer_load_dwordx4 v[16:19], v3, s[4:7], s41 offen offset:0 sc1
  buffer_load_dwordx4 v[20:23], v3, s[4:7], s41 offen offset:1024 sc1
  buffer_load_dwordx4 v[24:27], v3, s[4:7], s41 offen offset:2048 sc1
  buffer_load_dwordx4 v[28:31], v3, s[4:7], s41 offen offset:3072 sc1
  s_and_b32 s31, s29, 3
  s_lshl_b32 s43, s31, 17
  s_add_u32 s43, s43, s28
  s_add_u32 s42, s43, 0x80000
  s_add_u32 s49, s29, 1
  s_and_b32 s31, s49, 3
  s_lshl_b32 s45, s31, 15
  s_add_u32 s45, s45, s28
  s_add_u32 s45, s45, 0x100000
  s_waitcnt vmcnt(3)
  ds_write_b128 v4, v[16:19] offset:0
  v_max3_u32 v15, v16, v17, v18
  s_waitcnt vmcnt(2)
  ds_write_b128 v4, v[20:23] offset:1024
  v_max3_u32 v15, v15, v19, v20
  v_max3_u32 v15, v15, v21, v22
  s_waitcnt vmcnt(1)
  ds_write_b128 v4, v[24:27] offset:2048
  v_max3_u32 v15, v15, v23, v24
  v_max3_u32 v15, v15, v25, v26
  s_waitcnt vmcnt(0)
  ds_write_b128 v4, v[28:31] offset:3072
  v_max3_u32 v15, v15, v27, v28
  v_max3_u32 v15, v15, v29, v30
  v_max_u32 v15, v15, v31
  v_cmp_eq_u32 vcc, -1, v15
  s_cbranch_vccnz L_B_mretry
  s_waitcnt lgkmcnt(0)
  s_barrier
  ds_read_b128 v[32:35], v5 offset:0
  ds_read_b128 v[36:39], v5 offset:1024
  ds_read_b128 v[40:43], v5 offset:2048
  ds_read_b128 v[44:47], v5 offset:3072
  ds_read_b128 v[48:51], v5 offset:4096
  s_waitcnt lgkmcnt(4)
  v_smfmac_f32_16x16x64_bf16 v[96:99], v[32:35], v[128:135], v1
  ds_read_b128 v[52:55], v5 offset:5120
  s_waitcnt lgkmcnt(4)
  v_smfmac_f32_16x16x64_bf16 v[96:99], v[36:39], v[136:143], v1
  ds_read_b128 v[56:59], v5 offset:6144
  s_waitcnt lgkmcnt(4)
  v_smfmac_f32_16x16x64_bf16 v[96:99], v[40:43], v[144:151], v1
  ds_read_b128 v[60:63], v5 offset:7168
  s_waitcnt lgkmcnt(4)
  v_smfmac_f32_16x16x64_bf16 v[96:99], v[44:47], v[152:159], v1
  ds_read_b128 v[64:67], v5 offset:8192
  s_waitcnt lgkmcnt(4)
  v_smfmac_f32_16x16x64_bf16 v[96:99], v[48:51], v[160:167], v1
  ds_read_b128 v[68:71], v5 offset:9216
  s_waitcnt lgkmcnt(4)
  v_smfmac_f32_16x16x64_bf16 v[96:99], v[52:55], v[168:175], v1
  ds_read_b128 v[72:75], v5 offset:10240
  s_waitcnt lgkmcnt(4)
  v_smfmac_f32_16x16x64_bf16 v[96:99], v[56:59], v[176:183], v1
  ds_read_b128 v[76:79], v5 offset:11264
  s_waitcnt lgkmcnt(4)
  v_smfmac_f32_16x16x64_bf16 v[96:99], v[60:63], v[184:191], v1
  ds_read_b128 v[80:83], v5 offset:12288
  s_waitcnt lgkmcnt(4)
  v_smfmac_f32_16x16x64_bf16 v[96:99], v[64:67], v[192:199], v1
  ds_read_b128 v[84:87], v5 offset:13312
  s_waitcnt lgkmcnt(4)
  v_smfmac_f32_16x16x64_bf16 v[96:99], v[68:71], v[200:207], v1
  ds_read_b128 v[88:91], v5 offset:14336
  s_waitcnt lgkmcnt(4)
  v_smfmac_f32_16x16x64_bf16 v[96:99], v[72:75], v[208:215], v1
  ds_read_b128 v[92:95], v5 offset:15360
  s_waitcnt lgkmcnt(4)
  v_smfmac_f32_16x16x64_bf16 v[96:99], v[76:79], v[216:223], v1
  s_waitcnt lgkmcnt(3)
  v_smfmac_f32_16x16x64_bf16 v[96:99], v[80:83], v[224:231], v1
  s_waitcnt lgkmcnt(2)
  v_smfmac_f32_16x16x64_bf16 v[96:99], v[84:87], v[232:239], v1
  s_waitcnt lgkmcnt(1)
  v_smfmac_f32_16x16x64_bf16 v[96:99], v[88:91], v[240:247], v1
  s_waitcnt lgkmcnt(0)
  v_smfmac_f32_16x16x64_bf16 v[96:99], v[92:95], v[248:255], v1
  s_nop 7
  v_add_f32 v96, v96, v97
  v_add_f32 v98, v98, v99
  v_cvt_pk_bf16_f32 v15, v96, v98
  buffer_store_dword v15, v10, s[4:7], s42 offen sc1
  s_cmp_eq_u32 s29, 63
  s_cbranch_scc1 L_B_end
  s_add_u32 s31, s29, 2
  s_and_b32 s31, s31, 3
  s_lshl_b32 s32, s31, 17
  s_add_u32 s32, s32, s28
  s_add_u32 s32, s32, 0x80000
  buffer_store_dword v14, v10, s[4:7], s32 offen sc1
  s_add_u32 s31, s29, 3
  s_and_b32 s31, s31, 3
  s_lshl_b32 s32, s31, 15
  s_add_u32 s32, s32, s28
  s_add_u32 s32, s32, 0x100000
  s_cmp_eq_u32 s24, 0
  s_cselect_b32 s32, s32, 0x40000000
  buffer_store_dword v14, v13, s[4:7], s32 offen sc1
  v_mov_b32 v112, 0
  v_mov_b32 v113, 0
  v_mov_b32 v114, 0
  v_mov_b32 v115, 0
  v_mov_b32 v116, 0
  v_mov_b32 v117, 0
  v_mov_b32 v118, 0
  v_mov_b32 v119, 0
  v_mov_b32 v120, 0
  v_mov_b32 v121, 0
  v_mov_b32 v122, 0
  v_mov_b32 v123, 0
  v_mov_b32 v124, 0
  v_mov_b32 v125, 0
  v_mov_b32 v126, 0
  v_mov_b32 v127, 0
  v_add_u32 v34, 0, v0
  v_and_b32 v34, 7, v34
  s_lshl_b32 s31, s24, 3
  v_add_u32 v34, s31, v34
  v_lshlrev_b32 v34, 7, v34
  v_mov_b32 v36, s49
  s_mov_b64 exec, 0x3
L_hu_56:
  buffer_load_dword v32, v34, s[4:7], s47 offen sc1
  s_waitcnt vmcnt(0)
  v_cmp_gt_i32 vcc, s29, v32
  s_cbranch_vccz L_hu_ok_57
  s_add_u32 s30, s30, 1
  s_cmp_lt_u32 s30, 0x100000
  s_cbranch_scc1 L_hu_56
  s_branch L_abort
L_hu_ok_57:
  s_mov_b64 exec, -1
  s_barrier
  buffer_load_dwordx4 v[80:83], v8, s[4:7], s43 offen offset:0 sc1
  s_barrier
  buffer_load_dwordx4 v[84:87], v8, s[4:7], s43 offen offset:1024 sc1
  s_barrier
  buffer_load_dwordx4 v[88:91], v8, s[4:7], s43 offen offset:2048 sc1
  s_barrier
  buffer_load_dwordx4 v[92:95], v8, s[4:7], s43 offen offset:3072 sc1
  s_barrier
  buffer_load_dwordx4 v[96:99], v9, s[4:7], s43 offen offset:0 sc1
  s_barrier
  buffer_load_dwordx4 v[100:103], v9, s[4:7], s43 offen offset:1024 sc1
  s_barrier
  buffer_load_dwordx4 v[104:107], v9, s[4:7], s43 offen offset:2048 sc1
  s_barrier
  buffer_load_dwordx4 v[108:111], v9, s[4:7], s43 offen offset:3072 sc1
L_B_oproc:
  s_waitcnt vmcnt(7)
  v_cmp_eq_u32 vcc, -1, v83
  s_cbranch_vccnz L_B_slow0
L_B_back0:
  v_smfmac_f32_16x16x64_bf16 v[112:115], v[80:83], a[0:7], v1
  v_smfmac_f32_16x16x64_bf16 v[116:119], v[80:83], a[8:15], v1
  s_waitcnt vmcnt(6)
  v_cmp_eq_u32 vcc, -1, v87
  v_smfmac_f32_16x16x64_bf16 v[120:123], v[80:83], a[16:23], v1
  v_smfmac_f32_16x16x64_bf16 v[124:127], v[80:83], a[24:31], v1
  s_cbranch_vccnz L_B_slow1
L_B_back1:
  v_smfmac_f32_16x16x64_bf16 v[112:115], v[84:87], a[32:39], v1
  v_smfmac_f32_16x16x64_bf16 v[116:119], v[84:87], a[40:47], v1
  s_waitcnt vmcnt(5)
  v_cmp_eq_u32 vcc, -1, v91
  v_smfmac_f32_16x16x64_bf16 v[120:123], v[84:87], a[48:55], v1
  v_smfmac_f32_16x16x64_bf16 v[124:127], v[84:87], a[56:63], v1
  s_cbranch_vccnz L_B_slow2
L_B_back2:
  v_smfmac_f32_16x16x64_bf16 v[112:115], v[88:91], a[64:71], v1
  v_smfmac_f32_16x16x64_bf16 v[116:119], v[88:91], a[72:79], v1
  s_waitcnt vmcnt(4)
  v_cmp_eq_u32 vcc, -1, v95
  v_smfmac_f32_16x16x64_bf16 v[120:123], v[88:91], a[80:87], v1
  v_smfmac_f32_16x16x64_bf16 v[124:127], v[88:91], a[88:95], v1
  s_cbranch_vccnz L_B_slow3
L_B_back3:
  v_smfmac_f32_16x16x64_bf16 v[112:115], v[92:95], a[96:103], v1
  v_smfmac_f32_16x16x64_bf16 v[116:119], v[92:95], a[104:111], v1
  s_waitcnt vmcnt(3)
  v_cmp_eq_u32 vcc, -1, v99
  v_smfmac_f32_16x16x64_bf16 v[120:123], v[92:95], a[112:119], v1
  v_smfmac_f32_16x16x64_bf16 v[124:127], v[92:95], a[120:127], v1
  s_cbranch_vccnz L_B_slow4
L_B_back4:
  v_smfmac_f32_16x16x64_bf16 v[112:115], v[96:99], a[128:135], v1
  v_smfmac_f32_16x16x64_bf16 v[116:119], v[96:99], a[136:143], v1
  s_waitcnt vmcnt(2)
  v_cmp_eq_u32 vcc, -1, v103
  v_smfmac_f32_16x16x64_bf16 v[120:123], v[96:99], a[144:151], v1
  v_smfmac_f32_16x16x64_bf16 v[124:127], v[96:99], a[152:159], v1
  s_cbranch_vccnz L_B_slow5
L_B_back5:
  v_smfmac_f32_16x16x64_bf16 v[112:115], v[100:103], a[160:167], v1
  v_smfmac_f32_16x16x64_bf16 v[116:119], v[100:103], a[168:175], v1
  s_waitcnt vmcnt(1)
  v_cmp_eq_u32 vcc, -1, v107
  v_smfmac_f32_16x16x64_bf16 v[120:123], v[100:103], a[176:183], v1
  v_smfmac_f32_16x16x64_bf16 v[124:127], v[100:103], a[184:191], v1
  s_cbranch_vccnz L_B_slow6
L_B_back6:
  v_smfmac_f32_16x16x64_bf16 v[112:115], v[104:107], a[192:199], v1
  buffer_store_dword v36, v2, s[4:7], s48 offen sc1
  v_smfmac_f32_16x16x64_bf16 v[116:119], v[104:107], a[200:207], v1
  s_waitcnt vmcnt(1)
  v_cmp_eq_u32 vcc, -1, v111
  v_smfmac_f32_16x16x64_bf16 v[120:123], v[104:107], a[208:215], v1
  v_smfmac_f32_16x16x64_bf16 v[124:127], v[104:107], a[216:223], v1
  s_cbranch_vccnz L_B_slow7
L_B_back7:
  v_smfmac_f32_16x16x64_bf16 v[112:115], v[108:111], a[224:231], v1
  v_smfmac_f32_16x16x64_bf16 v[116:119], v[108:111], a[232:239], v1
  v_smfmac_f32_16x16x64_bf16 v[120:123], v[108:111], a[240:247], v1
  v_smfmac_f32_16x16x64_bf16 v[124:127], v[108:111], a[248:255], v1
  s_cmp_lg_u32 s24, 0
  s_nop 3
  v_add_f32 v112, v112, v113
  v_add_f32 v116, v116, v117
  v_add_f32 v122, v122, v123
  v_add_f32 v126, v126, v127
  v_add_f32 v112, v112, v122
  v_add_f32 v116, v116, v126
  ds_write2_b32 v11, v112, v116 offset0:0 offset1:16
  v_cmp_u_f32 vcc, v112, v116
  s_cbranch_vccnz L_B_ocheck
L_B_ogood:
  s_waitcnt lgkmcnt(0)
  s_barrier
  s_cbranch_scc1 L_B_nm_58
  ds_read_b64 v[32:33], v12 offset:0
  ds_read_b64 v[34:35], v12 offset:512
  ds_read_b64 v[36:37], v12 offset:1024
  ds_read_b64 v[38:39], v12 offset:1536
  s_waitcnt lgkmcnt(2)
  v_add_f32 v32, v32, v34
  v_add_f32 v33, v33, v35
  s_waitcnt lgkmcnt(0)
  v_add_f32 v36, v36, v38
  v_add_f32 v37, v37, v39
  v_add_f32 v32, v32, v36
  v_add_f32 v33, v33, v37
  v_cvt_pk_bf16_f32 v15, v32, v33
  buffer_store_dword v15, v13, s[4:7], s45 offen sc1
L_B_nm_58:
  s_add_u32 s29, s29, 1
  s_branch L_B_loop
L_B_end:
  s_branch L_exit
L_B_mretry:
  s_add_u32 s30, s30, 1
  s_cmp_lt_u32 s30, 0x100000
  s_cbranch_scc1 L_B_mload
  s_branch L_abort
L_B_slow0:
  buffer_load_dwordx4 v[80:83], v8, s[4:7], s43 offen offset:0 sc1
  buffer_load_dwordx4 v[84:87], v8, s[4:7], s43 offen offset:1024 sc1
  buffer_load_dwordx4 v[88:91], v8, s[4:7], s43 offen offset:2048 sc1
  buffer_load_dwordx4 v[92:95], v8, s[4:7], s43 offen offset:3072 sc1
  buffer_load_dwordx4 v[96:99], v9, s[4:7], s43 offen offset:0 sc1
  buffer_load_dwordx4 v[100:103], v9, s[4:7], s43 offen offset:1024 sc1
  buffer_load_dwordx4 v[104:107], v9, s[4:7], s43 offen offset:2048 sc1
  buffer_load_dwordx4 v[108:111], v9, s[4:7], s43 offen offset:3072 sc1
  s_waitcnt vmcnt(7)
  v_cmp_eq_u32 vcc, -1, v83
  s_cbranch_vccz L_B_back0
  s_add_u32 s30, s30, 1
  s_cmp_lt_u32 s30, 0x100000
  s_cbranch_scc1 L_B_slow0
  s_branch L_abort
L_B_slow1:
  buffer_load_dwordx4 v[84:87], v8, s[4:7], s43 offen offset:1024 sc1
  buffer_load_dwordx4 v[88:91], v8, s[4:7], s43 offen offset:2048 sc1
  buffer_load_dwordx4 v[92:95], v8, s[4:7], s43 offen offset:3072 sc1
  buffer_load_dwordx4 v[96:99], v9, s[4:7], s43 offen offset:0 sc1
  buffer_load_dwordx4 v[100:103], v9, s[4:7], s43 offen offset:1024 sc1
  buffer_load_dwordx4 v[104:107], v9, s[4:7], s43 offen offset:2048 sc1
  buffer_load_dwordx4 v[108:111], v9, s[4:7], s43 offen offset:3072 sc1
  s_waitcnt vmcnt(6)
  v_cmp_eq_u32 vcc, -1, v87
  s_cbranch_vccz L_B_back1
  s_add_u32 s30, s30, 1
  s_cmp_lt_u32 s30, 0x100000
  s_cbranch_scc1 L_B_slow1
  s_branch L_abort
L_B_slow2:
  buffer_load_dwordx4 v[88:91], v8, s[4:7], s43 offen offset:2048 sc1
  buffer_load_dwordx4 v[92:95], v8, s[4:7], s43 offen offset:3072 sc1
  buffer_load_dwordx4 v[96:99], v9, s[4:7], s43 offen offset:0 sc1
  buffer_load_dwordx4 v[100:103], v9, s[4:7], s43 offen offset:1024 sc1
  buffer_load_dwordx4 v[104:107], v9, s[4:7], s43 offen offset:2048 sc1
  buffer_load_dwordx4 v[108:111], v9, s[4:7], s43 offen offset:3072 sc1
  s_waitcnt vmcnt(5)
  v_cmp_eq_u32 vcc, -1, v91
  s_cbranch_vccz L_B_back2
  s_add_u32 s30, s30, 1
  s_cmp_lt_u32 s30, 0x100000
  s_cbranch_scc1 L_B_slow2
  s_branch L_abort
L_B_slow3:
  buffer_load_dwordx4 v[92:95], v8, s[4:7], s43 offen offset:3072 sc1
  buffer_load_dwordx4 v[96:99], v9, s[4:7], s43 offen offset:0 sc1
  buffer_load_dwordx4 v[100:103], v9, s[4:7], s43 offen offset:1024 sc1
  buffer_load_dwordx4 v[104:107], v9, s[4:7], s43 offen offset:2048 sc1
  buffer_load_dwordx4 v[108:111], v9, s[4:7], s43 offen offset:3072 sc1
  s_waitcnt vmcnt(4)
  v_cmp_eq_u32 vcc, -1, v95
  s_cbranch_vccz L_B_back3
  s_add_u32 s30, s30, 1
  s_cmp_lt_u32 s30, 0x100000
  s_cbranch_scc1 L_B_slow3
  s_branch L_abort
L_B_slow4:
  buffer_load_dwordx4 v[96:99], v9, s[4:7], s43 offen offset:0 sc1
  buffer_load_dwordx4 v[100:103], v9, s[4:7], s43 offen offset:1024 sc1
  buffer_load_dwordx4 v[104:107], v9, s[4:7], s43 offen offset:2048 sc1
  buffer_load_dwordx4 v[108:111], v9, s[4:7], s43 offen offset:3072 sc1
  s_waitcnt vmcnt(3)
  v_cmp_eq_u32 vcc, -1, v99
  s_cbranch_vccz L_B_back4
  s_add_u32 s30, s30, 1
  s_cmp_lt_u32 s30, 0x100000
  s_cbranch_scc1 L_B_slow4
  s_branch L_abort
L_B_slow5:
  buffer_load_dwordx4 v[100:103], v9, s[4:7], s43 offen offset:1024 sc1
  buffer_load_dwordx4 v[104:107], v9, s[4:7], s43 offen offset:2048 sc1
  buffer_load_dwordx4 v[108:111], v9, s[4:7], s43 offen offset:3072 sc1
  s_waitcnt vmcnt(2)
  v_cmp_eq_u32 vcc, -1, v103
  s_cbranch_vccz L_B_back5
  s_add_u32 s30, s30, 1
  s_cmp_lt_u32 s30, 0x100000
  s_cbranch_scc1 L_B_slow5
  s_branch L_abort
L_B_slow6:
  buffer_load_dwordx4 v[104:107], v9, s[4:7], s43 offen offset:2048 sc1
  buffer_load_dwordx4 v[108:111], v9, s[4:7], s43 offen offset:3072 sc1
  s_waitcnt vmcnt(1)
  v_cmp_eq_u32 vcc, -1, v107
  s_cbranch_vccz L_B_back6
  s_add_u32 s30, s30, 1
  s_cmp_lt_u32 s30, 0x100000
  s_cbranch_scc1 L_B_slow6
  s_branch L_abort
L_B_slow7:
  buffer_load_dwordx4 v[108:111], v9, s[4:7], s43 offen offset:3072 sc1
  buffer_store_dword v36, v2, s[4:7], s48 offen sc1
  s_waitcnt vmcnt(1)
  v_cmp_eq_u32 vcc, -1, v111
  s_cbranch_vccz L_B_back7
  s_add_u32 s30, s30, 1
  s_cmp_lt_u32 s30, 0x100000
  s_cbranch_scc1 L_B_slow7
  s_branch L_abort
L_B_ocheck:
  v_max3_u32 v15, v80, v81, v82
  v_max3_u32 v15, v15, v83, v84
  v_max3_u32 v15, v15, v85, v86
  v_max3_u32 v15, v15, v87, v88
  v_max3_u32 v15, v15, v89, v90
  v_max3_u32 v15, v15, v91, v92
  v_max3_u32 v15, v15, v93, v94
  v_max3_u32 v15, v15, v95, v96
  v_max3_u32 v15, v15, v97, v98
  v_max3_u32 v15, v15, v99, v100
  v_max3_u32 v15, v15, v101, v102
  v_max3_u32 v15, v15, v103, v104
  v_max3_u32 v15, v15, v105, v106
  v_max3_u32 v15, v15, v107, v108
  v_max3_u32 v15, v15, v109, v110
  v_max_u32 v15, v15, v111
  v_cmp_eq_u32 vcc, -1, v15
  s_cbranch_vccz L_B_ogood
  v_mov_b32 v112, 0
  v_mov_b32 v113, 0
  v_mov_b32 v114, 0
  v_mov_b32 v115, 0
  v_mov_b32 v116, 0
  v_mov_b32 v117, 0
  v_mov_b32 v118, 0
  v_mov_b32 v119, 0
  v_mov_b32 v120, 0
  v_mov_b32 v121, 0
  v_mov_b32 v122, 0
  v_mov_b32 v123, 0
  v_mov_b32 v124, 0
  v_mov_b32 v125, 0
  v_mov_b32 v126, 0
  v_mov_b32 v127, 0
  buffer_load_dwordx4 v[80:83], v8, s[4:7], s43 offen offset:0 sc1
  buffer_load_dwordx4 v[84:87], v8, s[4:7], s43 offen offset:1024 sc1
  buffer_load_dwordx4 v[88:91], v8, s[4:7], s43 offen offset:2048 sc1
  buffer_load_dwordx4 v[92:95], v8, s[4:7], s43 offen offset:3072 sc1
  buffer_load_dwordx4 v[96:99], v9, s[4:7], s43 offen offset:0 sc1
  buffer_load_dwordx4 v[100:103], v9, s[4:7], s43 offen offset:1024 sc1
  buffer_load_dwordx4 v[104:107], v9, s[4:7], s43 offen offset:2048 sc1
  buffer_load_dwordx4 v[108:111], v9, s[4:7], s43 offen offset:3072 sc1
  s_add_u32 s30, s30, 1
  s_cmp_lt_u32 s30, 0x100000
  s_cbranch_scc1 L_B_oproc
  s_branch L_abort
L_roleG1:
  s_mov_b32 s16, s64
  s_mov_b32 s17, s65
  s_mov_b32 s18, 0x400000
  s_mov_b32 s19, 0x20000
  s_mul_i32 s47, s26, 1572864
  s_mov_b32 s40, 8192
  s_mov_b32 s42, 24576
  s_cmp_eq_u32 s27, 4
  s_cbranch_scc1 L_G1_k
  s_cmp_eq_u32 s27, 5
  s_cbranch_scc1 L_G1_v
  s_cmp_eq_u32 s27, 6
  s_cbranch_scc1 L_G1_f
L_G1_q:
  s_mov_b32 s12, s68
  s_mov_b32 s13, s69
  s_mov_b32 s14, 0x800000
  s_mov_b32 s15, 0x20000
  s_add_u32 s47, s47, 0x804000
  s_add_u32 s44, s26, 0
  s_lshl_b32 s44, s44, 7
  s_add_u32 s44, s44, 0x400000
  s_lshl_b32 s31, s24, 2
  s_add_u32 s44, s44, s31
  s_branch L_G1_go
L_G1_k:
  s_mov_b32 s12, s70
  s_mov_b32 s13, s71
  s_mov_b32 s14, 0x800000
  s_mov_b32 s15, 0x20000
  s_add_u32 s47, s47, 0x800000
  s_add_u32 s44, s26, 32
  s_lshl_b32 s44, s44, 7
  s_add_u32 s44, s44, 0x400000
  s_lshl_b32 s31, s24, 2
  s_add_u32 s44, s44, s31
  s_branch L_G1_go
L_G1_v:
  s_mov_b32 s12, s72
  s_mov_b32 s13, s73
  s_mov_b32 s14, 0x800000
  s_mov_b32 s15, 0x20000
  s_add_u32 s47, s47, 0x802000
  s_add_u32 s44, s26, 64
  s_lshl_b32 s44, s44, 7
  s_add_u32 s44, s44, 0x400000
  s_lshl_b32 s31, s24, 2
  s_add_u32 s44, s44, s31
  s_branch L_G1_go
L_G1_f:
  s_mov_b32 s12, s80
  s_mov_b32 s13, s81
  s_mov_b32 s14, 0x700000
  s_mov_b32 s15, 0x20000
  s_lshl_b32 s47, s26, 13
  s_mov_b32 s40, 7168
  s_mov_b32 s42, 229376
  s_add_u32 s47, s47, 0x3800000
  s_add_u32 s44, s26, 96
  s_lshl_b32 s44, s44, 7
  s_add_u32 s44, s44, 0x400000
  s_lshl_b32 s31, s24, 2
  s_add_u32 s44, s44, s31
L_G1_go:
  s_lshl_b32 s31, s24, 11
  v_mov_b32 v4, 0x0
  v_bfe_u32 v6, v0, 0, 6
  v_lshl_add_u32 v4, v6, 4, v4
  v_add_u32 v4, s31, v4
  s_lshl_b32 s31, s24, 2
  v_lshrrev_b32 v6, 4, v0
  v_add_u32 v6, s31, v6
  v_xor_b32 v6, v6, v0
  v_and_b32 v6, 7, v6
  v_lshlrev_b32 v3, 4, v6
  v_lshrrev_b32 v6, 3, v0
  v_lshl_add_u32 v3, v6, 11, v3
  s_lshl_b32 s31, s24, 14
  v_add_u32 v3, s31, v3
  s_lshl_b32 s46, s24, 10
  s_mov_b32 s43, 0
  s_lshl_b32 s32, s26, 8
  s_lshl_b32 s33, s24, 4
  v_mov_b32 v1, 0x0
  v_bfe_u32 v6, v0, 4, 2
  v_lshl_add_u32 v1, v6, 0, v1
  v_add_u32 v1, s33, v1
  v_mul_lo_u32 v1, v1, s40
  v_mov_b32 v2, 0x0
  v_bfe_u32 v6, v0, 0, 4
  v_lshl_add_u32 v2, v6, 4, v2
  v_bfe_u32 v6, v0, 4, 2
  v_lshlrev_b32 v6, 5, v6
  v_xor_b32 v2, v2, v6
  v_add3_u32 v1, v1, v2, s32
  v_xor_b32 v2, 128, v1
  s_lshl_b32 s33, s24, 6
  v_mov_b32 v12, 0x0
  v_bfe_u32 v6, v0, 2, 2
  v_lshl_add_u32 v12, v6, 5, v12
  v_bfe_u32 v6, v0, 4, 1
  v_lshl_add_u32 v12, v6, 7, v12
  v_xor_b32 v12, s33, v12
  v_mov_b32 v13, 0x10000
  v_bfe_u32 v6, v0, 4, 2
  v_lshl_add_u32 v13, v6, 11, v13
  v_bfe_u32 v6, v0, 2, 2
  v_lshl_add_u32 v13, v6, 8, v13
  v_bfe_u32 v6, v0, 0, 2
  v_lshl_add_u32 v13, v6, 3, v13
  v_add_u32 v12, v12, v13
  v_xor_b32 v13, 32, v12
  v_add_u32 v14, 0x10000, v12
  v_add_u32 v15, 0x10000, v13
  s_lshl_b32 s45, s24, 12
  s_cmp_lg_u32 s27, 6
  s_cbranch_scc1 L_G1_now_59
  s_cmp_lg_u32 s36, 0
  s_cbranch_scc1 L_ci_60
  s_waitcnt vmcnt(0)
  v_readfirstlane_b32 s62, v30
  s_barrier
  s_cmp_lg_u32 s24, 0
  s_cbranch_scc1 L_ci_60
  s_lshr_b32 s32, s2, 3
  s_lshl_b32 s31, 1, s32
  s_lshl_b32 s32, s39, 2
  v_mov_b32 v22, s31
  s_mov_b64 exec, 1
  buffer_atomic_or v22, off, s[8:11], s32 sc0 sc1
  s_mov_b64 exec, -1
L_ci_60:
  s_waitcnt vmcnt(0)
  s_cmp_lg_u32 s36, 0
  s_cbranch_scc1 L_cf_61
  s_cmp_lg_u32 s24, 0
  s_cbranch_scc1 L_cf_62
  s_mov_b32 s37, s39
  s_lshr_b32 s38, s2, 3
  s_mov_b64 exec, 1
L_cf_63:
  v_readfirstlane_b32 s33, v22
  s_lshl_b32 s31, 1, s38
  s_and_b32 s34, s33, s31
  s_cbranch_scc0 L_cf_64
  s_not_b32 s33, s33
  s_cbranch_scc1 L_cf_66
  s_add_u32 s37, s37, 1
  s_and_b32 s37, s37, 7
  s_mov_b32 s31, 256
  s_cmp_eq_u32 s37, s39
  s_cbranch_scc1 L_cf_65
  s_lshl_b32 s33, 1, s38
L_cf_66:
  s_ff1_i32_b32 s38, s33
  s_lshl_b32 s31, 1, s38
  s_lshl_b32 s32, s37, 2
  v_mov_b32 v22, s31
  buffer_atomic_or v22, off, s[8:11], s32 sc0 sc1
  s_waitcnt vmcnt(0)
  s_branch L_cf_63
L_cf_64:
  s_or_b32 s33, s33, s31
  s_cmp_eq_u32 s33, -1
  s_cbranch_scc0 L_cf_67
  v_mov_b32 v22, 1
  buffer_atomic_add v22, off, s[8:11], 0 offset:128 sc0 sc1
  s_waitcnt vmcnt(0)
  v_readfirstlane_b32 s33, v22
  s_nop 0
  s_cmp_eq_u32 s33, 7
  s_cbranch_scc0 L_cf_67
  buffer_load_dwordx2 v[22:23], off, s[8:11], 0 offset:136 sc1
  s_waitcnt vmcnt(0)
  v_readfirstlane_b32 s33, v22
  v_readfirstlane_b32 s34, v23
  s_mov_b64 exec, 0xff
  s_mov_b32 s32, 0x408000
  v_lshlrev_b32 v23, 7, v0
  buffer_load_dword v22, v23, s[4:7], s32 offen sc1
  s_cmp_gt_u32 s34, s33
  s_cselect_b32 s33, 1, 0
  s_waitcnt vmcnt(0)
  v_add_u32 v22, 2, v22
  v_and_b32 v22, -2, v22
  v_or_b32 v22, s33, v22
  buffer_store_dword v22, v23, s[4:7], s32 offen sc1
  s_mov_b64 exec, 1
L_cf_67:
  s_lshl_b32 s31, s37, 5
  s_add_u32 s31, s31, s38
L_cf_65:
  v_mov_b32 v22, s31
  v_mov_b32 v23, 163836
  ds_write_b32 v23, v22
  s_waitcnt lgkmcnt(0)
  s_mov_b64 exec, -1
L_cf_62:
  s_barrier
  v_mov_b32 v23, 163836
  ds_read_b32 v22, v23
  s_mov_b32 s36, 1
  s_waitcnt lgkmcnt(0)
  v_readfirstlane_b32 s31, v22
  s_nop 0
  s_cmp_ge_u32 s31, 256
  s_cbranch_scc1 L_exit
  s_cmp_eq_u32 s31, s35
  s_cbranch_scc1 L_cf_61
  s_mov_b32 s35, s31
  s_waitcnt vmcnt(0)
  s_barrier
  s_branch L_dispatch
L_cf_61:
L_wi_68:
  buffer_load_dword v16, off, s[4:7], s63 sc1
  s_waitcnt vmcnt(0)
  v_readfirstlane_b32 s32, v16
  s_nop 0
  s_cmp_lg_u32 s32, s62
  s_cbranch_scc1 L_wi_ok_69
  s_sleep 8
  s_add_u32 s30, s30, 1
  s_cmp_lt_u32 s30, 0x100000
  s_cbranch_scc1 L_wi_68
  s_branch L_abort
L_wi_ok_69:
  s_and_b32 s32, s32, 1
  s_lshl_b32 s32, s32, 13
  s_add_u32 s28, s28, s32
  s_add_u32 s32, s26, 160
  s_lshl_b32 s32, s32, 7
  s_add_u32 s32, s32, 0x400000
L_df_70:
  buffer_load_dword v16, off, s[4:7], s32 sc1
  s_waitcnt vmcnt(0)
  v_readfirstlane_b32 s31, v16
  s_nop 0
  s_cmp_ge_u32 s31, 1
  s_cbranch_scc1 L_df_ok_71
  s_sleep 8
  s_add_u32 s30, s30, 1
  s_cmp_lt_u32 s30, 0x100000
  s_cbranch_scc1 L_df_70
  s_branch L_abort
L_df_ok_71:
  s_mul_i32 s31, s40, 0
  s_add_u32 m0, s45, 65536
  s_nop 0
  buffer_load_dwordx4 v1, s[12:15], s31 offen lds
  s_mul_i32 s31, s40, 4
  s_add_u32 m0, s45, 66560
  s_nop 0
  buffer_load_dwordx4 v1, s[12:15], s31 offen lds
  s_mul_i32 s31, s40, 8
  s_add_u32 m0, s45, 67584
  s_nop 0
  buffer_load_dwordx4 v2, s[12:15], s31 offen lds
  s_mul_i32 s31, s40, 12
  s_add_u32 m0, s45, 68608
  s_nop 0
  buffer_load_dwordx4 v2, s[12:15], s31 offen lds
  s_waitcnt vmcnt(0)
  s_barrier
  s_mul_i32 s31, s40, 64
  s_add_u32 m0, s45, 81920
  s_nop 0
  buffer_load_dwordx4 v1, s[12:15], s31 offen lds
  s_mul_i32 s31, s40, 68
  s_add_u32 m0, s45, 82944
  s_nop 0
  buffer_load_dwordx4 v1, s[12:15], s31 offen lds
  s_mul_i32 s31, s40, 72
  s_add_u32 m0, s45, 83968
  s_nop 0
  buffer_load_dwordx4 v2, s[12:15], s31 offen lds
  s_mul_i32 s31, s40, 76
  s_add_u32 m0, s45, 84992
  s_nop 0
  buffer_load_dwordx4 v2, s[12:15], s31 offen lds
  ds_read_b64_tr_b16 a[0:1], v12 offset:0
  ds_read_b64_tr_b16 a[2:3], v12 offset:1024
  ds_read_b64_tr_b16 a[8:9], v12 offset:8192
  ds_read_b64_tr_b16 a[10:11], v12 offset:9216
  ds_read_b64_tr_b16 a[4:5], v13 offset:0
  ds_read_b64_tr_b16 a[6:7], v13 offset:1024
  ds_read_b64_tr_b16 a[12:13], v13 offset:8192
  ds_read_b64_tr_b16 a[14:15], v13 offset:9216
  s_waitcnt lgkmcnt(0)
  s_waitcnt vmcnt(0)
  s_barrier
  s_mul_i32 s31, s40, 128
  s_add_u32 m0, s45, 65536
  s_nop 0
  buffer_load_dwordx4 v1, s[12:15], s31 offen lds
  s_mul_i32 s31, s40, 132
  s_add_u32 m0, s45, 66560
  s_nop 0
  buffer_load_dwordx4 v1, s[12:15], s31 offen lds
  s_mul_i32 s31, s40, 136
  s_add_u32 m0, s45, 67584
  s_nop 0
  buffer_load_dwordx4 v2, s[12:15], s31 offen lds
  s_mul_i32 s31, s40, 140
  s_add_u32 m0, s45, 68608
  s_nop 0
  buffer_load_dwordx4 v2, s[12:15], s31 offen lds
  ds_read_b64_tr_b16 a[16:17], v12 offset:16384
  ds_read_b64_tr_b16 a[18:19], v12 offset:17408
  ds_read_b64_tr_b16 a[24:25], v12 offset:24576
  ds_read_b64_tr_b16 a[26:27], v12 offset:25600
  ds_read_b64_tr_b16 a[20:21], v13 offset:16384
  ds_read_b64_tr_b16 a[22:23], v13 offset:17408
  ds_read_b64_tr_b16 a[28:29], v13 offset:24576
  ds_read_b64_tr_b16 a[30:31], v13 offset:25600
  s_waitcnt lgkmcnt(0)
  s_waitcnt vmcnt(0)
  s_barrier
  s_mul_i32 s31, s40, 192
  s_add_u32 m0, s45, 81920
  s_nop 0
  buffer_load_dwordx4 v1, s[12:15], s31 offen lds
  s_mul_i32 s31, s40, 196
  s_add_u32 m0, s45, 82944
  s_nop 0
  buffer_load_dwordx4 v1, s[12:15], s31 offen lds
  s_mul_i32 s31, s40, 200
  s_add_u32 m0, s45, 83968
  s_nop 0
  buffer_load_dwordx4 v2, s[12:15], s31 offen lds
  s_mul_i32 s31, s40, 204
  s_add_u32 m0, s45, 84992
  s_nop 0
  buffer_load_dwordx4 v2, s[12:15], s31 offen lds
  ds_read_b64_tr_b16 a[32:33], v12 offset:0
  ds_read_b64_tr_b16 a[34:35], v12 offset:1024
  ds_read_b64_tr_b16 a[40:41], v12 offset:8192
  ds_read_b64_tr_b16 a[42:43], v12 offset:9216
  ds_read_b64_tr_b16 a[36:37], v13 offset:0
  ds_read_b64_tr_b16 a[38:39], v13 offset:1024
  ds_read_b64_tr_b16 a[44:45], v13 offset:8192
  ds_read_b64_tr_b16 a[46:47], v13 offset:9216
  s_waitcnt lgkmcnt(0)
  s_waitcnt vmcnt(0)
  s_barrier
  s_mul_i32 s31, s40, 256
  s_add_u32 m0, s45, 65536
  s_nop 0
  buffer_load_dwordx4 v1, s[12:15], s31 offen lds
  s_mul_i32 s31, s40, 260
  s_add_u32 m0, s45, 66560
  s_nop 0
  buffer_load_dwordx4 v1, s[12:15], s31 offen lds
  s_mul_i32 s31, s40, 264
  s_add_u32 m0, s45, 67584
  s_nop 0
  buffer_load_dwordx4 v2, s[12:15], s31 offen lds
  s_mul_i32 s31, s40, 268
  s_add_u32 m0, s45, 68608
  s_nop 0
  buffer_load_dwordx4 v2, s[12:15], s31 offen lds
  ds_read_b64_tr_b16 a[48:49], v12 offset:16384
  ds_read_b64_tr_b16 a[50:51], v12 offset:17408
  ds_read_b64_tr_b16 a[56:57], v12 offset:24576
  ds_read_b64_tr_b16 a[58:59], v12 offset:25600
  ds_read_b64_tr_b16 a[52:53], v13 offset:16384
  ds_read_b64_tr_b16 a[54:55], v13 offset:17408
  ds_read_b64_tr_b16 a[60:61], v13 offset:24576
  ds_read_b64_tr_b16 a[62:63], v13 offset:25600
  s_waitcnt lgkmcnt(0)
  s_waitcnt vmcnt(0)
  s_barrier
  s_mul_i32 s31, s40, 320
  s_add_u32 m0, s45, 81920
  s_nop 0
  buffer_load_dwordx4 v1, s[12:15], s31 offen lds
  s_mul_i32 s31, s40, 324
  s_add_u32 m0, s45, 82944
  s_nop 0
  buffer_load_dwordx4 v1, s[12:15], s31 offen lds
  s_mul_i32 s31, s40, 328
  s_add_u32 m0, s45, 83968
  s_nop 0
  buffer_load_dwordx4 v2, s[12:15], s31 offen lds
  s_mul_i32 s31, s40, 332
  s_add_u32 m0, s45, 84992
  s_nop 0
  buffer_load_dwordx4 v2, s[12:15], s31 offen lds
  ds_read_b64_tr_b16 a[64:65], v12 offset:0
  ds_read_b64_tr_b16 a[66:67], v12 offset:1024
  ds_read_b64_tr_b16 a[72:73], v12 offset:8192
  ds_read_b64_tr_b16 a[74:75], v12 offset:9216
  ds_read_b64_tr_b16 a[68:69], v13 offset:0
  ds_read_b64_tr_b16 a[70:71], v13 offset:1024
  ds_read_b64_tr_b16 a[76:77], v13 offset:8192
  ds_read_b64_tr_b16 a[78:79], v13 offset:9216
  s_waitcnt lgkmcnt(0)
  s_waitcnt vmcnt(0)
  s_barrier
  s_mul_i32 s31, s40, 384
  s_add_u32 m0, s45, 65536
  s_nop 0
  buffer_load_dwordx4 v1, s[12:15], s31 offen lds
  s_mul_i32 s31, s40, 388
  s_add_u32 m0, s45, 66560
  s_nop 0
  buffer_load_dwordx4 v1, s[12:15], s31 offen lds
  s_mul_i32 s31, s40, 392
  s_add_u32 m0, s45, 67584
  s_nop 0
  buffer_load_dwordx4 v2, s[12:15], s31 offen lds
  s_mul_i32 s31, s40, 396
  s_add_u32 m0, s45, 68608
  s_nop 0
  buffer_load_dwordx4 v2, s[12:15], s31 offen lds
  ds_read_b64_tr_b16 a[80:81], v12 offset:16384
  ds_read_b64_tr_b16 a[82:83], v12 offset:17408
  ds_read_b64_tr_b16 a[88:89], v12 offset:24576
  ds_read_b64_tr_b16 a[90:91], v12 offset:25600
  ds_read_b64_tr_b16 a[84:85], v13 offset:16384
  ds_read_b64_tr_b16 a[86:87], v13 offset:17408
  ds_read_b64_tr_b16 a[92:93], v13 offset:24576
  ds_read_b64_tr_b16 a[94:95], v13 offset:25600
  s_waitcnt lgkmcnt(0)
  s_waitcnt vmcnt(0)
  s_barrier
  s_mul_i32 s31, s40, 448
  s_add_u32 m0, s45, 81920
  s_nop 0
  buffer_load_dwordx4 v1, s[12:15], s31 offen lds
  s_mul_i32 s31, s40, 452
  s_add_u32 m0, s45, 82944
  s_nop 0
  buffer_load_dwordx4 v1, s[12:15], s31 offen lds
  s_mul_i32 s31, s40, 456
  s_add_u32 m0, s45, 83968
  s_nop 0
  buffer_load_dwordx4 v2, s[12:15], s31 offen lds
  s_mul_i32 s31, s40, 460
  s_add_u32 m0, s45, 84992
  s_nop 0
  buffer_load_dwordx4 v2, s[12:15], s31 offen lds
  ds_read_b64_tr_b16 a[96:97], v12 offset:0
  ds_read_b64_tr_b16 a[98:99], v12 offset:1024
  ds_read_b64_tr_b16 a[104:105], v12 offset:8192
  ds_read_b64_tr_b16 a[106:107], v12 offset:9216
  ds_read_b64_tr_b16 a[100:101], v13 offset:0
  ds_read_b64_tr_b16 a[102:103], v13 offset:1024
  ds_read_b64_tr_b16 a[108:109], v13 offset:8192
  ds_read_b64_tr_b16 a[110:111], v13 offset:9216
  s_waitcnt lgkmcnt(0)
  s_waitcnt vmcnt(0)
  s_barrier
  s_mul_i32 s31, s40, 512
  s_add_u32 m0, s45, 65536
  s_nop 0
  buffer_load_dwordx4 v1, s[12:15], s31 offen lds
  s_mul_i32 s31, s40, 516
  s_add_u32 m0, s45, 66560
  s_nop 0
  buffer_load_dwordx4 v1, s[12:15], s31 offen lds
  s_mul_i32 s31, s40, 520
  s_add_u32 m0, s45, 67584
  s_nop 0
  buffer_load_dwordx4 v2, s[12:15], s31 offen lds
  s_mul_i32 s31, s40, 524
  s_add_u32 m0, s45, 68608
  s_nop 0
  buffer_load_dwordx4 v2, s[12:15], s31 offen lds
  ds_read_b64_tr_b16 a[112:113], v12 offset:16384
  ds_read_b64_tr_b16 a[114:115], v12 offset:17408
  ds_read_b64_tr_b16 a[120:121], v12 offset:24576
  ds_read_b64_tr_b16 a[122:123], v12 offset:25600
  ds_read_b64_tr_b16 a[116:117], v13 offset:16384
  ds_read_b64_tr_b16 a[118:119], v13 offset:17408
  ds_read_b64_tr_b16 a[124:125], v13 offset:24576
  ds_read_b64_tr_b16 a[126:127], v13 offset:25600
  s_waitcnt lgkmcnt(0)
  s_waitcnt vmcnt(0)
  s_barrier
  s_mul_i32 s31, s40, 576
  s_add_u32 m0, s45, 81920
  s_nop 0
  buffer_load_dwordx4 v1, s[12:15], s31 offen lds
  s_mul_i32 s31, s40, 580
  s_add_u32 m0, s45, 82944
  s_nop 0
  buffer_load_dwordx4 v1, s[12:15], s31 offen lds
  s_mul_i32 s31, s40, 584
  s_add_u32 m0, s45, 83968
  s_nop 0
  buffer_load_dwordx4 v2, s[12:15], s31 offen lds
  s_mul_i32 s31, s40, 588
  s_add_u32 m0, s45, 84992
  s_nop 0
  buffer_load_dwordx4 v2, s[12:15], s31 offen lds
  ds_read_b64_tr_b16 a[128:129], v12 offset:0
  ds_read_b64_tr_b16 a[130:131], v12 offset:1024
  ds_read_b64_tr_b16 a[136:137], v12 offset:8192
  ds_read_b64_tr_b16 a[138:139], v12 offset:9216
  ds_read_b64_tr_b16 a[132:133], v13 offset:0
  ds_read_b64_tr_b16 a[134:135], v13 offset:1024
  ds_read_b64_tr_b16 a[140:141], v13 offset:8192
  ds_read_b64_tr_b16 a[142:143], v13 offset:9216
  s_waitcnt lgkmcnt(0)
  s_waitcnt vmcnt(0)
  s_barrier
  s_mul_i32 s31, s40, 640
  s_add_u32 m0, s45, 65536
  s_nop 0
  buffer_load_dwordx4 v1, s[12:15], s31 offen lds
  s_mul_i32 s31, s40, 644
  s_add_u32 m0, s45, 66560
  s_nop 0
  buffer_load_dwordx4 v1, s[12:15], s31 offen lds
  s_mul_i32 s31, s40, 648
  s_add_u32 m0, s45, 67584
  s_nop 0
  buffer_load_dwordx4 v2, s[12:15], s31 offen lds
  s_mul_i32 s31, s40, 652
  s_add_u32 m0, s45, 68608
  s_nop 0
  buffer_load_dwordx4 v2, s[12:15], s31 offen lds
  ds_read_b64_tr_b16 a[144:145], v12 offset:16384
  ds_read_b64_tr_b16 a[146:147], v12 offset:17408
  ds_read_b64_tr_b16 a[152:153], v12 offset:24576
  ds_read_b64_tr_b16 a[154:155], v12 offset:25600
  ds_read_b64_tr_b16 a[148:149], v13 offset:16384
  ds_read_b64_tr_b16 a[150:151], v13 offset:17408
  ds_read_b64_tr_b16 a[156:157], v13 offset:24576
  ds_read_b64_tr_b16 a[158:159], v13 offset:25600
  s_waitcnt lgkmcnt(0)
  s_waitcnt vmcnt(0)
  s_barrier
  s_mul_i32 s31, s40, 704
  s_add_u32 m0, s45, 81920
  s_nop 0
  buffer_load_dwordx4 v1, s[12:15], s31 offen lds
  s_mul_i32 s31, s40, 708
  s_add_u32 m0, s45, 82944
  s_nop 0
  buffer_load_dwordx4 v1, s[12:15], s31 offen lds
  s_mul_i32 s31, s40, 712
  s_add_u32 m0, s45, 83968
  s_nop 0
  buffer_load_dwordx4 v2, s[12:15], s31 offen lds
  s_mul_i32 s31, s40, 716
  s_add_u32 m0, s45, 84992
  s_nop 0
  buffer_load_dwordx4 v2, s[12:15], s31 offen lds
  ds_read_b64_tr_b16 a[160:161], v12 offset:0
  ds_read_b64_tr_b16 a[162:163], v12 offset:1024
  ds_read_b64_tr_b16 a[168:169], v12 offset:8192
  ds_read_b64_tr_b16 a[170:171], v12 offset:9216
  ds_read_b64_tr_b16 a[164:165], v13 offset:0
  ds_read_b64_tr_b16 a[166:167], v13 offset:1024
  ds_read_b64_tr_b16 a[172:173], v13 offset:8192
  ds_read_b64_tr_b16 a[174:175], v13 offset:9216
  s_waitcnt lgkmcnt(0)
  s_waitcnt vmcnt(0)
  s_barrier
  s_mul_i32 s31, s40, 768
  s_add_u32 m0, s45, 65536
  s_nop 0
  buffer_load_dwordx4 v1, s[12:15], s31 offen lds
  s_mul_i32 s31, s40, 772
  s_add_u32 m0, s45, 66560
  s_nop 0
  buffer_load_dwordx4 v1, s[12:15], s31 offen lds
  s_mul_i32 s31, s40, 776
  s_add_u32 m0, s45, 67584
  s_nop 0
  buffer_load_dwordx4 v2, s[12:15], s31 offen lds
  s_mul_i32 s31, s40, 780
  s_add_u32 m0, s45, 68608
  s_nop 0
  buffer_load_dwordx4 v2, s[12:15], s31 offen lds
  ds_read_b64_tr_b16 a[176:177], v12 offset:16384
  ds_read_b64_tr_b16 a[178:179], v12 offset:17408
  ds_read_b64_tr_b16 a[184:185], v12 offset:24576
  ds_read_b64_tr_b16 a[186:187], v12 offset:25600
  ds_read_b64_tr_b16 a[180:181], v13 offset:16384
  ds_read_b64_tr_b16 a[182:183], v13 offset:17408
  ds_read_b64_tr_b16 a[188:189], v13 offset:24576
  ds_read_b64_tr_b16 a[190:191], v13 offset:25600
  s_waitcnt lgkmcnt(0)
  s_add_u32 m0, s46, 0
  s_nop 0
  buffer_load_dwordx4 v3, s[16:19], s43 offen offset:0 lds
  s_add_u32 m0, s46, 3968
  s_nop 0
  buffer_load_dwordx4 v3, s[16:19], s43 offen offset:128 lds
  s_add_u32 m0, s46, 7936
  s_nop 0
  buffer_load_dwordx4 v3, s[16:19], s43 offen offset:256 lds
  s_add_u32 m0, s46, 11904
  s_nop 0
  buffer_load_dwordx4 v3, s[16:19], s43 offen offset:384 lds
  s_add_u32 m0, s46, 15872
  s_nop 0
  buffer_load_dwordx4 v3, s[16:19], s43 offen offset:512 lds
  s_add_u32 m0, s46, 19840
  s_nop 0
  buffer_load_dwordx4 v3, s[16:19], s43 offen offset:640 lds
  s_add_u32 m0, s46, 23808
  s_nop 0
  buffer_load_dwordx4 v3, s[16:19], s43 offen offset:768 lds
  s_add_u32 m0, s46, 27776
  s_nop 0
  buffer_load_dwordx4 v3, s[16:19], s43 offen offset:896 lds
  s_add_u32 m0, s46, 31744
  s_nop 0
  buffer_load_dwordx4 v3, s[16:19], s43 offen offset:1024 lds
  s_add_u32 m0, s46, 35712
  s_nop 0
  buffer_load_dwordx4 v3, s[16:19], s43 offen offset:1152 lds
  s_add_u32 m0, s46, 39680
  s_nop 0
  buffer_load_dwordx4 v3, s[16:19], s43 offen offset:1280 lds
  s_add_u32 m0, s46, 43648
  s_nop 0
  buffer_load_dwordx4 v3, s[16:19], s43 offen offset:1408 lds
  s_add_u32 m0, s46, 47616
  s_nop 0
  buffer_load_dwordx4 v3, s[16:19], s43 offen offset:1536 lds
  s_add_u32 m0, s46, 51584
  s_nop 0
  buffer_load_dwordx4 v3, s[16:19], s43 offen offset:1664 lds
  s_add_u32 m0, s46, 55552
  s_nop 0
  buffer_load_dwordx4 v3, s[16:19], s43 offen offset:1792 lds
  s_add_u32 m0, s46, 59520
  s_nop 0
  buffer_load_dwordx4 v3, s[16:19], s43 offen offset:1920 lds
  s_waitcnt vmcnt(16)
  s_barrier
  s_mul_i32 s31, s40, 832
  s_add_u32 m0, s45, 81920
  s_nop 0
  buffer_load_dwordx4 v1, s[12:15], s31 offen lds
  s_mul_i32 s31, s40, 836
  s_add_u32 m0, s45, 82944
  s_nop 0
  buffer_load_dwordx4 v1, s[12:15], s31 offen lds
  s_mul_i32 s31, s40, 840
  s_add_u32 m0, s45, 83968
  s_nop 0
  buffer_load_dwordx4 v2, s[12:15], s31 offen lds
  s_mul_i32 s31, s40, 844
  s_add_u32 m0, s45, 84992
  s_nop 0
  buffer_load_dwordx4 v2, s[12:15], s31 offen lds
  ds_read_b64_tr_b16 a[192:193], v12 offset:0
  ds_read_b64_tr_b16 a[194:195], v12 offset:1024
  ds_read_b64_tr_b16 a[200:201], v12 offset:8192
  ds_read_b64_tr_b16 a[202:203], v12 offset:9216
  ds_read_b64_tr_b16 a[196:197], v13 offset:0
  ds_read_b64_tr_b16 a[198:199], v13 offset:1024
  ds_read_b64_tr_b16 a[204:205], v13 offset:8192
  ds_read_b64_tr_b16 a[206:207], v13 offset:9216
  s_waitcnt lgkmcnt(0)
  s_waitcnt vmcnt(0)
  s_barrier
  s_mul_i32 s31, s40, 896
  s_add_u32 m0, s45, 65536
  s_nop 0
  buffer_load_dwordx4 v1, s[12:15], s31 offen lds
  s_mul_i32 s31, s40, 900
  s_add_u32 m0, s45, 66560
  s_nop 0
  buffer_load_dwordx4 v1, s[12:15], s31 offen lds
  s_mul_i32 s31, s40, 904
  s_add_u32 m0, s45, 67584
  s_nop 0
  buffer_load_dwordx4 v2, s[12:15], s31 offen lds
  s_mul_i32 s31, s40, 908
  s_add_u32 m0, s45, 68608
  s_nop 0
  buffer_load_dwordx4 v2, s[12:15], s31 offen lds
  ds_read_b64_tr_b16 a[208:209], v12 offset:16384
  ds_read_b64_tr_b16 a[210:211], v12 offset:17408
  ds_read_b64_tr_b16 a[216:217], v12 offset:24576
  ds_read_b64_tr_b16 a[218:219], v12 offset:25600
  ds_read_b64_tr_b16 a[212:213], v13 offset:16384
  ds_read_b64_tr_b16 a[214:215], v13 offset:17408
  ds_read_b64_tr_b16 a[220:221], v13 offset:24576
  ds_read_b64_tr_b16 a[222:223], v13 offset:25600
  s_waitcnt lgkmcnt(0)
  s_waitcnt vmcnt(0)
  s_barrier
  s_mul_i32 s31, s40, 960
  s_add_u32 m0, s45, 81920
  s_nop 0
  buffer_load_dwordx4 v1, s[12:15], s31 offen lds
  s_mul_i32 s31, s40, 964
  s_add_u32 m0, s45, 82944
  s_nop 0
  buffer_load_dwordx4 v1, s[12:15], s31 offen lds
  s_mul_i32 s31, s40, 968
  s_add_u32 m0, s45, 83968
  s_nop 0
  buffer_load_dwordx4 v2, s[12:15], s31 offen lds
  s_mul_i32 s31, s40, 972
  s_add_u32 m0, s45, 84992
  s_nop 0
  buffer_load_dwordx4 v2, s[12:15], s31 offen lds
  ds_read_b64_tr_b16 a[224:225], v12 offset:0
  ds_read_b64_tr_b16 a[226:227], v12 offset:1024
  ds_read_b64_tr_b16 a[232:233], v12 offset:8192
  ds_read_b64_tr_b16 a[234:235], v12 offset:9216
  ds_read_b64_tr_b16 a[228:229], v13 offset:0
  ds_read_b64_tr_b16 a[230:231], v13 offset:1024
  ds_read_b64_tr_b16 a[236:237], v13 offset:8192
  ds_read_b64_tr_b16 a[238:239], v13 offset:9216
  s_waitcnt lgkmcnt(0)
  s_waitcnt vmcnt(0)
  s_barrier
  ds_read_b64_tr_b16 a[240:241], v12 offset:16384
  ds_read_b64_tr_b16 a[242:243], v12 offset:17408
  ds_read_b64_tr_b16 a[248:249], v12 offset:24576
  ds_read_b64_tr_b16 a[250:251], v12 offset:25600
  ds_read_b64_tr_b16 a[244:245], v13 offset:16384
  ds_read_b64_tr_b16 a[246:247], v13 offset:17408
  ds_read_b64_tr_b16 a[252:253], v13 offset:24576
  ds_read_b64_tr_b16 a[254:255], v13 offset:25600
  s_waitcnt lgkmcnt(0)
  s_branch L_G1_loaded
L_G1_now_59:
  s_mul_i32 s31, s40, 0
  s_add_u32 m0, s45, 65536
  s_nop 0
  buffer_load_dwordx4 v1, s[12:15], s31 offen lds
  s_mul_i32 s31, s40, 4
  s_add_u32 m0, s45, 66560
  s_nop 0
  buffer_load_dwordx4 v1, s[12:15], s31 offen lds
  s_mul_i32 s31, s40, 8
  s_add_u32 m0, s45, 67584
  s_nop 0
  buffer_load_dwordx4 v2, s[12:15], s31 offen lds
  s_mul_i32 s31, s40, 12
  s_add_u32 m0, s45, 68608
  s_nop 0
  buffer_load_dwordx4 v2, s[12:15], s31 offen lds
  s_mul_i32 s31, s40, 64
  s_add_u32 m0, s45, 81920
  s_nop 0
  buffer_load_dwordx4 v1, s[12:15], s31 offen lds
  s_mul_i32 s31, s40, 68
  s_add_u32 m0, s45, 82944
  s_nop 0
  buffer_load_dwordx4 v1, s[12:15], s31 offen lds
  s_mul_i32 s31, s40, 72
  s_add_u32 m0, s45, 83968
  s_nop 0
  buffer_load_dwordx4 v2, s[12:15], s31 offen lds
  s_mul_i32 s31, s40, 76
  s_add_u32 m0, s45, 84992
  s_nop 0
  buffer_load_dwordx4 v2, s[12:15], s31 offen lds
  s_mul_i32 s31, s40, 128
  s_add_u32 m0, s45, 98304
  s_nop 0
  buffer_load_dwordx4 v1, s[12:15], s31 offen lds
  s_mul_i32 s31, s40, 132
  s_add_u32 m0, s45, 99328
  s_nop 0
  buffer_load_dwordx4 v1, s[12:15], s31 offen lds
  s_mul_i32 s31, s40, 136
  s_add_u32 m0, s45, 100352
  s_nop 0
  buffer_load_dwordx4 v2, s[12:15], s31 offen lds
  s_mul_i32 s31, s40, 140
  s_add_u32 m0, s45, 101376
  s_nop 0
  buffer_load_dwordx4 v2, s[12:15], s31 offen lds
  s_mul_i32 s31, s40, 192
  s_add_u32 m0, s45, 114688
  s_nop 0
  buffer_load_dwordx4 v1, s[12:15], s31 offen lds
  s_mul_i32 s31, s40, 196
  s_add_u32 m0, s45, 115712
  s_nop 0
  buffer_load_dwordx4 v1, s[12:15], s31 offen lds
  s_mul_i32 s31, s40, 200
  s_add_u32 m0, s45, 116736
  s_nop 0
  buffer_load_dwordx4 v2, s[12:15], s31 offen lds
  s_mul_i32 s31, s40, 204
  s_add_u32 m0, s45, 117760
  s_nop 0
  buffer_load_dwordx4 v2, s[12:15], s31 offen lds
  s_cmp_lg_u32 s36, 0
  s_cbranch_scc1 L_ci_72
  s_waitcnt vmcnt(16)
  v_readfirstlane_b32 s62, v30
  s_barrier
  s_cmp_lg_u32 s24, 0
  s_cbranch_scc1 L_ci_72
  s_lshr_b32 s32, s2, 3
  s_lshl_b32 s31, 1, s32
  s_lshl_b32 s32, s39, 2
  v_mov_b32 v22, s31
  s_mov_b64 exec, 1
  buffer_atomic_or v22, off, s[8:11], s32 sc0 sc1
  s_mov_b64 exec, -1
L_ci_72:
  s_waitcnt vmcnt(12)
  s_barrier
  s_mul_i32 s31, s40, 256
  s_add_u32 m0, s45, 131072
  s_nop 0
  buffer_load_dwordx4 v1, s[12:15], s31 offen lds
  s_mul_i32 s31, s40, 260
  s_add_u32 m0, s45, 132096
  s_nop 0
  buffer_load_dwordx4 v1, s[12:15], s31 offen lds
  s_mul_i32 s31, s40, 264
  s_add_u32 m0, s45, 133120
  s_nop 0
  buffer_load_dwordx4 v2, s[12:15], s31 offen lds
  s_mul_i32 s31, s40, 268
  s_add_u32 m0, s45, 134144
  s_nop 0
  buffer_load_dwordx4 v2, s[12:15], s31 offen lds
  ds_read_b64_tr_b16 a[0:1], v12 offset:0
  ds_read_b64_tr_b16 a[2:3], v12 offset:1024
  ds_read_b64_tr_b16 a[8:9], v12 offset:8192
  ds_read_b64_tr_b16 a[10:11], v12 offset:9216
  ds_read_b64_tr_b16 a[4:5], v13 offset:0
  ds_read_b64_tr_b16 a[6:7], v13 offset:1024
  ds_read_b64_tr_b16 a[12:13], v13 offset:8192
  ds_read_b64_tr_b16 a[14:15], v13 offset:9216
  s_waitcnt lgkmcnt(0)
  s_waitcnt vmcnt(12)
  s_barrier
  s_mul_i32 s31, s40, 320
  s_add_u32 m0, s45, 65536
  s_nop 0
  buffer_load_dwordx4 v1, s[12:15], s31 offen lds
  s_mul_i32 s31, s40, 324
  s_add_u32 m0, s45, 66560
  s_nop 0
  buffer_load_dwordx4 v1, s[12:15], s31 offen lds
  s_mul_i32 s31, s40, 328
  s_add_u32 m0, s45, 67584
  s_nop 0
  buffer_load_dwordx4 v2, s[12:15], s31 offen lds
  s_mul_i32 s31, s40, 332
  s_add_u32 m0, s45, 68608
  s_nop 0
  buffer_load_dwordx4 v2, s[12:15], s31 offen lds
  ds_read_b64_tr_b16 a[16:17], v12 offset:16384
  ds_read_b64_tr_b16 a[18:19], v12 offset:17408
  ds_read_b64_tr_b16 a[24:25], v12 offset:24576
  ds_read_b64_tr_b16 a[26:27], v12 offset:25600
  ds_read_b64_tr_b16 a[20:21], v13 offset:16384
  ds_read_b64_tr_b16 a[22:23], v13 offset:17408
  ds_read_b64_tr_b16 a[28:29], v13 offset:24576
  ds_read_b64_tr_b16 a[30:31], v13 offset:25600
  s_waitcnt lgkmcnt(0)
  s_waitcnt vmcnt(12)
  s_barrier
  s_mul_i32 s31, s40, 384
  s_add_u32 m0, s45, 81920
  s_nop 0
  buffer_load_dwordx4 v1, s[12:15], s31 offen lds
  s_mul_i32 s31, s40, 388
  s_add_u32 m0, s45, 82944
  s_nop 0
  buffer_load_dwordx4 v1, s[12:15], s31 offen lds
  s_mul_i32 s31, s40, 392
  s_add_u32 m0, s45, 83968
  s_nop 0
  buffer_load_dwordx4 v2, s[12:15], s31 offen lds
  s_mul_i32 s31, s40, 396
  s_add_u32 m0, s45, 84992
  s_nop 0
  buffer_load_dwordx4 v2, s[12:15], s31 offen lds
  ds_read_b64_tr_b16 a[32:33], v12 offset:32768
  ds_read_b64_tr_b16 a[34:35], v12 offset:33792
  ds_read_b64_tr_b16 a[40:41], v12 offset:40960
  ds_read_b64_tr_b16 a[42:43], v12 offset:41984
  ds_read_b64_tr_b16 a[36:37], v13 offset:32768
  ds_read_b64_tr_b16 a[38:39], v13 offset:33792
  ds_read_b64_tr_b16 a[44:45], v13 offset:40960
  ds_read_b64_tr_b16 a[46:47], v13 offset:41984
  s_waitcnt lgkmcnt(0)
  s_waitcnt vmcnt(12)
  s_barrier
  s_mul_i32 s31, s40, 448
  s_add_u32 m0, s45, 98304
  s_nop 0
  buffer_load_dwordx4 v1, s[12:15], s31 offen lds
  s_mul_i32 s31, s40, 452
  s_add_u32 m0, s45, 99328
  s_nop 0
  buffer_load_dwordx4 v1, s[12:15], s31 offen lds
  s_mul_i32 s31, s40, 456
  s_add_u32 m0, s45, 100352
  s_nop 0
  buffer_load_dwordx4 v2, s[12:15], s31 offen lds
  s_mul_i32 s31, s40, 460
  s_add_u32 m0, s45, 101376
  s_nop 0
  buffer_load_dwordx4 v2, s[12:15], s31 offen lds
  ds_read_b64_tr_b16 a[48:49], v12 offset:49152
  ds_read_b64_tr_b16 a[50:51], v12 offset:50176
  ds_read_b64_tr_b16 a[56:57], v12 offset:57344
  ds_read_b64_tr_b16 a[58:59], v12 offset:58368
  ds_read_b64_tr_b16 a[52:53], v13 offset:49152
  ds_read_b64_tr_b16 a[54:55], v13 offset:50176
  ds_read_b64_tr_b16 a[60:61], v13 offset:57344
  ds_read_b64_tr_b16 a[62:63], v13 offset:58368
  s_waitcnt lgkmcnt(0)
  s_waitcnt vmcnt(12)
  s_barrier
  s_mul_i32 s31, s40, 512
  s_add_u32 m0, s45, 114688
  s_nop 0
  buffer_load_dwordx4 v1, s[12:15], s31 offen lds
  s_mul_i32 s31, s40, 516
  s_add_u32 m0, s45, 115712
  s_nop 0
  buffer_load_dwordx4 v1, s[12:15], s31 offen lds
  s_mul_i32 s31, s40, 520
  s_add_u32 m0, s45, 116736
  s_nop 0
  buffer_load_dwordx4 v2, s[12:15], s31 offen lds
  s_mul_i32 s31, s40, 524
  s_add_u32 m0, s45, 117760
  s_nop 0
  buffer_load_dwordx4 v2, s[12:15], s31 offen lds
  ds_read_b64_tr_b16 a[64:65], v14 offset:0
  ds_read_b64_tr_b16 a[66:67], v14 offset:1024
  ds_read_b64_tr_b16 a[72:73], v14 offset:8192
  ds_read_b64_tr_b16 a[74:75], v14 offset:9216
  ds_read_b64_tr_b16 a[68:69], v15 offset:0
  ds_read_b64_tr_b16 a[70:71], v15 offset:1024
  ds_read_b64_tr_b16 a[76:77], v15 offset:8192
  ds_read_b64_tr_b16 a[78:79], v15 offset:9216
  s_waitcnt lgkmcnt(0)
  s_cmp_lg_u32 s36, 0
  s_cbranch_scc1 L_cf_73
  s_cmp_lg_u32 s24, 0
  s_cbranch_scc1 L_cf_74
  s_mov_b32 s37, s39
  s_lshr_b32 s38, s2, 3
  s_mov_b64 exec, 1
L_cf_75:
  v_readfirstlane_b32 s33, v22
  s_lshl_b32 s31, 1, s38
  s_and_b32 s34, s33, s31
  s_cbranch_scc0 L_cf_76
  s_not_b32 s33, s33
  s_cbranch_scc1 L_cf_78
  s_add_u32 s37, s37, 1
  s_and_b32 s37, s37, 7
  s_mov_b32 s31, 256
  s_cmp_eq_u32 s37, s39
  s_cbranch_scc1 L_cf_77
  s_lshl_b32 s33, 1, s38
L_cf_78:
  s_ff1_i32_b32 s38, s33
  s_lshl_b32 s31, 1, s38
  s_lshl_b32 s32, s37, 2
  v_mov_b32 v22, s31
  buffer_atomic_or v22, off, s[8:11], s32 sc0 sc1
  s_waitcnt vmcnt(0)
  s_branch L_cf_75
L_cf_76:
  s_or_b32 s33, s33, s31
  s_cmp_eq_u32 s33, -1
  s_cbranch_scc0 L_cf_79
  v_mov_b32 v22, 1
  buffer_atomic_add v22, off, s[8:11], 0 offset:128 sc0 sc1
  s_waitcnt vmcnt(0)
  v_readfirstlane_b32 s33, v22
  s_nop 0
  s_cmp_eq_u32 s33, 7
  s_cbranch_scc0 L_cf_79
  buffer_load_dwordx2 v[22:23], off, s[8:11], 0 offset:136 sc1
  s_waitcnt vmcnt(0)
  v_readfirstlane_b32 s33, v22
  v_readfirstlane_b32 s34, v23
  s_mov_b64 exec, 0xff
  s_mov_b32 s32, 0x408000
  v_lshlrev_b32 v23, 7, v0
  buffer_load_dword v22, v23, s[4:7], s32 offen sc1
  s_cmp_gt_u32 s34, s33
  s_cselect_b32 s33, 1, 0
  s_waitcnt vmcnt(0)
  v_add_u32 v22, 2, v22
  v_and_b32 v22, -2, v22
  v_or_b32 v22, s33, v22
  buffer_store_dword v22, v23, s[4:7], s32 offen sc1
  s_mov_b64 exec, 1
L_cf_79:
  s_lshl_b32 s31, s37, 5
  s_add_u32 s31, s31, s38
L_cf_77:
  v_mov_b32 v22, s31
  v_mov_b32 v23, 163836
  ds_write_b32 v23, v22
  s_waitcnt lgkmcnt(0)
  s_mov_b64 exec, -1
L_cf_74:
  s_barrier
  v_mov_b32 v23, 163836
  ds_read_b32 v22, v23
  s_mov_b32 s36, 1
  s_waitcnt lgkmcnt(0)
  v_readfirstlane_b32 s31, v22
  s_nop 0
  s_cmp_ge_u32 s31, 256
  s_cbranch_scc1 L_exit
  s_cmp_eq_u32 s31, s35
  s_cbranch_scc1 L_cf_73
  s_mov_b32 s35, s31
  s_waitcnt vmcnt(0)
  s_barrier
  s_branch L_dispatch
L_cf_73:
  s_waitcnt vmcnt(12)
  s_barrier
  s_mul_i32 s31, s40, 576
  s_add_u32 m0, s45, 131072
  s_nop 0
  buffer_load_dwordx4 v1, s[12:15], s31 offen lds
  s_mul_i32 s31, s40, 580
  s_add_u32 m0, s45, 132096
  s_nop 0
  buffer_load_dwordx4 v1, s[12:15], s31 offen lds
  s_mul_i32 s31, s40, 584
  s_add_u32 m0, s45, 133120
  s_nop 0
  buffer_load_dwordx4 v2, s[12:15], s31 offen lds
  s_mul_i32 s31, s40, 588
  s_add_u32 m0, s45, 134144
  s_nop 0
  buffer_load_dwordx4 v2, s[12:15], s31 offen lds
  ds_read_b64_tr_b16 a[80:81], v12 offset:0
  ds_read_b64_tr_b16 a[82:83], v12 offset:1024
  ds_read_b64_tr_b16 a[88:89], v12 offset:8192
  ds_read_b64_tr_b16 a[90:91], v12 offset:9216
  ds_read_b64_tr_b16 a[84:85], v13 offset:0
  ds_read_b64_tr_b16 a[86:87], v13 offset:1024
  ds_read_b64_tr_b16 a[92:93], v13 offset:8192
  ds_read_b64_tr_b16 a[94:95], v13 offset:9216
  s_waitcnt lgkmcnt(0)
  s_waitcnt vmcnt(12)
  s_barrier
  s_mul_i32 s31, s40, 640
  s_add_u32 m0, s45, 65536
  s_nop 0
  buffer_load_dwordx4 v1, s[12:15], s31 offen lds
  s_mul_i32 s31, s40, 644
  s_add_u32 m0, s45, 66560
  s_nop 0
  buffer_load_dwordx4 v1, s[12:15], s31 offen lds
  s_mul_i32 s31, s40, 648
  s_add_u32 m0, s45, 67584
  s_nop 0
  buffer_load_dwordx4 v2, s[12:15], s31 offen lds
  s_mul_i32 s31, s40, 652
  s_add_u32 m0, s45, 68608
  s_nop 0
  buffer_load_dwordx4 v2, s[12:15], s31 offen lds
  ds_read_b64_tr_b16 a[96:97], v12 offset:16384
  ds_read_b64_tr_b16 a[98:99], v12 offset:17408
  ds_read_b64_tr_b16 a[104:105], v12 offset:24576
  ds_read_b64_tr_b16 a[106:107], v12 offset:25600
  ds_read_b64_tr_b16 a[100:101], v13 offset:16384
  ds_read_b64_tr_b16 a[102:103], v13 offset:17408
  ds_read_b64_tr_b16 a[108:109], v13 offset:24576
  ds_read_b64_tr_b16 a[110:111], v13 offset:25600
  s_waitcnt lgkmcnt(0)
  s_waitcnt vmcnt(12)
  s_barrier
  s_mul_i32 s31, s40, 704
  s_add_u32 m0, s45, 81920
  s_nop 0
  buffer_load_dwordx4 v1, s[12:15], s31 offen lds
  s_mul_i32 s31, s40, 708
  s_add_u32 m0, s45, 82944
  s_nop 0
  buffer_load_dwordx4 v1, s[12:15], s31 offen lds
  s_mul_i32 s31, s40, 712
  s_add_u32 m0, s45, 83968
  s_nop 0
  buffer_load_dwordx4 v2, s[12:15], s31 offen lds
  s_mul_i32 s31, s40, 716
  s_add_u32 m0, s45, 84992
  s_nop 0
  buffer_load_dwordx4 v2, s[12:15], s31 offen lds
  ds_read_b64_tr_b16 a[112:113], v12 offset:32768
  ds_read_b64_tr_b16 a[114:115], v12 offset:33792
  ds_read_b64_tr_b16 a[120:121], v12 offset:40960
  ds_read_b64_tr_b16 a[122:123], v12 offset:41984
  ds_read_b64_tr_b16 a[116:117], v13 offset:32768
  ds_read_b64_tr_b16 a[118:119], v13 offset:33792
  ds_read_b64_tr_b16 a[124:125], v13 offset:40960
  ds_read_b64_tr_b16 a[126:127], v13 offset:41984
  s_waitcnt lgkmcnt(0)
  s_waitcnt vmcnt(12)
  s_barrier
  s_mul_i32 s31, s40, 768
  s_add_u32 m0, s45, 98304
  s_nop 0
  buffer_load_dwordx4 v1, s[12:15], s31 offen lds
  s_mul_i32 s31, s40, 772
  s_add_u32 m0, s45, 99328
  s_nop 0
  buffer_load_dwordx4 v1, s[12:15], s31 offen lds
  s_mul_i32 s31, s40, 776
  s_add_u32 m0, s45, 100352
  s_nop 0
  buffer_load_dwordx4 v2, s[12:15], s31 offen lds
  s_mul_i32 s31, s40, 780
  s_add_u32 m0, s45, 101376
  s_nop 0
  buffer_load_dwordx4 v2, s[12:15], s31 offen lds
  ds_read_b64_tr_b16 a[128:129], v12 offset:49152
  ds_read_b64_tr_b16 a[130:131], v12 offset:50176
  ds_read_b64_tr_b16 a[136:137], v12 offset:57344
  ds_read_b64_tr_b16 a[138:139], v12 offset:58368
  ds_read_b64_tr_b16 a[132:133], v13 offset:49152
  ds_read_b64_tr_b16 a[134:135], v13 offset:50176
  ds_read_b64_tr_b16 a[140:141], v13 offset:57344
  ds_read_b64_tr_b16 a[142:143], v13 offset:58368
  s_waitcnt lgkmcnt(0)
  s_waitcnt vmcnt(12)
  s_barrier
  s_mul_i32 s31, s40, 832
  s_add_u32 m0, s45, 114688
  s_nop 0
  buffer_load_dwordx4 v1, s[12:15], s31 offen lds
  s_mul_i32 s31, s40, 836
  s_add_u32 m0, s45, 115712
  s_nop 0
  buffer_load_dwordx4 v1, s[12:15], s31 offen lds
  s_mul_i32 s31, s40, 840
  s_add_u32 m0, s45, 116736
  s_nop 0
  buffer_load_dwordx4 v2, s[12:15], s31 offen lds
  s_mul_i32 s31, s40, 844
  s_add_u32 m0, s45, 117760
  s_nop 0
  buffer_load_dwordx4 v2, s[12:15], s31 offen lds
  ds_read_b64_tr_b16 a[144:145], v14 offset:0
  ds_read_b64_tr_b16 a[146:147], v14 offset:1024
  ds_read_b64_tr_b16 a[152:153], v14 offset:8192
  ds_read_b64_tr_b16 a[154:155], v14 offset:9216
  ds_read_b64_tr_b16 a[148:149], v15 offset:0
  ds_read_b64_tr_b16 a[150:151], v15 offset:1024
  ds_read_b64_tr_b16 a[156:157], v15 offset:8192
  ds_read_b64_tr_b16 a[158:159], v15 offset:9216
  s_waitcnt lgkmcnt(0)
  s_waitcnt vmcnt(12)
  s_barrier
  s_mul_i32 s31, s40, 896
  s_add_u32 m0, s45, 131072
  s_nop 0
  buffer_load_dwordx4 v1, s[12:15], s31 offen lds
  s_mul_i32 s31, s40, 900
  s_add_u32 m0, s45, 132096
  s_nop 0
  buffer_load_dwordx4 v1, s[12:15], s31 offen lds
  s_mul_i32 s31, s40, 904
  s_add_u32 m0, s45, 133120
  s_nop 0
  buffer_load_dwordx4 v2, s[12:15], s31 offen lds
  s_mul_i32 s31, s40, 908
  s_add_u32 m0, s45, 134144
  s_nop 0
  buffer_load_dwordx4 v2, s[12:15], s31 offen lds
  ds_read_b64_tr_b16 a[160:161], v12 offset:0
  ds_read_b64_tr_b16 a[162:163], v12 offset:1024
  ds_read_b64_tr_b16 a[168:169], v12 offset:8192
  ds_read_b64_tr_b16 a[170:171], v12 offset:9216
  ds_read_b64_tr_b16 a[164:165], v13 offset:0
  ds_read_b64_tr_b16 a[166:167], v13 offset:1024
  ds_read_b64_tr_b16 a[172:173], v13 offset:8192
  ds_read_b64_tr_b16 a[174:175], v13 offset:9216
  s_waitcnt lgkmcnt(0)
  s_waitcnt vmcnt(12)
  s_barrier
  s_mul_i32 s31, s40, 960
  s_add_u32 m0, s45, 65536
  s_nop 0
  buffer_load_dwordx4 v1, s[12:15], s31 offen lds
  s_mul_i32 s31, s40, 964
  s_add_u32 m0, s45, 66560
  s_nop 0
  buffer_load_dwordx4 v1, s[12:15], s31 offen lds
  s_mul_i32 s31, s40, 968
  s_add_u32 m0, s45, 67584
  s_nop 0
  buffer_load_dwordx4 v2, s[12:15], s31 offen lds
  s_mul_i32 s31, s40, 972
  s_add_u32 m0, s45, 68608
  s_nop 0
  buffer_load_dwordx4 v2, s[12:15], s31 offen lds
  ds_read_b64_tr_b16 a[176:177], v12 offset:16384
  ds_read_b64_tr_b16 a[178:179], v12 offset:17408
  ds_read_b64_tr_b16 a[184:185], v12 offset:24576
  ds_read_b64_tr_b16 a[186:187], v12 offset:25600
  ds_read_b64_tr_b16 a[180:181], v13 offset:16384
  ds_read_b64_tr_b16 a[182:183], v13 offset:17408
  ds_read_b64_tr_b16 a[188:189], v13 offset:24576
  ds_read_b64_tr_b16 a[190:191], v13 offset:25600
  s_waitcnt lgkmcnt(0)
  s_add_u32 m0, s46, 0
  s_nop 0
  buffer_load_dwordx4 v3, s[16:19], s43 offen offset:0 lds
  s_add_u32 m0, s46, 3968
  s_nop 0
  buffer_load_dwordx4 v3, s[16:19], s43 offen offset:128 lds
  s_add_u32 m0, s46, 7936
  s_nop 0
  buffer_load_dwordx4 v3, s[16:19], s43 offen offset:256 lds
  s_add_u32 m0, s46, 11904
  s_nop 0
  buffer_load_dwordx4 v3, s[16:19], s43 offen offset:384 lds
  s_add_u32 m0, s46, 15872
  s_nop 0
  buffer_load_dwordx4 v3, s[16:19], s43 offen offset:512 lds
  s_add_u32 m0, s46, 19840
  s_nop 0
  buffer_load_dwordx4 v3, s[16:19], s43 offen offset:640 lds
  s_add_u32 m0, s46, 23808
  s_nop 0
  buffer_load_dwordx4 v3, s[16:19], s43 offen offset:768 lds
  s_add_u32 m0, s46, 27776
  s_nop 0
  buffer_load_dwordx4 v3, s[16:19], s43 offen offset:896 lds
  s_add_u32 m0, s46, 31744
  s_nop 0
  buffer_load_dwordx4 v3, s[16:19], s43 offen offset:1024 lds
  s_add_u32 m0, s46, 35712
  s_nop 0
  buffer_load_dwordx4 v3, s[16:19], s43 offen offset:1152 lds
  s_add_u32 m0, s46, 39680
  s_nop 0
  buffer_load_dwordx4 v3, s[16:19], s43 offen offset:1280 lds
  s_add_u32 m0, s46, 43648
  s_nop 0
  buffer_load_dwordx4 v3, s[16:19], s43 offen offset:1408 lds
  s_add_u32 m0, s46, 47616
  s_nop 0
  buffer_load_dwordx4 v3, s[16:19], s43 offen offset:1536 lds
  s_add_u32 m0, s46, 51584
  s_nop 0
  buffer_load_dwordx4 v3, s[16:19], s43 offen offset:1664 lds
  s_add_u32 m0, s46, 55552
  s_nop 0
  buffer_load_dwordx4 v3, s[16:19], s43 offen offset:1792 lds
  s_add_u32 m0, s46, 59520
  s_nop 0
  buffer_load_dwordx4 v3, s[16:19], s43 offen offset:1920 lds
  s_waitcnt vmcnt(28)
  s_barrier
  ds_read_b64_tr_b16 a[192:193], v12 offset:32768
  ds_read_b64_tr_b16 a[194:195], v12 offset:33792
  ds_read_b64_tr_b16 a[200:201], v12 offset:40960
  ds_read_b64_tr_b16 a[202:203], v12 offset:41984
  ds_read_b64_tr_b16 a[196:197], v13 offset:32768
  ds_read_b64_tr_b16 a[198:199], v13 offset:33792
  ds_read_b64_tr_b16 a[204:205], v13 offset:40960
  ds_read_b64_tr_b16 a[206:207], v13 offset:41984
  s_waitcnt lgkmcnt(0)
  s_waitcnt vmcnt(24)
  s_barrier
  ds_read_b64_tr_b16 a[208:209], v12 offset:49152
  ds_read_b64_tr_b16 a[210:211], v12 offset:50176
  ds_read_b64_tr_b16 a[216:217], v12 offset:57344
  ds_read_b64_tr_b16 a[218:219], v12 offset:58368
  ds_read_b64_tr_b16 a[212:213], v13 offset:49152
  ds_read_b64_tr_b16 a[214:215], v13 offset:50176
  ds_read_b64_tr_b16 a[220:221], v13 offset:57344
  ds_read_b64_tr_b16 a[222:223], v13 offset:58368
  s_waitcnt lgkmcnt(0)
  s_waitcnt vmcnt(20)
  s_barrier
  ds_read_b64_tr_b16 a[224:225], v14 offset:0
  ds_read_b64_tr_b16 a[226:227], v14 offset:1024
  ds_read_b64_tr_b16 a[232:233], v14 offset:8192
  ds_read_b64_tr_b16 a[234:235], v14 offset:9216
  ds_read_b64_tr_b16 a[228:229], v15 offset:0
  ds_read_b64_tr_b16 a[230:231], v15 offset:1024
  ds_read_b64_tr_b16 a[236:237], v15 offset:8192
  ds_read_b64_tr_b16 a[238:239], v15 offset:9216
  s_waitcnt lgkmcnt(0)
  s_waitcnt vmcnt(16)
  s_barrier
  ds_read_b64_tr_b16 a[240:241], v12 offset:0
  ds_read_b64_tr_b16 a[242:243], v12 offset:1024
  ds_read_b64_tr_b16 a[248:249], v12 offset:8192
  ds_read_b64_tr_b16 a[250:251], v12 offset:9216
  ds_read_b64_tr_b16 a[244:245], v13 offset:0
  ds_read_b64_tr_b16 a[246:247], v13 offset:1024
  ds_read_b64_tr_b16 a[252:253], v13 offset:8192
  ds_read_b64_tr_b16 a[254:255], v13 offset:9216
  s_waitcnt lgkmcnt(0)
L_G1_loaded:
  v_bfe_u32 v6, v0, 1, 3
  v_lshrrev_b32 v8, 4, v0
  v_add_u32 v8, 0, v8
  v_xor_b32 v6, v6, v8
  v_lshlrev_b32 v6, 4, v6
  v_and_b32 v8, 15, v0
  v_lshl_add_u32 v8, v8, 7, v6
  v_add_u32 v10, 0x10000, v8
  v_bfe_u32 v6, v0, 1, 3
  v_lshrrev_b32 v9, 4, v0
  v_add_u32 v9, 4, v9
  v_xor_b32 v6, v6, v9
  v_lshlrev_b32 v6, 4, v6
  v_and_b32 v9, 15, v0
  v_lshl_add_u32 v9, v9, 7, v6
  v_add_u32 v11, 0x10000, v9
  s_and_b32 s31, s26, 15
  s_lshl_b32 s31, s31, 2
  s_add_u32 s31, s31, s24
  s_lshl_b32 s31, s31, 10
  v_mov_b32 v7, 0x0
  v_bfe_u32 v6, v0, 0, 3
  v_lshl_add_u32 v7, v6, 7, v7
  v_bfe_u32 v6, v0, 3, 1
  v_lshl_add_u32 v7, v6, 27, v7
  v_bfe_u32 v6, v0, 4, 1
  v_lshl_add_u32 v7, v6, 28, v7
  v_bfe_u32 v6, v0, 5, 1
  v_lshl_add_u32 v7, v6, 29, v7
  v_add_u32 v7, s31, v7
L_wi_80:
  buffer_load_dword v16, off, s[4:7], s63 sc1
  s_waitcnt vmcnt(0)
  v_readfirstlane_b32 s32, v16
  s_nop 0
  s_cmp_lg_u32 s32, s62
  s_cbranch_scc1 L_wi_ok_81
  s_sleep 8
  s_add_u32 s30, s30, 1
  s_cmp_lt_u32 s30, 0x100000
  s_cbranch_scc1 L_wi_80
  s_branch L_abort
L_wi_ok_81:
  s_and_b32 s32, s32, 1
  s_lshl_b32 s32, s32, 13
  s_add_u32 s28, s28, s32
  s_mov_b32 s41, 0x40000000
  s_mov_b32 s29, 0
  s_barrier
  ds_read_b128 v[32:35], v8 offset:0
  ds_read_b128 v[36:39], v8 offset:2048
  ds_read_b128 v[40:43], v9 offset:0
  ds_read_b128 v[44:47], v9 offset:2048
  ds_read_b128 v[48:51], v8 offset:4096
  ds_read_b128 v[52:55], v8 offset:6144
  s_cmp_eq_u32 s27, 5
  s_cbranch_scc1 L_G1_loopN
  s_cmp_eq_u32 s27, 6
  s_cbranch_scc1 L_G1_loopR
.p2align 6
L_G1_loopT:
  s_add_u32 s43, s43, 0x10000
  s_waitcnt lgkmcnt(5)
  v_mfma_f32_16x16x32_bf16 v[64:67], a[0:3], v[32:35], 0
  ds_read_b128 v[56:59], v9 offset:4096
  s_add_u32 m0, s46, 65536
  v_mfma_f32_16x16x32_bf16 v[68:71], a[4:7], v[32:35], 0
  buffer_load_dwordx4 v3, s[16:19], s43 offen offset:0 lds
  s_waitcnt lgkmcnt(5)
  v_mfma_f32_16x16x32_bf16 v[72:75], a[0:3], v[36:39], 0
  ds_read_b128 v[60:63], v9 offset:6144
  v_mfma_f32_16x16x32_bf16 v[76:79], a[4:7], v[36:39], 0
  s_waitcnt lgkmcnt(5)
  v_mfma_f32_16x16x32_bf16 v[64:67], a[8:11], v[40:43], v[64:67]
  ds_read_b128 v[32:35], v8 offset:8192
  s_add_u32 m0, s46, 69504
  v_mfma_f32_16x16x32_bf16 v[68:71], a[12:15], v[40:43], v[68:71]
  buffer_load_dwordx4 v3, s[16:19], s43 offen offset:128 lds
  s_waitcnt lgkmcnt(5)
  v_mfma_f32_16x16x32_bf16 v[72:75], a[8:11], v[44:47], v[72:75]
  ds_read_b128 v[36:39], v8 offset:10240
  v_mfma_f32_16x16x32_bf16 v[76:79], a[12:15], v[44:47], v[76:79]
  v_cvt_pk_bf16_f32 v16, v80, v81
  s_waitcnt lgkmcnt(5)
  v_mfma_f32_16x16x32_bf16 v[64:67], a[16:19], v[48:51], v[64:67]
  ds_read_b128 v[40:43], v9 offset:8192
  s_add_u32 m0, s46, 73472
  v_mfma_f32_16x16x32_bf16 v[68:71], a[20:23], v[48:51], v[68:71]
  buffer_load_dwordx4 v3, s[16:19], s43 offen offset:256 lds
  s_waitcnt lgkmcnt(5)
  v_mfma_f32_16x16x32_bf16 v[72:75], a[16:19], v[52:55], v[72:75]
  ds_read_b128 v[44:47], v9 offset:10240
  v_mfma_f32_16x16x32_bf16 v[76:79], a[20:23], v[52:55], v[76:79]
  v_cvt_pk_bf16_f32 v17, v82, v83
  s_waitcnt lgkmcnt(5)
  v_mfma_f32_16x16x32_bf16 v[64:67], a[24:27], v[56:59], v[64:67]
  ds_read_b128 v[48:51], v8 offset:12288
  s_add_u32 m0, s46, 77440
  v_mfma_f32_16x16x32_bf16 v[68:71], a[28:31], v[56:59], v[68:71]
  buffer_load_dwordx4 v3, s[16:19], s43 offen offset:384 lds
  s_waitcnt lgkmcnt(5)
  v_mfma_f32_16x16x32_bf16 v[72:75], a[24:27], v[60:63], v[72:75]
  ds_read_b128 v[52:55], v8 offset:14336
  v_mfma_f32_16x16x32_bf16 v[76:79], a[28:31], v[60:63], v[76:79]
  v_cvt_pk_bf16_f32 v18, v84, v85
  s_waitcnt lgkmcnt(5)
  v_mfma_f32_16x16x32_bf16 v[64:67], a[32:35], v[32:35], v[64:67]
  ds_read_b128 v[56:59], v9 offset:12288
  s_add_u32 m0, s46, 81408
  v_mfma_f32_16x16x32_bf16 v[68:71], a[36:39], v[32:35], v[68:71]
  buffer_load_dwordx4 v3, s[16:19], s43 offen offset:512 lds
  s_waitcnt lgkmcnt(5)
  v_mfma_f32_16x16x32_bf16 v[72:75], a[32:35], v[36:39], v[72:75]
  ds_read_b128 v[60:63], v9 offset:14336
  v_mfma_f32_16x16x32_bf16 v[76:79], a[36:39], v[36:39], v[76:79]
  v_cvt_pk_bf16_f32 v19, v86, v87
  s_waitcnt lgkmcnt(5)
  v_mfma_f32_16x16x32_bf16 v[64:67], a[40:43], v[40:43], v[64:67]
  ds_read_b128 v[32:35], v8 offset:16384
  s_add_u32 m0, s46, 85376
  v_mfma_f32_16x16x32_bf16 v[68:71], a[44:47], v[40:43], v[68:71]
  buffer_load_dwordx4 v3, s[16:19], s43 offen offset:640 lds
  s_waitcnt lgkmcnt(5)
  v_mfma_f32_16x16x32_bf16 v[72:75], a[40:43], v[44:47], v[72:75]
  ds_read_b128 v[36:39], v8 offset:18432
  v_mfma_f32_16x16x32_bf16 v[76:79], a[44:47], v[44:47], v[76:79]
  buffer_store_dwordx4 v[16:19], v4, s[4:7], s41 offen offset:0 sc1
  s_waitcnt lgkmcnt(5)
  v_mfma_f32_16x16x32_bf16 v[64:67], a[48:51], v[48:51], v[64:67]
  ds_read_b128 v[40:43], v9 offset:16384
  s_add_u32 m0, s46, 89344
  v_mfma_f32_16x16x32_bf16 v[68:71], a[52:55], v[48:51], v[68:71]
  buffer_load_dwordx4 v3, s[16:19], s43 offen offset:768 lds
  s_waitcnt lgkmcnt(5)
  v_mfma_f32_16x16x32_bf16 v[72:75], a[48:51], v[52:55], v[72:75]
  ds_read_b128 v[44:47], v9 offset:18432
  v_mfma_f32_16x16x32_bf16 v[76:79], a[52:55], v[52:55], v[76:79]
  v_cvt_pk_bf16_f32 v20, v88, v89
  s_waitcnt lgkmcnt(5)
  v_mfma_f32_16x16x32_bf16 v[64:67], a[56:59], v[56:59], v[64:67]
  ds_read_b128 v[48:51], v8 offset:20480
  s_add_u32 m0, s46, 93312
  v_mfma_f32_16x16x32_bf16 v[68:71], a[60:63], v[56:59], v[68:71]
  buffer_load_dwordx4 v3, s[16:19], s43 offen offset:896 lds
  s_waitcnt lgkmcnt(5)
  v_mfma_f32_16x16x32_bf16 v[72:75], a[56:59], v[60:63], v[72:75]
  ds_read_b128 v[52:55], v8 offset:22528
  v_mfma_f32_16x16x32_bf16 v[76:79], a[60:63], v[60:63], v[76:79]
  v_cvt_pk_bf16_f32 v21, v90, v91
  s_waitcnt lgkmcnt(5)
  v_mfma_f32_16x16x32_bf16 v[64:67], a[64:67], v[32:35], v[64:67]
  ds_read_b128 v[56:59], v9 offset:20480
  s_add_u32 m0, s46, 97280
  v_mfma_f32_16x16x32_bf16 v[68:71], a[68:71], v[32:35], v[68:71]
  buffer_load_dwordx4 v3, s[16:19], s43 offen offset:1024 lds
  s_waitcnt lgkmcnt(5)
  v_mfma_f32_16x16x32_bf16 v[72:75], a[64:67], v[36:39], v[72:75]
  ds_read_b128 v[60:63], v9 offset:22528
  v_mfma_f32_16x16x32_bf16 v[76:79], a[68:71], v[36:39], v[76:79]
  v_cvt_pk_bf16_f32 v22, v92, v93
  s_waitcnt lgkmcnt(5)
  v_mfma_f32_16x16x32_bf16 v[64:67], a[72:75], v[40:43], v[64:67]
  ds_read_b128 v[32:35], v8 offset:24576
  s_add_u32 m0, s46, 101248
  v_mfma_f32_16x16x32_bf16 v[68:71], a[76:79], v[40:43], v[68:71]
  buffer_load_dwordx4 v3, s[16:19], s43 offen offset:1152 lds
  s_waitcnt lgkmcnt(5)
  v_mfma_f32_16x16x32_bf16 v[72:75], a[72:75], v[44:47], v[72:75]
  ds_read_b128 v[36:39], v8 offset:26624
  v_mfma_f32_16x16x32_bf16 v[76:79], a[76:79], v[44:47], v[76:79]
  v_cvt_pk_bf16_f32 v23, v94, v95
  s_waitcnt lgkmcnt(5)
  v_mfma_f32_16x16x32_bf16 v[64:67], a[80:83], v[48:51], v[64:67]
  ds_read_b128 v[40:43], v9 offset:24576
  s_add_u32 m0, s46, 105216
  v_mfma_f32_16x16x32_bf16 v[68:71], a[84:87], v[48:51], v[68:71]
  buffer_load_dwordx4 v3, s[16:19], s43 offen offset:1280 lds
  s_waitcnt lgkmcnt(5)
  v_mfma_f32_16x16x32_bf16 v[72:75], a[80:83], v[52:55], v[72:75]
  ds_read_b128 v[44:47], v9 offset:26624
  v_mfma_f32_16x16x32_bf16 v[76:79], a[84:87], v[52:55], v[76:79]
  buffer_store_dwordx4 v[20:23], v4, s[4:7], s41 offen offset:1024 sc1
  s_waitcnt lgkmcnt(5)
  v_mfma_f32_16x16x32_bf16 v[64:67], a[88:91], v[56:59], v[64:67]
  ds_read_b128 v[48:51], v8 offset:28672
  s_add_u32 m0, s46, 109184
  v_mfma_f32_16x16x32_bf16 v[68:71], a[92:95], v[56:59], v[68:71]
  buffer_load_dwordx4 v3, s[16:19], s43 offen offset:1408 lds
  s_waitcnt lgkmcnt(5)
  v_mfma_f32_16x16x32_bf16 v[72:75], a[88:91], v[60:63], v[72:75]
  ds_read_b128 v[52:55], v8 offset:30720
  v_mfma_f32_16x16x32_bf16 v[76:79], a[92:95], v[60:63], v[76:79]
  s_waitcnt lgkmcnt(5)
  v_mfma_f32_16x16x32_bf16 v[64:67], a[96:99], v[32:35], v[64:67]
  ds_read_b128 v[56:59], v9 offset:28672
  s_add_u32 m0, s46, 113152
  v_mfma_f32_16x16x32_bf16 v[68:71], a[100:103], v[32:35], v[68:71]
  buffer_load_dwordx4 v3, s[16:19], s43 offen offset:1536 lds
  s_waitcnt lgkmcnt(5)
  v_mfma_f32_16x16x32_bf16 v[72:75], a[96:99], v[36:39], v[72:75]
  ds_read_b128 v[60:63], v9 offset:30720
  v_mfma_f32_16x16x32_bf16 v[76:79], a[100:103], v[36:39], v[76:79]
  s_waitcnt lgkmcnt(5)
  v_mfma_f32_16x16x32_bf16 v[64:67], a[104:107], v[40:43], v[64:67]
  ds_read_b128 v[32:35], v8 offset:32768
  s_add_u32 m0, s46, 117120
  v_mfma_f32_16x16x32_bf16 v[68:71], a[108:111], v[40:43], v[68:71]
  buffer_load_dwordx4 v3, s[16:19], s43 offen offset:1664 lds
  s_waitcnt lgkmcnt(5)
  v_mfma_f32_16x16x32_bf16 v[72:75], a[104:107], v[44:47], v[72:75]
  ds_read_b128 v[36:39], v8 offset:34816
  v_mfma_f32_16x16x32_bf16 v[76:79], a[108:111], v[44:47], v[76:79]
  s_waitcnt lgkmcnt(5)
  v_mfma_f32_16x16x32_bf16 v[64:67], a[112:115], v[48:51], v[64:67]
  ds_read_b128 v[40:43], v9 offset:32768
  s_add_u32 m0, s46, 121088
  v_mfma_f32_16x16x32_bf16 v[68:71], a[116:119], v[48:51], v[68:71]
  buffer_load_dwordx4 v3, s[16:19], s43 offen offset:1792 lds
  s_waitcnt lgkmcnt(5)
  v_mfma_f32_16x16x32_bf16 v[72:75], a[112:115], v[52:55], v[72:75]
  ds_read_b128 v[44:47], v9 offset:34816
  v_mfma_f32_16x16x32_bf16 v[76:79], a[116:119], v[52:55], v[76:79]
  s_waitcnt lgkmcnt(5)
  v_mfma_f32_16x16x32_bf16 v[64:67], a[120:123], v[56:59], v[64:67]
  ds_read_b128 v[48:51], v8 offset:36864
  s_add_u32 m0, s46, 125056
  v_mfma_f32_16x16x32_bf16 v[68:71], a[124:127], v[56:59], v[68:71]
  buffer_load_dwordx4 v3, s[16:19], s43 offen offset:1920 lds
  s_waitcnt lgkmcnt(5)
  v_mfma_f32_16x16x32_bf16 v[72:75], a[120:123], v[60:63], v[72:75]
  ds_read_b128 v[52:55], v8 offset:38912
  v_mfma_f32_16x16x32_bf16 v[76:79], a[124:127], v[60:63], v[76:79]
  s_waitcnt lgkmcnt(5)
  v_mfma_f32_16x16x32_bf16 v[64:67], a[128:131], v[32:35], v[64:67]
  ds_read_b128 v[56:59], v9 offset:36864
  v_mfma_f32_16x16x32_bf16 v[68:71], a[132:135], v[32:35], v[68:71]
  s_waitcnt lgkmcnt(5)
  v_mfma_f32_16x16x32_bf16 v[72:75], a[128:131], v[36:39], v[72:75]
  ds_read_b128 v[60:63], v9 offset:38912
  v_mfma_f32_16x16x32_bf16 v[76:79], a[132:135], v[36:39], v[76:79]
  s_waitcnt lgkmcnt(5)
  v_mfma_f32_16x16x32_bf16 v[64:67], a[136:139], v[40:43], v[64:67]
  ds_read_b128 v[32:35], v8 offset:40960
  v_mfma_f32_16x16x32_bf16 v[68:71], a[140:143], v[40:43], v[68:71]
  s_waitcnt lgkmcnt(5)
  v_mfma_f32_16x16x32_bf16 v[72:75], a[136:139], v[44:47], v[72:75]
  ds_read_b128 v[36:39], v8 offset:43008
  v_mfma_f32_16x16x32_bf16 v[76:79], a[140:143], v[44:47], v[76:79]
  s_waitcnt lgkmcnt(5)
  v_mfma_f32_16x16x32_bf16 v[64:67], a[144:147], v[48:51], v[64:67]
  ds_read_b128 v[40:43], v9 offset:40960
  v_mfma_f32_16x16x32_bf16 v[68:71], a[148:151], v[48:51], v[68:71]
  s_waitcnt lgkmcnt(5)
  v_mfma_f32_16x16x32_bf16 v[72:75], a[144:147], v[52:55], v[72:75]
  ds_read_b128 v[44:47], v9 offset:43008
  v_mfma_f32_16x16x32_bf16 v[76:79], a[148:151], v[52:55], v[76:79]
  s_waitcnt lgkmcnt(5)
  v_mfma_f32_16x16x32_bf16 v[64:67], a[152:155], v[56:59], v[64:67]
  ds_read_b128 v[48:51], v8 offset:45056
  v_mfma_f32_16x16x32_bf16 v[68:71], a[156:159], v[56:59], v[68:71]
  s_waitcnt lgkmcnt(5)
  v_mfma_f32_16x16x32_bf16 v[72:75], a[152:155], v[60:63], v[72:75]
  ds_read_b128 v[52:55], v8 offset:47104
  v_mfma_f32_16x16x32_bf16 v[76:79], a[156:159], v[60:63], v[76:79]
  v_mov_b32 v5, s29
  s_waitcnt lgkmcnt(5)
  v_mfma_f32_16x16x32_bf16 v[64:67], a[160:163], v[32:35], v[64:67]
  ds_read_b128 v[56:59], v9 offset:45056
  v_mfma_f32_16x16x32_bf16 v[68:71], a[164:167], v[32:35], v[68:71]
  s_waitcnt vmcnt(5)
  s_mov_b64 exec, 1
  buffer_store_dword v5, off, s[4:7], s44 sc1
  s_mov_b64 exec, -1
  s_waitcnt lgkmcnt(5)
  v_mfma_f32_16x16x32_bf16 v[72:75], a[160:163], v[36:39], v[72:75]
  ds_read_b128 v[60:63], v9 offset:47104
  v_mfma_f32_16x16x32_bf16 v[76:79], a[164:167], v[36:39], v[76:79]
  s_waitcnt lgkmcnt(5)
  v_mfma_f32_16x16x32_bf16 v[64:67], a[168:171], v[40:43], v[64:67]
  ds_read_b128 v[32:35], v8 offset:49152
  v_mfma_f32_16x16x32_bf16 v[68:71], a[172:175], v[40:43], v[68:71]
  s_waitcnt lgkmcnt(5)
  v_mfma_f32_16x16x32_bf16 v[72:75], a[168:171], v[44:47], v[72:75]
  ds_read_b128 v[36:39], v8 offset:51200
  v_mfma_f32_16x16x32_bf16 v[76:79], a[172:175], v[44:47], v[76:79]
  s_waitcnt lgkmcnt(5)
  v_mfma_f32_16x16x32_bf16 v[64:67], a[176:179], v[48:51], v[64:67]
  ds_read_b128 v[40:43], v9 offset:49152
  v_mfma_f32_16x16x32_bf16 v[68:71], a[180:183], v[48:51], v[68:71]
  s_waitcnt lgkmcnt(5)
  v_mfma_f32_16x16x32_bf16 v[72:75], a[176:179], v[52:55], v[72:75]
  ds_read_b128 v[44:47], v9 offset:51200
  v_mfma_f32_16x16x32_bf16 v[76:79], a[180:183], v[52:55], v[76:79]
  s_waitcnt lgkmcnt(5)
  v_mfma_f32_16x16x32_bf16 v[64:67], a[184:187], v[56:59], v[64:67]
  ds_read_b128 v[48:51], v8 offset:53248
  v_mfma_f32_16x16x32_bf16 v[68:71], a[188:191], v[56:59], v[68:71]
  s_waitcnt lgkmcnt(5)
  v_mfma_f32_16x16x32_bf16 v[72:75], a[184:187], v[60:63], v[72:75]
  ds_read_b128 v[52:55], v8 offset:55296
  v_mfma_f32_16x16x32_bf16 v[76:79], a[188:191], v[60:63], v[76:79]
  s_waitcnt lgkmcnt(5)
  v_mfma_f32_16x16x32_bf16 v[64:67], a[192:195], v[32:35], v[64:67]
  ds_read_b128 v[56:59], v9 offset:53248
  v_mfma_f32_16x16x32_bf16 v[68:71], a[196:199], v[32:35], v[68:71]
  s_waitcnt lgkmcnt(5)
  v_mfma_f32_16x16x32_bf16 v[72:75], a[192:195], v[36:39], v[72:75]
  ds_read_b128 v[60:63], v9 offset:55296
  v_mfma_f32_16x16x32_bf16 v[76:79], a[196:199], v[36:39], v[76:79]
  s_waitcnt lgkmcnt(5)
  v_mfma_f32_16x16x32_bf16 v[64:67], a[200:203], v[40:43], v[64:67]
  ds_read_b128 v[32:35], v8 offset:57344
  v_mfma_f32_16x16x32_bf16 v[68:71], a[204:207], v[40:43], v[68:71]
  s_waitcnt lgkmcnt(5)
  v_mfma_f32_16x16x32_bf16 v[72:75], a[200:203], v[44:47], v[72:75]
  ds_read_b128 v[36:39], v8 offset:59392
  v_mfma_f32_16x16x32_bf16 v[76:79], a[204:207], v[44:47], v[76:79]
  s_waitcnt lgkmcnt(5)
  v_mfma_f32_16x16x32_bf16 v[64:67], a[208:211], v[48:51], v[64:67]
  ds_read_b128 v[40:43], v9 offset:57344
  v_mfma_f32_16x16x32_bf16 v[68:71], a[212:215], v[48:51], v[68:71]
  s_waitcnt lgkmcnt(5)
  v_mfma_f32_16x16x32_bf16 v[72:75], a[208:211], v[52:55], v[72:75]
  ds_read_b128 v[44:47], v9 offset:59392
  v_mfma_f32_16x16x32_bf16 v[76:79], a[212:215], v[52:55], v[76:79]
  s_waitcnt lgkmcnt(5)
  v_mfma_f32_16x16x32_bf16 v[64:67], a[216:219], v[56:59], v[64:67]
  ds_read_b128 v[48:51], v8 offset:61440
  v_mfma_f32_16x16x32_bf16 v[68:71], a[220:223], v[56:59], v[68:71]
  s_add_u32 s31, s43, 0x20000
  s_mov_b32 m0, 0x24000
  s_waitcnt lgkmcnt(5)
  v_mfma_f32_16x16x32_bf16 v[72:75], a[216:219], v[60:63], v[72:75]
  ds_read_b128 v[52:55], v8 offset:63488
  v_mfma_f32_16x16x32_bf16 v[76:79], a[220:223], v[60:63], v[76:79]
  buffer_load_dword v7, s[16:19], s31 offen lds
  s_waitcnt lgkmcnt(5)
  v_mfma_f32_16x16x32_bf16 v[64:67], a[224:227], v[32:35], v[64:67]
  ds_read_b128 v[56:59], v9 offset:61440
  v_mfma_f32_16x16x32_bf16 v[68:71], a[228:231], v[32:35], v[68:71]
  s_waitcnt lgkmcnt(5)
  v_mfma_f32_16x16x32_bf16 v[72:75], a[224:227], v[36:39], v[72:75]
  ds_read_b128 v[60:63], v9 offset:63488
  v_mfma_f32_16x16x32_bf16 v[76:79], a[228:231], v[36:39], v[76:79]
  s_waitcnt lgkmcnt(5)
  v_mfma_f32_16x16x32_bf16 v[64:67], a[232:235], v[40:43], v[64:67]
  v_mfma_f32_16x16x32_bf16 v[68:71], a[236:239], v[40:43], v[68:71]
  s_mov_b32 s41, s47
  s_add_u32 s47, s47, s42
  s_waitcnt lgkmcnt(4)
  v_mfma_f32_16x16x32_bf16 v[72:75], a[232:235], v[44:47], v[72:75]
  v_mfma_f32_16x16x32_bf16 v[76:79], a[236:239], v[44:47], v[76:79]
  s_waitcnt vmcnt(2) lgkmcnt(0)
  s_barrier
  v_mfma_f32_16x16x32_bf16 v[64:67], a[240:243], v[48:51], v[64:67]
  ds_read_b128 v[32:35], v10 offset:0
  v_mfma_f32_16x16x32_bf16 v[68:71], a[244:247], v[48:51], v[68:71]
  ds_read_b128 v[36:39], v10 offset:2048
  v_mfma_f32_16x16x32_bf16 v[72:75], a[240:243], v[52:55], v[72:75]
  ds_read_b128 v[40:43], v11 offset:0
  v_mfma_f32_16x16x32_bf16 v[76:79], a[244:247], v[52:55], v[76:79]
  ds_read_b128 v[44:47], v11 offset:2048
  v_mfma_f32_16x16x32_bf16 v[64:67], a[248:251], v[56:59], v[64:67]
  ds_read_b128 v[48:51], v10 offset:4096
  v_mfma_f32_16x16x32_bf16 v[68:71], a[252:255], v[56:59], v[68:71]
  ds_read_b128 v[52:55], v10 offset:6144
  v_mfma_f32_16x16x32_bf16 v[72:75], a[248:251], v[60:63], v[72:75]
  v_mfma_f32_16x16x32_bf16 v[76:79], a[252:255], v[60:63], v[76:79]
  s_add_u32 s29, s29, 1
  s_add_u32 s43, s43, 0x10000
  s_waitcnt lgkmcnt(5)
  v_mfma_f32_16x16x32_bf16 v[80:83], a[0:3], v[32:35], 0
  ds_read_b128 v[56:59], v11 offset:4096
  s_add_u32 m0, s46, 0
  v_mfma_f32_16x16x32_bf16 v[84:87], a[4:7], v[32:35], 0
  buffer_load_dwordx4 v3, s[16:19], s43 offen offset:0 lds
  s_waitcnt lgkmcnt(5)
  v_mfma_f32_16x16x32_bf16 v[88:91], a[0:3], v[36:39], 0
  ds_read_b128 v[60:63], v11 offset:6144
  v_mfma_f32_16x16x32_bf16 v[92:95], a[4:7], v[36:39], 0
  s_waitcnt lgkmcnt(5)
  v_mfma_f32_16x16x32_bf16 v[80:83], a[8:11], v[40:43], v[80:83]
  ds_read_b128 v[32:35], v10 offset:8192
  s_add_u32 m0, s46, 3968
  v_mfma_f32_16x16x32_bf16 v[84:87], a[12:15], v[40:43], v[84:87]
  buffer_load_dwordx4 v3, s[16:19], s43 offen offset:128 lds
  s_waitcnt lgkmcnt(5)
  v_mfma_f32_16x16x32_bf16 v[88:91], a[8:11], v[44:47], v[88:91]
  ds_read_b128 v[36:39], v10 offset:10240
  v_mfma_f32_16x16x32_bf16 v[92:95], a[12:15], v[44:47], v[92:95]
  v_cvt_pk_bf16_f32 v16, v64, v65
  s_waitcnt lgkmcnt(5)
  v_mfma_f32_16x16x32_bf16 v[80:83], a[16:19], v[48:51], v[80:83]
  ds_read_b128 v[40:43], v11 offset:8192
  s_add_u32 m0, s46, 7936
  v_mfma_f32_16x16x32_bf16 v[84:87], a[20:23], v[48:51], v[84:87]
  buffer_load_dwordx4 v3, s[16:19], s43 offen offset:256 lds
  s_waitcnt lgkmcnt(5)
  v_mfma_f32_16x16x32_bf16 v[88:91], a[16:19], v[52:55], v[88:91]
  ds_read_b128 v[44:47], v11 offset:10240
  v_mfma_f32_16x16x32_bf16 v[92:95], a[20:23], v[52:55], v[92:95]
  v_cvt_pk_bf16_f32 v17, v66, v67
  s_waitcnt lgkmcnt(5)
  v_mfma_f32_16x16x32_bf16 v[80:83], a[24:27], v[56:59], v[80:83]
  ds_read_b128 v[48:51], v10 offset:12288
  s_add_u32 m0, s46, 11904
  v_mfma_f32_16x16x32_bf16 v[84:87], a[28:31], v[56:59], v[84:87]
  buffer_load_dwordx4 v3, s[16:19], s43 offen offset:384 lds
  s_waitcnt lgkmcnt(5)
  v_mfma_f32_16x16x32_bf16 v[88:91], a[24:27], v[60:63], v[88:91]
  ds_read_b128 v[52:55], v10 offset:14336
  v_mfma_f32_16x16x32_bf16 v[92:95], a[28:31], v[60:63], v[92:95]
  v_cvt_pk_bf16_f32 v18, v68, v69
  s_waitcnt lgkmcnt(5)
  v_mfma_f32_16x16x32_bf16 v[80:83], a[32:35], v[32:35], v[80:83]
  ds_read_b128 v[56:59], v11 offset:12288
  s_add_u32 m0, s46, 15872
  v_mfma_f32_16x16x32_bf16 v[84:87], a[36:39], v[32:35], v[84:87]
  buffer_load_dwordx4 v3, s[16:19], s43 offen offset:512 lds
  s_waitcnt lgkmcnt(5)
  v_mfma_f32_16x16x32_bf16 v[88:91], a[32:35], v[36:39], v[88:91]
  ds_read_b128 v[60:63], v11 offset:14336
  v_mfma_f32_16x16x32_bf16 v[92:95], a[36:39], v[36:39], v[92:95]
  v_cvt_pk_bf16_f32 v19, v70, v71
  s_waitcnt lgkmcnt(5)
  v_mfma_f32_16x16x32_bf16 v[80:83], a[40:43], v[40:43], v[80:83]
  ds_read_b128 v[32:35], v10 offset:16384
  s_add_u32 m0, s46, 19840
  v_mfma_f32_16x16x32_bf16 v[84:87], a[44:47], v[40:43], v[84:87]
  buffer_load_dwordx4 v3, s[16:19], s43 offen offset:640 lds
  s_waitcnt lgkmcnt(5)
  v_mfma_f32_16x16x32_bf16 v[88:91], a[40:43], v[44:47], v[88:91]
  ds_read_b128 v[36:39], v10 offset:18432
  v_mfma_f32_16x16x32_bf16 v[92:95], a[44:47], v[44:47], v[92:95]
  buffer_store_dwordx4 v[16:19], v4, s[4:7], s41 offen offset:0 sc1
  s_waitcnt lgkmcnt(5)
  v_mfma_f32_16x16x32_bf16 v[80:83], a[48:51], v[48:51], v[80:83]
  ds_read_b128 v[40:43], v11 offset:16384
  s_add_u32 m0, s46, 23808
  v_mfma_f32_16x16x32_bf16 v[84:87], a[52:55], v[48:51], v[84:87]
  buffer_load_dwordx4 v3, s[16:19], s43 offen offset:768 lds
  s_waitcnt lgkmcnt(5)
  v_mfma_f32_16x16x32_bf16 v[88:91], a[48:51], v[52:55], v[88:91]
  ds_read_b128 v[44:47], v11 offset:18432
  v_mfma_f32_16x16x32_bf16 v[92:95], a[52:55], v[52:55], v[92:95]
  v_cvt_pk_bf16_f32 v20, v72, v73
  s_waitcnt lgkmcnt(5)
  v_mfma_f32_16x16x32_bf16 v[80:83], a[56:59], v[56:59], v[80:83]
  ds_read_b128 v[48:51], v10 offset:20480
  s_add_u32 m0, s46, 27776
  v_mfma_f32_16x16x32_bf16 v[84:87], a[60:63], v[56:59], v[84:87]
  buffer_load_dwordx4 v3, s[16:19], s43 offen offset:896 lds
  s_waitcnt lgkmcnt(5)
  v_mfma_f32_16x16x32_bf16 v[88:91], a[56:59], v[60:63], v[88:91]
  ds_read_b128 v[52:55], v10 offset:22528
  v_mfma_f32_16x16x32_bf16 v[92:95], a[60:63], v[60:63], v[92:95]
  v_cvt_pk_bf16_f32 v21, v74, v75
  s_waitcnt lgkmcnt(5)
  v_mfma_f32_16x16x32_bf16 v[80:83], a[64:67], v[32:35], v[80:83]
  ds_read_b128 v[56:59], v11 offset:20480
  s_add_u32 m0, s46, 31744
  v_mfma_f32_16x16x32_bf16 v[84:87], a[68:71], v[32:35], v[84:87]
  buffer_load_dwordx4 v3, s[16:19], s43 offen offset:1024 lds
  s_waitcnt lgkmcnt(5)
  v_mfma_f32_16x16x32_bf16 v[88:91], a[64:67], v[36:39], v[88:91]
  ds_read_b128 v[60:63], v11 offset:22528
  v_mfma_f32_16x16x32_bf16 v[92:95], a[68:71], v[36:39], v[92:95]
  v_cvt_pk_bf16_f32 v22, v76, v77
  s_waitcnt lgkmcnt(5)
  v_mfma_f32_16x16x32_bf16 v[80:83], a[72:75], v[40:43], v[80:83]
  ds_read_b128 v[32:35], v10 offset:24576
  s_add_u32 m0, s46, 35712
  v_mfma_f32_16x16x32_bf16 v[84:87], a[76:79], v[40:43], v[84:87]
  buffer_load_dwordx4 v3, s[16:19], s43 offen offset:1152 lds
  s_waitcnt lgkmcnt(5)
  v_mfma_f32_16x16x32_bf16 v[88:91], a[72:75], v[44:47], v[88:91]
  ds_read_b128 v[36:39], v10 offset:26624
  v_mfma_f32_16x16x32_bf16 v[92:95], a[76:79], v[44:47], v[92:95]
  v_cvt_pk_bf16_f32 v23, v78, v79
  s_waitcnt lgkmcnt(5)
  v_mfma_f32_16x16x32_bf16 v[80:83], a[80:83], v[48:51], v[80:83]
  ds_read_b128 v[40:43], v11 offset:24576
  s_add_u32 m0, s46, 39680
  v_mfma_f32_16x16x32_bf16 v[84:87], a[84:87], v[48:51], v[84:87]
  buffer_load_dwordx4 v3, s[16:19], s43 offen offset:1280 lds
  s_waitcnt lgkmcnt(5)
  v_mfma_f32_16x16x32_bf16 v[88:91], a[80:83], v[52:55], v[88:91]
  ds_read_b128 v[44:47], v11 offset:26624
  v_mfma_f32_16x16x32_bf16 v[92:95], a[84:87], v[52:55], v[92:95]
  buffer_store_dwordx4 v[20:23], v4, s[4:7], s41 offen offset:1024 sc1
  s_waitcnt lgkmcnt(5)
  v_mfma_f32_16x16x32_bf16 v[80:83], a[88:91], v[56:59], v[80:83]
  ds_read_b128 v[48:51], v10 offset:28672
  s_add_u32 m0, s46, 43648
  v_mfma_f32_16x16x32_bf16 v[84:87], a[92:95], v[56:59], v[84:87]
  buffer_load_dwordx4 v3, s[16:19], s43 offen offset:1408 lds
  s_waitcnt lgkmcnt(5)
  v_mfma_f32_16x16x32_bf16 v[88:91], a[88:91], v[60:63], v[88:91]
  ds_read_b128 v[52:55], v10 offset:30720
  v_mfma_f32_16x16x32_bf16 v[92:95], a[92:95], v[60:63], v[92:95]
  s_waitcnt lgkmcnt(5)
  v_mfma_f32_16x16x32_bf16 v[80:83], a[96:99], v[32:35], v[80:83]
  ds_read_b128 v[56:59], v11 offset:28672
  s_add_u32 m0, s46, 47616
  v_mfma_f32_16x16x32_bf16 v[84:87], a[100:103], v[32:35], v[84:87]
  buffer_load_dwordx4 v3, s[16:19], s43 offen offset:1536 lds
  s_waitcnt lgkmcnt(5)
  v_mfma_f32_16x16x32_bf16 v[88:91], a[96:99], v[36:39], v[88:91]
  ds_read_b128 v[60:63], v11 offset:30720
  v_mfma_f32_16x16x32_bf16 v[92:95], a[100:103], v[36:39], v[92:95]
  s_waitcnt lgkmcnt(5)
  v_mfma_f32_16x16x32_bf16 v[80:83], a[104:107], v[40:43], v[80:83]
  ds_read_b128 v[32:35], v10 offset:32768
  s_add_u32 m0, s46, 51584
  v_mfma_f32_16x16x32_bf16 v[84:87], a[108:111], v[40:43], v[84:87]
  buffer_load_dwordx4 v3, s[16:19], s43 offen offset:1664 lds
  s_waitcnt lgkmcnt(5)
  v_mfma_f32_16x16x32_bf16 v[88:91], a[104:107], v[44:47], v[88:91]
  ds_read_b128 v[36:39], v10 offset:34816
  v_mfma_f32_16x16x32_bf16 v[92:95], a[108:111], v[44:47], v[92:95]
  s_waitcnt lgkmcnt(5)
  v_mfma_f32_16x16x32_bf16 v[80:83], a[112:115], v[48:51], v[80:83]
  ds_read_b128 v[40:43], v11 offset:32768
  s_add_u32 m0, s46, 55552
  v_mfma_f32_16x16x32_bf16 v[84:87], a[116:119], v[48:51], v[84:87]
  buffer_load_dwordx4 v3, s[16:19], s43 offen offset:1792 lds
  s_waitcnt lgkmcnt(5)
  v_mfma_f32_16x16x32_bf16 v[88:91], a[112:115], v[52:55], v[88:91]
  ds_read_b128 v[44:47], v11 offset:34816
  v_mfma_f32_16x16x32_bf16 v[92:95], a[116:119], v[52:55], v[92:95]
  s_waitcnt lgkmcnt(5)
  v_mfma_f32_16x16x32_bf16 v[80:83], a[120:123], v[56:59], v[80:83]
  ds_read_b128 v[48:51], v10 offset:36864
  s_add_u32 m0, s46, 59520
  v_mfma_f32_16x16x32_bf16 v[84:87], a[124:127], v[56:59], v[84:87]
  buffer_load_dwordx4 v3, s[16:19], s43 offen offset:1920 lds
  s_waitcnt lgkmcnt(5)
  v_mfma_f32_16x16x32_bf16 v[88:91], a[120:123], v[60:63], v[88:91]
  ds_read_b128 v[52:55], v10 offset:38912
  v_mfma_f32_16x16x32_bf16 v[92:95], a[124:127], v[60:63], v[92:95]
  s_waitcnt lgkmcnt(5)
  v_mfma_f32_16x16x32_bf16 v[80:83], a[128:131], v[32:35], v[80:83]
  ds_read_b128 v[56:59], v11 offset:36864
  v_mfma_f32_16x16x32_bf16 v[84:87], a[132:135], v[32:35], v[84:87]
  s_waitcnt lgkmcnt(5)
  v_mfma_f32_16x16x32_bf16 v[88:91], a[128:131], v[36:39], v[88:91]
  ds_read_b128 v[60:63], v11 offset:38912
  v_mfma_f32_16x16x32_bf16 v[92:95], a[132:135], v[36:39], v[92:95]
  s_waitcnt lgkmcnt(5)
  v_mfma_f32_16x16x32_bf16 v[80:83], a[136:139], v[40:43], v[80:83]
  ds_read_b128 v[32:35], v10 offset:40960
  v_mfma_f32_16x16x32_bf16 v[84:87], a[140:143], v[40:43], v[84:87]
  s_waitcnt lgkmcnt(5)
  v_mfma_f32_16x16x32_bf16 v[88:91], a[136:139], v[44:47], v[88:91]
  ds_read_b128 v[36:39], v10 offset:43008
  v_mfma_f32_16x16x32_bf16 v[92:95], a[140:143], v[44:47], v[92:95]
  s_waitcnt lgkmcnt(5)
  v_mfma_f32_16x16x32_bf16 v[80:83], a[144:147], v[48:51], v[80:83]
  ds_read_b128 v[40:43], v11 offset:40960
  v_mfma_f32_16x16x32_bf16 v[84:87], a[148:151], v[48:51], v[84:87]
  s_waitcnt lgkmcnt(5)
  v_mfma_f32_16x16x32_bf16 v[88:91], a[144:147], v[52:55], v[88:91]
  ds_read_b128 v[44:47], v11 offset:43008
  v_mfma_f32_16x16x32_bf16 v[92:95], a[148:151], v[52:55], v[92:95]
  s_waitcnt lgkmcnt(5)
  v_mfma_f32_16x16x32_bf16 v[80:83], a[152:155], v[56:59], v[80:83]
  ds_read_b128 v[48:51], v10 offset:45056
  v_mfma_f32_16x16x32_bf16 v[84:87], a[156:159], v[56:59], v[84:87]
  s_waitcnt lgkmcnt(5)
  v_mfma_f32_16x16x32_bf16 v[88:91], a[152:155], v[60:63], v[88:91]
  ds_read_b128 v[52:55], v10 offset:47104
  v_mfma_f32_16x16x32_bf16 v[92:95], a[156:159], v[60:63], v[92:95]
  v_mov_b32 v5, s29
  s_waitcnt lgkmcnt(5)
  v_mfma_f32_16x16x32_bf16 v[80:83], a[160:163], v[32:35], v[80:83]
  ds_read_b128 v[56:59], v11 offset:45056
  v_mfma_f32_16x16x32_bf16 v[84:87], a[164:167], v[32:35], v[84:87]
  s_waitcnt vmcnt(5)
  s_mov_b64 exec, 1
  buffer_store_dword v5, off, s[4:7], s44 sc1
  s_mov_b64 exec, -1
  s_waitcnt lgkmcnt(5)
  v_mfma_f32_16x16x32_bf16 v[88:91], a[160:163], v[36:39], v[88:91]
  ds_read_b128 v[60:63], v11 offset:47104
  v_mfma_f32_16x16x32_bf16 v[92:95], a[164:167], v[36:39], v[92:95]
  s_waitcnt lgkmcnt(5)
  v_mfma_f32_16x16x32_bf16 v[80:83], a[168:171], v[40:43], v[80:83]
  ds_read_b128 v[32:35], v10 offset:49152
  v_mfma_f32_16x16x32_bf16 v[84:87], a[172:175], v[40:43], v[84:87]
  s_waitcnt lgkmcnt(5)
  v_mfma_f32_16x16x32_bf16 v[88:91], a[168:171], v[44:47], v[88:91]
  ds_read_b128 v[36:39], v10 offset:51200
  v_mfma_f32_16x16x32_bf16 v[92:95], a[172:175], v[44:47], v[92:95]
  s_waitcnt lgkmcnt(5)
  v_mfma_f32_16x16x32_bf16 v[80:83], a[176:179], v[48:51], v[80:83]
  ds_read_b128 v[40:43], v11 offset:49152
  v_mfma_f32_16x16x32_bf16 v[84:87], a[180:183], v[48:51], v[84:87]
  s_waitcnt lgkmcnt(5)
  v_mfma_f32_16x16x32_bf16 v[88:91], a[176:179], v[52:55], v[88:91]
  ds_read_b128 v[44:47], v11 offset:51200
  v_mfma_f32_16x16x32_bf16 v[92:95], a[180:183], v[52:55], v[92:95]
  s_waitcnt lgkmcnt(5)
  v_mfma_f32_16x16x32_bf16 v[80:83], a[184:187], v[56:59], v[80:83]
  ds_read_b128 v[48:51], v10 offset:53248
  v_mfma_f32_16x16x32_bf16 v[84:87], a[188:191], v[56:59], v[84:87]
  s_waitcnt lgkmcnt(5)
  v_mfma_f32_16x16x32_bf16 v[88:91], a[184:187], v[60:63], v[88:91]
  ds_read_b128 v[52:55], v10 offset:55296
  v_mfma_f32_16x16x32_bf16 v[92:95], a[188:191], v[60:63], v[92:95]
  s_waitcnt lgkmcnt(5)
  v_mfma_f32_16x16x32_bf16 v[80:83], a[192:195], v[32:35], v[80:83]
  ds_read_b128 v[56:59], v11 offset:53248
  v_mfma_f32_16x16x32_bf16 v[84:87], a[196:199], v[32:35], v[84:87]
  s_waitcnt lgkmcnt(5)
  v_mfma_f32_16x16x32_bf16 v[88:91], a[192:195], v[36:39], v[88:91]
  ds_read_b128 v[60:63], v11 offset:55296
  v_mfma_f32_16x16x32_bf16 v[92:95], a[196:199], v[36:39], v[92:95]
  s_waitcnt lgkmcnt(5)
  v_mfma_f32_16x16x32_bf16 v[80:83], a[200:203], v[40:43], v[80:83]
  ds_read_b128 v[32:35], v10 offset:57344
  v_mfma_f32_16x16x32_bf16 v[84:87], a[204:207], v[40:43], v[84:87]
  s_waitcnt lgkmcnt(5)
  v_mfma_f32_16x16x32_bf16 v[88:91], a[200:203], v[44:47], v[88:91]
  ds_read_b128 v[36:39], v10 offset:59392
  v_mfma_f32_16x16x32_bf16 v[92:95], a[204:207], v[44:47], v[92:95]
  s_waitcnt lgkmcnt(5)
  v_mfma_f32_16x16x32_bf16 v[80:83], a[208:211], v[48:51], v[80:83]
  ds_read_b128 v[40:43], v11 offset:57344
  v_mfma_f32_16x16x32_bf16 v[84:87], a[212:215], v[48:51], v[84:87]
  s_waitcnt lgkmcnt(5)
  v_mfma_f32_16x16x32_bf16 v[88:91], a[208:211], v[52:55], v[88:91]
  ds_read_b128 v[44:47], v11 offset:59392
  v_mfma_f32_16x16x32_bf16 v[92:95], a[212:215], v[52:55], v[92:95]
  s_waitcnt lgkmcnt(5)
  v_mfma_f32_16x16x32_bf16 v[80:83], a[216:219], v[56:59], v[80:83]
  ds_read_b128 v[48:51], v10 offset:61440
  v_mfma_f32_16x16x32_bf16 v[84:87], a[220:223], v[56:59], v[84:87]
  s_add_u32 s31, s43, 0x20000
  s_mov_b32 m0, 0x24000
  s_waitcnt lgkmcnt(5)
  v_mfma_f32_16x16x32_bf16 v[88:91], a[216:219], v[60:63], v[88:91]
  ds_read_b128 v[52:55], v10 offset:63488
  v_mfma_f32_16x16x32_bf16 v[92:95], a[220:223], v[60:63], v[92:95]
  buffer_load_dword v7, s[16:19], s31 offen lds
  s_waitcnt lgkmcnt(5)
  v_mfma_f32_16x16x32_bf16 v[80:83], a[224:227], v[32:35], v[80:83]
  ds_read_b128 v[56:59], v11 offset:61440
  v_mfma_f32_16x16x32_bf16 v[84:87], a[228:231], v[32:35], v[84:87]
  s_waitcnt lgkmcnt(5)
  v_mfma_f32_16x16x32_bf16 v[88:91], a[224:227], v[36:39], v[88:91]
  ds_read_b128 v[60:63], v11 offset:63488
  v_mfma_f32_16x16x32_bf16 v[92:95], a[228:231], v[36:39], v[92:95]
  s_waitcnt lgkmcnt(5)
  v_mfma_f32_16x16x32_bf16 v[80:83], a[232:235], v[40:43], v[80:83]
  v_mfma_f32_16x16x32_bf16 v[84:87], a[236:239], v[40:43], v[84:87]
  s_mov_b32 s41, s47
  s_add_u32 s47, s47, s42
  s_waitcnt lgkmcnt(4)
  v_mfma_f32_16x16x32_bf16 v[88:91], a[232:235], v[44:47], v[88:91]
  v_mfma_f32_16x16x32_bf16 v[92:95], a[236:239], v[44:47], v[92:95]
  s_waitcnt vmcnt(2) lgkmcnt(0)
  s_barrier
  v_mfma_f32_16x16x32_bf16 v[80:83], a[240:243], v[48:51], v[80:83]
  ds_read_b128 v[32:35], v8 offset:0
  v_mfma_f32_16x16x32_bf16 v[84:87], a[244:247], v[48:51], v[84:87]
  ds_read_b128 v[36:39], v8 offset:2048
  v_mfma_f32_16x16x32_bf16 v[88:91], a[240:243], v[52:55], v[88:91]
  ds_read_b128 v[40:43], v9 offset:0
  v_mfma_f32_16x16x32_bf16 v[92:95], a[244:247], v[52:55], v[92:95]
  ds_read_b128 v[44:47], v9 offset:2048
  v_mfma_f32_16x16x32_bf16 v[80:83], a[248:251], v[56:59], v[80:83]
  ds_read_b128 v[48:51], v8 offset:4096
  v_mfma_f32_16x16x32_bf16 v[84:87], a[252:255], v[56:59], v[84:87]
  ds_read_b128 v[52:55], v8 offset:6144
  v_mfma_f32_16x16x32_bf16 v[88:91], a[248:251], v[60:63], v[88:91]
  v_mfma_f32_16x16x32_bf16 v[92:95], a[252:255], v[60:63], v[92:95]
  s_add_u32 s29, s29, 1
  s_cmp_lt_u32 s29, 64
  s_cbranch_scc1 L_G1_loopT
  s_nop 7
  v_cvt_pk_bf16_f32 v16, v80, v81
  v_cvt_pk_bf16_f32 v17, v82, v83
  v_cvt_pk_bf16_f32 v18, v84, v85
  v_cvt_pk_bf16_f32 v19, v86, v87
  buffer_store_dwordx4 v[16:19], v4, s[4:7], s41 offen offset:0 sc1
  v_cvt_pk_bf16_f32 v20, v88, v89
  v_cvt_pk_bf16_f32 v21, v90, v91
  v_cvt_pk_bf16_f32 v22, v92, v93
  v_cvt_pk_bf16_f32 v23, v94, v95
  buffer_store_dwordx4 v[20:23], v4, s[4:7], s41 offen offset:1024 sc1
  s_branch L_G1_done
.p2align 6
L_G1_loopN:
  s_add_u32 s43, s43, 0x10000
  s_waitcnt lgkmcnt(5)
  v_mfma_f32_16x16x32_bf16 v[64:67], v[32:35], a[0:3], 0
  ds_read_b128 v[56:59], v9 offset:4096
  s_add_u32 m0, s46, 65536
  v_mfma_f32_16x16x32_bf16 v[72:75], v[32:35], a[4:7], 0
  buffer_load_dwordx4 v3, s[16:19], s43 offen offset:0 lds
  s_waitcnt lgkmcnt(5)
  v_mfma_f32_16x16x32_bf16 v[68:71], v[36:39], a[0:3], 0
  ds_read_b128 v[60:63], v9 offset:6144
  v_mfma_f32_16x16x32_bf16 v[76:79], v[36:39], a[4:7], 0
  s_waitcnt lgkmcnt(5)
  v_mfma_f32_16x16x32_bf16 v[64:67], v[40:43], a[8:11], v[64:67]
  ds_read_b128 v[32:35], v8 offset:8192
  s_add_u32 m0, s46, 69504
  v_mfma_f32_16x16x32_bf16 v[72:75], v[40:43], a[12:15], v[72:75]
  buffer_load_dwordx4 v3, s[16:19], s43 offen offset:128 lds
  s_waitcnt lgkmcnt(5)
  v_mfma_f32_16x16x32_bf16 v[68:71], v[44:47], a[8:11], v[68:71]
  ds_read_b128 v[36:39], v8 offset:10240
  v_mfma_f32_16x16x32_bf16 v[76:79], v[44:47], a[12:15], v[76:79]
  v_cvt_pk_bf16_f32 v16, v80, v81
  s_waitcnt lgkmcnt(5)
  v_mfma_f32_16x16x32_bf16 v[64:67], v[48:51], a[16:19], v[64:67]
  ds_read_b128 v[40:43], v9 offset:8192
  s_add_u32 m0, s46, 73472
  v_mfma_f32_16x16x32_bf16 v[72:75], v[48:51], a[20:23], v[72:75]
  buffer_load_dwordx4 v3, s[16:19], s43 offen offset:256 lds
  s_waitcnt lgkmcnt(5)
  v_mfma_f32_16x16x32_bf16 v[68:71], v[52:55], a[16:19], v[68:71]
  ds_read_b128 v[44:47], v9 offset:10240
  v_mfma_f32_16x16x32_bf16 v[76:79], v[52:55], a[20:23], v[76:79]
  v_cvt_pk_bf16_f32 v17, v82, v83
  s_waitcnt lgkmcnt(5)
  v_mfma_f32_16x16x32_bf16 v[64:67], v[56:59], a[24:27], v[64:67]
  ds_read_b128 v[48:51], v8 offset:12288
  s_add_u32 m0, s46, 77440
  v_mfma_f32_16x16x32_bf16 v[72:75], v[56:59], a[28:31], v[72:75]
  buffer_load_dwordx4 v3, s[16:19], s43 offen offset:384 lds
  s_waitcnt lgkmcnt(5)
  v_mfma_f32_16x16x32_bf16 v[68:71], v[60:63], a[24:27], v[68:71]
  ds_read_b128 v[52:55], v8 offset:14336
  v_mfma_f32_16x16x32_bf16 v[76:79], v[60:63], a[28:31], v[76:79]
  v_cvt_pk_bf16_f32 v18, v84, v85
  s_waitcnt lgkmcnt(5)
  v_mfma_f32_16x16x32_bf16 v[64:67], v[32:35], a[32:35], v[64:67]
  ds_read_b128 v[56:59], v9 offset:12288
  s_add_u32 m0, s46, 81408
  v_mfma_f32_16x16x32_bf16 v[72:75], v[32:35], a[36:39], v[72:75]
  buffer_load_dwordx4 v3, s[16:19], s43 offen offset:512 lds
  s_waitcnt lgkmcnt(5)
  v_mfma_f32_16x16x32_bf16 v[68:71], v[36:39], a[32:35], v[68:71]
  ds_read_b128 v[60:63], v9 offset:14336
  v_mfma_f32_16x16x32_bf16 v[76:79], v[36:39], a[36:39], v[76:79]
  v_cvt_pk_bf16_f32 v19, v86, v87
  s_waitcnt lgkmcnt(5)
  v_mfma_f32_16x16x32_bf16 v[64:67], v[40:43], a[40:43], v[64:67]
  ds_read_b128 v[32:35], v8 offset:16384
  s_add_u32 m0, s46, 85376
  v_mfma_f32_16x16x32_bf16 v[72:75], v[40:43], a[44:47], v[72:75]
  buffer_load_dwordx4 v3, s[16:19], s43 offen offset:640 lds
  s_waitcnt lgkmcnt(5)
  v_mfma_f32_16x16x32_bf16 v[68:71], v[44:47], a[40:43], v[68:71]
  ds_read_b128 v[36:39], v8 offset:18432
  v_mfma_f32_16x16x32_bf16 v[76:79], v[44:47], a[44:47], v[76:79]
  buffer_store_dwordx4 v[16:19], v4, s[4:7], s41 offen offset:0 sc1
  s_waitcnt lgkmcnt(5)
  v_mfma_f32_16x16x32_bf16 v[64:67], v[48:51], a[48:51], v[64:67]
  ds_read_b128 v[40:43], v9 offset:16384
  s_add_u32 m0, s46, 89344
  v_mfma_f32_16x16x32_bf16 v[72:75], v[48:51], a[52:55], v[72:75]
  buffer_load_dwordx4 v3, s[16:19], s43 offen offset:768 lds
  s_waitcnt lgkmcnt(5)
  v_mfma_f32_16x16x32_bf16 v[68:71], v[52:55], a[48:51], v[68:71]
  ds_read_b128 v[44:47], v9 offset:18432
  v_mfma_f32_16x16x32_bf16 v[76:79], v[52:55], a[52:55], v[76:79]
  v_cvt_pk_bf16_f32 v20, v88, v89
  s_waitcnt lgkmcnt(5)
  v_mfma_f32_16x16x32_bf16 v[64:67], v[56:59], a[56:59], v[64:67]
  ds_read_b128 v[48:51], v8 offset:20480
  s_add_u32 m0, s46, 93312
  v_mfma_f32_16x16x32_bf16 v[72:75], v[56:59], a[60:63], v[72:75]
  buffer_load_dwordx4 v3, s[16:19], s43 offen offset:896 lds
  s_waitcnt lgkmcnt(5)
  v_mfma_f32_16x16x32_bf16 v[68:71], v[60:63], a[56:59], v[68:71]
  ds_read_b128 v[52:55], v8 offset:22528
  v_mfma_f32_16x16x32_bf16 v[76:79], v[60:63], a[60:63], v[76:79]
  v_cvt_pk_bf16_f32 v21, v90, v91
  s_waitcnt lgkmcnt(5)
  v_mfma_f32_16x16x32_bf16 v[64:67], v[32:35], a[64:67], v[64:67]
  ds_read_b128 v[56:59], v9 offset:20480
  s_add_u32 m0, s46, 97280
  v_mfma_f32_16x16x32_bf16 v[72:75], v[32:35], a[68:71], v[72:75]
  buffer_load_dwordx4 v3, s[16:19], s43 offen offset:1024 lds
  s_waitcnt lgkmcnt(5)
  v_mfma_f32_16x16x32_bf16 v[68:71], v[36:39], a[64:67], v[68:71]
  ds_read_b128 v[60:63], v9 offset:22528
  v_mfma_f32_16x16x32_bf16 v[76:79], v[36:39], a[68:71], v[76:79]
  v_cvt_pk_bf16_f32 v22, v92, v93
  s_waitcnt lgkmcnt(5)
  v_mfma_f32_16x16x32_bf16 v[64:67], v[40:43], a[72:75], v[64:67]
  ds_read_b128 v[32:35], v8 offset:24576
  s_add_u32 m0, s46, 101248
  v_mfma_f32_16x16x32_bf16 v[72:75], v[40:43], a[76:79], v[72:75]
  buffer_load_dwordx4 v3, s[16:19], s43 offen offset:1152 lds
  s_waitcnt lgkmcnt(5)
  v_mfma_f32_16x16x32_bf16 v[68:71], v[44:47], a[72:75], v[68:71]
  ds_read_b128 v[36:39], v8 offset:26624
  v_mfma_f32_16x16x32_bf16 v[76:79], v[44:47], a[76:79], v[76:79]
  v_cvt_pk_bf16_f32 v23, v94, v95
  s_waitcnt lgkmcnt(5)
  v_mfma_f32_16x16x32_bf16 v[64:67], v[48:51], a[80:83], v[64:67]
  ds_read_b128 v[40:43], v9 offset:24576
  s_add_u32 m0, s46, 105216
  v_mfma_f32_16x16x32_bf16 v[72:75], v[48:51], a[84:87], v[72:75]
  buffer_load_dwordx4 v3, s[16:19], s43 offen offset:1280 lds
  s_waitcnt lgkmcnt(5)
  v_mfma_f32_16x16x32_bf16 v[68:71], v[52:55], a[80:83], v[68:71]
  ds_read_b128 v[44:47], v9 offset:26624
  v_mfma_f32_16x16x32_bf16 v[76:79], v[52:55], a[84:87], v[76:79]
  buffer_store_dwordx4 v[20:23], v4, s[4:7], s41 offen offset:1024 sc1
  s_waitcnt lgkmcnt(5)
  v_mfma_f32_16x16x32_bf16 v[64:67], v[56:59], a[88:91], v[64:67]
  ds_read_b128 v[48:51], v8 offset:28672
  s_add_u32 m0, s46, 109184
  v_mfma_f32_16x16x32_bf16 v[72:75], v[56:59], a[92:95], v[72:75]
  buffer_load_dwordx4 v3, s[16:19], s43 offen offset:1408 lds
  s_waitcnt lgkmcnt(5)
  v_mfma_f32_16x16x32_bf16 v[68:71], v[60:63], a[88:91], v[68:71]
  ds_read_b128 v[52:55], v8 offset:30720
  v_mfma_f32_16x16x32_bf16 v[76:79], v[60:63], a[92:95], v[76:79]
  s_waitcnt lgkmcnt(5)
  v_mfma_f32_16x16x32_bf16 v[64:67], v[32:35], a[96:99], v[64:67]
  ds_read_b128 v[56:59], v9 offset:28672
  s_add_u32 m0, s46, 113152
  v_mfma_f32_16x16x32_bf16 v[72:75], v[32:35], a[100:103], v[72:75]
  buffer_load_dwordx4 v3, s[16:19], s43 offen offset:1536 lds
  s_waitcnt lgkmcnt(5)
  v_mfma_f32_16x16x32_bf16 v[68:71], v[36:39], a[96:99], v[68:71]
  ds_read_b128 v[60:63], v9 offset:30720
  v_mfma_f32_16x16x32_bf16 v[76:79], v[36:39], a[100:103], v[76:79]
  s_waitcnt lgkmcnt(5)
  v_mfma_f32_16x16x32_bf16 v[64:67], v[40:43], a[104:107], v[64:67]
  ds_read_b128 v[32:35], v8 offset:32768
  s_add_u32 m0, s46, 117120
  v_mfma_f32_16x16x32_bf16 v[72:75], v[40:43], a[108:111], v[72:75]
  buffer_load_dwordx4 v3, s[16:19], s43 offen offset:1664 lds
  s_waitcnt lgkmcnt(5)
  v_mfma_f32_16x16x32_bf16 v[68:71], v[44:47], a[104:107], v[68:71]
  ds_read_b128 v[36:39], v8 offset:34816
  v_mfma_f32_16x16x32_bf16 v[76:79], v[44:47], a[108:111], v[76:79]
  s_waitcnt lgkmcnt(5)
  v_mfma_f32_16x16x32_bf16 v[64:67], v[48:51], a[112:115], v[64:67]
  ds_read_b128 v[40:43], v9 offset:32768
  s_add_u32 m0, s46, 121088
  v_mfma_f32_16x16x32_bf16 v[72:75], v[48:51], a[116:119], v[72:75]
  buffer_load_dwordx4 v3, s[16:19], s43 offen offset:1792 lds
  s_waitcnt lgkmcnt(5)
  v_mfma_f32_16x16x32_bf16 v[68:71], v[52:55], a[112:115], v[68:71]
  ds_read_b128 v[44:47], v9 offset:34816
  v_mfma_f32_16x16x32_bf16 v[76:79], v[52:55], a[116:119], v[76:79]
  s_waitcnt lgkmcnt(5)
  v_mfma_f32_16x16x32_bf16 v[64:67], v[56:59], a[120:123], v[64:67]
  ds_read_b128 v[48:51], v8 offset:36864
  s_add_u32 m0, s46, 125056
  v_mfma_f32_16x16x32_bf16 v[72:75], v[56:59], a[124:127], v[72:75]
  buffer_load_dwordx4 v3, s[16:19], s43 offen offset:1920 lds
  s_waitcnt lgkmcnt(5)
  v_mfma_f32_16x16x32_bf16 v[68:71], v[60:63], a[120:123], v[68:71]
  ds_read_b128 v[52:55], v8 offset:38912
  v_mfma_f32_16x16x32_bf16 v[76:79], v[60:63], a[124:127], v[76:79]
  s_waitcnt lgkmcnt(5)
  v_mfma_f32_16x16x32_bf16 v[64:67], v[32:35], a[128:131], v[64:67]
  ds_read_b128 v[56:59], v9 offset:36864
  v_mfma_f32_16x16x32_bf16 v[72:75], v[32:35], a[132:135], v[72:75]
  s_waitcnt lgkmcnt(5)
  v_mfma_f32_16x16x32_bf16 v[68:71], v[36:39], a[128:131], v[68:71]
  ds_read_b128 v[60:63], v9 offset:38912
  v_mfma_f32_16x16x32_bf16 v[76:79], v[36:39], a[132:135], v[76:79]
  s_waitcnt lgkmcnt(5)
  v_mfma_f32_16x16x32_bf16 v[64:67], v[40:43], a[136:139], v[64:67]
  ds_read_b128 v[32:35], v8 offset:40960
  v_mfma_f32_16x16x32_bf16 v[72:75], v[40:43], a[140:143], v[72:75]
  s_waitcnt lgkmcnt(5)
  v_mfma_f32_16x16x32_bf16 v[68:71], v[44:47], a[136:139], v[68:71]
  ds_read_b128 v[36:39], v8 offset:43008
  v_mfma_f32_16x16x32_bf16 v[76:79], v[44:47], a[140:143], v[76:79]
  s_waitcnt lgkmcnt(5)
  v_mfma_f32_16x16x32_bf16 v[64:67], v[48:51], a[144:147], v[64:67]
  ds_read_b128 v[40:43], v9 offset:40960
  v_mfma_f32_16x16x32_bf16 v[72:75], v[48:51], a[148:151], v[72:75]
  s_waitcnt lgkmcnt(5)
  v_mfma_f32_16x16x32_bf16 v[68:71], v[52:55], a[144:147], v[68:71]
  ds_read_b128 v[44:47], v9 offset:43008
  v_mfma_f32_16x16x32_bf16 v[76:79], v[52:55], a[148:151], v[76:79]
  s_waitcnt lgkmcnt(5)
  v_mfma_f32_16x16x32_bf16 v[64:67], v[56:59], a[152:155], v[64:67]
  ds_read_b128 v[48:51], v8 offset:45056
  v_mfma_f32_16x16x32_bf16 v[72:75], v[56:59], a[156:159], v[72:75]
  s_waitcnt lgkmcnt(5)
  v_mfma_f32_16x16x32_bf16 v[68:71], v[60:63], a[152:155], v[68:71]
  ds_read_b128 v[52:55], v8 offset:47104
  v_mfma_f32_16x16x32_bf16 v[76:79], v[60:63], a[156:159], v[76:79]
  v_mov_b32 v5, s29
  s_waitcnt lgkmcnt(5)
  v_mfma_f32_16x16x32_bf16 v[64:67], v[32:35], a[160:163], v[64:67]
  ds_read_b128 v[56:59], v9 offset:45056
  v_mfma_f32_16x16x32_bf16 v[72:75], v[32:35], a[164:167], v[72:75]
  s_waitcnt vmcnt(5)
  s_mov_b64 exec, 1
  buffer_store_dword v5, off, s[4:7], s44 sc1
  s_mov_b64 exec, -1
  s_waitcnt lgkmcnt(5)
  v_mfma_f32_16x16x32_bf16 v[68:71], v[36:39], a[160:163], v[68:71]
  ds_read_b128 v[60:63], v9 offset:47104
  v_mfma_f32_16x16x32_bf16 v[76:79], v[36:39], a[164:167], v[76:79]
  s_waitcnt lgkmcnt(5)
  v_mfma_f32_16x16x32_bf16 v[64:67], v[40:43], a[168:171], v[64:67]
  ds_read_b128 v[32:35], v8 offset:49152
  v_mfma_f32_16x16x32_bf16 v[72:75], v[40:43], a[172:175], v[72:75]
  s_waitcnt lgkmcnt(5)
  v_mfma_f32_16x16x32_bf16 v[68:71], v[44:47], a[168:171], v[68:71]
  ds_read_b128 v[36:39], v8 offset:51200
  v_mfma_f32_16x16x32_bf16 v[76:79], v[44:47], a[172:175], v[76:79]
  s_waitcnt lgkmcnt(5)
  v_mfma_f32_16x16x32_bf16 v[64:67], v[48:51], a[176:179], v[64:67]
  ds_read_b128 v[40:43], v9 offset:49152
  v_mfma_f32_16x16x32_bf16 v[72:75], v[48:51], a[180:183], v[72:75]
  s_waitcnt lgkmcnt(5)
  v_mfma_f32_16x16x32_bf16 v[68:71], v[52:55], a[176:179], v[68:71]
  ds_read_b128 v[44:47], v9 offset:51200
  v_mfma_f32_16x16x32_bf16 v[76:79], v[52:55], a[180:183], v[76:79]
  s_waitcnt lgkmcnt(5)
  v_mfma_f32_16x16x32_bf16 v[64:67], v[56:59], a[184:187], v[64:67]
  ds_read_b128 v[48:51], v8 offset:53248
  v_mfma_f32_16x16x32_bf16 v[72:75], v[56:59], a[188:191], v[72:75]
  s_waitcnt lgkmcnt(5)
  v_mfma_f32_16x16x32_bf16 v[68:71], v[60:63], a[184:187], v[68:71]
  ds_read_b128 v[52:55], v8 offset:55296
  v_mfma_f32_16x16x32_bf16 v[76:79], v[60:63], a[188:191], v[76:79]
  s_waitcnt lgkmcnt(5)
  v_mfma_f32_16x16x32_bf16 v[64:67], v[32:35], a[192:195], v[64:67]
  ds_read_b128 v[56:59], v9 offset:53248
  v_mfma_f32_16x16x32_bf16 v[72:75], v[32:35], a[196:199], v[72:75]
  s_waitcnt lgkmcnt(5)
  v_mfma_f32_16x16x32_bf16 v[68:71], v[36:39], a[192:195], v[68:71]
  ds_read_b128 v[60:63], v9 offset:55296
  v_mfma_f32_16x16x32_bf16 v[76:79], v[36:39], a[196:199], v[76:79]
  s_waitcnt lgkmcnt(5)
  v_mfma_f32_16x16x32_bf16 v[64:67], v[40:43], a[200:203], v[64:67]
  ds_read_b128 v[32:35], v8 offset:57344
  v_mfma_f32_16x16x32_bf16 v[72:75], v[40:43], a[204:207], v[72:75]
  s_waitcnt lgkmcnt(5)
  v_mfma_f32_16x16x32_bf16 v[68:71], v[44:47], a[200:203], v[68:71]
  ds_read_b128 v[36:39], v8 offset:59392
  v_mfma_f32_16x16x32_bf16 v[76:79], v[44:47], a[204:207], v[76:79]
  s_waitcnt lgkmcnt(5)
  v_mfma_f32_16x16x32_bf16 v[64:67], v[48:51], a[208:211], v[64:67]
  ds_read_b128 v[40:43], v9 offset:57344
  v_mfma_f32_16x16x32_bf16 v[72:75], v[48:51], a[212:215], v[72:75]
  s_waitcnt lgkmcnt(5)
  v_mfma_f32_16x16x32_bf16 v[68:71], v[52:55], a[208:211], v[68:71]
  ds_read_b128 v[44:47], v9 offset:59392
  v_mfma_f32_16x16x32_bf16 v[76:79], v[52:55], a[212:215], v[76:79]
  s_waitcnt lgkmcnt(5)
  v_mfma_f32_16x16x32_bf16 v[64:67], v[56:59], a[216:219], v[64:67]
  ds_read_b128 v[48:51], v8 offset:61440
  v_mfma_f32_16x16x32_bf16 v[72:75], v[56:59], a[220:223], v[72:75]
  s_add_u32 s31, s43, 0x20000
  s_mov_b32 m0, 0x24000
  s_waitcnt lgkmcnt(5)
  v_mfma_f32_16x16x32_bf16 v[68:71], v[60:63], a[216:219], v[68:71]
  ds_read_b128 v[52:55], v8 offset:63488
  v_mfma_f32_16x16x32_bf16 v[76:79], v[60:63], a[220:223], v[76:79]
  buffer_load_dword v7, s[16:19], s31 offen lds
  s_waitcnt lgkmcnt(5)
  v_mfma_f32_16x16x32_bf16 v[64:67], v[32:35], a[224:227], v[64:67]
  ds_read_b128 v[56:59], v9 offset:61440
  v_mfma_f32_16x16x32_bf16 v[72:75], v[32:35], a[228:231], v[72:75]
  s_waitcnt lgkmcnt(5)
  v_mfma_f32_16x16x32_bf16 v[68:71], v[36:39], a[224:227], v[68:71]
  ds_read_b128 v[60:63], v9 offset:63488
  v_mfma_f32_16x16x32_bf16 v[76:79], v[36:39], a[228:231], v[76:79]
  s_waitcnt lgkmcnt(5)
  v_mfma_f32_16x16x32_bf16 v[64:67], v[40:43], a[232:235], v[64:67]
  v_mfma_f32_16x16x32_bf16 v[72:75], v[40:43], a[236:239], v[72:75]
  s_mov_b32 s41, s47
  s_add_u32 s47, s47, s42
  s_waitcnt lgkmcnt(4)
  v_mfma_f32_16x16x32_bf16 v[68:71], v[44:47], a[232:235], v[68:71]
  v_mfma_f32_16x16x32_bf16 v[76:79], v[44:47], a[236:239], v[76:79]
  s_waitcnt vmcnt(2) lgkmcnt(0)
  s_barrier
  v_mfma_f32_16x16x32_bf16 v[64:67], v[48:51], a[240:243], v[64:67]
  ds_read_b128 v[32:35], v10 offset:0
  v_mfma_f32_16x16x32_bf16 v[72:75], v[48:51], a[244:247], v[72:75]
  ds_read_b128 v[36:39], v10 offset:2048
  v_mfma_f32_16x16x32_bf16 v[68:71], v[52:55], a[240:243], v[68:71]
  ds_read_b128 v[40:43], v11 offset:0
  v_mfma_f32_16x16x32_bf16 v[76:79], v[52:55], a[244:247], v[76:79]
  ds_read_b128 v[44:47], v11 offset:2048
  v_mfma_f32_16x16x32_bf16 v[64:67], v[56:59], a[248:251], v[64:67]
  ds_read_b128 v[48:51], v10 offset:4096
  v_mfma_f32_16x16x32_bf16 v[72:75], v[56:59], a[252:255], v[72:75]
  ds_read_b128 v[52:55], v10 offset:6144
  v_mfma_f32_16x16x32_bf16 v[68:71], v[60:63], a[248:251], v[68:71]
  v_mfma_f32_16x16x32_bf16 v[76:79], v[60:63], a[252:255], v[76:79]
  s_add_u32 s29, s29, 1
  s_add_u32 s43, s43, 0x10000
  s_waitcnt lgkmcnt(5)
  v_mfma_f32_16x16x32_bf16 v[80:83], v[32:35], a[0:3], 0
  ds_read_b128 v[56:59], v11 offset:4096
  s_add_u32 m0, s46, 0
  v_mfma_f32_16x16x32_bf16 v[88:91], v[32:35], a[4:7], 0
  buffer_load_dwordx4 v3, s[16:19], s43 offen offset:0 lds
  s_waitcnt lgkmcnt(5)
  v_mfma_f32_16x16x32_bf16 v[84:87], v[36:39], a[0:3], 0
  ds_read_b128 v[60:63], v11 offset:6144
  v_mfma_f32_16x16x32_bf16 v[92:95], v[36:39], a[4:7], 0
  s_waitcnt lgkmcnt(5)
  v_mfma_f32_16x16x32_bf16 v[80:83], v[40:43], a[8:11], v[80:83]
  ds_read_b128 v[32:35], v10 offset:8192
  s_add_u32 m0, s46, 3968
  v_mfma_f32_16x16x32_bf16 v[88:91], v[40:43], a[12:15], v[88:91]
  buffer_load_dwordx4 v3, s[16:19], s43 offen offset:128 lds
  s_waitcnt lgkmcnt(5)
  v_mfma_f32_16x16x32_bf16 v[84:87], v[44:47], a[8:11], v[84:87]
  ds_read_b128 v[36:39], v10 offset:10240
  v_mfma_f32_16x16x32_bf16 v[92:95], v[44:47], a[12:15], v[92:95]
  v_cvt_pk_bf16_f32 v16, v64, v65
  s_waitcnt lgkmcnt(5)
  v_mfma_f32_16x16x32_bf16 v[80:83], v[48:51], a[16:19], v[80:83]
  ds_read_b128 v[40:43], v11 offset:8192
  s_add_u32 m0, s46, 7936
  v_mfma_f32_16x16x32_bf16 v[88:91], v[48:51], a[20:23], v[88:91]
  buffer_load_dwordx4 v3, s[16:19], s43 offen offset:256 lds
  s_waitcnt lgkmcnt(5)
  v_mfma_f32_16x16x32_bf16 v[84:87], v[52:55], a[16:19], v[84:87]
  ds_read_b128 v[44:47], v11 offset:10240
  v_mfma_f32_16x16x32_bf16 v[92:95], v[52:55], a[20:23], v[92:95]
  v_cvt_pk_bf16_f32 v17, v66, v67
  s_waitcnt lgkmcnt(5)
  v_mfma_f32_16x16x32_bf16 v[80:83], v[56:59], a[24:27], v[80:83]
  ds_read_b128 v[48:51], v10 offset:12288
  s_add_u32 m0, s46, 11904
  v_mfma_f32_16x16x32_bf16 v[88:91], v[56:59], a[28:31], v[88:91]
  buffer_load_dwordx4 v3, s[16:19], s43 offen offset:384 lds
  s_waitcnt lgkmcnt(5)
  v_mfma_f32_16x16x32_bf16 v[84:87], v[60:63], a[24:27], v[84:87]
  ds_read_b128 v[52:55], v10 offset:14336
  v_mfma_f32_16x16x32_bf16 v[92:95], v[60:63], a[28:31], v[92:95]
  v_cvt_pk_bf16_f32 v18, v68, v69
  s_waitcnt lgkmcnt(5)
  v_mfma_f32_16x16x32_bf16 v[80:83], v[32:35], a[32:35], v[80:83]
  ds_read_b128 v[56:59], v11 offset:12288
  s_add_u32 m0, s46, 15872
  v_mfma_f32_16x16x32_bf16 v[88:91], v[32:35], a[36:39], v[88:91]
  buffer_load_dwordx4 v3, s[16:19], s43 offen offset:512 lds
  s_waitcnt lgkmcnt(5)
  v_mfma_f32_16x16x32_bf16 v[84:87], v[36:39], a[32:35], v[84:87]
  ds_read_b128 v[60:63], v11 offset:14336
  v_mfma_f32_16x16x32_bf16 v[92:95], v[36:39], a[36:39], v[92:95]
  v_cvt_pk_bf16_f32 v19, v70, v71
  s_waitcnt lgkmcnt(5)
  v_mfma_f32_16x16x32_bf16 v[80:83], v[40:43], a[40:43], v[80:83]
  ds_read_b128 v[32:35], v10 offset:16384
  s_add_u32 m0, s46, 19840
  v_mfma_f32_16x16x32_bf16 v[88:91], v[40:43], a[44:47], v[88:91]
  buffer_load_dwordx4 v3, s[16:19], s43 offen offset:640 lds
  s_waitcnt lgkmcnt(5)
  v_mfma_f32_16x16x32_bf16 v[84:87], v[44:47], a[40:43], v[84:87]
  ds_read_b128 v[36:39], v10 offset:18432
  v_mfma_f32_16x16x32_bf16 v[92:95], v[44:47], a[44:47], v[92:95]
  buffer_store_dwordx4 v[16:19], v4, s[4:7], s41 offen offset:0 sc1
  s_waitcnt lgkmcnt(5)
  v_mfma_f32_16x16x32_bf16 v[80:83], v[48:51], a[48:51], v[80:83]
  ds_read_b128 v[40:43], v11 offset:16384
  s_add_u32 m0, s46, 23808
  v_mfma_f32_16x16x32_bf16 v[88:91], v[48:51], a[52:55], v[88:91]
  buffer_load_dwordx4 v3, s[16:19], s43 offen offset:768 lds
  s_waitcnt lgkmcnt(5)
  v_mfma_f32_16x16x32_bf16 v[84:87], v[52:55], a[48:51], v[84:87]
  ds_read_b128 v[44:47], v11 offset:18432
  v_mfma_f32_16x16x32_bf16 v[92:95], v[52:55], a[52:55], v[92:95]
  v_cvt_pk_bf16_f32 v20, v72, v73
  s_waitcnt lgkmcnt(5)
  v_mfma_f32_16x16x32_bf16 v[80:83], v[56:59], a[56:59], v[80:83]
  ds_read_b128 v[48:51], v10 offset:20480
  s_add_u32 m0, s46, 27776
  v_mfma_f32_16x16x32_bf16 v[88:91], v[56:59], a[60:63], v[88:91]
  buffer_load_dwordx4 v3, s[16:19], s43 offen offset:896 lds
  s_waitcnt lgkmcnt(5)
  v_mfma_f32_16x16x32_bf16 v[84:87], v[60:63], a[56:59], v[84:87]
  ds_read_b128 v[52:55], v10 offset:22528
  v_mfma_f32_16x16x32_bf16 v[92:95], v[60:63], a[60:63], v[92:95]
  v_cvt_pk_bf16_f32 v21, v74, v75
  s_waitcnt lgkmcnt(5)
  v_mfma_f32_16x16x32_bf16 v[80:83], v[32:35], a[64:67], v[80:83]
  ds_read_b128 v[56:59], v11 offset:20480
  s_add_u32 m0, s46, 31744
  v_mfma_f32_16x16x32_bf16 v[88:91], v[32:35], a[68:71], v[88:91]
  buffer_load_dwordx4 v3, s[16:19], s43 offen offset:1024 lds
  s_waitcnt lgkmcnt(5)
  v_mfma_f32_16x16x32_bf16 v[84:87], v[36:39], a[64:67], v[84:87]
  ds_read_b128 v[60:63], v11 offset:22528
  v_mfma_f32_16x16x32_bf16 v[92:95], v[36:39], a[68:71], v[92:95]
  v_cvt_pk_bf16_f32 v22, v76, v77
  s_waitcnt lgkmcnt(5)
  v_mfma_f32_16x16x32_bf16 v[80:83], v[40:43], a[72:75], v[80:83]
  ds_read_b128 v[32:35], v10 offset:24576
  s_add_u32 m0, s46, 35712
  v_mfma_f32_16x16x32_bf16 v[88:91], v[40:43], a[76:79], v[88:91]
  buffer_load_dwordx4 v3, s[16:19], s43 offen offset:1152 lds
  s_waitcnt lgkmcnt(5)
  v_mfma_f32_16x16x32_bf16 v[84:87], v[44:47], a[72:75], v[84:87]
  ds_read_b128 v[36:39], v10 offset:26624
  v_mfma_f32_16x16x32_bf16 v[92:95], v[44:47], a[76:79], v[92:95]
  v_cvt_pk_bf16_f32 v23, v78, v79
  s_waitcnt lgkmcnt(5)
  v_mfma_f32_16x16x32_bf16 v[80:83], v[48:51], a[80:83], v[80:83]
  ds_read_b128 v[40:43], v11 offset:24576
  s_add_u32 m0, s46, 39680
  v_mfma_f32_16x16x32_bf16 v[88:91], v[48:51], a[84:87], v[88:91]
  buffer_load_dwordx4 v3, s[16:19], s43 offen offset:1280 lds
  s_waitcnt lgkmcnt(5)
  v_mfma_f32_16x16x32_bf16 v[84:87], v[52:55], a[80:83], v[84:87]
  ds_read_b128 v[44:47], v11 offset:26624
  v_mfma_f32_16x16x32_bf16 v[92:95], v[52:55], a[84:87], v[92:95]
  buffer_store_dwordx4 v[20:23], v4, s[4:7], s41 offen offset:1024 sc1
  s_waitcnt lgkmcnt(5)
  v_mfma_f32_16x16x32_bf16 v[80:83], v[56:59], a[88:91], v[80:83]
  ds_read_b128 v[48:51], v10 offset:28672
  s_add_u32 m0, s46, 43648
  v_mfma_f32_16x16x32_bf16 v[88:91], v[56:59], a[92:95], v[88:91]
  buffer_load_dwordx4 v3, s[16:19], s43 offen offset:1408 lds
  s_waitcnt lgkmcnt(5)
  v_mfma_f32_16x16x32_bf16 v[84:87], v[60:63], a[88:91], v[84:87]
  ds_read_b128 v[52:55], v10 offset:30720
  v_mfma_f32_16x16x32_bf16 v[92:95], v[60:63], a[92:95], v[92:95]
  s_waitcnt lgkmcnt(5)
  v_mfma_f32_16x16x32_bf16 v[80:83], v[32:35], a[96:99], v[80:83]
  ds_read_b128 v[56:59], v11 offset:28672
  s_add_u32 m0, s46, 47616
  v_mfma_f32_16x16x32_bf16 v[88:91], v[32:35], a[100:103], v[88:91]
  buffer_load_dwordx4 v3, s[16:19], s43 offen offset:1536 lds
  s_waitcnt lgkmcnt(5)
  v_mfma_f32_16x16x32_bf16 v[84:87], v[36:39], a[96:99], v[84:87]
  ds_read_b128 v[60:63], v11 offset:30720
  v_mfma_f32_16x16x32_bf16 v[92:95], v[36:39], a[100:103], v[92:95]
  s_waitcnt lgkmcnt(5)
  v_mfma_f32_16x16x32_bf16 v[80:83], v[40:43], a[104:107], v[80:83]
  ds_read_b128 v[32:35], v10 offset:32768
  s_add_u32 m0, s46, 51584
  v_mfma_f32_16x16x32_bf16 v[88:91], v[40:43], a[108:111], v[88:91]
  buffer_load_dwordx4 v3, s[16:19], s43 offen offset:1664 lds
  s_waitcnt lgkmcnt(5)
  v_mfma_f32_16x16x32_bf16 v[84:87], v[44:47], a[104:107], v[84:87]
  ds_read_b128 v[36:39], v10 offset:34816
  v_mfma_f32_16x16x32_bf16 v[92:95], v[44:47], a[108:111], v[92:95]
  s_waitcnt lgkmcnt(5)
  v_mfma_f32_16x16x32_bf16 v[80:83], v[48:51], a[112:115], v[80:83]
  ds_read_b128 v[40:43], v11 offset:32768
  s_add_u32 m0, s46, 55552
  v_mfma_f32_16x16x32_bf16 v[88:91], v[48:51], a[116:119], v[88:91]
  buffer_load_dwordx4 v3, s[16:19], s43 offen offset:1792 lds
  s_waitcnt lgkmcnt(5)
  v_mfma_f32_16x16x32_bf16 v[84:87], v[52:55], a[112:115], v[84:87]
  ds_read_b128 v[44:47], v11 offset:34816
  v_mfma_f32_16x16x32_bf16 v[92:95], v[52:55], a[116:119], v[92:95]
  s_waitcnt lgkmcnt(5)
  v_mfma_f32_16x16x32_bf16 v[80:83], v[56:59], a[120:123], v[80:83]
  ds_read_b128 v[48:51], v10 offset:36864
  s_add_u32 m0, s46, 59520
  v_mfma_f32_16x16x32_bf16 v[88:91], v[56:59], a[124:127], v[88:91]
  buffer_load_dwordx4 v3, s[16:19], s43 offen offset:1920 lds
  s_waitcnt lgkmcnt(5)
  v_mfma_f32_16x16x32_bf16 v[84:87], v[60:63], a[120:123], v[84:87]
  ds_read_b128 v[52:55], v10 offset:38912
  v_mfma_f32_16x16x32_bf16 v[92:95], v[60:63], a[124:127], v[92:95]
  s_waitcnt lgkmcnt(5)
  v_mfma_f32_16x16x32_bf16 v[80:83], v[32:35], a[128:131], v[80:83]
  ds_read_b128 v[56:59], v11 offset:36864
  v_mfma_f32_16x16x32_bf16 v[88:91], v[32:35], a[132:135], v[88:91]
  s_waitcnt lgkmcnt(5)
  v_mfma_f32_16x16x32_bf16 v[84:87], v[36:39], a[128:131], v[84:87]
  ds_read_b128 v[60:63], v11 offset:38912
  v_mfma_f32_16x16x32_bf16 v[92:95], v[36:39], a[132:135], v[92:95]
  s_waitcnt lgkmcnt(5)
  v_mfma_f32_16x16x32_bf16 v[80:83], v[40:43], a[136:139], v[80:83]
  ds_read_b128 v[32:35], v10 offset:40960
  v_mfma_f32_16x16x32_bf16 v[88:91], v[40:43], a[140:143], v[88:91]
  s_waitcnt lgkmcnt(5)
  v_mfma_f32_16x16x32_bf16 v[84:87], v[44:47], a[136:139], v[84:87]
  ds_read_b128 v[36:39], v10 offset:43008
  v_mfma_f32_16x16x32_bf16 v[92:95], v[44:47], a[140:143], v[92:95]
  s_waitcnt lgkmcnt(5)
  v_mfma_f32_16x16x32_bf16 v[80:83], v[48:51], a[144:147], v[80:83]
  ds_read_b128 v[40:43], v11 offset:40960
  v_mfma_f32_16x16x32_bf16 v[88:91], v[48:51], a[148:151], v[88:91]
  s_waitcnt lgkmcnt(5)
  v_mfma_f32_16x16x32_bf16 v[84:87], v[52:55], a[144:147], v[84:87]
  ds_read_b128 v[44:47], v11 offset:43008
  v_mfma_f32_16x16x32_bf16 v[92:95], v[52:55], a[148:151], v[92:95]
  s_waitcnt lgkmcnt(5)
  v_mfma_f32_16x16x32_bf16 v[80:83], v[56:59], a[152:155], v[80:83]
  ds_read_b128 v[48:51], v10 offset:45056
  v_mfma_f32_16x16x32_bf16 v[88:91], v[56:59], a[156:159], v[88:91]
  s_waitcnt lgkmcnt(5)
  v_mfma_f32_16x16x32_bf16 v[84:87], v[60:63], a[152:155], v[84:87]
  ds_read_b128 v[52:55], v10 offset:47104
  v_mfma_f32_16x16x32_bf16 v[92:95], v[60:63], a[156:159], v[92:95]
  v_mov_b32 v5, s29
  s_waitcnt lgkmcnt(5)
  v_mfma_f32_16x16x32_bf16 v[80:83], v[32:35], a[160:163], v[80:83]
  ds_read_b128 v[56:59], v11 offset:45056
  v_mfma_f32_16x16x32_bf16 v[88:91], v[32:35], a[164:167], v[88:91]
  s_waitcnt vmcnt(5)
  s_mov_b64 exec, 1
  buffer_store_dword v5, off, s[4:7], s44 sc1
  s_mov_b64 exec, -1
  s_waitcnt lgkmcnt(5)
  v_mfma_f32_16x16x32_bf16 v[84:87], v[36:39], a[160:163], v[84:87]
  ds_read_b128 v[60:63], v11 offset:47104
  v_mfma_f32_16x16x32_bf16 v[92:95], v[36:39], a[164:167], v[92:95]
  s_waitcnt lgkmcnt(5)
  v_mfma_f32_16x16x32_bf16 v[80:83], v[40:43], a[168:171], v[80:83]
  ds_read_b128 v[32:35], v10 offset:49152
  v_mfma_f32_16x16x32_bf16 v[88:91], v[40:43], a[172:175], v[88:91]
  s_waitcnt lgkmcnt(5)
  v_mfma_f32_16x16x32_bf16 v[84:87], v[44:47], a[168:171], v[84:87]
  ds_read_b128 v[36:39], v10 offset:51200
  v_mfma_f32_16x16x32_bf16 v[92:95], v[44:47], a[172:175], v[92:95]
  s_waitcnt lgkmcnt(5)
  v_mfma_f32_16x16x32_bf16 v[80:83], v[48:51], a[176:179], v[80:83]
  ds_read_b128 v[40:43], v11 offset:49152
  v_mfma_f32_16x16x32_bf16 v[88:91], v[48:51], a[180:183], v[88:91]
  s_waitcnt lgkmcnt(5)
  v_mfma_f32_16x16x32_bf16 v[84:87], v[52:55], a[176:179], v[84:87]
  ds_read_b128 v[44:47], v11 offset:51200
  v_mfma_f32_16x16x32_bf16 v[92:95], v[52:55], a[180:183], v[92:95]
  s_waitcnt lgkmcnt(5)
  v_mfma_f32_16x16x32_bf16 v[80:83], v[56:59], a[184:187], v[80:83]
  ds_read_b128 v[48:51], v10 offset:53248
  v_mfma_f32_16x16x32_bf16 v[88:91], v[56:59], a[188:191], v[88:91]
  s_waitcnt lgkmcnt(5)
  v_mfma_f32_16x16x32_bf16 v[84:87], v[60:63], a[184:187], v[84:87]
  ds_read_b128 v[52:55], v10 offset:55296
  v_mfma_f32_16x16x32_bf16 v[92:95], v[60:63], a[188:191], v[92:95]
  s_waitcnt lgkmcnt(5)
  v_mfma_f32_16x16x32_bf16 v[80:83], v[32:35], a[192:195], v[80:83]
  ds_read_b128 v[56:59], v11 offset:53248
  v_mfma_f32_16x16x32_bf16 v[88:91], v[32:35], a[196:199], v[88:91]
  s_waitcnt lgkmcnt(5)
  v_mfma_f32_16x16x32_bf16 v[84:87], v[36:39], a[192:195], v[84:87]
  ds_read_b128 v[60:63], v11 offset:55296
  v_mfma_f32_16x16x32_bf16 v[92:95], v[36:39], a[196:199], v[92:95]
  s_waitcnt lgkmcnt(5)
  v_mfma_f32_16x16x32_bf16 v[80:83], v[40:43], a[200:203], v[80:83]
  ds_read_b128 v[32:35], v10 offset:57344
  v_mfma_f32_16x16x32_bf16 v[88:91], v[40:43], a[204:207], v[88:91]
  s_waitcnt lgkmcnt(5)
  v_mfma_f32_16x16x32_bf16 v[84:87], v[44:47], a[200:203], v[84:87]
  ds_read_b128 v[36:39], v10 offset:59392
  v_mfma_f32_16x16x32_bf16 v[92:95], v[44:47], a[204:207], v[92:95]
  s_waitcnt lgkmcnt(5)
  v_mfma_f32_16x16x32_bf16 v[80:83], v[48:51], a[208:211], v[80:83]
  ds_read_b128 v[40:43], v11 offset:57344
  v_mfma_f32_16x16x32_bf16 v[88:91], v[48:51], a[212:215], v[88:91]
  s_waitcnt lgkmcnt(5)
  v_mfma_f32_16x16x32_bf16 v[84:87], v[52:55], a[208:211], v[84:87]
  ds_read_b128 v[44:47], v11 offset:59392
  v_mfma_f32_16x16x32_bf16 v[92:95], v[52:55], a[212:215], v[92:95]
  s_waitcnt lgkmcnt(5)
  v_mfma_f32_16x16x32_bf16 v[80:83], v[56:59], a[216:219], v[80:83]
  ds_read_b128 v[48:51], v10 offset:61440
  v_mfma_f32_16x16x32_bf16 v[88:91], v[56:59], a[220:223], v[88:91]
  s_add_u32 s31, s43, 0x20000
  s_mov_b32 m0, 0x24000
  s_waitcnt lgkmcnt(5)
  v_mfma_f32_16x16x32_bf16 v[84:87], v[60:63], a[216:219], v[84:87]
  ds_read_b128 v[52:55], v10 offset:63488
  v_mfma_f32_16x16x32_bf16 v[92:95], v[60:63], a[220:223], v[92:95]
  buffer_load_dword v7, s[16:19], s31 offen lds
  s_waitcnt lgkmcnt(5)
  v_mfma_f32_16x16x32_bf16 v[80:83], v[32:35], a[224:227], v[80:83]
  ds_read_b128 v[56:59], v11 offset:61440
  v_mfma_f32_16x16x32_bf16 v[88:91], v[32:35], a[228:231], v[88:91]
  s_waitcnt lgkmcnt(5)
  v_mfma_f32_16x16x32_bf16 v[84:87], v[36:39], a[224:227], v[84:87]
  ds_read_b128 v[60:63], v11 offset:63488
  v_mfma_f32_16x16x32_bf16 v[92:95], v[36:39], a[228:231], v[92:95]
  s_waitcnt lgkmcnt(5)
  v_mfma_f32_16x16x32_bf16 v[80:83], v[40:43], a[232:235], v[80:83]
  v_mfma_f32_16x16x32_bf16 v[88:91], v[40:43], a[236:239], v[88:91]
  s_mov_b32 s41, s47
  s_add_u32 s47, s47, s42
  s_waitcnt lgkmcnt(4)
  v_mfma_f32_16x16x32_bf16 v[84:87], v[44:47], a[232:235], v[84:87]
  v_mfma_f32_16x16x32_bf16 v[92:95], v[44:47], a[236:239], v[92:95]
  s_waitcnt vmcnt(2) lgkmcnt(0)
  s_barrier
  v_mfma_f32_16x16x32_bf16 v[80:83], v[48:51], a[240:243], v[80:83]
  ds_read_b128 v[32:35], v8 offset:0
  v_mfma_f32_16x16x32_bf16 v[88:91], v[48:51], a[244:247], v[88:91]
  ds_read_b128 v[36:39], v8 offset:2048
  v_mfma_f32_16x16x32_bf16 v[84:87], v[52:55], a[240:243], v[84:87]
  ds_read_b128 v[40:43], v9 offset:0
  v_mfma_f32_16x16x32_bf16 v[92:95], v[52:55], a[244:247], v[92:95]
  ds_read_b128 v[44:47], v9 offset:2048
  v_mfma_f32_16x16x32_bf16 v[80:83], v[56:59], a[248:251], v[80:83]
  ds_read_b128 v[48:51], v8 offset:4096
  v_mfma_f32_16x16x32_bf16 v[88:91], v[56:59], a[252:255], v[88:91]
  ds_read_b128 v[52:55], v8 offset:6144
  v_mfma_f32_16x16x32_bf16 v[84:87], v[60:63], a[248:251], v[84:87]
  v_mfma_f32_16x16x32_bf16 v[92:95], v[60:63], a[252:255], v[92:95]
  s_add_u32 s29, s29, 1
  s_cmp_lt_u32 s29, 64
  s_cbranch_scc1 L_G1_loopN
  s_nop 7
  v_cvt_pk_bf16_f32 v16, v80, v81
  v_cvt_pk_bf16_f32 v17, v82, v83
  v_cvt_pk_bf16_f32 v18, v84, v85
  v_cvt_pk_bf16_f32 v19, v86, v87
  buffer_store_dwordx4 v[16:19], v4, s[4:7], s41 offen offset:0 sc1
  v_cvt_pk_bf16_f32 v20, v88, v89
  v_cvt_pk_bf16_f32 v21, v90, v91
  v_cvt_pk_bf16_f32 v22, v92, v93
  v_cvt_pk_bf16_f32 v23, v94, v95
  buffer_store_dwordx4 v[20:23], v4, s[4:7], s41 offen offset:1024 sc1
  s_branch L_G1_done
.p2align 6
L_G1_loopR:
  s_add_u32 s43, s43, 0x10000
  s_waitcnt lgkmcnt(5)
  v_mfma_f32_16x16x32_bf16 v[64:67], a[0:3], v[32:35], 0
  ds_read_b128 v[56:59], v9 offset:4096
  s_add_u32 m0, s46, 65536
  v_mfma_f32_16x16x32_bf16 v[68:71], a[4:7], v[32:35], 0
  buffer_load_dwordx4 v3, s[16:19], s43 offen offset:0 lds
  s_waitcnt lgkmcnt(5)
  v_mfma_f32_16x16x32_bf16 v[72:75], a[0:3], v[36:39], 0
  ds_read_b128 v[60:63], v9 offset:6144
  v_mfma_f32_16x16x32_bf16 v[76:79], a[4:7], v[36:39], 0
  s_waitcnt lgkmcnt(5)
  v_mfma_f32_16x16x32_bf16 v[64:67], a[8:11], v[40:43], v[64:67]
  ds_read_b128 v[32:35], v8 offset:8192
  s_add_u32 m0, s46, 69504
  v_mfma_f32_16x16x32_bf16 v[68:71], a[12:15], v[40:43], v[68:71]
  buffer_load_dwordx4 v3, s[16:19], s43 offen offset:128 lds
  s_waitcnt lgkmcnt(5)
  v_mfma_f32_16x16x32_bf16 v[72:75], a[8:11], v[44:47], v[72:75]
  ds_read_b128 v[36:39], v8 offset:10240
  v_mfma_f32_16x16x32_bf16 v[76:79], a[12:15], v[44:47], v[76:79]
  v_maximum3_f32 v80, v80, 0, 0
  v_maximum3_f32 v81, v81, 0, 0
  s_waitcnt lgkmcnt(5)
  v_mfma_f32_16x16x32_bf16 v[64:67], a[16:19], v[48:51], v[64:67]
  ds_read_b128 v[40:43], v9 offset:8192
  s_add_u32 m0, s46, 73472
  v_mfma_f32_16x16x32_bf16 v[68:71], a[20:23], v[48:51], v[68:71]
  buffer_load_dwordx4 v3, s[16:19], s43 offen offset:256 lds
  s_waitcnt lgkmcnt(5)
  v_mfma_f32_16x16x32_bf16 v[72:75], a[16:19], v[52:55], v[72:75]
  ds_read_b128 v[44:47], v9 offset:10240
  v_mfma_f32_16x16x32_bf16 v[76:79], a[20:23], v[52:55], v[76:79]
  v_cvt_pk_bf16_f32 v16, v80, v81
  v_maximum3_f32 v82, v82, 0, 0
  s_waitcnt lgkmcnt(5)
  v_mfma_f32_16x16x32_bf16 v[64:67], a[24:27], v[56:59], v[64:67]
  ds_read_b128 v[48:51], v8 offset:12288
  s_add_u32 m0, s46, 77440
  v_mfma_f32_16x16x32_bf16 v[68:71], a[28:31], v[56:59], v[68:71]
  buffer_load_dwordx4 v3, s[16:19], s43 offen offset:384 lds
  s_waitcnt lgkmcnt(5)
  v_mfma_f32_16x16x32_bf16 v[72:75], a[24:27], v[60:63], v[72:75]
  ds_read_b128 v[52:55], v8 offset:14336
  v_mfma_f32_16x16x32_bf16 v[76:79], a[28:31], v[60:63], v[76:79]
  v_maximum3_f32 v83, v83, 0, 0
  v_cvt_pk_bf16_f32 v17, v82, v83
  s_waitcnt lgkmcnt(5)
  v_mfma_f32_16x16x32_bf16 v[64:67], a[32:35], v[32:35], v[64:67]
  ds_read_b128 v[56:59], v9 offset:12288
  s_add_u32 m0, s46, 81408
  v_mfma_f32_16x16x32_bf16 v[68:71], a[36:39], v[32:35], v[68:71]
  buffer_load_dwordx4 v3, s[16:19], s43 offen offset:512 lds
  s_waitcnt lgkmcnt(5)
  v_mfma_f32_16x16x32_bf16 v[72:75], a[32:35], v[36:39], v[72:75]
  ds_read_b128 v[60:63], v9 offset:14336
  v_mfma_f32_16x16x32_bf16 v[76:79], a[36:39], v[36:39], v[76:79]
  v_maximum3_f32 v84, v84, 0, 0
  v_maximum3_f32 v85, v85, 0, 0
  s_waitcnt lgkmcnt(5)
  v_mfma_f32_16x16x32_bf16 v[64:67], a[40:43], v[40:43], v[64:67]
  ds_read_b128 v[32:35], v8 offset:16384
  s_add_u32 m0, s46, 85376
  v_mfma_f32_16x16x32_bf16 v[68:71], a[44:47], v[40:43], v[68:71]
  buffer_load_dwordx4 v3, s[16:19], s43 offen offset:640 lds
  s_waitcnt lgkmcnt(5)
  v_mfma_f32_16x16x32_bf16 v[72:75], a[40:43], v[44:47], v[72:75]
  ds_read_b128 v[36:39], v8 offset:18432
  v_mfma_f32_16x16x32_bf16 v[76:79], a[44:47], v[44:47], v[76:79]
  v_cvt_pk_bf16_f32 v18, v84, v85
  v_maximum3_f32 v86, v86, 0, 0
  s_waitcnt lgkmcnt(5)
  v_mfma_f32_16x16x32_bf16 v[64:67], a[48:51], v[48:51], v[64:67]
  ds_read_b128 v[40:43], v9 offset:16384
  s_add_u32 m0, s46, 89344
  v_mfma_f32_16x16x32_bf16 v[68:71], a[52:55], v[48:51], v[68:71]
  buffer_load_dwordx4 v3, s[16:19], s43 offen offset:768 lds
  s_waitcnt lgkmcnt(5)
  v_mfma_f32_16x16x32_bf16 v[72:75], a[48:51], v[52:55], v[72:75]
  ds_read_b128 v[44:47], v9 offset:18432
  v_mfma_f32_16x16x32_bf16 v[76:79], a[52:55], v[52:55], v[76:79]
  v_maximum3_f32 v87, v87, 0, 0
  v_cvt_pk_bf16_f32 v19, v86, v87
  s_waitcnt lgkmcnt(5)
  v_mfma_f32_16x16x32_bf16 v[64:67], a[56:59], v[56:59], v[64:67]
  ds_read_b128 v[48:51], v8 offset:20480
  s_add_u32 m0, s46, 93312
  v_mfma_f32_16x16x32_bf16 v[68:71], a[60:63], v[56:59], v[68:71]
  buffer_load_dwordx4 v3, s[16:19], s43 offen offset:896 lds
  s_waitcnt lgkmcnt(5)
  v_mfma_f32_16x16x32_bf16 v[72:75], a[56:59], v[60:63], v[72:75]
  ds_read_b128 v[52:55], v8 offset:22528
  v_mfma_f32_16x16x32_bf16 v[76:79], a[60:63], v[60:63], v[76:79]
  buffer_store_dwordx4 v[16:19], v4, s[4:7], s41 offen offset:0 sc1
  v_maximum3_f32 v88, v88, 0, 0
  s_waitcnt lgkmcnt(5)
  v_mfma_f32_16x16x32_bf16 v[64:67], a[64:67], v[32:35], v[64:67]
  ds_read_b128 v[56:59], v9 offset:20480
  s_add_u32 m0, s46, 97280
  v_mfma_f32_16x16x32_bf16 v[68:71], a[68:71], v[32:35], v[68:71]
  buffer_load_dwordx4 v3, s[16:19], s43 offen offset:1024 lds
  s_waitcnt lgkmcnt(5)
  v_mfma_f32_16x16x32_bf16 v[72:75], a[64:67], v[36:39], v[72:75]
  ds_read_b128 v[60:63], v9 offset:22528
  v_mfma_f32_16x16x32_bf16 v[76:79], a[68:71], v[36:39], v[76:79]
  v_maximum3_f32 v89, v89, 0, 0
  v_cvt_pk_bf16_f32 v20, v88, v89
  s_waitcnt lgkmcnt(5)
  v_mfma_f32_16x16x32_bf16 v[64:67], a[72:75], v[40:43], v[64:67]
  ds_read_b128 v[32:35], v8 offset:24576
  s_add_u32 m0, s46, 101248
  v_mfma_f32_16x16x32_bf16 v[68:71], a[76:79], v[40:43], v[68:71]
  buffer_load_dwordx4 v3, s[16:19], s43 offen offset:1152 lds
  s_waitcnt lgkmcnt(5)
  v_mfma_f32_16x16x32_bf16 v[72:75], a[72:75], v[44:47], v[72:75]
  ds_read_b128 v[36:39], v8 offset:26624
  v_mfma_f32_16x16x32_bf16 v[76:79], a[76:79], v[44:47], v[76:79]
  v_maximum3_f32 v90, v90, 0, 0
  v_maximum3_f32 v91, v91, 0, 0
  s_waitcnt lgkmcnt(5)
  v_mfma_f32_16x16x32_bf16 v[64:67], a[80:83], v[48:51], v[64:67]
  ds_read_b128 v[40:43], v9 offset:24576
  s_add_u32 m0, s46, 105216
  v_mfma_f32_16x16x32_bf16 v[68:71], a[84:87], v[48:51], v[68:71]
  buffer_load_dwordx4 v3, s[16:19], s43 offen offset:1280 lds
  s_waitcnt lgkmcnt(5)
  v_mfma_f32_16x16x32_bf16 v[72:75], a[80:83], v[52:55], v[72:75]
  ds_read_b128 v[44:47], v9 offset:26624
  v_mfma_f32_16x16x32_bf16 v[76:79], a[84:87], v[52:55], v[76:79]
  v_cvt_pk_bf16_f32 v21, v90, v91
  v_maximum3_f32 v92, v92, 0, 0
  s_waitcnt lgkmcnt(5)
  v_mfma_f32_16x16x32_bf16 v[64:67], a[88:91], v[56:59], v[64:67]
  ds_read_b128 v[48:51], v8 offset:28672
  s_add_u32 m0, s46, 109184
  v_mfma_f32_16x16x32_bf16 v[68:71], a[92:95], v[56:59], v[68:71]
  buffer_load_dwordx4 v3, s[16:19], s43 offen offset:1408 lds
  s_waitcnt lgkmcnt(5)
  v_mfma_f32_16x16x32_bf16 v[72:75], a[88:91], v[60:63], v[72:75]
  ds_read_b128 v[52:55], v8 offset:30720
  v_mfma_f32_16x16x32_bf16 v[76:79], a[92:95], v[60:63], v[76:79]
  v_maximum3_f32 v93, v93, 0, 0
  v_cvt_pk_bf16_f32 v22, v92, v93
  s_waitcnt lgkmcnt(5)
  v_mfma_f32_16x16x32_bf16 v[64:67], a[96:99], v[32:35], v[64:67]
  ds_read_b128 v[56:59], v9 offset:28672
  s_add_u32 m0, s46, 113152
  v_mfma_f32_16x16x32_bf16 v[68:71], a[100:103], v[32:35], v[68:71]
  buffer_load_dwordx4 v3, s[16:19], s43 offen offset:1536 lds
  s_waitcnt lgkmcnt(5)
  v_mfma_f32_16x16x32_bf16 v[72:75], a[96:99], v[36:39], v[72:75]
  ds_read_b128 v[60:63], v9 offset:30720
  v_mfma_f32_16x16x32_bf16 v[76:79], a[100:103], v[36:39], v[76:79]
  v_maximum3_f32 v94, v94, 0, 0
  v_maximum3_f32 v95, v95, 0, 0
  s_waitcnt lgkmcnt(5)
  v_mfma_f32_16x16x32_bf16 v[64:67], a[104:107], v[40:43], v[64:67]
  ds_read_b128 v[32:35], v8 offset:32768
  s_add_u32 m0, s46, 117120
  v_mfma_f32_16x16x32_bf16 v[68:71], a[108:111], v[40:43], v[68:71]
  buffer_load_dwordx4 v3, s[16:19], s43 offen offset:1664 lds
  s_waitcnt lgkmcnt(5)
  v_mfma_f32_16x16x32_bf16 v[72:75], a[104:107], v[44:47], v[72:75]
  ds_read_b128 v[36:39], v8 offset:34816
  v_mfma_f32_16x16x32_bf16 v[76:79], a[108:111], v[44:47], v[76:79]
  v_cvt_pk_bf16_f32 v23, v94, v95
  buffer_store_dwordx4 v[20:23], v4, s[4:7], s41 offen offset:1024 sc1
  s_waitcnt lgkmcnt(5)
  v_mfma_f32_16x16x32_bf16 v[64:67], a[112:115], v[48:51], v[64:67]
  ds_read_b128 v[40:43], v9 offset:32768
  s_add_u32 m0, s46, 121088
  v_mfma_f32_16x16x32_bf16 v[68:71], a[116:119], v[48:51], v[68:71]
  buffer_load_dwordx4 v3, s[16:19], s43 offen offset:1792 lds
  s_waitcnt lgkmcnt(5)
  v_mfma_f32_16x16x32_bf16 v[72:75], a[112:115], v[52:55], v[72:75]
  ds_read_b128 v[44:47], v9 offset:34816
  v_mfma_f32_16x16x32_bf16 v[76:79], a[116:119], v[52:55], v[76:79]
  s_waitcnt lgkmcnt(5)
  v_mfma_f32_16x16x32_bf16 v[64:67], a[120:123], v[56:59], v[64:67]
  ds_read_b128 v[48:51], v8 offset:36864
  s_add_u32 m0, s46, 125056
  v_mfma_f32_16x16x32_bf16 v[68:71], a[124:127], v[56:59], v[68:71]
  buffer_load_dwordx4 v3, s[16:19], s43 offen offset:1920 lds
  s_waitcnt lgkmcnt(5)
  v_mfma_f32_16x16x32_bf16 v[72:75], a[120:123], v[60:63], v[72:75]
  ds_read_b128 v[52:55], v8 offset:38912
  v_mfma_f32_16x16x32_bf16 v[76:79], a[124:127], v[60:63], v[76:79]
  s_waitcnt lgkmcnt(5)
  v_mfma_f32_16x16x32_bf16 v[64:67], a[128:131], v[32:35], v[64:67]
  ds_read_b128 v[56:59], v9 offset:36864
  v_mfma_f32_16x16x32_bf16 v[68:71], a[132:135], v[32:35], v[68:71]
  s_waitcnt lgkmcnt(5)
  v_mfma_f32_16x16x32_bf16 v[72:75], a[128:131], v[36:39], v[72:75]
  ds_read_b128 v[60:63], v9 offset:38912
  v_mfma_f32_16x16x32_bf16 v[76:79], a[132:135], v[36:39], v[76:79]
  s_waitcnt lgkmcnt(5)
  v_mfma_f32_16x16x32_bf16 v[64:67], a[136:139], v[40:43], v[64:67]
  ds_read_b128 v[32:35], v8 offset:40960
  v_mfma_f32_16x16x32_bf16 v[68:71], a[140:143], v[40:43], v[68:71]
  s_waitcnt lgkmcnt(5)
  v_mfma_f32_16x16x32_bf16 v[72:75], a[136:139], v[44:47], v[72:75]
  ds_read_b128 v[36:39], v8 offset:43008
  v_mfma_f32_16x16x32_bf16 v[76:79], a[140:143], v[44:47], v[76:79]
  s_waitcnt lgkmcnt(5)
  v_mfma_f32_16x16x32_bf16 v[64:67], a[144:147], v[48:51], v[64:67]
  ds_read_b128 v[40:43], v9 offset:40960
  v_mfma_f32_16x16x32_bf16 v[68:71], a[148:151], v[48:51], v[68:71]
  s_waitcnt lgkmcnt(5)
  v_mfma_f32_16x16x32_bf16 v[72:75], a[144:147], v[52:55], v[72:75]
  ds_read_b128 v[44:47], v9 offset:43008
  v_mfma_f32_16x16x32_bf16 v[76:79], a[148:151], v[52:55], v[76:79]
  s_waitcnt lgkmcnt(5)
  v_mfma_f32_16x16x32_bf16 v[64:67], a[152:155], v[56:59], v[64:67]
  ds_read_b128 v[48:51], v8 offset:45056
  v_mfma_f32_16x16x32_bf16 v[68:71], a[156:159], v[56:59], v[68:71]
  s_waitcnt lgkmcnt(5)
  v_mfma_f32_16x16x32_bf16 v[72:75], a[152:155], v[60:63], v[72:75]
  ds_read_b128 v[52:55], v8 offset:47104
  v_mfma_f32_16x16x32_bf16 v[76:79], a[156:159], v[60:63], v[76:79]
  v_mov_b32 v5, s29
  s_waitcnt lgkmcnt(5)
  v_mfma_f32_16x16x32_bf16 v[64:67], a[160:163], v[32:35], v[64:67]
  ds_read_b128 v[56:59], v9 offset:45056
  v_mfma_f32_16x16x32_bf16 v[68:71], a[164:167], v[32:35], v[68:71]
  s_waitcnt vmcnt(2)
  s_mov_b64 exec, 1
  buffer_store_dword v5, off, s[4:7], s44 sc1
  s_mov_b64 exec, -1
  s_waitcnt lgkmcnt(5)
  v_mfma_f32_16x16x32_bf16 v[72:75], a[160:163], v[36:39], v[72:75]
  ds_read_b128 v[60:63], v9 offset:47104
  v_mfma_f32_16x16x32_bf16 v[76:79], a[164:167], v[36:39], v[76:79]
  s_waitcnt lgkmcnt(5)
  v_mfma_f32_16x16x32_bf16 v[64:67], a[168:171], v[40:43], v[64:67]
  ds_read_b128 v[32:35], v8 offset:49152
  v_mfma_f32_16x16x32_bf16 v[68:71], a[172:175], v[40:43], v[68:71]
  s_waitcnt lgkmcnt(5)
  v_mfma_f32_16x16x32_bf16 v[72:75], a[168:171], v[44:47], v[72:75]
  ds_read_b128 v[36:39], v8 offset:51200
  v_mfma_f32_16x16x32_bf16 v[76:79], a[172:175], v[44:47], v[76:79]
  s_waitcnt lgkmcnt(5)
  v_mfma_f32_16x16x32_bf16 v[64:67], a[176:179], v[48:51], v[64:67]
  ds_read_b128 v[40:43], v9 offset:49152
  v_mfma_f32_16x16x32_bf16 v[68:71], a[180:183], v[48:51], v[68:71]
  s_waitcnt lgkmcnt(5)
  v_mfma_f32_16x16x32_bf16 v[72:75], a[176:179], v[52:55], v[72:75]
  ds_read_b128 v[44:47], v9 offset:51200
  v_mfma_f32_16x16x32_bf16 v[76:79], a[180:183], v[52:55], v[76:79]
  s_waitcnt lgkmcnt(5)
  v_mfma_f32_16x16x32_bf16 v[64:67], a[184:187], v[56:59], v[64:67]
  ds_read_b128 v[48:51], v8 offset:53248
  v_mfma_f32_16x16x32_bf16 v[68:71], a[188:191], v[56:59], v[68:71]
  s_waitcnt lgkmcnt(5)
  v_mfma_f32_16x16x32_bf16 v[72:75], a[184:187], v[60:63], v[72:75]
  ds_read_b128 v[52:55], v8 offset:55296
  v_mfma_f32_16x16x32_bf16 v[76:79], a[188:191], v[60:63], v[76:79]
  s_waitcnt lgkmcnt(5)
  v_mfma_f32_16x16x32_bf16 v[64:67], a[192:195], v[32:35], v[64:67]
  ds_read_b128 v[56:59], v9 offset:53248
  v_mfma_f32_16x16x32_bf16 v[68:71], a[196:199], v[32:35], v[68:71]
  s_waitcnt lgkmcnt(5)
  v_mfma_f32_16x16x32_bf16 v[72:75], a[192:195], v[36:39], v[72:75]
  ds_read_b128 v[60:63], v9 offset:55296
  v_mfma_f32_16x16x32_bf16 v[76:79], a[196:199], v[36:39], v[76:79]
  s_waitcnt lgkmcnt(5)
  v_mfma_f32_16x16x32_bf16 v[64:67], a[200:203], v[40:43], v[64:67]
  ds_read_b128 v[32:35], v8 offset:57344
  v_mfma_f32_16x16x32_bf16 v[68:71], a[204:207], v[40:43], v[68:71]
  s_waitcnt lgkmcnt(5)
  v_mfma_f32_16x16x32_bf16 v[72:75], a[200:203], v[44:47], v[72:75]
  ds_read_b128 v[36:39], v8 offset:59392
  v_mfma_f32_16x16x32_bf16 v[76:79], a[204:207], v[44:47], v[76:79]
  s_waitcnt lgkmcnt(5)
  v_mfma_f32_16x16x32_bf16 v[64:67], a[208:211], v[48:51], v[64:67]
  ds_read_b128 v[40:43], v9 offset:57344
  v_mfma_f32_16x16x32_bf16 v[68:71], a[212:215], v[48:51], v[68:71]
  s_waitcnt lgkmcnt(5)
  v_mfma_f32_16x16x32_bf16 v[72:75], a[208:211], v[52:55], v[72:75]
  ds_read_b128 v[44:47], v9 offset:59392
  v_mfma_f32_16x16x32_bf16 v[76:79], a[212:215], v[52:55], v[76:79]
  s_waitcnt lgkmcnt(5)
  v_mfma_f32_16x16x32_bf16 v[64:67], a[216:219], v[56:59], v[64:67]
  ds_read_b128 v[48:51], v8 offset:61440
  v_mfma_f32_16x16x32_bf16 v[68:71], a[220:223], v[56:59], v[68:71]
  s_add_u32 s31, s43, 0x20000
  s_mov_b32 m0, 0x24000
  s_waitcnt lgkmcnt(5)
  v_mfma_f32_16x16x32_bf16 v[72:75], a[216:219], v[60:63], v[72:75]
  ds_read_b128 v[52:55], v8 offset:63488
  v_mfma_f32_16x16x32_bf16 v[76:79], a[220:223], v[60:63], v[76:79]
  buffer_load_dword v7, s[16:19], s31 offen lds
  s_waitcnt lgkmcnt(5)
  v_mfma_f32_16x16x32_bf16 v[64:67], a[224:227], v[32:35], v[64:67]
  ds_read_b128 v[56:59], v9 offset:61440
  v_mfma_f32_16x16x32_bf16 v[68:71], a[228:231], v[32:35], v[68:71]
  s_waitcnt lgkmcnt(5)
  v_mfma_f32_16x16x32_bf16 v[72:75], a[224:227], v[36:39], v[72:75]
  ds_read_b128 v[60:63], v9 offset:63488
  v_mfma_f32_16x16x32_bf16 v[76:79], a[228:231], v[36:39], v[76:79]
  s_waitcnt lgkmcnt(5)
  v_mfma_f32_16x16x32_bf16 v[64:67], a[232:235], v[40:43], v[64:67]
  v_mfma_f32_16x16x32_bf16 v[68:71], a[236:239], v[40:43], v[68:71]
  s_mov_b32 s41, s47
  s_add_u32 s47, s47, s42
  s_waitcnt lgkmcnt(4)
  v_mfma_f32_16x16x32_bf16 v[72:75], a[232:235], v[44:47], v[72:75]
  v_mfma_f32_16x16x32_bf16 v[76:79], a[236:239], v[44:47], v[76:79]
  s_waitcnt vmcnt(2) lgkmcnt(0)
  s_barrier
  v_mfma_f32_16x16x32_bf16 v[64:67], a[240:243], v[48:51], v[64:67]
  ds_read_b128 v[32:35], v10 offset:0
  v_mfma_f32_16x16x32_bf16 v[68:71], a[244:247], v[48:51], v[68:71]
  ds_read_b128 v[36:39], v10 offset:2048
  v_mfma_f32_16x16x32_bf16 v[72:75], a[240:243], v[52:55], v[72:75]
  ds_read_b128 v[40:43], v11 offset:0
  v_mfma_f32_16x16x32_bf16 v[76:79], a[244:247], v[52:55], v[76:79]
  ds_read_b128 v[44:47], v11 offset:2048
  v_mfma_f32_16x16x32_bf16 v[64:67], a[248:251], v[56:59], v[64:67]
  ds_read_b128 v[48:51], v10 offset:4096
  v_mfma_f32_16x16x32_bf16 v[68:71], a[252:255], v[56:59], v[68:71]
  ds_read_b128 v[52:55], v10 offset:6144
  v_mfma_f32_16x16x32_bf16 v[72:75], a[248:251], v[60:63], v[72:75]
  v_mfma_f32_16x16x32_bf16 v[76:79], a[252:255], v[60:63], v[76:79]
  s_add_u32 s29, s29, 1
  s_add_u32 s43, s43, 0x10000
  s_waitcnt lgkmcnt(5)
  v_mfma_f32_16x16x32_bf16 v[80:83], a[0:3], v[32:35], 0
  ds_read_b128 v[56:59], v11 offset:4096
  s_add_u32 m0, s46, 0
  v_mfma_f32_16x16x32_bf16 v[84:87], a[4:7], v[32:35], 0
  buffer_load_dwordx4 v3, s[16:19], s43 offen offset:0 lds
  s_waitcnt lgkmcnt(5)
  v_mfma_f32_16x16x32_bf16 v[88:91], a[0:3], v[36:39], 0
  ds_read_b128 v[60:63], v11 offset:6144
  v_mfma_f32_16x16x32_bf16 v[92:95], a[4:7], v[36:39], 0
  s_waitcnt lgkmcnt(5)
  v_mfma_f32_16x16x32_bf16 v[80:83], a[8:11], v[40:43], v[80:83]
  ds_read_b128 v[32:35], v10 offset:8192
  s_add_u32 m0, s46, 3968
  v_mfma_f32_16x16x32_bf16 v[84:87], a[12:15], v[40:43], v[84:87]
  buffer_load_dwordx4 v3, s[16:19], s43 offen offset:128 lds
  s_waitcnt lgkmcnt(5)
  v_mfma_f32_16x16x32_bf16 v[88:91], a[8:11], v[44:47], v[88:91]
  ds_read_b128 v[36:39], v10 offset:10240
  v_mfma_f32_16x16x32_bf16 v[92:95], a[12:15], v[44:47], v[92:95]
  v_maximum3_f32 v64, v64, 0, 0
  v_maximum3_f32 v65, v65, 0, 0
  s_waitcnt lgkmcnt(5)
  v_mfma_f32_16x16x32_bf16 v[80:83], a[16:19], v[48:51], v[80:83]
  ds_read_b128 v[40:43], v11 offset:8192
  s_add_u32 m0, s46, 7936
  v_mfma_f32_16x16x32_bf16 v[84:87], a[20:23], v[48:51], v[84:87]
  buffer_load_dwordx4 v3, s[16:19], s43 offen offset:256 lds
  s_waitcnt lgkmcnt(5)
  v_mfma_f32_16x16x32_bf16 v[88:91], a[16:19], v[52:55], v[88:91]
  ds_read_b128 v[44:47], v11 offset:10240
  v_mfma_f32_16x16x32_bf16 v[92:95], a[20:23], v[52:55], v[92:95]
  v_cvt_pk_bf16_f32 v16, v64, v65
  v_maximum3_f32 v66, v66, 0, 0
  s_waitcnt lgkmcnt(5)
  v_mfma_f32_16x16x32_bf16 v[80:83], a[24:27], v[56:59], v[80:83]
  ds_read_b128 v[48:51], v10 offset:12288
  s_add_u32 m0, s46, 11904
  v_mfma_f32_16x16x32_bf16 v[84:87], a[28:31], v[56:59], v[84:87]
  buffer_load_dwordx4 v3, s[16:19], s43 offen offset:384 lds
  s_waitcnt lgkmcnt(5)
  v_mfma_f32_16x16x32_bf16 v[88:91], a[24:27], v[60:63], v[88:91]
  ds_read_b128 v[52:55], v10 offset:14336
  v_mfma_f32_16x16x32_bf16 v[92:95], a[28:31], v[60:63], v[92:95]
  v_maximum3_f32 v67, v67, 0, 0
  v_cvt_pk_bf16_f32 v17, v66, v67
  s_waitcnt lgkmcnt(5)
  v_mfma_f32_16x16x32_bf16 v[80:83], a[32:35], v[32:35], v[80:83]
  ds_read_b128 v[56:59], v11 offset:12288
  s_add_u32 m0, s46, 15872
  v_mfma_f32_16x16x32_bf16 v[84:87], a[36:39], v[32:35], v[84:87]
  buffer_load_dwordx4 v3, s[16:19], s43 offen offset:512 lds
  s_waitcnt lgkmcnt(5)
  v_mfma_f32_16x16x32_bf16 v[88:91], a[32:35], v[36:39], v[88:91]
  ds_read_b128 v[60:63], v11 offset:14336
  v_mfma_f32_16x16x32_bf16 v[92:95], a[36:39], v[36:39], v[92:95]
  v_maximum3_f32 v68, v68, 0, 0
  v_maximum3_f32 v69, v69, 0, 0
  s_waitcnt lgkmcnt(5)
  v_mfma_f32_16x16x32_bf16 v[80:83], a[40:43], v[40:43], v[80:83]
  ds_read_b128 v[32:35], v10 offset:16384
  s_add_u32 m0, s46, 19840
  v_mfma_f32_16x16x32_bf16 v[84:87], a[44:47], v[40:43], v[84:87]
  buffer_load_dwordx4 v3, s[16:19], s43 offen offset:640 lds
  s_waitcnt lgkmcnt(5)
  v_mfma_f32_16x16x32_bf16 v[88:91], a[40:43], v[44:47], v[88:91]
  ds_read_b128 v[36:39], v10 offset:18432
  v_mfma_f32_16x16x32_bf16 v[92:95], a[44:47], v[44:47], v[92:95]
  v_cvt_pk_bf16_f32 v18, v68, v69
  v_maximum3_f32 v70, v70, 0, 0
  s_waitcnt lgkmcnt(5)
  v_mfma_f32_16x16x32_bf16 v[80:83], a[48:51], v[48:51], v[80:83]
  ds_read_b128 v[40:43], v11 offset:16384
  s_add_u32 m0, s46, 23808
  v_mfma_f32_16x16x32_bf16 v[84:87], a[52:55], v[48:51], v[84:87]
  buffer_load_dwordx4 v3, s[16:19], s43 offen offset:768 lds
  s_waitcnt lgkmcnt(5)
  v_mfma_f32_16x16x32_bf16 v[88:91], a[48:51], v[52:55], v[88:91]
  ds_read_b128 v[44:47], v11 offset:18432
  v_mfma_f32_16x16x32_bf16 v[92:95], a[52:55], v[52:55], v[92:95]
  v_maximum3_f32 v71, v71, 0, 0
  v_cvt_pk_bf16_f32 v19, v70, v71
  s_waitcnt lgkmcnt(5)
  v_mfma_f32_16x16x32_bf16 v[80:83], a[56:59], v[56:59], v[80:83]
  ds_read_b128 v[48:51], v10 offset:20480
  s_add_u32 m0, s46, 27776
  v_mfma_f32_16x16x32_bf16 v[84:87], a[60:63], v[56:59], v[84:87]
  buffer_load_dwordx4 v3, s[16:19], s43 offen offset:896 lds
  s_waitcnt lgkmcnt(5)
  v_mfma_f32_16x16x32_bf16 v[88:91], a[56:59], v[60:63], v[88:91]
  ds_read_b128 v[52:55], v10 offset:22528
  v_mfma_f32_16x16x32_bf16 v[92:95], a[60:63], v[60:63], v[92:95]
  buffer_store_dwordx4 v[16:19], v4, s[4:7], s41 offen offset:0 sc1
  v_maximum3_f32 v72, v72, 0, 0
  s_waitcnt lgkmcnt(5)
  v_mfma_f32_16x16x32_bf16 v[80:83], a[64:67], v[32:35], v[80:83]
  ds_read_b128 v[56:59], v11 offset:20480
  s_add_u32 m0, s46, 31744
  v_mfma_f32_16x16x32_bf16 v[84:87], a[68:71], v[32:35], v[84:87]
  buffer_load_dwordx4 v3, s[16:19], s43 offen offset:1024 lds
  s_waitcnt lgkmcnt(5)
  v_mfma_f32_16x16x32_bf16 v[88:91], a[64:67], v[36:39], v[88:91]
  ds_read_b128 v[60:63], v11 offset:22528
  v_mfma_f32_16x16x32_bf16 v[92:95], a[68:71], v[36:39], v[92:95]
  v_maximum3_f32 v73, v73, 0, 0
  v_cvt_pk_bf16_f32 v20, v72, v73
  s_waitcnt lgkmcnt(5)
  v_mfma_f32_16x16x32_bf16 v[80:83], a[72:75], v[40:43], v[80:83]
  ds_read_b128 v[32:35], v10 offset:24576
  s_add_u32 m0, s46, 35712
  v_mfma_f32_16x16x32_bf16 v[84:87], a[76:79], v[40:43], v[84:87]
  buffer_load_dwordx4 v3, s[16:19], s43 offen offset:1152 lds
  s_waitcnt lgkmcnt(5)
  v_mfma_f32_16x16x32_bf16 v[88:91], a[72:75], v[44:47], v[88:91]
  ds_read_b128 v[36:39], v10 offset:26624
  v_mfma_f32_16x16x32_bf16 v[92:95], a[76:79], v[44:47], v[92:95]
  v_maximum3_f32 v74, v74, 0, 0
  v_maximum3_f32 v75, v75, 0, 0
  s_waitcnt lgkmcnt(5)
  v_mfma_f32_16x16x32_bf16 v[80:83], a[80:83], v[48:51], v[80:83]
  ds_read_b128 v[40:43], v11 offset:24576
  s_add_u32 m0, s46, 39680
  v_mfma_f32_16x16x32_bf16 v[84:87], a[84:87], v[48:51], v[84:87]
  buffer_load_dwordx4 v3, s[16:19], s43 offen offset:1280 lds
  s_waitcnt lgkmcnt(5)
  v_mfma_f32_16x16x32_bf16 v[88:91], a[80:83], v[52:55], v[88:91]
  ds_read_b128 v[44:47], v11 offset:26624
  v_mfma_f32_16x16x32_bf16 v[92:95], a[84:87], v[52:55], v[92:95]
  v_cvt_pk_bf16_f32 v21, v74, v75
  v_maximum3_f32 v76, v76, 0, 0
  s_waitcnt lgkmcnt(5)
  v_mfma_f32_16x16x32_bf16 v[80:83], a[88:91], v[56:59], v[80:83]
  ds_read_b128 v[48:51], v10 offset:28672
  s_add_u32 m0, s46, 43648
  v_mfma_f32_16x16x32_bf16 v[84:87], a[92:95], v[56:59], v[84:87]
  buffer_load_dwordx4 v3, s[16:19], s43 offen offset:1408 lds
  s_waitcnt lgkmcnt(5)
  v_mfma_f32_16x16x32_bf16 v[88:91], a[88:91], v[60:63], v[88:91]
  ds_read_b128 v[52:55], v10 offset:30720
  v_mfma_f32_16x16x32_bf16 v[92:95], a[92:95], v[60:63], v[92:95]
  v_maximum3_f32 v77, v77, 0, 0
  v_cvt_pk_bf16_f32 v22, v76, v77
  s_waitcnt lgkmcnt(5)
  v_mfma_f32_16x16x32_bf16 v[80:83], a[96:99], v[32:35], v[80:83]
  ds_read_b128 v[56:59], v11 offset:28672
  s_add_u32 m0, s46, 47616
  v_mfma_f32_16x16x32_bf16 v[84:87], a[100:103], v[32:35], v[84:87]
  buffer_load_dwordx4 v3, s[16:19], s43 offen offset:1536 lds
  s_waitcnt lgkmcnt(5)
  v_mfma_f32_16x16x32_bf16 v[88:91], a[96:99], v[36:39], v[88:91]
  ds_read_b128 v[60:63], v11 offset:30720
  v_mfma_f32_16x16x32_bf16 v[92:95], a[100:103], v[36:39], v[92:95]
  v_maximum3_f32 v78, v78, 0, 0
  v_maximum3_f32 v79, v79, 0, 0
  s_waitcnt lgkmcnt(5)
  v_mfma_f32_16x16x32_bf16 v[80:83], a[104:107], v[40:43], v[80:83]
  ds_read_b128 v[32:35], v10 offset:32768
  s_add_u32 m0, s46, 51584
  v_mfma_f32_16x16x32_bf16 v[84:87], a[108:111], v[40:43], v[84:87]
  buffer_load_dwordx4 v3, s[16:19], s43 offen offset:1664 lds
  s_waitcnt lgkmcnt(5)
  v_mfma_f32_16x16x32_bf16 v[88:91], a[104:107], v[44:47], v[88:91]
  ds_read_b128 v[36:39], v10 offset:34816
  v_mfma_f32_16x16x32_bf16 v[92:95], a[108:111], v[44:47], v[92:95]
  v_cvt_pk_bf16_f32 v23, v78, v79
  buffer_store_dwordx4 v[20:23], v4, s[4:7], s41 offen offset:1024 sc1
  s_waitcnt lgkmcnt(5)
  v_mfma_f32_16x16x32_bf16 v[80:83], a[112:115], v[48:51], v[80:83]
  ds_read_b128 v[40:43], v11 offset:32768
  s_add_u32 m0, s46, 55552
  v_mfma_f32_16x16x32_bf16 v[84:87], a[116:119], v[48:51], v[84:87]
  buffer_load_dwordx4 v3, s[16:19], s43 offen offset:1792 lds
  s_waitcnt lgkmcnt(5)
  v_mfma_f32_16x16x32_bf16 v[88:91], a[112:115], v[52:55], v[88:91]
  ds_read_b128 v[44:47], v11 offset:34816
  v_mfma_f32_16x16x32_bf16 v[92:95], a[116:119], v[52:55], v[92:95]
  s_waitcnt lgkmcnt(5)
  v_mfma_f32_16x16x32_bf16 v[80:83], a[120:123], v[56:59], v[80:83]
  ds_read_b128 v[48:51], v10 offset:36864
  s_add_u32 m0, s46, 59520
  v_mfma_f32_16x16x32_bf16 v[84:87], a[124:127], v[56:59], v[84:87]
  buffer_load_dwordx4 v3, s[16:19], s43 offen offset:1920 lds
  s_waitcnt lgkmcnt(5)
  v_mfma_f32_16x16x32_bf16 v[88:91], a[120:123], v[60:63], v[88:91]
  ds_read_b128 v[52:55], v10 offset:38912
  v_mfma_f32_16x16x32_bf16 v[92:95], a[124:127], v[60:63], v[92:95]
  s_waitcnt lgkmcnt(5)
  v_mfma_f32_16x16x32_bf16 v[80:83], a[128:131], v[32:35], v[80:83]
  ds_read_b128 v[56:59], v11 offset:36864
  v_mfma_f32_16x16x32_bf16 v[84:87], a[132:135], v[32:35], v[84:87]
  s_waitcnt lgkmcnt(5)
  v_mfma_f32_16x16x32_bf16 v[88:91], a[128:131], v[36:39], v[88:91]
  ds_read_b128 v[60:63], v11 offset:38912
  v_mfma_f32_16x16x32_bf16 v[92:95], a[132:135], v[36:39], v[92:95]
  s_waitcnt lgkmcnt(5)
  v_mfma_f32_16x16x32_bf16 v[80:83], a[136:139], v[40:43], v[80:83]
  ds_read_b128 v[32:35], v10 offset:40960
  v_mfma_f32_16x16x32_bf16 v[84:87], a[140:143], v[40:43], v[84:87]
  s_waitcnt lgkmcnt(5)
  v_mfma_f32_16x16x32_bf16 v[88:91], a[136:139], v[44:47], v[88:91]
  ds_read_b128 v[36:39], v10 offset:43008
  v_mfma_f32_16x16x32_bf16 v[92:95], a[140:143], v[44:47], v[92:95]
  s_waitcnt lgkmcnt(5)
  v_mfma_f32_16x16x32_bf16 v[80:83], a[144:147], v[48:51], v[80:83]
  ds_read_b128 v[40:43], v11 offset:40960
  v_mfma_f32_16x16x32_bf16 v[84:87], a[148:151], v[48:51], v[84:87]
  s_waitcnt lgkmcnt(5)
  v_mfma_f32_16x16x32_bf16 v[88:91], a[144:147], v[52:55], v[88:91]
  ds_read_b128 v[44:47], v11 offset:43008
  v_mfma_f32_16x16x32_bf16 v[92:95], a[148:151], v[52:55], v[92:95]
  s_waitcnt lgkmcnt(5)
  v_mfma_f32_16x16x32_bf16 v[80:83], a[152:155], v[56:59], v[80:83]
  ds_read_b128 v[48:51], v10 offset:45056
  v_mfma_f32_16x16x32_bf16 v[84:87], a[156:159], v[56:59], v[84:87]
  s_waitcnt lgkmcnt(5)
  v_mfma_f32_16x16x32_bf16 v[88:91], a[152:155], v[60:63], v[88:91]
  ds_read_b128 v[52:55], v10 offset:47104
  v_mfma_f32_16x16x32_bf16 v[92:95], a[156:159], v[60:63], v[92:95]
  v_mov_b32 v5, s29
  s_waitcnt lgkmcnt(5)
  v_mfma_f32_16x16x32_bf16 v[80:83], a[160:163], v[32:35], v[80:83]
  ds_read_b128 v[56:59], v11 offset:45056
  v_mfma_f32_16x16x32_bf16 v[84:87], a[164:167], v[32:35], v[84:87]
  s_waitcnt vmcnt(2)
  s_mov_b64 exec, 1
  buffer_store_dword v5, off, s[4:7], s44 sc1
  s_mov_b64 exec, -1
  s_waitcnt lgkmcnt(5)
  v_mfma_f32_16x16x32_bf16 v[88:91], a[160:163], v[36:39], v[88:91]
  ds_read_b128 v[60:63], v11 offset:47104
  v_mfma_f32_16x16x32_bf16 v[92:95], a[164:167], v[36:39], v[92:95]
  s_waitcnt lgkmcnt(5)
  v_mfma_f32_16x16x32_bf16 v[80:83], a[168:171], v[40:43], v[80:83]
  ds_read_b128 v[32:35], v10 offset:49152
  v_mfma_f32_16x16x32_bf16 v[84:87], a[172:175], v[40:43], v[84:87]
  s_waitcnt lgkmcnt(5)
  v_mfma_f32_16x16x32_bf16 v[88:91], a[168:171], v[44:47], v[88:91]
  ds_read_b128 v[36:39], v10 offset:51200
  v_mfma_f32_16x16x32_bf16 v[92:95], a[172:175], v[44:47], v[92:95]
  s_waitcnt lgkmcnt(5)
  v_mfma_f32_16x16x32_bf16 v[80:83], a[176:179], v[48:51], v[80:83]
  ds_read_b128 v[40:43], v11 offset:49152
  v_mfma_f32_16x16x32_bf16 v[84:87], a[180:183], v[48:51], v[84:87]
  s_waitcnt lgkmcnt(5)
  v_mfma_f32_16x16x32_bf16 v[88:91], a[176:179], v[52:55], v[88:91]
  ds_read_b128 v[44:47], v11 offset:51200
  v_mfma_f32_16x16x32_bf16 v[92:95], a[180:183], v[52:55], v[92:95]
  s_waitcnt lgkmcnt(5)
  v_mfma_f32_16x16x32_bf16 v[80:83], a[184:187], v[56:59], v[80:83]
  ds_read_b128 v[48:51], v10 offset:53248
  v_mfma_f32_16x16x32_bf16 v[84:87], a[188:191], v[56:59], v[84:87]
  s_waitcnt lgkmcnt(5)
  v_mfma_f32_16x16x32_bf16 v[88:91], a[184:187], v[60:63], v[88:91]
  ds_read_b128 v[52:55], v10 offset:55296
  v_mfma_f32_16x16x32_bf16 v[92:95], a[188:191], v[60:63], v[92:95]
  s_waitcnt lgkmcnt(5)
  v_mfma_f32_16x16x32_bf16 v[80:83], a[192:195], v[32:35], v[80:83]
  ds_read_b128 v[56:59], v11 offset:53248
  v_mfma_f32_16x16x32_bf16 v[84:87], a[196:199], v[32:35], v[84:87]
  s_waitcnt lgkmcnt(5)
  v_mfma_f32_16x16x32_bf16 v[88:91], a[192:195], v[36:39], v[88:91]
  ds_read_b128 v[60:63], v11 offset:55296
  v_mfma_f32_16x16x32_bf16 v[92:95], a[196:199], v[36:39], v[92:95]
  s_waitcnt lgkmcnt(5)
  v_mfma_f32_16x16x32_bf16 v[80:83], a[200:203], v[40:43], v[80:83]
  ds_read_b128 v[32:35], v10 offset:57344
  v_mfma_f32_16x16x32_bf16 v[84:87], a[204:207], v[40:43], v[84:87]
  s_waitcnt lgkmcnt(5)
  v_mfma_f32_16x16x32_bf16 v[88:91], a[200:203], v[44:47], v[88:91]
  ds_read_b128 v[36:39], v10 offset:59392
  v_mfma_f32_16x16x32_bf16 v[92:95], a[204:207], v[44:47], v[92:95]
  s_waitcnt lgkmcnt(5)
  v_mfma_f32_16x16x32_bf16 v[80:83], a[208:211], v[48:51], v[80:83]
  ds_read_b128 v[40:43], v11 offset:57344
  v_mfma_f32_16x16x32_bf16 v[84:87], a[212:215], v[48:51], v[84:87]
  s_waitcnt lgkmcnt(5)
  v_mfma_f32_16x16x32_bf16 v[88:91], a[208:211], v[52:55], v[88:91]
  ds_read_b128 v[44:47], v11 offset:59392
  v_mfma_f32_16x16x32_bf16 v[92:95], a[212:215], v[52:55], v[92:95]
  s_waitcnt lgkmcnt(5)
  v_mfma_f32_16x16x32_bf16 v[80:83], a[216:219], v[56:59], v[80:83]
  ds_read_b128 v[48:51], v10 offset:61440
  v_mfma_f32_16x16x32_bf16 v[84:87], a[220:223], v[56:59], v[84:87]
  s_add_u32 s31, s43, 0x20000
  s_mov_b32 m0, 0x24000
  s_waitcnt lgkmcnt(5)
  v_mfma_f32_16x16x32_bf16 v[88:91], a[216:219], v[60:63], v[88:91]
  ds_read_b128 v[52:55], v10 offset:63488
  v_mfma_f32_16x16x32_bf16 v[92:95], a[220:223], v[60:63], v[92:95]
  buffer_load_dword v7, s[16:19], s31 offen lds
  s_waitcnt lgkmcnt(5)
  v_mfma_f32_16x16x32_bf16 v[80:83], a[224:227], v[32:35], v[80:83]
  ds_read_b128 v[56:59], v11 offset:61440
  v_mfma_f32_16x16x32_bf16 v[84:87], a[228:231], v[32:35], v[84:87]
  s_waitcnt lgkmcnt(5)
  v_mfma_f32_16x16x32_bf16 v[88:91], a[224:227], v[36:39], v[88:91]
  ds_read_b128 v[60:63], v11 offset:63488
  v_mfma_f32_16x16x32_bf16 v[92:95], a[228:231], v[36:39], v[92:95]
  s_waitcnt lgkmcnt(5)
  v_mfma_f32_16x16x32_bf16 v[80:83], a[232:235], v[40:43], v[80:83]
  v_mfma_f32_16x16x32_bf16 v[84:87], a[236:239], v[40:43], v[84:87]
  s_mov_b32 s41, s47
  s_add_u32 s47, s47, s42
  s_waitcnt lgkmcnt(4)
  v_mfma_f32_16x16x32_bf16 v[88:91], a[232:235], v[44:47], v[88:91]
  v_mfma_f32_16x16x32_bf16 v[92:95], a[236:239], v[44:47], v[92:95]
  s_waitcnt vmcnt(2) lgkmcnt(0)
  s_barrier
  v_mfma_f32_16x16x32_bf16 v[80:83], a[240:243], v[48:51], v[80:83]
  ds_read_b128 v[32:35], v8 offset:0
  v_mfma_f32_16x16x32_bf16 v[84:87], a[244:247], v[48:51], v[84:87]
  ds_read_b128 v[36:39], v8 offset:2048
  v_mfma_f32_16x16x32_bf16 v[88:91], a[240:243], v[52:55], v[88:91]
  ds_read_b128 v[40:43], v9 offset:0
  v_mfma_f32_16x16x32_bf16 v[92:95], a[244:247], v[52:55], v[92:95]
  ds_read_b128 v[44:47], v9 offset:2048
  v_mfma_f32_16x16x32_bf16 v[80:83], a[248:251], v[56:59], v[80:83]
  ds_read_b128 v[48:51], v8 offset:4096
  v_mfma_f32_16x16x32_bf16 v[84:87], a[252:255], v[56:59], v[84:87]
  ds_read_b128 v[52:55], v8 offset:6144
  v_mfma_f32_16x16x32_bf16 v[88:91], a[248:251], v[60:63], v[88:91]
  v_mfma_f32_16x16x32_bf16 v[92:95], a[252:255], v[60:63], v[92:95]
  s_add_u32 s29, s29, 1
  s_cmp_lt_u32 s29, 64
  s_cbranch_scc1 L_G1_loopR
  s_nop 7
  v_maximum3_f32 v80, v80, 0, 0
  v_maximum3_f32 v81, v81, 0, 0
  v_cvt_pk_bf16_f32 v16, v80, v81
  v_maximum3_f32 v82, v82, 0, 0
  v_maximum3_f32 v83, v83, 0, 0
  v_cvt_pk_bf16_f32 v17, v82, v83
  v_maximum3_f32 v84, v84, 0, 0
  v_maximum3_f32 v85, v85, 0, 0
  v_cvt_pk_bf16_f32 v18, v84, v85
  v_maximum3_f32 v86, v86, 0, 0
  v_maximum3_f32 v87, v87, 0, 0
  v_cvt_pk_bf16_f32 v19, v86, v87
  buffer_store_dwordx4 v[16:19], v4, s[4:7], s41 offen offset:0 sc1
  v_maximum3_f32 v88, v88, 0, 0
  v_maximum3_f32 v89, v89, 0, 0
  v_cvt_pk_bf16_f32 v20, v88, v89
  v_maximum3_f32 v90, v90, 0, 0
  v_maximum3_f32 v91, v91, 0, 0
  v_cvt_pk_bf16_f32 v21, v90, v91
  v_maximum3_f32 v92, v92, 0, 0
  v_maximum3_f32 v93, v93, 0, 0
  v_cvt_pk_bf16_f32 v22, v92, v93
  v_maximum3_f32 v94, v94, 0, 0
  v_maximum3_f32 v95, v95, 0, 0
  v_cvt_pk_bf16_f32 v23, v94, v95
  buffer_store_dwordx4 v[20:23], v4, s[4:7], s41 offen offset:1024 sc1
L_G1_done:
  v_mov_b32 v5, 64
  s_waitcnt vmcnt(0) lgkmcnt(0)
  s_mov_b64 exec, 1
  buffer_store_dword v5, off, s[4:7], s44 sc1
  s_mov_b64 exec, -1
  s_barrier
  s_cmp_eq_u32 s27, 6
  s_cbranch_scc1 L_exit
  s_branch L_roleOP
L_roleX:
  s_cmp_lg_u32 s36, 0
  s_cbranch_scc1 L_ci_82
  s_waitcnt vmcnt(0)
  v_readfirstlane_b32 s62, v30
  s_barrier
  s_cmp_lg_u32 s24, 0
  s_cbranch_scc1 L_ci_82
  s_lshr_b32 s32, s2, 3
  s_lshl_b32 s31, 1, s32
  s_lshl_b32 s32, s39, 2
  v_mov_b32 v22, s31
  s_mov_b64 exec, 1
  buffer_atomic_or v22, off, s[8:11], s32 sc0 sc1
  s_mov_b64 exec, -1
L_ci_82:
  s_waitcnt vmcnt(0)
  s_cmp_lg_u32 s36, 0
  s_cbranch_scc1 L_cf_83
  s_cmp_lg_u32 s24, 0
  s_cbranch_scc1 L_cf_84
  s_mov_b32 s37, s39
  s_lshr_b32 s38, s2, 3
  s_mov_b64 exec, 1
L_cf_85:
  v_readfirstlane_b32 s33, v22
  s_lshl_b32 s31, 1, s38
  s_and_b32 s34, s33, s31
  s_cbranch_scc0 L_cf_86
  s_not_b32 s33, s33
  s_cbranch_scc1 L_cf_88
  s_add_u32 s37, s37, 1
  s_and_b32 s37, s37, 7
  s_mov_b32 s31, 256
  s_cmp_eq_u32 s37, s39
  s_cbranch_scc1 L_cf_87
  s_lshl_b32 s33, 1, s38
L_cf_88:
  s_ff1_i32_b32 s38, s33
  s_lshl_b32 s31, 1, s38
  s_lshl_b32 s32, s37, 2
  v_mov_b32 v22, s31
  buffer_atomic_or v22, off, s[8:11], s32 sc0 sc1
  s_waitcnt vmcnt(0)
  s_branch L_cf_85
L_cf_86:
  s_or_b32 s33, s33, s31
  s_cmp_eq_u32 s33, -1
  s_cbranch_scc0 L_cf_89
  v_mov_b32 v22, 1
  buffer_atomic_add v22, off, s[8:11], 0 offset:128 sc0 sc1
  s_waitcnt vmcnt(0)
  v_readfirstlane_b32 s33, v22
  s_nop 0
  s_cmp_eq_u32 s33, 7
  s_cbranch_scc0 L_cf_89
  buffer_load_dwordx2 v[22:23], off, s[8:11], 0 offset:136 sc1
  s_waitcnt vmcnt(0)
  v_readfirstlane_b32 s33, v22
  v_readfirstlane_b32 s34, v23
  s_mov_b64 exec, 0xff
  s_mov_b32 s32, 0x408000
  v_lshlrev_b32 v23, 7, v0
  buffer_load_dword v22, v23, s[4:7], s32 offen sc1
  s_cmp_gt_u32 s34, s33
  s_cselect_b32 s33, 1, 0
  s_waitcnt vmcnt(0)
  v_add_u32 v22, 2, v22
  v_and_b32 v22, -2, v22
  v_or_b32 v22, s33, v22
  buffer_store_dword v22, v23, s[4:7], s32 offen sc1
  s_mov_b64 exec, 1
L_cf_89:
  s_lshl_b32 s31, s37, 5
  s_add_u32 s31, s31, s38
L_cf_87:
  v_mov_b32 v22, s31
  v_mov_b32 v23, 163836
  ds_write_b32 v23, v22
  s_waitcnt lgkmcnt(0)
  s_mov_b64 exec, -1
L_cf_84:
  s_barrier
  v_mov_b32 v23, 163836
  ds_read_b32 v22, v23
  s_mov_b32 s36, 1
  s_waitcnt lgkmcnt(0)
  v_readfirstlane_b32 s31, v22
  s_nop 0
  s_cmp_ge_u32 s31, 256
  s_cbranch_scc1 L_exit
  s_cmp_eq_u32 s31, s35
  s_cbranch_scc1 L_cf_83
  s_mov_b32 s35, s31
  s_waitcnt vmcnt(0)
  s_barrier
  s_branch L_dispatch
L_cf_83:
L_wi_90:
  buffer_load_dword v8, off, s[4:7], s63 sc1
  s_waitcnt vmcnt(0)
  v_readfirstlane_b32 s32, v8
  s_nop 0
  s_cmp_lg_u32 s32, s62
  s_cbranch_scc1 L_wi_ok_91
  s_sleep 8
  s_add_u32 s30, s30, 1
  s_cmp_lt_u32 s30, 0x100000
  s_cbranch_scc1 L_wi_90
  s_branch L_abort
L_wi_ok_91:
  s_and_b32 s32, s32, 1
  s_lshl_b32 s32, s32, 13
  s_add_u32 s28, s28, s32
  s_add_u32 s32, s26, 160
  s_lshl_b32 s32, s32, 7
  s_add_u32 s32, s32, 0x400000
L_df_92:
  buffer_load_dword v8, off, s[4:7], s32 sc1
  s_waitcnt vmcnt(0)
  v_readfirstlane_b32 s31, v8
  s_nop 0
  s_cmp_ge_u32 s31, 1
  s_cbranch_scc1 L_df_ok_93
  s_sleep 8
  s_add_u32 s30, s30, 1
  s_cmp_lt_u32 s30, 0x100000
  s_cbranch_scc1 L_df_92
  s_branch L_abort
L_df_ok_93:
  s_mov_b32 s12, s64
  s_mov_b32 s13, s65
  s_mov_b32 s14, 0x400000
  s_mov_b32 s15, 0x20000
  s_mov_b32 s16, s84
  s_mov_b32 s17, s85
  s_mov_b32 s18, 0x800
  s_mov_b32 s19, 0x20000
  v_lshlrev_b32 v1, 5, v0
  buffer_load_dwordx4 v[32:35], v1, s[16:19], 0 offen
  buffer_load_dwordx4 v[36:39], v1, s[16:19], 0 offen offset:16
  s_add_u32 s40, s26, 196
  s_lshl_b32 s40, s40, 7
  s_add_u32 s40, s40, 0x400000
  s_cmp_eq_u32 s24, 0
  s_cselect_b32 s40, s40, 0x40000000
  s_sub_u32 s31, s26, 28
  s_lshl_b32 s31, s31, 2
  s_add_u32 s31, s31, s24
  s_lshl_b32 s41, s31, 18
  s_waitcnt vmcnt(0)
  v_lshlrev_b32 v16, 16, v32
  v_and_b32 v17, 0xffff0000, v32
  v_lshlrev_b32 v18, 16, v33
  v_and_b32 v19, 0xffff0000, v33
  v_lshlrev_b32 v20, 16, v34
  v_and_b32 v21, 0xffff0000, v34
  v_lshlrev_b32 v22, 16, v35
  v_and_b32 v23, 0xffff0000, v35
  v_lshlrev_b32 v24, 16, v36
  v_and_b32 v25, 0xffff0000, v36
  v_lshlrev_b32 v26, 16, v37
  v_and_b32 v27, 0xffff0000, v37
  v_lshlrev_b32 v28, 16, v38
  v_and_b32 v29, 0xffff0000, v38
  v_lshlrev_b32 v30, 16, v39
  v_and_b32 v31, 0xffff0000, v39
  s_mov_b32 s29, 0
  buffer_load_dwordx4 v[32:35], v1, s[12:15], s41 offen
  buffer_load_dwordx4 v[36:39], v1, s[12:15], s41 offen offset:16
  s_add_u32 s41, s41, 2048
L_X_half:
  s_mov_b64 s[44:45], 1
  s_mov_b32 s42, 0
L_X_row:
  buffer_load_dwordx4 v[40:43], v1, s[12:15], s41 offen
  buffer_load_dwordx4 v[44:47], v1, s[12:15], s41 offen offset:16
  s_add_u32 s41, s41, 2048
  s_waitcnt vmcnt(2)
  v_lshlrev_b32 v48, 16, v32
  v_and_b32 v49, 0xffff0000, v32
  v_mul_f32 v48, v48, v16
  v_mul_f32 v49, v49, v17
  v_cvt_pk_bf16_f32 v48, v48, v49
  v_and_b32 v49, 0xffff0000, v48
  v_lshlrev_b32 v48, 16, v48
  v_add_f32 v2, v48, v49
  v_lshlrev_b32 v48, 16, v33
  v_and_b32 v49, 0xffff0000, v33
  v_mul_f32 v48, v48, v18
  v_mul_f32 v49, v49, v19
  v_cvt_pk_bf16_f32 v48, v48, v49
  v_and_b32 v49, 0xffff0000, v48
  v_lshlrev_b32 v48, 16, v48
  v_add_f32 v2, v2, v48
  v_add_f32 v2, v2, v49
  v_lshlrev_b32 v48, 16, v34
  v_and_b32 v49, 0xffff0000, v34
  v_mul_f32 v48, v48, v20
  v_mul_f32 v49, v49, v21
  v_cvt_pk_bf16_f32 v48, v48, v49
  v_and_b32 v49, 0xffff0000, v48
  v_lshlrev_b32 v48, 16, v48
  v_add_f32 v2, v2, v48
  v_add_f32 v2, v2, v49
  v_lshlrev_b32 v48, 16, v35
  v_and_b32 v49, 0xffff0000, v35
  v_mul_f32 v48, v48, v22
  v_mul_f32 v49, v49, v23
  v_cvt_pk_bf16_f32 v48, v48, v49
  v_and_b32 v49, 0xffff0000, v48
  v_lshlrev_b32 v48, 16, v48
  v_add_f32 v2, v2, v48
  v_add_f32 v2, v2, v49
  v_lshlrev_b32 v48, 16, v36
  v_and_b32 v49, 0xffff0000, v36
  v_mul_f32 v48, v48, v24
  v_mul_f32 v49, v49, v25
  v_cvt_pk_bf16_f32 v48, v48, v49
  v_and_b32 v49, 0xffff0000, v48
  v_lshlrev_b32 v48, 16, v48
  v_add_f32 v2, v2, v48
  v_add_f32 v2, v2, v49
  v_lshlrev_b32 v48, 16, v37
  v_and_b32 v49, 0xffff0000, v37
  v_mul_f32 v48, v48, v26
  v_mul_f32 v49, v49, v27
  v_cvt_pk_bf16_f32 v48, v48, v49
  v_and_b32 v49, 0xffff0000, v48
  v_lshlrev_b32 v48, 16, v48
  v_add_f32 v2, v2, v48
  v_add_f32 v2, v2, v49
  v_lshlrev_b32 v48, 16, v38
  v_and_b32 v49, 0xffff0000, v38
  v_mul_f32 v48, v48, v28
  v_mul_f32 v49, v49, v29
  v_cvt_pk_bf16_f32 v48, v48, v49
  v_and_b32 v49, 0xffff0000, v48
  v_lshlrev_b32 v48, 16, v48
  v_add_f32 v2, v2, v48
  v_add_f32 v2, v2, v49
  v_lshlrev_b32 v48, 16, v39
  v_and_b32 v49, 0xffff0000, v39
  v_mul_f32 v48, v48, v30
  v_mul_f32 v49, v49, v31
  v_cvt_pk_bf16_f32 v48, v48, v49
  v_and_b32 v49, 0xffff0000, v48
  v_lshlrev_b32 v48, 16, v48
  v_add_f32 v2, v2, v48
  v_add_f32 v2, v2, v49
  s_nop 1
  v_add_f32_dpp v2, v2, v2 quad_perm:[1,0,3,2] row_mask:0xf bank_mask:0xf
  s_nop 1
  v_add_f32_dpp v2, v2, v2 quad_perm:[2,3,0,1] row_mask:0xf bank_mask:0xf
  s_nop 1
  v_add_f32_dpp v2, v2, v2 row_half_mirror row_mask:0xf bank_mask:0xf
  s_nop 1
  v_add_f32_dpp v2, v2, v2 row_mirror row_mask:0xf bank_mask:0xf
  v_mov_b32 v4, v2
  s_nop 1
  v_permlane16_swap_b32 v2, v4
  v_add_f32 v2, v2, v4
  v_mov_b32 v4, v2
  s_nop 1
  v_permlane32_swap_b32 v2, v4
  v_add_f32 v2, v2, v4
  v_cndmask_b32 v3, v3, v2, s[44:45]
  s_lshl_b64 s[44:45], s[44:45], 1
  buffer_load_dwordx4 v[32:35], v1, s[12:15], s41 offen
  buffer_load_dwordx4 v[36:39], v1, s[12:15], s41 offen offset:16
  s_add_u32 s41, s41, 2048
  s_waitcnt vmcnt(2)
  v_lshlrev_b32 v48, 16, v40
  v_and_b32 v49, 0xffff0000, v40
  v_mul_f32 v48, v48, v16
  v_mul_f32 v49, v49, v17
  v_cvt_pk_bf16_f32 v48, v48, v49
  v_and_b32 v49, 0xffff0000, v48
  v_lshlrev_b32 v48, 16, v48
  v_add_f32 v2, v48, v49
  v_lshlrev_b32 v48, 16, v41
  v_and_b32 v49, 0xffff0000, v41
  v_mul_f32 v48, v48, v18
  v_mul_f32 v49, v49, v19
  v_cvt_pk_bf16_f32 v48, v48, v49
  v_and_b32 v49, 0xffff0000, v48
  v_lshlrev_b32 v48, 16, v48
  v_add_f32 v2, v2, v48
  v_add_f32 v2, v2, v49
  v_lshlrev_b32 v48, 16, v42
  v_and_b32 v49, 0xffff0000, v42
  v_mul_f32 v48, v48, v20
  v_mul_f32 v49, v49, v21
  v_cvt_pk_bf16_f32 v48, v48, v49
  v_and_b32 v49, 0xffff0000, v48
  v_lshlrev_b32 v48, 16, v48
  v_add_f32 v2, v2, v48
  v_add_f32 v2, v2, v49
  v_lshlrev_b32 v48, 16, v43
  v_and_b32 v49, 0xffff0000, v43
  v_mul_f32 v48, v48, v22
  v_mul_f32 v49, v49, v23
  v_cvt_pk_bf16_f32 v48, v48, v49
  v_and_b32 v49, 0xffff0000, v48
  v_lshlrev_b32 v48, 16, v48
  v_add_f32 v2, v2, v48
  v_add_f32 v2, v2, v49
  v_lshlrev_b32 v48, 16, v44
  v_and_b32 v49, 0xffff0000, v44
  v_mul_f32 v48, v48, v24
  v_mul_f32 v49, v49, v25
  v_cvt_pk_bf16_f32 v48, v48, v49
  v_and_b32 v49, 0xffff0000, v48
  v_lshlrev_b32 v48, 16, v48
  v_add_f32 v2, v2, v48
  v_add_f32 v2, v2, v49
  v_lshlrev_b32 v48, 16, v45
  v_and_b32 v49, 0xffff0000, v45
  v_mul_f32 v48, v48, v26
  v_mul_f32 v49, v49, v27
  v_cvt_pk_bf16_f32 v48, v48, v49
  v_and_b32 v49, 0xffff0000, v48
  v_lshlrev_b32 v48, 16, v48
  v_add_f32 v2, v2, v48
  v_add_f32 v2, v2, v49
  v_lshlrev_b32 v48, 16, v46
  v_and_b32 v49, 0xffff0000, v46
  v_mul_f32 v48, v48, v28
  v_mul_f32 v49, v49, v29
  v_cvt_pk_bf16_f32 v48, v48, v49
  v_and_b32 v49, 0xffff0000, v48
  v_lshlrev_b32 v48, 16, v48
  v_add_f32 v2, v2, v48
  v_add_f32 v2, v2, v49
  v_lshlrev_b32 v48, 16, v47
  v_and_b32 v49, 0xffff0000, v47
  v_mul_f32 v48, v48, v30
  v_mul_f32 v49, v49, v31
  v_cvt_pk_bf16_f32 v48, v48, v49
  v_and_b32 v49, 0xffff0000, v48
  v_lshlrev_b32 v48, 16, v48
  v_add_f32 v2, v2, v48
  v_add_f32 v2, v2, v49
  s_nop 1
  v_add_f32_dpp v2, v2, v2 quad_perm:[1,0,3,2] row_mask:0xf bank_mask:0xf
  s_nop 1
  v_add_f32_dpp v2, v2, v2 quad_perm:[2,3,0,1] row_mask:0xf bank_mask:0xf
  s_nop 1
  v_add_f32_dpp v2, v2, v2 row_half_mirror row_mask:0xf bank_mask:0xf
  s_nop 1
  v_add_f32_dpp v2, v2, v2 row_mirror row_mask:0xf bank_mask:0xf
  v_mov_b32 v4, v2
  s_nop 1
  v_permlane16_swap_b32 v2, v4
  v_add_f32 v2, v2, v4
  v_mov_b32 v4, v2
  s_nop 1
  v_permlane32_swap_b32 v2, v4
  v_add_f32 v2, v2, v4
  v_cndmask_b32 v3, v3, v2, s[44:45]
  s_lshl_b64 s[44:45], s[44:45], 1
  s_add_u32 s42, s42, 1
  s_cmp_lt_u32 s42, 32
  s_cbranch_scc1 L_X_row
  v_cvt_pk_bf16_f32 v4, v3, v3
  v_lshlrev_b32 v4, 16, v4
  v_mul_f32 v4, 0xbfb8aa3b, v4
  v_exp_f32 v4, v4
  s_nop 0
  v_add_f32 v4, 1.0, v4
  v_rcp_f32 v4, v4
  s_nop 0
  v_cvt_pk_bf16_f32 v4, v4, v4
  v_lshlrev_b32 v4, 16, v4
  s_lshr_b32 s31, s41, 9
  s_add_u32 s31, s31, 0x40fefc
  v_lshlrev_b32 v5, 2, v0
  buffer_store_dword v4, v5, s[4:7], s31 offen sc1
  s_add_u32 s29, s29, 1
  s_cmp_lt_u32 s29, 2
  s_cbranch_scc1 L_X_half
  s_waitcnt vmcnt(0)
  s_barrier
  v_mov_b32 v5, 64
  s_mov_b64 exec, 1
  buffer_store_dword v5, off, s[4:7], s40 sc1
  s_mov_b64 exec, -1
  s_branch L_exit
L_roleF2:
  s_lshr_b32 s29, s26, 4
  s_mov_b32 s41, 2
  s_mov_b32 s12, s74
  s_mov_b32 s13, s75
  s_mov_b32 s14, 0x800000
  s_mov_b32 s15, 0x20000
  s_lshl_b32 s31, s24, 21
  s_lshl_b32 s32, s26, 13
  s_add_u32 s31, s31, s32
  v_mov_b32 v12, 0x0
  v_bfe_u32 v15, v0, 0, 6
  v_lshl_add_u32 v12, v15, 4, v12
  v_add_u32 v12, s31, v12
  s_lshl_b32 s32, s24, 13
  s_mov_b32 m0, s32
  s_mov_b32 s31, 0x0
  buffer_load_dwordx4 v12, s[12:15], s31 offen offset:0 lds
  buffer_load_dwordx4 v12, s[12:15], s31 offen offset:1024 lds
  buffer_load_dwordx4 v12, s[12:15], s31 offen offset:2048 lds
  buffer_load_dwordx4 v12, s[12:15], s31 offen offset:3072 lds
  s_mov_b32 s31, 0x1000
  buffer_load_dwordx4 v12, s[12:15], s31 offen offset:0 lds
  buffer_load_dwordx4 v12, s[12:15], s31 offen offset:1024 lds
  buffer_load_dwordx4 v12, s[12:15], s31 offen offset:2048 lds
  buffer_load_dwordx4 v12, s[12:15], s31 offen offset:3072 lds
  s_cmp_lg_u32 s36, 0
  s_cbranch_scc1 L_ci_94
  s_waitcnt vmcnt(8)
  v_readfirstlane_b32 s62, v30
  s_barrier
  s_cmp_lg_u32 s24, 0
  s_cbranch_scc1 L_ci_94
  s_lshr_b32 s32, s2, 3
  s_lshl_b32 s31, 1, s32
  s_lshl_b32 s32, s39, 2
  v_mov_b32 v22, s31
  s_mov_b64 exec, 1
  buffer_atomic_or v22, off, s[8:11], s32 sc0 sc1
  s_mov_b64 exec, -1
L_ci_94:
  s_mov_b32 s31, 0x40000
  buffer_load_dwordx4 v12, s[12:15], s31 offen offset:0 lds
  buffer_load_dwordx4 v12, s[12:15], s31 offen offset:1024 lds
  buffer_load_dwordx4 v12, s[12:15], s31 offen offset:2048 lds
  buffer_load_dwordx4 v12, s[12:15], s31 offen offset:3072 lds
  s_mov_b32 s31, 0x41000
  buffer_load_dwordx4 v12, s[12:15], s31 offen offset:0 lds
  buffer_load_dwordx4 v12, s[12:15], s31 offen offset:1024 lds
  buffer_load_dwordx4 v12, s[12:15], s31 offen offset:2048 lds
  buffer_load_dwordx4 v12, s[12:15], s31 offen offset:3072 lds
  s_mov_b32 s31, 0x80000
  buffer_load_dwordx4 v12, s[12:15], s31 offen offset:0 lds
  buffer_load_dwordx4 v12, s[12:15], s31 offen offset:1024 lds
  buffer_load_dwordx4 v12, s[12:15], s31 offen offset:2048 lds
  buffer_load_dwordx4 v12, s[12:15], s31 offen offset:3072 lds
  s_mov_b32 s31, 0x81000
  buffer_load_dwordx4 v12, s[12:15], s31 offen offset:0 lds
  buffer_load_dwordx4 v12, s[12:15], s31 offen offset:1024 lds
  buffer_load_dwordx4 v12, s[12:15], s31 offen offset:2048 lds
  buffer_load_dwordx4 v12, s[12:15], s31 offen offset:3072 lds
  s_mov_b32 s31, 0xc0000
  buffer_load_dwordx4 v12, s[12:15], s31 offen offset:0 lds
  buffer_load_dwordx4 v12, s[12:15], s31 offen offset:1024 lds
  buffer_load_dwordx4 v12, s[12:15], s31 offen offset:2048 lds
  buffer_load_dwordx4 v12, s[12:15], s31 offen offset:3072 lds
  s_mov_b32 s31, 0xc1000
  buffer_load_dwordx4 v12, s[12:15], s31 offen offset:0 lds
  buffer_load_dwordx4 v12, s[12:15], s31 offen offset:1024 lds
  buffer_load_dwordx4 v12, s[12:15], s31 offen offset:2048 lds
  buffer_load_dwordx4 v12, s[12:15], s31 offen offset:3072 lds
  s_waitcnt vmcnt(24)
  s_mov_b32 s31, 0x100000
  buffer_load_dwordx4 v12, s[12:15], s31 offen offset:0 lds
  buffer_load_dwordx4 v12, s[12:15], s31 offen offset:1024 lds
  buffer_load_dwordx4 v12, s[12:15], s31 offen offset:2048 lds
  buffer_load_dwordx4 v12, s[12:15], s31 offen offset:3072 lds
  s_mov_b32 s31, 0x101000
  buffer_load_dwordx4 v12, s[12:15], s31 offen offset:0 lds
  buffer_load_dwordx4 v12, s[12:15], s31 offen offset:1024 lds
  buffer_load_dwordx4 v12, s[12:15], s31 offen offset:2048 lds
  buffer_load_dwordx4 v12, s[12:15], s31 offen offset:3072 lds
  s_waitcnt vmcnt(24)
  s_cmp_lg_u32 s36, 0
  s_cbranch_scc1 L_cf_95
  s_cmp_lg_u32 s24, 0
  s_cbranch_scc1 L_cf_96
  s_mov_b32 s37, s39
  s_lshr_b32 s38, s2, 3
  s_mov_b64 exec, 1
L_cf_97:
  v_readfirstlane_b32 s33, v22
  s_lshl_b32 s31, 1, s38
  s_and_b32 s34, s33, s31
  s_cbranch_scc0 L_cf_98
  s_not_b32 s33, s33
  s_cbranch_scc1 L_cf_100
  s_add_u32 s37, s37, 1
  s_and_b32 s37, s37, 7
  s_mov_b32 s31, 256
  s_cmp_eq_u32 s37, s39
  s_cbranch_scc1 L_cf_99
  s_lshl_b32 s33, 1, s38
L_cf_100:
  s_ff1_i32_b32 s38, s33
  s_lshl_b32 s31, 1, s38
  s_lshl_b32 s32, s37, 2
  v_mov_b32 v22, s31
  buffer_atomic_or v22, off, s[8:11], s32 sc0 sc1
  s_waitcnt vmcnt(0)
  s_branch L_cf_97
L_cf_98:
  s_or_b32 s33, s33, s31
  s_cmp_eq_u32 s33, -1
  s_cbranch_scc0 L_cf_101
  v_mov_b32 v22, 1
  buffer_atomic_add v22, off, s[8:11], 0 offset:128 sc0 sc1
  s_waitcnt vmcnt(0)
  v_readfirstlane_b32 s33, v22
  s_nop 0
  s_cmp_eq_u32 s33, 7
  s_cbranch_scc0 L_cf_101
  buffer_load_dwordx2 v[22:23], off, s[8:11], 0 offset:136 sc1
  s_waitcnt vmcnt(0)
  v_readfirstlane_b32 s33, v22
  v_readfirstlane_b32 s34, v23
  s_mov_b64 exec, 0xff
  s_mov_b32 s32, 0x408000
  v_lshlrev_b32 v23, 7, v0
  buffer_load_dword v22, v23, s[4:7], s32 offen sc1
  s_cmp_gt_u32 s34, s33
  s_cselect_b32 s33, 1, 0
  s_waitcnt vmcnt(0)
  v_add_u32 v22, 2, v22
  v_and_b32 v22, -2, v22
  v_or_b32 v22, s33, v22
  buffer_store_dword v22, v23, s[4:7], s32 offen sc1
  s_mov_b64 exec, 1
L_cf_101:
  s_lshl_b32 s31, s37, 5
  s_add_u32 s31, s31, s38
L_cf_99:
  v_mov_b32 v22, s31
  v_mov_b32 v23, 163836
  ds_write_b32 v23, v22
  s_waitcnt lgkmcnt(0)
  s_mov_b64 exec, -1
L_cf_96:
  s_barrier
  v_mov_b32 v23, 163836
  ds_read_b32 v22, v23
  s_mov_b32 s36, 1
  s_waitcnt lgkmcnt(0)
  v_readfirstlane_b32 s31, v22
  s_nop 0
  s_cmp_ge_u32 s31, 256
  s_cbranch_scc1 L_exit
  s_cmp_eq_u32 s31, s35
  s_cbranch_scc1 L_cf_95
  s_mov_b32 s35, s31
  s_waitcnt vmcnt(0)
  s_barrier
  s_branch L_dispatch
L_cf_95:
  s_mov_b32 s31, 0x140000
  buffer_load_dwordx4 v12, s[12:15], s31 offen offset:0 lds
  buffer_load_dwordx4 v12, s[12:15], s31 offen offset:1024 lds
  buffer_load_dwordx4 v12, s[12:15], s31 offen offset:2048 lds
  buffer_load_dwordx4 v12, s[12:15], s31 offen offset:3072 lds
  s_mov_b32 s31, 0x141000
  buffer_load_dwordx4 v12, s[12:15], s31 offen offset:0 lds
  buffer_load_dwordx4 v12, s[12:15], s31 offen offset:1024 lds
  buffer_load_dwordx4 v12, s[12:15], s31 offen offset:2048 lds
  buffer_load_dwordx4 v12, s[12:15], s31 offen offset:3072 lds
  s_waitcnt vmcnt(24)
  s_mov_b32 s31, 0x180000
  buffer_load_dwordx4 v12, s[12:15], s31 offen offset:0 lds
  buffer_load_dwordx4 v12, s[12:15], s31 offen offset:1024 lds
  buffer_load_dwordx4 v12, s[12:15], s31 offen offset:2048 lds
  buffer_load_dwordx4 v12, s[12:15], s31 offen offset:3072 lds
  s_mov_b32 s31, 0x181000
  buffer_load_dwordx4 v12, s[12:15], s31 offen offset:0 lds
  buffer_load_dwordx4 v12, s[12:15], s31 offen offset:1024 lds
  buffer_load_dwordx4 v12, s[12:15], s31 offen offset:2048 lds
  buffer_load_dwordx4 v12, s[12:15], s31 offen offset:3072 lds
  s_waitcnt vmcnt(24)
  s_mov_b32 s31, 0x1c0000
  buffer_load_dwordx4 v12, s[12:15], s31 offen offset:0 lds
  buffer_load_dwordx4 v12, s[12:15], s31 offen offset:1024 lds
  buffer_load_dwordx4 v12, s[12:15], s31 offen offset:2048 lds
  buffer_load_dwordx4 v12, s[12:15], s31 offen offset:3072 lds
  s_mov_b32 s31, 0x1c1000
  buffer_load_dwordx4 v12, s[12:15], s31 offen offset:0 lds
  buffer_load_dwordx4 v12, s[12:15], s31 offen offset:1024 lds
  buffer_load_dwordx4 v12, s[12:15], s31 offen offset:2048 lds
  buffer_load_dwordx4 v12, s[12:15], s31 offen offset:3072 lds
  s_waitcnt vmcnt(24)
L_wi_102:
  buffer_load_dword v16, off, s[4:7], s63 sc1
  s_waitcnt vmcnt(0)
  v_readfirstlane_b32 s32, v16
  s_nop 0
  s_cmp_lg_u32 s32, s62
  s_cbranch_scc1 L_wi_ok_103
  s_sleep 8
  s_add_u32 s30, s30, 1
  s_cmp_lt_u32 s30, 0x100000
  s_cbranch_scc1 L_wi_102
  s_branch L_abort
L_wi_ok_103:
  s_and_b32 s32, s32, 1
  s_lshl_b32 s32, s32, 13
  s_add_u32 s28, s28, s32
  s_add_u32 s32, s26, 160
  s_lshl_b32 s32, s32, 7
  s_add_u32 s32, s32, 0x400000
L_df_104:
  buffer_load_dword v16, off, s[4:7], s32 sc1
  s_waitcnt vmcnt(0)
  v_readfirstlane_b32 s31, v16
  s_nop 0
  s_cmp_ge_u32 s31, 1
  s_cbranch_scc1 L_df_ok_105
  s_sleep 8
  s_add_u32 s30, s30, 1
  s_cmp_lt_u32 s30, 0x100000
  s_cbranch_scc1 L_df_104
  s_branch L_abort
L_df_ok_105:
  s_add_u32 s42, s26, 128
  s_lshl_b32 s42, s42, 7
  s_add_u32 s42, s42, 0x400000
  s_lshl_b32 s31, s24, 2
  s_add_u32 s42, s42, s31
  s_mov_b32 s12, s82
  s_mov_b32 s13, s83
  s_mov_b32 s14, 0x700000
  s_mov_b32 s15, 0x20000
  s_and_b32 s47, s26, 15
  s_mul_i32 s31, s24, 1835008
  s_lshl_b32 s32, s47, 7
  s_add_u32 s31, s31, s32
  v_mov_b32 v12, 0x0
  v_bfe_u32 v15, v0, 3, 3
  v_lshl_add_u32 v12, v15, 11, v12
  v_bfe_u32 v15, v0, 0, 3
  v_lshl_add_u32 v12, v15, 4, v12
  v_add_u32 v12, s31, v12
  v_bfe_u32 v15, v0, 4, 2
  v_lshlrev_b32 v15, 5, v15
  v_xor_b32 v12, v12, v15
  s_lshl_b32 s43, s24, 15
  v_mov_b32 v16, 0x0
  v_bfe_u32 v15, v0, 2, 4
  v_lshl_add_u32 v16, v15, 7, v16
  v_bfe_u32 v15, v0, 3, 2
  v_lshl_add_u32 v16, v15, 5, v16
  v_bfe_u32 v15, v0, 0, 2
  v_lshl_add_u32 v16, v15, 3, v16
  v_add_u32 v16, s43, v16
  v_xor_b32 v17, 32, v16
  v_xor_b32 v18, 64, v16
  v_xor_b32 v19, 96, v16
  v_mov_b32 v8, 0x0
  v_bfe_u32 v15, v0, 0, 6
  v_lshl_add_u32 v8, v15, 4, v8
  v_add_u32 v8, s43, v8
  s_mov_b32 s31, 0x0
  s_add_u32 m0, s43, 0
  s_nop 0
  buffer_load_dwordx4 v12, s[12:15], s31 offen nt lds
  s_mov_b32 s31, 0x4000
  s_add_u32 m0, s43, 1024
  s_nop 0
  buffer_load_dwordx4 v12, s[12:15], s31 offen nt lds
  s_mov_b32 s31, 0x8000
  s_add_u32 m0, s43, 2048
  s_nop 0
  buffer_load_dwordx4 v12, s[12:15], s31 offen nt lds
  s_mov_b32 s31, 0xc000
  s_add_u32 m0, s43, 3072
  s_nop 0
  buffer_load_dwordx4 v12, s[12:15], s31 offen nt lds
  s_mov_b32 s31, 0x10000
  s_add_u32 m0, s43, 4096
  s_nop 0
  buffer_load_dwordx4 v12, s[12:15], s31 offen nt lds
  s_mov_b32 s31, 0x14000
  s_add_u32 m0, s43, 5120
  s_nop 0
  buffer_load_dwordx4 v12, s[12:15], s31 offen nt lds
  s_mov_b32 s31, 0x18000
  s_add_u32 m0, s43, 6144
  s_nop 0
  buffer_load_dwordx4 v12, s[12:15], s31 offen nt lds
  s_mov_b32 s31, 0x1c000
  s_add_u32 m0, s43, 7168
  s_nop 0
  buffer_load_dwordx4 v12, s[12:15], s31 offen nt lds
  s_mov_b32 s31, 0x20000
  s_add_u32 m0, s43, 8192
  s_nop 0
  buffer_load_dwordx4 v12, s[12:15], s31 offen nt lds
  s_mov_b32 s31, 0x24000
  s_add_u32 m0, s43, 9216
  s_nop 0
  buffer_load_dwordx4 v12, s[12:15], s31 offen nt lds
  s_mov_b32 s31, 0x28000
  s_add_u32 m0, s43, 10240
  s_nop 0
  buffer_load_dwordx4 v12, s[12:15], s31 offen nt lds
  s_mov_b32 s31, 0x2c000
  s_add_u32 m0, s43, 11264
  s_nop 0
  buffer_load_dwordx4 v12, s[12:15], s31 offen nt lds
  s_mov_b32 s31, 0x30000
  s_add_u32 m0, s43, 12288
  s_nop 0
  buffer_load_dwordx4 v12, s[12:15], s31 offen nt lds
  s_mov_b32 s31, 0x34000
  s_add_u32 m0, s43, 13312
  s_nop 0
  buffer_load_dwordx4 v12, s[12:15], s31 offen nt lds
  s_mov_b32 s31, 0x38000
  s_add_u32 m0, s43, 14336
  s_nop 0
  buffer_load_dwordx4 v12, s[12:15], s31 offen nt lds
  s_mov_b32 s31, 0x3c000
  s_add_u32 m0, s43, 15360
  s_nop 0
  buffer_load_dwordx4 v12, s[12:15], s31 offen nt lds
  s_mov_b32 s31, 0x40000
  s_add_u32 m0, s43, 16384
  s_nop 0
  buffer_load_dwordx4 v12, s[12:15], s31 offen nt lds
  s_mov_b32 s31, 0x44000
  s_add_u32 m0, s43, 17408
  s_nop 0
  buffer_load_dwordx4 v12, s[12:15], s31 offen nt lds
  s_mov_b32 s31, 0x48000
  s_add_u32 m0, s43, 18432
  s_nop 0
  buffer_load_dwordx4 v12, s[12:15], s31 offen nt lds
  s_mov_b32 s31, 0x4c000
  s_add_u32 m0, s43, 19456
  s_nop 0
  buffer_load_dwordx4 v12, s[12:15], s31 offen nt lds
  s_mov_b32 s31, 0x50000
  s_add_u32 m0, s43, 20480
  s_nop 0
  buffer_load_dwordx4 v12, s[12:15], s31 offen nt lds
  s_mov_b32 s31, 0x54000
  s_add_u32 m0, s43, 21504
  s_nop 0
  buffer_load_dwordx4 v12, s[12:15], s31 offen nt lds
  s_mov_b32 s31, 0x58000
  s_add_u32 m0, s43, 22528
  s_nop 0
  buffer_load_dwordx4 v12, s[12:15], s31 offen nt lds
  s_mov_b32 s31, 0x5c000
  s_add_u32 m0, s43, 23552
  s_nop 0
  buffer_load_dwordx4 v12, s[12:15], s31 offen nt lds
  s_mov_b32 s31, 0x60000
  s_add_u32 m0, s43, 24576
  s_nop 0
  buffer_load_dwordx4 v12, s[12:15], s31 offen nt lds
  s_mov_b32 s31, 0x64000
  s_add_u32 m0, s43, 25600
  s_nop 0
  buffer_load_dwordx4 v12, s[12:15], s31 offen nt lds
  s_mov_b32 s31, 0x68000
  s_add_u32 m0, s43, 26624
  s_nop 0
  buffer_load_dwordx4 v12, s[12:15], s31 offen nt lds
  s_mov_b32 s31, 0x6c000
  s_add_u32 m0, s43, 27648
  s_nop 0
  buffer_load_dwordx4 v12, s[12:15], s31 offen nt lds
  s_mov_b32 s31, 0x70000
  s_add_u32 m0, s43, 28672
  s_nop 0
  buffer_load_dwordx4 v12, s[12:15], s31 offen nt lds
  s_mov_b32 s31, 0x74000
  s_add_u32 m0, s43, 29696
  s_nop 0
  buffer_load_dwordx4 v12, s[12:15], s31 offen nt lds
  s_mov_b32 s31, 0x78000
  s_add_u32 m0, s43, 30720
  s_nop 0
  buffer_load_dwordx4 v12, s[12:15], s31 offen nt lds
  s_mov_b32 s31, 0x7c000
  s_add_u32 m0, s43, 31744
  s_nop 0
  buffer_load_dwordx4 v12, s[12:15], s31 offen nt lds
  s_waitcnt vmcnt(28)
  ds_read_b64_tr_b16 a[0:1], v16 offset:0
  ds_read_b64_tr_b16 a[2:3], v16 offset:2048
  ds_read_b64_tr_b16 a[4:5], v17 offset:0
  ds_read_b64_tr_b16 a[6:7], v17 offset:2048
  ds_read_b64_tr_b16 a[8:9], v18 offset:0
  ds_read_b64_tr_b16 a[10:11], v18 offset:2048
  ds_read_b64_tr_b16 a[12:13], v19 offset:0
  ds_read_b64_tr_b16 a[14:15], v19 offset:2048
  s_waitcnt lgkmcnt(0)
  s_mov_b32 s31, 0x80000
  s_add_u32 m0, s43, 0
  s_nop 0
  buffer_load_dwordx4 v12, s[12:15], s31 offen nt lds
  s_mov_b32 s31, 0x84000
  s_add_u32 m0, s43, 1024
  s_nop 0
  buffer_load_dwordx4 v12, s[12:15], s31 offen nt lds
  s_mov_b32 s31, 0x88000
  s_add_u32 m0, s43, 2048
  s_nop 0
  buffer_load_dwordx4 v12, s[12:15], s31 offen nt lds
  s_mov_b32 s31, 0x8c000
  s_add_u32 m0, s43, 3072
  s_nop 0
  buffer_load_dwordx4 v12, s[12:15], s31 offen nt lds
  s_waitcnt vmcnt(28)
  ds_read_b64_tr_b16 a[16:17], v16 offset:4096
  ds_read_b64_tr_b16 a[18:19], v16 offset:6144
  ds_read_b64_tr_b16 a[20:21], v17 offset:4096
  ds_read_b64_tr_b16 a[22:23], v17 offset:6144
  ds_read_b64_tr_b16 a[24:25], v18 offset:4096
  ds_read_b64_tr_b16 a[26:27], v18 offset:6144
  ds_read_b64_tr_b16 a[28:29], v19 offset:4096
  ds_read_b64_tr_b16 a[30:31], v19 offset:6144
  s_waitcnt lgkmcnt(0)
  s_mov_b32 s31, 0x90000
  s_add_u32 m0, s43, 4096
  s_nop 0
  buffer_load_dwordx4 v12, s[12:15], s31 offen nt lds
  s_mov_b32 s31, 0x94000
  s_add_u32 m0, s43, 5120
  s_nop 0
  buffer_load_dwordx4 v12, s[12:15], s31 offen nt lds
  s_mov_b32 s31, 0x98000
  s_add_u32 m0, s43, 6144
  s_nop 0
  buffer_load_dwordx4 v12, s[12:15], s31 offen nt lds
  s_mov_b32 s31, 0x9c000
  s_add_u32 m0, s43, 7168
  s_nop 0
  buffer_load_dwordx4 v12, s[12:15], s31 offen nt lds
  s_waitcnt vmcnt(28)
  ds_read_b64_tr_b16 a[32:33], v16 offset:8192
  ds_read_b64_tr_b16 a[34:35], v16 offset:10240
  ds_read_b64_tr_b16 a[36:37], v17 offset:8192
  ds_read_b64_tr_b16 a[38:39], v17 offset:10240
  ds_read_b64_tr_b16 a[40:41], v18 offset:8192
  ds_read_b64_tr_b16 a[42:43], v18 offset:10240
  ds_read_b64_tr_b16 a[44:45], v19 offset:8192
  ds_read_b64_tr_b16 a[46:47], v19 offset:10240
  s_waitcnt lgkmcnt(0)
  s_mov_b32 s31, 0xa0000
  s_add_u32 m0, s43, 8192
  s_nop 0
  buffer_load_dwordx4 v12, s[12:15], s31 offen nt lds
  s_mov_b32 s31, 0xa4000
  s_add_u32 m0, s43, 9216
  s_nop 0
  buffer_load_dwordx4 v12, s[12:15], s31 offen nt lds
  s_mov_b32 s31, 0xa8000
  s_add_u32 m0, s43, 10240
  s_nop 0
  buffer_load_dwordx4 v12, s[12:15], s31 offen nt lds
  s_mov_b32 s31, 0xac000
  s_add_u32 m0, s43, 11264
  s_nop 0
  buffer_load_dwordx4 v12, s[12:15], s31 offen nt lds
  s_waitcnt vmcnt(28)
  ds_read_b64_tr_b16 a[48:49], v16 offset:12288
  ds_read_b64_tr_b16 a[50:51], v16 offset:14336
  ds_read_b64_tr_b16 a[52:53], v17 offset:12288
  ds_read_b64_tr_b16 a[54:55], v17 offset:14336
  ds_read_b64_tr_b16 a[56:57], v18 offset:12288
  ds_read_b64_tr_b16 a[58:59], v18 offset:14336
  ds_read_b64_tr_b16 a[60:61], v19 offset:12288
  ds_read_b64_tr_b16 a[62:63], v19 offset:14336
  s_waitcnt lgkmcnt(0)
  s_mov_b32 s31, 0xb0000
  s_add_u32 m0, s43, 12288
  s_nop 0
  buffer_load_dwordx4 v12, s[12:15], s31 offen nt lds
  s_mov_b32 s31, 0xb4000
  s_add_u32 m0, s43, 13312
  s_nop 0
  buffer_load_dwordx4 v12, s[12:15], s31 offen nt lds
  s_mov_b32 s31, 0xb8000
  s_add_u32 m0, s43, 14336
  s_nop 0
  buffer_load_dwordx4 v12, s[12:15], s31 offen nt lds
  s_mov_b32 s31, 0xbc000
  s_add_u32 m0, s43, 15360
  s_nop 0
  buffer_load_dwordx4 v12, s[12:15], s31 offen nt lds
  s_waitcnt vmcnt(28)
  ds_read_b64_tr_b16 a[64:65], v16 offset:16384
  ds_read_b64_tr_b16 a[66:67], v16 offset:18432
  ds_read_b64_tr_b16 a[68:69], v17 offset:16384
  ds_read_b64_tr_b16 a[70:71], v17 offset:18432
  ds_read_b64_tr_b16 a[72:73], v18 offset:16384
  ds_read_b64_tr_b16 a[74:75], v18 offset:18432
  ds_read_b64_tr_b16 a[76:77], v19 offset:16384
  ds_read_b64_tr_b16 a[78:79], v19 offset:18432
  s_waitcnt lgkmcnt(0)
  s_mov_b32 s31, 0xc0000
  s_add_u32 m0, s43, 16384
  s_nop 0
  buffer_load_dwordx4 v12, s[12:15], s31 offen nt lds
  s_mov_b32 s31, 0xc4000
  s_add_u32 m0, s43, 17408
  s_nop 0
  buffer_load_dwordx4 v12, s[12:15], s31 offen nt lds
  s_mov_b32 s31, 0xc8000
  s_add_u32 m0, s43, 18432
  s_nop 0
  buffer_load_dwordx4 v12, s[12:15], s31 offen nt lds
  s_mov_b32 s31, 0xcc000
  s_add_u32 m0, s43, 19456
  s_nop 0
  buffer_load_dwordx4 v12, s[12:15], s31 offen nt lds
  s_waitcnt vmcnt(28)
  ds_read_b64_tr_b16 a[80:81], v16 offset:20480
  ds_read_b64_tr_b16 a[82:83], v16 offset:22528
  ds_read_b64_tr_b16 a[84:85], v17 offset:20480
  ds_read_b64_tr_b16 a[86:87], v17 offset:22528
  ds_read_b64_tr_b16 a[88:89], v18 offset:20480
  ds_read_b64_tr_b16 a[90:91], v18 offset:22528
  ds_read_b64_tr_b16 a[92:93], v19 offset:20480
  ds_read_b64_tr_b16 a[94:95], v19 offset:22528
  s_waitcnt lgkmcnt(0)
  s_mov_b32 s31, 0xd0000
  s_add_u32 m0, s43, 20480
  s_nop 0
  buffer_load_dwordx4 v12, s[12:15], s31 offen nt lds
  s_mov_b32 s31, 0xd4000
  s_add_u32 m0, s43, 21504
  s_nop 0
  buffer_load_dwordx4 v12, s[12:15], s31 offen nt lds
  s_mov_b32 s31, 0xd8000
  s_add_u32 m0, s43, 22528
  s_nop 0
  buffer_load_dwordx4 v12, s[12:15], s31 offen nt lds
  s_mov_b32 s31, 0xdc000
  s_add_u32 m0, s43, 23552
  s_nop 0
  buffer_load_dwordx4 v12, s[12:15], s31 offen nt lds
  s_waitcnt vmcnt(28)
  ds_read_b64_tr_b16 a[96:97], v16 offset:24576
  ds_read_b64_tr_b16 a[98:99], v16 offset:26624
  ds_read_b64_tr_b16 a[100:101], v17 offset:24576
  ds_read_b64_tr_b16 a[102:103], v17 offset:26624
  ds_read_b64_tr_b16 a[104:105], v18 offset:24576
  ds_read_b64_tr_b16 a[106:107], v18 offset:26624
  ds_read_b64_tr_b16 a[108:109], v19 offset:24576
  ds_read_b64_tr_b16 a[110:111], v19 offset:26624
  s_waitcnt lgkmcnt(0)
  s_mov_b32 s31, 0xe0000
  s_add_u32 m0, s43, 24576
  s_nop 0
  buffer_load_dwordx4 v12, s[12:15], s31 offen nt lds
  s_mov_b32 s31, 0xe4000
  s_add_u32 m0, s43, 25600
  s_nop 0
  buffer_load_dwordx4 v12, s[12:15], s31 offen nt lds
  s_mov_b32 s31, 0xe8000
  s_add_u32 m0, s43, 26624
  s_nop 0
  buffer_load_dwordx4 v12, s[12:15], s31 offen nt lds
  s_mov_b32 s31, 0xec000
  s_add_u32 m0, s43, 27648
  s_nop 0
  buffer_load_dwordx4 v12, s[12:15], s31 offen nt lds
  s_waitcnt vmcnt(28)
  ds_read_b64_tr_b16 a[112:113], v16 offset:28672
  ds_read_b64_tr_b16 a[114:115], v16 offset:30720
  ds_read_b64_tr_b16 a[116:117], v17 offset:28672
  ds_read_b64_tr_b16 a[118:119], v17 offset:30720
  ds_read_b64_tr_b16 a[120:121], v18 offset:28672
  ds_read_b64_tr_b16 a[122:123], v18 offset:30720
  ds_read_b64_tr_b16 a[124:125], v19 offset:28672
  ds_read_b64_tr_b16 a[126:127], v19 offset:30720
  s_waitcnt lgkmcnt(0)
  s_mov_b32 s31, 0xf0000
  s_add_u32 m0, s43, 28672
  s_nop 0
  buffer_load_dwordx4 v12, s[12:15], s31 offen nt lds
  s_mov_b32 s31, 0xf4000
  s_add_u32 m0, s43, 29696
  s_nop 0
  buffer_load_dwordx4 v12, s[12:15], s31 offen nt lds
  s_mov_b32 s31, 0xf8000
  s_add_u32 m0, s43, 30720
  s_nop 0
  buffer_load_dwordx4 v12, s[12:15], s31 offen nt lds
  s_mov_b32 s31, 0xfc000
  s_add_u32 m0, s43, 31744
  s_nop 0
  buffer_load_dwordx4 v12, s[12:15], s31 offen nt lds
  s_waitcnt vmcnt(28)
  ds_read_b64_tr_b16 a[128:129], v16 offset:0
  ds_read_b64_tr_b16 a[130:131], v16 offset:2048
  ds_read_b64_tr_b16 a[132:133], v17 offset:0
  ds_read_b64_tr_b16 a[134:135], v17 offset:2048
  ds_read_b64_tr_b16 a[136:137], v18 offset:0
  ds_read_b64_tr_b16 a[138:139], v18 offset:2048
  ds_read_b64_tr_b16 a[140:141], v19 offset:0
  ds_read_b64_tr_b16 a[142:143], v19 offset:2048
  s_waitcnt lgkmcnt(0)
  s_mov_b32 s31, 0x100000
  s_add_u32 m0, s43, 0
  s_nop 0
  buffer_load_dwordx4 v12, s[12:15], s31 offen nt lds
  s_mov_b32 s31, 0x104000
  s_add_u32 m0, s43, 1024
  s_nop 0
  buffer_load_dwordx4 v12, s[12:15], s31 offen nt lds
  s_mov_b32 s31, 0x108000
  s_add_u32 m0, s43, 2048
  s_nop 0
  buffer_load_dwordx4 v12, s[12:15], s31 offen nt lds
  s_mov_b32 s31, 0x10c000
  s_add_u32 m0, s43, 3072
  s_nop 0
  buffer_load_dwordx4 v12, s[12:15], s31 offen nt lds
  s_waitcnt vmcnt(28)
  ds_read_b64_tr_b16 a[144:145], v16 offset:4096
  ds_read_b64_tr_b16 a[146:147], v16 offset:6144
  ds_read_b64_tr_b16 a[148:149], v17 offset:4096
  ds_read_b64_tr_b16 a[150:151], v17 offset:6144
  ds_read_b64_tr_b16 a[152:153], v18 offset:4096
  ds_read_b64_tr_b16 a[154:155], v18 offset:6144
  ds_read_b64_tr_b16 a[156:157], v19 offset:4096
  ds_read_b64_tr_b16 a[158:159], v19 offset:6144
  s_waitcnt lgkmcnt(0)
  s_mov_b32 s31, 0x110000
  s_add_u32 m0, s43, 4096
  s_nop 0
  buffer_load_dwordx4 v12, s[12:15], s31 offen nt lds
  s_mov_b32 s31, 0x114000
  s_add_u32 m0, s43, 5120
  s_nop 0
  buffer_load_dwordx4 v12, s[12:15], s31 offen nt lds
  s_mov_b32 s31, 0x118000
  s_add_u32 m0, s43, 6144
  s_nop 0
  buffer_load_dwordx4 v12, s[12:15], s31 offen nt lds
  s_mov_b32 s31, 0x11c000
  s_add_u32 m0, s43, 7168
  s_nop 0
  buffer_load_dwordx4 v12, s[12:15], s31 offen nt lds
  s_waitcnt vmcnt(28)
  ds_read_b64_tr_b16 a[160:161], v16 offset:8192
  ds_read_b64_tr_b16 a[162:163], v16 offset:10240
  ds_read_b64_tr_b16 a[164:165], v17 offset:8192
  ds_read_b64_tr_b16 a[166:167], v17 offset:10240
  ds_read_b64_tr_b16 a[168:169], v18 offset:8192
  ds_read_b64_tr_b16 a[170:171], v18 offset:10240
  ds_read_b64_tr_b16 a[172:173], v19 offset:8192
  ds_read_b64_tr_b16 a[174:175], v19 offset:10240
  s_waitcnt lgkmcnt(0)
  s_mov_b32 s31, 0x120000
  s_add_u32 m0, s43, 8192
  s_nop 0
  buffer_load_dwordx4 v12, s[12:15], s31 offen nt lds
  s_mov_b32 s31, 0x124000
  s_add_u32 m0, s43, 9216
  s_nop 0
  buffer_load_dwordx4 v12, s[12:15], s31 offen nt lds
  s_mov_b32 s31, 0x128000
  s_add_u32 m0, s43, 10240
  s_nop 0
  buffer_load_dwordx4 v12, s[12:15], s31 offen nt lds
  s_mov_b32 s31, 0x12c000
  s_add_u32 m0, s43, 11264
  s_nop 0
  buffer_load_dwordx4 v12, s[12:15], s31 offen nt lds
  s_waitcnt vmcnt(28)
  ds_read_b64_tr_b16 a[176:177], v16 offset:12288
  ds_read_b64_tr_b16 a[178:179], v16 offset:14336
  ds_read_b64_tr_b16 a[180:181], v17 offset:12288
  ds_read_b64_tr_b16 a[182:183], v17 offset:14336
  ds_read_b64_tr_b16 a[184:185], v18 offset:12288
  ds_read_b64_tr_b16 a[186:187], v18 offset:14336
  ds_read_b64_tr_b16 a[188:189], v19 offset:12288
  ds_read_b64_tr_b16 a[190:191], v19 offset:14336
  s_waitcnt lgkmcnt(0)
  s_mov_b32 s31, 0x130000
  s_add_u32 m0, s43, 12288
  s_nop 0
  buffer_load_dwordx4 v12, s[12:15], s31 offen nt lds
  s_mov_b32 s31, 0x134000
  s_add_u32 m0, s43, 13312
  s_nop 0
  buffer_load_dwordx4 v12, s[12:15], s31 offen nt lds
  s_mov_b32 s31, 0x138000
  s_add_u32 m0, s43, 14336
  s_nop 0
  buffer_load_dwordx4 v12, s[12:15], s31 offen nt lds
  s_mov_b32 s31, 0x13c000
  s_add_u32 m0, s43, 15360
  s_nop 0
  buffer_load_dwordx4 v12, s[12:15], s31 offen nt lds
  s_waitcnt vmcnt(28)
  ds_read_b64_tr_b16 a[192:193], v16 offset:16384
  ds_read_b64_tr_b16 a[194:195], v16 offset:18432
  ds_read_b64_tr_b16 a[196:197], v17 offset:16384
  ds_read_b64_tr_b16 a[198:199], v17 offset:18432
  ds_read_b64_tr_b16 a[200:201], v18 offset:16384
  ds_read_b64_tr_b16 a[202:203], v18 offset:18432
  ds_read_b64_tr_b16 a[204:205], v19 offset:16384
  ds_read_b64_tr_b16 a[206:207], v19 offset:18432
  s_waitcnt lgkmcnt(0)
  s_mov_b32 s31, 0x140000
  s_add_u32 m0, s43, 16384
  s_nop 0
  buffer_load_dwordx4 v12, s[12:15], s31 offen nt lds
  s_mov_b32 s31, 0x144000
  s_add_u32 m0, s43, 17408
  s_nop 0
  buffer_load_dwordx4 v12, s[12:15], s31 offen nt lds
  s_mov_b32 s31, 0x148000
  s_add_u32 m0, s43, 18432
  s_nop 0
  buffer_load_dwordx4 v12, s[12:15], s31 offen nt lds
  s_mov_b32 s31, 0x14c000
  s_add_u32 m0, s43, 19456
  s_nop 0
  buffer_load_dwordx4 v12, s[12:15], s31 offen nt lds
  s_waitcnt vmcnt(28)
  ds_read_b64_tr_b16 a[208:209], v16 offset:20480
  ds_read_b64_tr_b16 a[210:211], v16 offset:22528
  ds_read_b64_tr_b16 a[212:213], v17 offset:20480
  ds_read_b64_tr_b16 a[214:215], v17 offset:22528
  ds_read_b64_tr_b16 a[216:217], v18 offset:20480
  ds_read_b64_tr_b16 a[218:219], v18 offset:22528
  ds_read_b64_tr_b16 a[220:221], v19 offset:20480
  ds_read_b64_tr_b16 a[222:223], v19 offset:22528
  s_waitcnt lgkmcnt(0)
  s_mov_b32 s31, 0x150000
  s_add_u32 m0, s43, 20480
  s_nop 0
  buffer_load_dwordx4 v12, s[12:15], s31 offen nt lds
  s_mov_b32 s31, 0x154000
  s_add_u32 m0, s43, 21504
  s_nop 0
  buffer_load_dwordx4 v12, s[12:15], s31 offen nt lds
  s_mov_b32 s31, 0x158000
  s_add_u32 m0, s43, 22528
  s_nop 0
  buffer_load_dwordx4 v12, s[12:15], s31 offen nt lds
  s_mov_b32 s31, 0x15c000
  s_add_u32 m0, s43, 23552
  s_nop 0
  buffer_load_dwordx4 v12, s[12:15], s31 offen nt lds
  s_waitcnt vmcnt(28)
  ds_read_b64_tr_b16 a[224:225], v16 offset:24576
  ds_read_b64_tr_b16 a[226:227], v16 offset:26624
  ds_read_b64_tr_b16 a[228:229], v17 offset:24576
  ds_read_b64_tr_b16 a[230:231], v17 offset:26624
  ds_read_b64_tr_b16 a[232:233], v18 offset:24576
  ds_read_b64_tr_b16 a[234:235], v18 offset:26624
  ds_read_b64_tr_b16 a[236:237], v19 offset:24576
  ds_read_b64_tr_b16 a[238:239], v19 offset:26624
  s_waitcnt lgkmcnt(0)
  s_mov_b32 s31, 0x160000
  s_add_u32 m0, s43, 24576
  s_nop 0
  buffer_load_dwordx4 v12, s[12:15], s31 offen nt lds
  s_mov_b32 s31, 0x164000
  s_add_u32 m0, s43, 25600
  s_nop 0
  buffer_load_dwordx4 v12, s[12:15], s31 offen nt lds
  s_mov_b32 s31, 0x168000
  s_add_u32 m0, s43, 26624
  s_nop 0
  buffer_load_dwordx4 v12, s[12:15], s31 offen nt lds
  s_mov_b32 s31, 0x16c000
  s_add_u32 m0, s43, 27648
  s_nop 0
  buffer_load_dwordx4 v12, s[12:15], s31 offen nt lds
  s_waitcnt vmcnt(28)
  ds_read_b64_tr_b16 a[240:241], v16 offset:28672
  ds_read_b64_tr_b16 a[242:243], v16 offset:30720
  ds_read_b64_tr_b16 a[244:245], v17 offset:28672
  ds_read_b64_tr_b16 a[246:247], v17 offset:30720
  ds_read_b64_tr_b16 a[248:249], v18 offset:28672
  ds_read_b64_tr_b16 a[250:251], v18 offset:30720
  ds_read_b64_tr_b16 a[252:253], v19 offset:28672
  ds_read_b64_tr_b16 a[254:255], v19 offset:30720
  s_waitcnt lgkmcnt(0)
  s_mov_b32 s31, 0x170000
  s_add_u32 m0, s43, 28672
  s_nop 0
  buffer_load_dwordx4 v12, s[12:15], s31 offen nt lds
  s_mov_b32 s31, 0x174000
  s_add_u32 m0, s43, 29696
  s_nop 0
  buffer_load_dwordx4 v12, s[12:15], s31 offen nt lds
  s_mov_b32 s31, 0x178000
  s_add_u32 m0, s43, 30720
  s_nop 0
  buffer_load_dwordx4 v12, s[12:15], s31 offen nt lds
  s_mov_b32 s31, 0x17c000
  s_add_u32 m0, s43, 31744
  s_nop 0
  buffer_load_dwordx4 v12, s[12:15], s31 offen nt lds
  s_waitcnt vmcnt(28)
  ds_read_b64_tr_b16 v[128:129], v16 offset:0
  ds_read_b64_tr_b16 v[130:131], v16 offset:2048
  ds_read_b64_tr_b16 v[132:133], v17 offset:0
  ds_read_b64_tr_b16 v[134:135], v17 offset:2048
  ds_read_b64_tr_b16 v[136:137], v18 offset:0
  ds_read_b64_tr_b16 v[138:139], v18 offset:2048
  ds_read_b64_tr_b16 v[140:141], v19 offset:0
  ds_read_b64_tr_b16 v[142:143], v19 offset:2048
  s_waitcnt lgkmcnt(0)
  s_mov_b32 s31, 0x180000
  s_add_u32 m0, s43, 0
  s_nop 0
  buffer_load_dwordx4 v12, s[12:15], s31 offen nt lds
  s_mov_b32 s31, 0x184000
  s_add_u32 m0, s43, 1024
  s_nop 0
  buffer_load_dwordx4 v12, s[12:15], s31 offen nt lds
  s_mov_b32 s31, 0x188000
  s_add_u32 m0, s43, 2048
  s_nop 0
  buffer_load_dwordx4 v12, s[12:15], s31 offen nt lds
  s_mov_b32 s31, 0x18c000
  s_add_u32 m0, s43, 3072
  s_nop 0
  buffer_load_dwordx4 v12, s[12:15], s31 offen nt lds
  s_waitcnt vmcnt(28)
  ds_read_b64_tr_b16 v[144:145], v16 offset:4096
  ds_read_b64_tr_b16 v[146:147], v16 offset:6144
  ds_read_b64_tr_b16 v[148:149], v17 offset:4096
  ds_read_b64_tr_b16 v[150:151], v17 offset:6144
  ds_read_b64_tr_b16 v[152:153], v18 offset:4096
  ds_read_b64_tr_b16 v[154:155], v18 offset:6144
  ds_read_b64_tr_b16 v[156:157], v19 offset:4096
  ds_read_b64_tr_b16 v[158:159], v19 offset:6144
  s_waitcnt lgkmcnt(0)
  s_mov_b32 s31, 0x190000
  s_add_u32 m0, s43, 4096
  s_nop 0
  buffer_load_dwordx4 v12, s[12:15], s31 offen nt lds
  s_mov_b32 s31, 0x194000
  s_add_u32 m0, s43, 5120
  s_nop 0
  buffer_load_dwordx4 v12, s[12:15], s31 offen nt lds
  s_mov_b32 s31, 0x198000
  s_add_u32 m0, s43, 6144
  s_nop 0
  buffer_load_dwordx4 v12, s[12:15], s31 offen nt lds
  s_mov_b32 s31, 0x19c000
  s_add_u32 m0, s43, 7168
  s_nop 0
  buffer_load_dwordx4 v12, s[12:15], s31 offen nt lds
  s_waitcnt vmcnt(28)
  ds_read_b64_tr_b16 v[160:161], v16 offset:8192
  ds_read_b64_tr_b16 v[162:163], v16 offset:10240
  ds_read_b64_tr_b16 v[164:165], v17 offset:8192
  ds_read_b64_tr_b16 v[166:167], v17 offset:10240
  ds_read_b64_tr_b16 v[168:169], v18 offset:8192
  ds_read_b64_tr_b16 v[170:171], v18 offset:10240
  ds_read_b64_tr_b16 v[172:173], v19 offset:8192
  ds_read_b64_tr_b16 v[174:175], v19 offset:10240
  s_waitcnt lgkmcnt(0)
  s_mov_b32 s31, 0x1a0000
  s_add_u32 m0, s43, 8192
  s_nop 0
  buffer_load_dwordx4 v12, s[12:15], s31 offen nt lds
  s_mov_b32 s31, 0x1a4000
  s_add_u32 m0, s43, 9216
  s_nop 0
  buffer_load_dwordx4 v12, s[12:15], s31 offen nt lds
  s_mov_b32 s31, 0x1a8000
  s_add_u32 m0, s43, 10240
  s_nop 0
  buffer_load_dwordx4 v12, s[12:15], s31 offen nt lds
  s_mov_b32 s31, 0x1ac000
  s_add_u32 m0, s43, 11264
  s_nop 0
  buffer_load_dwordx4 v12, s[12:15], s31 offen nt lds
  s_waitcnt vmcnt(28)
  ds_read_b64_tr_b16 v[176:177], v16 offset:12288
  ds_read_b64_tr_b16 v[178:179], v16 offset:14336
  ds_read_b64_tr_b16 v[180:181], v17 offset:12288
  ds_read_b64_tr_b16 v[182:183], v17 offset:14336
  ds_read_b64_tr_b16 v[184:185], v18 offset:12288
  ds_read_b64_tr_b16 v[186:187], v18 offset:14336
  ds_read_b64_tr_b16 v[188:189], v19 offset:12288
  ds_read_b64_tr_b16 v[190:191], v19 offset:14336
  s_waitcnt lgkmcnt(0)
  s_mov_b32 s31, 0x1b0000
  s_add_u32 m0, s43, 12288
  s_nop 0
  buffer_load_dwordx4 v12, s[12:15], s31 offen nt lds
  s_mov_b32 s31, 0x1b4000
  s_add_u32 m0, s43, 13312
  s_nop 0
  buffer_load_dwordx4 v12, s[12:15], s31 offen nt lds
  s_mov_b32 s31, 0x1b8000
  s_add_u32 m0, s43, 14336
  s_nop 0
  buffer_load_dwordx4 v12, s[12:15], s31 offen nt lds
  s_mov_b32 s31, 0x1bc000
  s_add_u32 m0, s43, 15360
  s_nop 0
  buffer_load_dwordx4 v12, s[12:15], s31 offen nt lds
  s_waitcnt vmcnt(28)
  ds_read_b64_tr_b16 v[192:193], v16 offset:16384
  ds_read_b64_tr_b16 v[194:195], v16 offset:18432
  ds_read_b64_tr_b16 v[196:197], v17 offset:16384
  ds_read_b64_tr_b16 v[198:199], v17 offset:18432
  ds_read_b64_tr_b16 v[200:201], v18 offset:16384
  ds_read_b64_tr_b16 v[202:203], v18 offset:18432
  ds_read_b64_tr_b16 v[204:205], v19 offset:16384
  ds_read_b64_tr_b16 v[206:207], v19 offset:18432
  s_waitcnt lgkmcnt(0)
  s_waitcnt vmcnt(24)
  ds_read_b64_tr_b16 v[208:209], v16 offset:20480
  ds_read_b64_tr_b16 v[210:211], v16 offset:22528
  ds_read_b64_tr_b16 v[212:213], v17 offset:20480
  ds_read_b64_tr_b16 v[214:215], v17 offset:22528
  ds_read_b64_tr_b16 v[216:217], v18 offset:20480
  ds_read_b64_tr_b16 v[218:219], v18 offset:22528
  ds_read_b64_tr_b16 v[220:221], v19 offset:20480
  ds_read_b64_tr_b16 v[222:223], v19 offset:22528
  s_waitcnt lgkmcnt(0)
  s_waitcnt vmcnt(20)
  ds_read_b64_tr_b16 v[224:225], v16 offset:24576
  ds_read_b64_tr_b16 v[226:227], v16 offset:26624
  ds_read_b64_tr_b16 v[228:229], v17 offset:24576
  ds_read_b64_tr_b16 v[230:231], v17 offset:26624
  ds_read_b64_tr_b16 v[232:233], v18 offset:24576
  ds_read_b64_tr_b16 v[234:235], v18 offset:26624
  ds_read_b64_tr_b16 v[236:237], v19 offset:24576
  ds_read_b64_tr_b16 v[238:239], v19 offset:26624
  s_waitcnt lgkmcnt(0)
  s_waitcnt vmcnt(16)
  ds_read_b64_tr_b16 v[240:241], v16 offset:28672
  ds_read_b64_tr_b16 v[242:243], v16 offset:30720
  ds_read_b64_tr_b16 v[244:245], v17 offset:28672
  ds_read_b64_tr_b16 v[246:247], v17 offset:30720
  ds_read_b64_tr_b16 v[248:249], v18 offset:28672
  ds_read_b64_tr_b16 v[250:251], v18 offset:30720
  ds_read_b64_tr_b16 v[252:253], v19 offset:28672
  ds_read_b64_tr_b16 v[254:255], v19 offset:30720
  s_waitcnt lgkmcnt(0)
  s_waitcnt vmcnt(12)
  ds_read_b64_tr_b16 v[48:49], v16 offset:0
  ds_read_b64_tr_b16 v[50:51], v16 offset:2048
  ds_read_b64_tr_b16 v[52:53], v17 offset:0
  ds_read_b64_tr_b16 v[54:55], v17 offset:2048
  ds_read_b64_tr_b16 v[56:57], v18 offset:0
  ds_read_b64_tr_b16 v[58:59], v18 offset:2048
  ds_read_b64_tr_b16 v[60:61], v19 offset:0
  ds_read_b64_tr_b16 v[62:63], v19 offset:2048
  s_waitcnt lgkmcnt(0)
  ds_write_b128 v8, v[48:51] offset:0
  ds_write_b128 v8, v[52:55] offset:1024
  ds_write_b128 v8, v[56:59] offset:2048
  ds_write_b128 v8, v[60:63] offset:3072
  s_waitcnt lgkmcnt(0)
  s_waitcnt vmcnt(8)
  ds_read_b64_tr_b16 v[48:49], v16 offset:4096
  ds_read_b64_tr_b16 v[50:51], v16 offset:6144
  ds_read_b64_tr_b16 v[52:53], v17 offset:4096
  ds_read_b64_tr_b16 v[54:55], v17 offset:6144
  ds_read_b64_tr_b16 v[56:57], v18 offset:4096
  ds_read_b64_tr_b16 v[58:59], v18 offset:6144
  ds_read_b64_tr_b16 v[60:61], v19 offset:4096
  ds_read_b64_tr_b16 v[62:63], v19 offset:6144
  s_waitcnt lgkmcnt(0)
  ds_write_b128 v8, v[48:51] offset:4096
  ds_write_b128 v8, v[52:55] offset:5120
  ds_write_b128 v8, v[56:59] offset:6144
  ds_write_b128 v8, v[60:63] offset:7168
  s_waitcnt lgkmcnt(0)
  s_waitcnt vmcnt(4)
  ds_read_b64_tr_b16 v[48:49], v16 offset:8192
  ds_read_b64_tr_b16 v[50:51], v16 offset:10240
  ds_read_b64_tr_b16 v[52:53], v17 offset:8192
  ds_read_b64_tr_b16 v[54:55], v17 offset:10240
  ds_read_b64_tr_b16 v[56:57], v18 offset:8192
  ds_read_b64_tr_b16 v[58:59], v18 offset:10240
  ds_read_b64_tr_b16 v[60:61], v19 offset:8192
  ds_read_b64_tr_b16 v[62:63], v19 offset:10240
  s_waitcnt lgkmcnt(0)
  ds_write_b128 v8, v[48:51] offset:8192
  ds_write_b128 v8, v[52:55] offset:9216
  ds_write_b128 v8, v[56:59] offset:10240
  ds_write_b128 v8, v[60:63] offset:11264
  s_waitcnt lgkmcnt(0)
  s_waitcnt vmcnt(0)
  ds_read_b64_tr_b16 v[48:49], v16 offset:12288
  ds_read_b64_tr_b16 v[50:51], v16 offset:14336
  ds_read_b64_tr_b16 v[52:53], v17 offset:12288
  ds_read_b64_tr_b16 v[54:55], v17 offset:14336
  ds_read_b64_tr_b16 v[56:57], v18 offset:12288
  ds_read_b64_tr_b16 v[58:59], v18 offset:14336
  ds_read_b64_tr_b16 v[60:61], v19 offset:12288
  ds_read_b64_tr_b16 v[62:63], v19 offset:14336
  s_waitcnt lgkmcnt(0)
  ds_write_b128 v8, v[48:51] offset:12288
  ds_write_b128 v8, v[52:55] offset:13312
  ds_write_b128 v8, v[56:59] offset:14336
  ds_write_b128 v8, v[60:63] offset:15360
  s_waitcnt lgkmcnt(0)
  s_mul_i32 s31, s24, 57344
  v_mov_b32 v1, 0x0
  v_bfe_u32 v15, v0, 0, 6
  v_lshl_add_u32 v1, v15, 4, v1
  v_add_u32 v1, s31, v1
  v_lshrrev_b32 v15, 4, v0
  v_and_b32 v9, 7, v0
  v_xor_b32 v15, v15, v9
  v_lshlrev_b32 v15, 4, v15
  v_and_b32 v9, 15, v0
  v_lshl_add_u32 v9, v9, 8, v15
  s_lshl_b32 s31, s24, 13
  s_add_u32 s31, s31, 131072
  v_add_u32 v9, s31, v9
  v_xor_b32 v10, 64, v9
  v_lshrrev_b32 v3, 3, v0
  v_and_b32 v15, 7, v0
  v_lshlrev_b32 v15, 1, v15
  v_xor_b32 v15, v15, v3
  v_lshlrev_b32 v15, 4, v15
  v_lshl_add_u32 v3, v3, 8, v15
  s_lshl_b32 s31, s24, 11
  s_add_u32 s31, s31, 131072
  v_add_u32 v3, s31, v3
  v_xor_b32 v4, 16, v3
  s_lshl_b32 s31, s47, 12
  s_lshl_b32 s32, s24, 10
  s_add_u32 s31, s31, s32
  v_mov_b32 v5, 0x0
  v_bfe_u32 v15, v0, 0, 6
  v_lshl_add_u32 v5, v15, 4, v5
  v_add_u32 v5, s31, v5
  s_mul_i32 s31, s24, 7
  s_add_u32 s31, s31, 96
  s_lshl_b32 s31, s31, 7
  v_mov_b32 v2, 0x0
  v_bfe_u32 v15, v0, 2, 3
  v_lshl_add_u32 v2, v15, 7, v2
  v_bfe_u32 v15, v0, 0, 2
  v_lshl_add_u32 v2, v15, 2, v2
  v_add_u32 v2, s31, v2
  s_mov_b32 s38, 0x400000
  v_mov_b32 v11, 0
  s_mov_b32 s48, 0
  s_mov_b32 s49, 0
.p2align 6
L_G2F_loop:
  s_add_u32 s45, s29, 1
  s_mul_i32 s44, s29, 229376
  s_add_u32 s44, s44, 0x3800000
  s_lshl_b32 s46, s29, 16
  ds_read_b128 v[48:51], v8 offset:0
  ds_read_b128 v[52:55], v8 offset:1024
  ds_read_b128 v[56:59], v8 offset:2048
  ds_read_b128 v[60:63], v8 offset:3072
  s_cmp_lg_u32 s48, 0
  s_cbranch_scc1 L_G2F_go
  s_mov_b64 exec, 0xfffffff
L_G2F_poll:
  buffer_load_dword v11, v2, s[4:7], s38 offen sc1
  s_waitcnt vmcnt(0)
  v_cmp_gt_u32 vcc, s45, v11
  s_cbranch_vccz L_G2F_ready
  s_sleep 1
  s_add_u32 s30, s30, 1
  s_cmp_lt_u32 s30, 0x100000
  s_cbranch_scc1 L_G2F_poll
  s_branch L_abort
L_G2F_ready:
  s_mov_b64 exec, -1
  s_add_u32 s32, s44, 0
  buffer_load_dwordx4 v[64:67], v1, s[4:7], s32 offen offset:0 sc1
  buffer_load_dwordx4 v[68:71], v1, s[4:7], s32 offen offset:1024 sc1
  s_add_u32 s32, s44, 2048
  buffer_load_dwordx4 v[72:75], v1, s[4:7], s32 offen offset:0 sc1
  buffer_load_dwordx4 v[76:79], v1, s[4:7], s32 offen offset:1024 sc1
  s_add_u32 s32, s44, 4096
  buffer_load_dwordx4 v[80:83], v1, s[4:7], s32 offen offset:0 sc1
  buffer_load_dwordx4 v[84:87], v1, s[4:7], s32 offen offset:1024 sc1
  s_add_u32 s32, s44, 6144
  buffer_load_dwordx4 v[88:91], v1, s[4:7], s32 offen offset:0 sc1
  buffer_load_dwordx4 v[92:95], v1, s[4:7], s32 offen offset:1024 sc1
  s_add_u32 s32, s44, 8192
  buffer_load_dwordx4 v[96:99], v1, s[4:7], s32 offen offset:0 sc1
  buffer_load_dwordx4 v[100:103], v1, s[4:7], s32 offen offset:1024 sc1
  s_add_u32 s32, s44, 10240
  buffer_load_dwordx4 v[104:107], v1, s[4:7], s32 offen offset:0 sc1
  buffer_load_dwordx4 v[108:111], v1, s[4:7], s32 offen offset:1024 sc1
  s_add_u32 s32, s44, 49152
  buffer_load_dwordx4 v[112:115], v1, s[4:7], s32 offen offset:0 sc1
  buffer_load_dwordx4 v[116:119], v1, s[4:7], s32 offen offset:1024 sc1
L_G2F_go:
  s_waitcnt vmcnt(13)
  v_mfma_f32_16x16x32_bf16 v[16:19], a[0:3], v[64:67], 0
  v_mfma_f32_16x16x32_bf16 v[24:27], a[4:7], v[64:67], 0
  v_mfma_f32_16x16x32_bf16 v[32:35], a[8:11], v[64:67], 0
  v_mfma_f32_16x16x32_bf16 v[40:43], a[12:15], v[64:67], 0
  s_add_u32 s32, s44, 12288
  buffer_load_dwordx4 v[64:67], v1, s[4:7], s32 offen offset:0 sc1
  s_waitcnt vmcnt(13)
  v_mfma_f32_16x16x32_bf16 v[20:23], a[0:3], v[68:71], 0
  v_mfma_f32_16x16x32_bf16 v[28:31], a[4:7], v[68:71], 0
  v_mfma_f32_16x16x32_bf16 v[36:39], a[8:11], v[68:71], 0
  v_mfma_f32_16x16x32_bf16 v[44:47], a[12:15], v[68:71], 0
  buffer_load_dwordx4 v[68:71], v1, s[4:7], s32 offen offset:1024 sc1
  s_waitcnt vmcnt(13)
  v_mfma_f32_16x16x32_bf16 v[16:19], a[16:19], v[72:75], v[16:19]
  v_mfma_f32_16x16x32_bf16 v[24:27], a[20:23], v[72:75], v[24:27]
  v_mfma_f32_16x16x32_bf16 v[32:35], a[24:27], v[72:75], v[32:35]
  v_mfma_f32_16x16x32_bf16 v[40:43], a[28:31], v[72:75], v[40:43]
  s_add_u32 s32, s44, 14336
  buffer_load_dwordx4 v[72:75], v1, s[4:7], s32 offen offset:0 sc1
  s_waitcnt vmcnt(13)
  v_mfma_f32_16x16x32_bf16 v[20:23], a[16:19], v[76:79], v[20:23]
  v_mfma_f32_16x16x32_bf16 v[28:31], a[20:23], v[76:79], v[28:31]
  v_mfma_f32_16x16x32_bf16 v[36:39], a[24:27], v[76:79], v[36:39]
  v_mfma_f32_16x16x32_bf16 v[44:47], a[28:31], v[76:79], v[44:47]
  buffer_load_dwordx4 v[76:79], v1, s[4:7], s32 offen offset:1024 sc1
  s_waitcnt vmcnt(13)
  v_mfma_f32_16x16x32_bf16 v[16:19], a[32:35], v[80:83], v[16:19]
  v_mfma_f32_16x16x32_bf16 v[24:27], a[36:39], v[80:83], v[24:27]
  v_mfma_f32_16x16x32_bf16 v[32:35], a[40:43], v[80:83], v[32:35]
  v_mfma_f32_16x16x32_bf16 v[40:43], a[44:47], v[80:83], v[40:43]
  s_add_u32 s32, s44, 16384
  buffer_load_dwordx4 v[80:83], v1, s[4:7], s32 offen offset:0 sc1
  s_waitcnt vmcnt(13)
  v_mfma_f32_16x16x32_bf16 v[20:23], a[32:35], v[84:87], v[20:23]
  v_mfma_f32_16x16x32_bf16 v[28:31], a[36:39], v[84:87], v[28:31]
  v_mfma_f32_16x16x32_bf16 v[36:39], a[40:43], v[84:87], v[36:39]
  v_mfma_f32_16x16x32_bf16 v[44:47], a[44:47], v[84:87], v[44:47]
  buffer_load_dwordx4 v[84:87], v1, s[4:7], s32 offen offset:1024 sc1
  s_waitcnt vmcnt(13)
  v_mfma_f32_16x16x32_bf16 v[16:19], a[48:51], v[88:91], v[16:19]
  v_mfma_f32_16x16x32_bf16 v[24:27], a[52:55], v[88:91], v[24:27]
  v_mfma_f32_16x16x32_bf16 v[32:35], a[56:59], v[88:91], v[32:35]
  v_mfma_f32_16x16x32_bf16 v[40:43], a[60:63], v[88:91], v[40:43]
  s_add_u32 s32, s44, 18432
  buffer_load_dwordx4 v[88:91], v1, s[4:7], s32 offen offset:0 sc1
  s_waitcnt vmcnt(13)
  v_mfma_f32_16x16x32_bf16 v[20:23], a[48:51], v[92:95], v[20:23]
  v_mfma_f32_16x16x32_bf16 v[28:31], a[52:55], v[92:95], v[28:31]
  v_mfma_f32_16x16x32_bf16 v[36:39], a[56:59], v[92:95], v[36:39]
  v_mfma_f32_16x16x32_bf16 v[44:47], a[60:63], v[92:95], v[44:47]
  buffer_load_dwordx4 v[92:95], v1, s[4:7], s32 offen offset:1024 sc1
  s_waitcnt vmcnt(13)
  v_mfma_f32_16x16x32_bf16 v[16:19], a[64:67], v[96:99], v[16:19]
  v_mfma_f32_16x16x32_bf16 v[24:27], a[68:71], v[96:99], v[24:27]
  v_mfma_f32_16x16x32_bf16 v[32:35], a[72:75], v[96:99], v[32:35]
  v_mfma_f32_16x16x32_bf16 v[40:43], a[76:79], v[96:99], v[40:43]
  s_add_u32 s32, s44, 20480
  buffer_load_dwordx4 v[96:99], v1, s[4:7], s32 offen offset:0 sc1
  s_waitcnt vmcnt(13)
  v_mfma_f32_16x16x32_bf16 v[20:23], a[64:67], v[100:103], v[20:23]
  v_mfma_f32_16x16x32_bf16 v[28:31], a[68:71], v[100:103], v[28:31]
  v_mfma_f32_16x16x32_bf16 v[36:39], a[72:75], v[100:103], v[36:39]
  v_mfma_f32_16x16x32_bf16 v[44:47], a[76:79], v[100:103], v[44:47]
  buffer_load_dwordx4 v[100:103], v1, s[4:7], s32 offen offset:1024 sc1
  s_waitcnt vmcnt(13)
  v_mfma_f32_16x16x32_bf16 v[16:19], a[80:83], v[104:107], v[16:19]
  v_mfma_f32_16x16x32_bf16 v[24:27], a[84:87], v[104:107], v[24:27]
  v_mfma_f32_16x16x32_bf16 v[32:35], a[88:91], v[104:107], v[32:35]
  v_mfma_f32_16x16x32_bf16 v[40:43], a[92:95], v[104:107], v[40:43]
  s_add_u32 s32, s44, 22528
  buffer_load_dwordx4 v[104:107], v1, s[4:7], s32 offen offset:0 sc1
  s_waitcnt vmcnt(13)
  v_mfma_f32_16x16x32_bf16 v[20:23], a[80:83], v[108:111], v[20:23]
  v_mfma_f32_16x16x32_bf16 v[28:31], a[84:87], v[108:111], v[28:31]
  v_mfma_f32_16x16x32_bf16 v[36:39], a[88:91], v[108:111], v[36:39]
  v_mfma_f32_16x16x32_bf16 v[44:47], a[92:95], v[108:111], v[44:47]
  buffer_load_dwordx4 v[108:111], v1, s[4:7], s32 offen offset:1024 sc1
  s_waitcnt vmcnt(13)
  s_waitcnt lgkmcnt(3)
  v_mfma_f32_16x16x32_bf16 v[16:19], v[48:51], v[112:115], v[16:19]
  s_waitcnt lgkmcnt(2)
  v_mfma_f32_16x16x32_bf16 v[24:27], v[52:55], v[112:115], v[24:27]
  s_waitcnt lgkmcnt(1)
  v_mfma_f32_16x16x32_bf16 v[32:35], v[56:59], v[112:115], v[32:35]
  s_waitcnt lgkmcnt(0)
  v_mfma_f32_16x16x32_bf16 v[40:43], v[60:63], v[112:115], v[40:43]
  s_add_u32 s32, s44, 51200
  buffer_load_dwordx4 v[112:115], v1, s[4:7], s32 offen offset:0 sc1
  s_waitcnt vmcnt(13)
  v_mfma_f32_16x16x32_bf16 v[20:23], v[48:51], v[116:119], v[20:23]
  v_mfma_f32_16x16x32_bf16 v[28:31], v[52:55], v[116:119], v[28:31]
  v_mfma_f32_16x16x32_bf16 v[36:39], v[56:59], v[116:119], v[36:39]
  v_mfma_f32_16x16x32_bf16 v[44:47], v[60:63], v[116:119], v[44:47]
  buffer_load_dwordx4 v[116:119], v1, s[4:7], s32 offen offset:1024 sc1
  ds_read_b128 v[48:51], v8 offset:4096
  ds_read_b128 v[52:55], v8 offset:5120
  ds_read_b128 v[56:59], v8 offset:6144
  ds_read_b128 v[60:63], v8 offset:7168
  s_waitcnt vmcnt(13)
  v_mfma_f32_16x16x32_bf16 v[16:19], a[96:99], v[64:67], v[16:19]
  v_mfma_f32_16x16x32_bf16 v[24:27], a[100:103], v[64:67], v[24:27]
  v_mfma_f32_16x16x32_bf16 v[32:35], a[104:107], v[64:67], v[32:35]
  v_mfma_f32_16x16x32_bf16 v[40:43], a[108:111], v[64:67], v[40:43]
  v_mov_b32 v15, s49
  s_mov_b64 exec, 1
  buffer_store_dword v15, off, s[4:7], s42 sc1
  s_mov_b64 exec, -1
  s_mov_b64 exec, 0xfffffff
  buffer_load_dword v11, v2, s[4:7], s38 offen sc1
  s_mov_b64 exec, -1
  s_add_u32 s32, s44, 24576
  buffer_load_dwordx4 v[64:67], v1, s[4:7], s32 offen offset:0 sc1
  s_waitcnt vmcnt(15)
  v_mfma_f32_16x16x32_bf16 v[20:23], a[96:99], v[68:71], v[20:23]
  v_mfma_f32_16x16x32_bf16 v[28:31], a[100:103], v[68:71], v[28:31]
  v_mfma_f32_16x16x32_bf16 v[36:39], a[104:107], v[68:71], v[36:39]
  v_mfma_f32_16x16x32_bf16 v[44:47], a[108:111], v[68:71], v[44:47]
  buffer_load_dwordx4 v[68:71], v1, s[4:7], s32 offen offset:1024 sc1
  s_waitcnt vmcnt(15)
  v_mfma_f32_16x16x32_bf16 v[16:19], a[112:115], v[72:75], v[16:19]
  v_mfma_f32_16x16x32_bf16 v[24:27], a[116:119], v[72:75], v[24:27]
  v_mfma_f32_16x16x32_bf16 v[32:35], a[120:123], v[72:75], v[32:35]
  v_mfma_f32_16x16x32_bf16 v[40:43], a[124:127], v[72:75], v[40:43]
  s_add_u32 s32, s44, 26624
  buffer_load_dwordx4 v[72:75], v1, s[4:7], s32 offen offset:0 sc1
  s_waitcnt vmcnt(15)
  v_mfma_f32_16x16x32_bf16 v[20:23], a[112:115], v[76:79], v[20:23]
  v_mfma_f32_16x16x32_bf16 v[28:31], a[116:119], v[76:79], v[28:31]
  v_mfma_f32_16x16x32_bf16 v[36:39], a[120:123], v[76:79], v[36:39]
  v_mfma_f32_16x16x32_bf16 v[44:47], a[124:127], v[76:79], v[44:47]
  buffer_load_dwordx4 v[76:79], v1, s[4:7], s32 offen offset:1024 sc1
  s_waitcnt vmcnt(15)
  v_mfma_f32_16x16x32_bf16 v[16:19], a[128:131], v[80:83], v[16:19]
  v_mfma_f32_16x16x32_bf16 v[24:27], a[132:135], v[80:83], v[24:27]
  v_mfma_f32_16x16x32_bf16 v[32:35], a[136:139], v[80:83], v[32:35]
  v_mfma_f32_16x16x32_bf16 v[40:43], a[140:143], v[80:83], v[40:43]
  s_add_u32 s32, s44, 28672
  buffer_load_dwordx4 v[80:83], v1, s[4:7], s32 offen offset:0 sc1
  s_waitcnt vmcnt(15)
  v_mfma_f32_16x16x32_bf16 v[20:23], a[128:131], v[84:87], v[20:23]
  v_mfma_f32_16x16x32_bf16 v[28:31], a[132:135], v[84:87], v[28:31]
  v_mfma_f32_16x16x32_bf16 v[36:39], a[136:139], v[84:87], v[36:39]
  v_mfma_f32_16x16x32_bf16 v[44:47], a[140:143], v[84:87], v[44:47]
  buffer_load_dwordx4 v[84:87], v1, s[4:7], s32 offen offset:1024 sc1
  s_waitcnt vmcnt(15)
  v_mfma_f32_16x16x32_bf16 v[16:19], a[144:147], v[88:91], v[16:19]
  v_mfma_f32_16x16x32_bf16 v[24:27], a[148:151], v[88:91], v[24:27]
  v_mfma_f32_16x16x32_bf16 v[32:35], a[152:155], v[88:91], v[32:35]
  v_mfma_f32_16x16x32_bf16 v[40:43], a[156:159], v[88:91], v[40:43]
  s_add_u32 s32, s44, 30720
  buffer_load_dwordx4 v[88:91], v1, s[4:7], s32 offen offset:0 sc1
  s_waitcnt vmcnt(15)
  v_mfma_f32_16x16x32_bf16 v[20:23], a[144:147], v[92:95], v[20:23]
  v_mfma_f32_16x16x32_bf16 v[28:31], a[148:151], v[92:95], v[28:31]
  v_mfma_f32_16x16x32_bf16 v[36:39], a[152:155], v[92:95], v[36:39]
  v_mfma_f32_16x16x32_bf16 v[44:47], a[156:159], v[92:95], v[44:47]
  buffer_load_dwordx4 v[92:95], v1, s[4:7], s32 offen offset:1024 sc1
  s_waitcnt vmcnt(15)
  v_mfma_f32_16x16x32_bf16 v[16:19], a[160:163], v[96:99], v[16:19]
  v_mfma_f32_16x16x32_bf16 v[24:27], a[164:167], v[96:99], v[24:27]
  v_mfma_f32_16x16x32_bf16 v[32:35], a[168:171], v[96:99], v[32:35]
  v_mfma_f32_16x16x32_bf16 v[40:43], a[172:175], v[96:99], v[40:43]
  s_add_u32 s32, s44, 32768
  buffer_load_dwordx4 v[96:99], v1, s[4:7], s32 offen offset:0 sc1
  s_waitcnt vmcnt(15)
  v_mfma_f32_16x16x32_bf16 v[20:23], a[160:163], v[100:103], v[20:23]
  v_mfma_f32_16x16x32_bf16 v[28:31], a[164:167], v[100:103], v[28:31]
  v_mfma_f32_16x16x32_bf16 v[36:39], a[168:171], v[100:103], v[36:39]
  v_mfma_f32_16x16x32_bf16 v[44:47], a[172:175], v[100:103], v[44:47]
  buffer_load_dwordx4 v[100:103], v1, s[4:7], s32 offen offset:1024 sc1
  s_waitcnt vmcnt(15)
  v_mfma_f32_16x16x32_bf16 v[16:19], a[176:179], v[104:107], v[16:19]
  v_mfma_f32_16x16x32_bf16 v[24:27], a[180:183], v[104:107], v[24:27]
  v_mfma_f32_16x16x32_bf16 v[32:35], a[184:187], v[104:107], v[32:35]
  v_mfma_f32_16x16x32_bf16 v[40:43], a[188:191], v[104:107], v[40:43]
  s_add_u32 s32, s44, 34816
  buffer_load_dwordx4 v[104:107], v1, s[4:7], s32 offen offset:0 sc1
  s_waitcnt vmcnt(15)
  v_mfma_f32_16x16x32_bf16 v[20:23], a[176:179], v[108:111], v[20:23]
  v_mfma_f32_16x16x32_bf16 v[28:31], a[180:183], v[108:111], v[28:31]
  v_mfma_f32_16x16x32_bf16 v[36:39], a[184:187], v[108:111], v[36:39]
  v_mfma_f32_16x16x32_bf16 v[44:47], a[188:191], v[108:111], v[44:47]
  buffer_load_dwordx4 v[108:111], v1, s[4:7], s32 offen offset:1024 sc1
  s_waitcnt vmcnt(15)
  s_waitcnt lgkmcnt(3)
  v_mfma_f32_16x16x32_bf16 v[16:19], v[48:51], v[112:115], v[16:19]
  s_waitcnt lgkmcnt(2)
  v_mfma_f32_16x16x32_bf16 v[24:27], v[52:55], v[112:115], v[24:27]
  s_waitcnt lgkmcnt(1)
  v_mfma_f32_16x16x32_bf16 v[32:35], v[56:59], v[112:115], v[32:35]
  s_waitcnt lgkmcnt(0)
  v_mfma_f32_16x16x32_bf16 v[40:43], v[60:63], v[112:115], v[40:43]
  s_add_u32 s32, s44, 53248
  buffer_load_dwordx4 v[112:115], v1, s[4:7], s32 offen offset:0 sc1
  s_waitcnt vmcnt(15)
  v_mfma_f32_16x16x32_bf16 v[20:23], v[48:51], v[116:119], v[20:23]
  v_mfma_f32_16x16x32_bf16 v[28:31], v[52:55], v[116:119], v[28:31]
  v_mfma_f32_16x16x32_bf16 v[36:39], v[56:59], v[116:119], v[36:39]
  v_mfma_f32_16x16x32_bf16 v[44:47], v[60:63], v[116:119], v[44:47]
  buffer_load_dwordx4 v[116:119], v1, s[4:7], s32 offen offset:1024 sc1
  ds_read_b128 v[48:51], v8 offset:8192
  ds_read_b128 v[52:55], v8 offset:9216
  ds_read_b128 v[56:59], v8 offset:10240
  ds_read_b128 v[60:63], v8 offset:11264
  s_waitcnt vmcnt(13)
  v_mfma_f32_16x16x32_bf16 v[16:19], a[192:195], v[64:67], v[16:19]
  v_mfma_f32_16x16x32_bf16 v[24:27], a[196:199], v[64:67], v[24:27]
  v_mfma_f32_16x16x32_bf16 v[32:35], a[200:203], v[64:67], v[32:35]
  v_mfma_f32_16x16x32_bf16 v[40:43], a[204:207], v[64:67], v[40:43]
  s_add_u32 s32, s44, 36864
  buffer_load_dwordx4 v[64:67], v1, s[4:7], s32 offen offset:0 sc1
  s_waitcnt vmcnt(13)
  v_mfma_f32_16x16x32_bf16 v[20:23], a[192:195], v[68:71], v[20:23]
  v_mfma_f32_16x16x32_bf16 v[28:31], a[196:199], v[68:71], v[28:31]
  v_mfma_f32_16x16x32_bf16 v[36:39], a[200:203], v[68:71], v[36:39]
  v_mfma_f32_16x16x32_bf16 v[44:47], a[204:207], v[68:71], v[44:47]
  buffer_load_dwordx4 v[68:71], v1, s[4:7], s32 offen offset:1024 sc1
  s_waitcnt vmcnt(13)
  v_mfma_f32_16x16x32_bf16 v[16:19], a[208:211], v[72:75], v[16:19]
  v_mfma_f32_16x16x32_bf16 v[24:27], a[212:215], v[72:75], v[24:27]
  v_mfma_f32_16x16x32_bf16 v[32:35], a[216:219], v[72:75], v[32:35]
  v_mfma_f32_16x16x32_bf16 v[40:43], a[220:223], v[72:75], v[40:43]
  s_add_u32 s32, s44, 38912
  buffer_load_dwordx4 v[72:75], v1, s[4:7], s32 offen offset:0 sc1
  s_waitcnt vmcnt(13)
  v_mfma_f32_16x16x32_bf16 v[20:23], a[208:211], v[76:79], v[20:23]
  v_mfma_f32_16x16x32_bf16 v[28:31], a[212:215], v[76:79], v[28:31]
  v_mfma_f32_16x16x32_bf16 v[36:39], a[216:219], v[76:79], v[36:39]
  v_mfma_f32_16x16x32_bf16 v[44:47], a[220:223], v[76:79], v[44:47]
  buffer_load_dwordx4 v[76:79], v1, s[4:7], s32 offen offset:1024 sc1
  s_waitcnt vmcnt(13)
  v_mfma_f32_16x16x32_bf16 v[16:19], a[224:227], v[80:83], v[16:19]
  v_mfma_f32_16x16x32_bf16 v[24:27], a[228:231], v[80:83], v[24:27]
  v_mfma_f32_16x16x32_bf16 v[32:35], a[232:235], v[80:83], v[32:35]
  v_mfma_f32_16x16x32_bf16 v[40:43], a[236:239], v[80:83], v[40:43]
  s_add_u32 s32, s44, 40960
  buffer_load_dwordx4 v[80:83], v1, s[4:7], s32 offen offset:0 sc1
  s_waitcnt vmcnt(13)
  v_mfma_f32_16x16x32_bf16 v[20:23], a[224:227], v[84:87], v[20:23]
  v_mfma_f32_16x16x32_bf16 v[28:31], a[228:231], v[84:87], v[28:31]
  v_mfma_f32_16x16x32_bf16 v[36:39], a[232:235], v[84:87], v[36:39]
  v_mfma_f32_16x16x32_bf16 v[44:47], a[236:239], v[84:87], v[44:47]
  buffer_load_dwordx4 v[84:87], v1, s[4:7], s32 offen offset:1024 sc1
  s_waitcnt vmcnt(13)
  v_mfma_f32_16x16x32_bf16 v[16:19], a[240:243], v[88:91], v[16:19]
  v_mfma_f32_16x16x32_bf16 v[24:27], a[244:247], v[88:91], v[24:27]
  v_mfma_f32_16x16x32_bf16 v[32:35], a[248:251], v[88:91], v[32:35]
  v_mfma_f32_16x16x32_bf16 v[40:43], a[252:255], v[88:91], v[40:43]
  s_add_u32 s32, s44, 43008
  buffer_load_dwordx4 v[88:91], v1, s[4:7], s32 offen offset:0 sc1
  s_waitcnt vmcnt(13)
  v_mfma_f32_16x16x32_bf16 v[20:23], a[240:243], v[92:95], v[20:23]
  v_mfma_f32_16x16x32_bf16 v[28:31], a[244:247], v[92:95], v[28:31]
  v_mfma_f32_16x16x32_bf16 v[36:39], a[248:251], v[92:95], v[36:39]
  v_mfma_f32_16x16x32_bf16 v[44:47], a[252:255], v[92:95], v[44:47]
  buffer_load_dwordx4 v[92:95], v1, s[4:7], s32 offen offset:1024 sc1
  s_waitcnt vmcnt(13)
  v_mfma_f32_16x16x32_bf16 v[16:19], v[128:131], v[96:99], v[16:19]
  v_mfma_f32_16x16x32_bf16 v[24:27], v[132:135], v[96:99], v[24:27]
  v_mfma_f32_16x16x32_bf16 v[32:35], v[136:139], v[96:99], v[32:35]
  v_mfma_f32_16x16x32_bf16 v[40:43], v[140:143], v[96:99], v[40:43]
  s_add_u32 s32, s44, 45056
  buffer_load_dwordx4 v[96:99], v1, s[4:7], s32 offen offset:0 sc1
  s_waitcnt vmcnt(13)
  v_mfma_f32_16x16x32_bf16 v[20:23], v[128:131], v[100:103], v[20:23]
  v_mfma_f32_16x16x32_bf16 v[28:31], v[132:135], v[100:103], v[28:31]
  v_mfma_f32_16x16x32_bf16 v[36:39], v[136:139], v[100:103], v[36:39]
  v_mfma_f32_16x16x32_bf16 v[44:47], v[140:143], v[100:103], v[44:47]
  buffer_load_dwordx4 v[100:103], v1, s[4:7], s32 offen offset:1024 sc1
  s_waitcnt vmcnt(13)
  v_mfma_f32_16x16x32_bf16 v[16:19], v[144:147], v[104:107], v[16:19]
  v_mfma_f32_16x16x32_bf16 v[24:27], v[148:151], v[104:107], v[24:27]
  v_mfma_f32_16x16x32_bf16 v[32:35], v[152:155], v[104:107], v[32:35]
  v_mfma_f32_16x16x32_bf16 v[40:43], v[156:159], v[104:107], v[40:43]
  s_add_u32 s32, s44, 47104
  buffer_load_dwordx4 v[104:107], v1, s[4:7], s32 offen offset:0 sc1
  s_waitcnt vmcnt(13)
  v_mfma_f32_16x16x32_bf16 v[20:23], v[144:147], v[108:111], v[20:23]
  v_mfma_f32_16x16x32_bf16 v[28:31], v[148:151], v[108:111], v[28:31]
  v_mfma_f32_16x16x32_bf16 v[36:39], v[152:155], v[108:111], v[36:39]
  v_mfma_f32_16x16x32_bf16 v[44:47], v[156:159], v[108:111], v[44:47]
  buffer_load_dwordx4 v[108:111], v1, s[4:7], s32 offen offset:1024 sc1
  s_waitcnt vmcnt(13)
  s_waitcnt lgkmcnt(3)
  v_mfma_f32_16x16x32_bf16 v[16:19], v[48:51], v[112:115], v[16:19]
  s_waitcnt lgkmcnt(2)
  v_mfma_f32_16x16x32_bf16 v[24:27], v[52:55], v[112:115], v[24:27]
  s_waitcnt lgkmcnt(1)
  v_mfma_f32_16x16x32_bf16 v[32:35], v[56:59], v[112:115], v[32:35]
  s_waitcnt lgkmcnt(0)
  v_mfma_f32_16x16x32_bf16 v[40:43], v[60:63], v[112:115], v[40:43]
  s_add_u32 s33, s45, s41
  s_mov_b64 exec, 0xfffffff
  v_cmp_gt_u32 vcc, s33, v11
  s_mov_b64 exec, -1
  s_mul_i32 s40, s41, 229376
  s_add_u32 s40, s40, s44
  s_cmp_eq_u64 vcc, 0
  s_cselect_b32 s48, 1, 0
  s_cselect_b32 s40, s40, 0x40000000
  s_add_u32 s32, s44, 55296
  buffer_load_dwordx4 v[112:115], v1, s[4:7], s32 offen offset:0 sc1
  s_waitcnt vmcnt(13)
  v_mfma_f32_16x16x32_bf16 v[20:23], v[48:51], v[116:119], v[20:23]
  v_mfma_f32_16x16x32_bf16 v[28:31], v[52:55], v[116:119], v[28:31]
  v_mfma_f32_16x16x32_bf16 v[36:39], v[56:59], v[116:119], v[36:39]
  v_mfma_f32_16x16x32_bf16 v[44:47], v[60:63], v[116:119], v[44:47]
  buffer_load_dwordx4 v[116:119], v1, s[4:7], s32 offen offset:1024 sc1
  ds_read_b128 v[48:51], v8 offset:12288
  ds_read_b128 v[52:55], v8 offset:13312
  ds_read_b128 v[56:59], v8 offset:14336
  ds_read_b128 v[60:63], v8 offset:15360
  s_waitcnt vmcnt(13)
  v_mfma_f32_16x16x32_bf16 v[16:19], v[160:163], v[64:67], v[16:19]
  v_mfma_f32_16x16x32_bf16 v[24:27], v[164:167], v[64:67], v[24:27]
  v_mfma_f32_16x16x32_bf16 v[32:35], v[168:171], v[64:67], v[32:35]
  v_mfma_f32_16x16x32_bf16 v[40:43], v[172:175], v[64:67], v[40:43]
  s_add_u32 s32, s40, 0
  buffer_load_dwordx4 v[64:67], v1, s[4:7], s32 offen offset:0 sc1
  s_waitcnt vmcnt(13)
  v_mfma_f32_16x16x32_bf16 v[20:23], v[160:163], v[68:71], v[20:23]
  v_mfma_f32_16x16x32_bf16 v[28:31], v[164:167], v[68:71], v[28:31]
  v_mfma_f32_16x16x32_bf16 v[36:39], v[168:171], v[68:71], v[36:39]
  v_mfma_f32_16x16x32_bf16 v[44:47], v[172:175], v[68:71], v[44:47]
  buffer_load_dwordx4 v[68:71], v1, s[4:7], s32 offen offset:1024 sc1
  s_waitcnt vmcnt(13)
  v_mfma_f32_16x16x32_bf16 v[16:19], v[176:179], v[72:75], v[16:19]
  v_mfma_f32_16x16x32_bf16 v[24:27], v[180:183], v[72:75], v[24:27]
  v_mfma_f32_16x16x32_bf16 v[32:35], v[184:187], v[72:75], v[32:35]
  v_mfma_f32_16x16x32_bf16 v[40:43], v[188:191], v[72:75], v[40:43]
  s_add_u32 s32, s40, 2048
  buffer_load_dwordx4 v[72:75], v1, s[4:7], s32 offen offset:0 sc1
  s_waitcnt vmcnt(13)
  v_mfma_f32_16x16x32_bf16 v[20:23], v[176:179], v[76:79], v[20:23]
  v_mfma_f32_16x16x32_bf16 v[28:31], v[180:183], v[76:79], v[28:31]
  v_mfma_f32_16x16x32_bf16 v[36:39], v[184:187], v[76:79], v[36:39]
  v_mfma_f32_16x16x32_bf16 v[44:47], v[188:191], v[76:79], v[44:47]
  buffer_load_dwordx4 v[76:79], v1, s[4:7], s32 offen offset:1024 sc1
  s_waitcnt vmcnt(13)
  v_mfma_f32_16x16x32_bf16 v[16:19], v[192:195], v[80:83], v[16:19]
  v_mfma_f32_16x16x32_bf16 v[24:27], v[196:199], v[80:83], v[24:27]
  v_mfma_f32_16x16x32_bf16 v[32:35], v[200:203], v[80:83], v[32:35]
  v_mfma_f32_16x16x32_bf16 v[40:43], v[204:207], v[80:83], v[40:43]
  s_add_u32 s32, s40, 4096
  buffer_load_dwordx4 v[80:83], v1, s[4:7], s32 offen offset:0 sc1
  s_waitcnt vmcnt(13)
  v_mfma_f32_16x16x32_bf16 v[20:23], v[192:195], v[84:87], v[20:23]
  v_mfma_f32_16x16x32_bf16 v[28:31], v[196:199], v[84:87], v[28:31]
  v_mfma_f32_16x16x32_bf16 v[36:39], v[200:203], v[84:87], v[36:39]
  v_mfma_f32_16x16x32_bf16 v[44:47], v[204:207], v[84:87], v[44:47]
  buffer_load_dwordx4 v[84:87], v1, s[4:7], s32 offen offset:1024 sc1
  s_waitcnt vmcnt(13)
  v_mfma_f32_16x16x32_bf16 v[16:19], v[208:211], v[88:91], v[16:19]
  v_mfma_f32_16x16x32_bf16 v[24:27], v[212:215], v[88:91], v[24:27]
  v_mfma_f32_16x16x32_bf16 v[32:35], v[216:219], v[88:91], v[32:35]
  v_mfma_f32_16x16x32_bf16 v[40:43], v[220:223], v[88:91], v[40:43]
  s_add_u32 s32, s40, 6144
  buffer_load_dwordx4 v[88:91], v1, s[4:7], s32 offen offset:0 sc1
  s_waitcnt vmcnt(13)
  v_mfma_f32_16x16x32_bf16 v[20:23], v[208:211], v[92:95], v[20:23]
  v_mfma_f32_16x16x32_bf16 v[28:31], v[212:215], v[92:95], v[28:31]
  v_mfma_f32_16x16x32_bf16 v[36:39], v[216:219], v[92:95], v[36:39]
  v_mfma_f32_16x16x32_bf16 v[44:47], v[220:223], v[92:95], v[44:47]
  buffer_load_dwordx4 v[92:95], v1, s[4:7], s32 offen offset:1024 sc1
  s_waitcnt vmcnt(13)
  v_mfma_f32_16x16x32_bf16 v[16:19], v[224:227], v[96:99], v[16:19]
  v_mfma_f32_16x16x32_bf16 v[24:27], v[228:231], v[96:99], v[24:27]
  v_mfma_f32_16x16x32_bf16 v[32:35], v[232:235], v[96:99], v[32:35]
  v_mfma_f32_16x16x32_bf16 v[40:43], v[236:239], v[96:99], v[40:43]
  s_add_u32 s32, s40, 8192
  buffer_load_dwordx4 v[96:99], v1, s[4:7], s32 offen offset:0 sc1
  s_waitcnt vmcnt(13)
  v_mfma_f32_16x16x32_bf16 v[20:23], v[224:227], v[100:103], v[20:23]
  v_mfma_f32_16x16x32_bf16 v[28:31], v[228:231], v[100:103], v[28:31]
  v_mfma_f32_16x16x32_bf16 v[36:39], v[232:235], v[100:103], v[36:39]
  v_mfma_f32_16x16x32_bf16 v[44:47], v[236:239], v[100:103], v[44:47]
  buffer_load_dwordx4 v[100:103], v1, s[4:7], s32 offen offset:1024 sc1
  s_waitcnt vmcnt(13)
  v_mfma_f32_16x16x32_bf16 v[16:19], v[240:243], v[104:107], v[16:19]
  v_mfma_f32_16x16x32_bf16 v[24:27], v[244:247], v[104:107], v[24:27]
  v_mfma_f32_16x16x32_bf16 v[32:35], v[248:251], v[104:107], v[32:35]
  v_mfma_f32_16x16x32_bf16 v[40:43], v[252:255], v[104:107], v[40:43]
  s_add_u32 s32, s40, 10240
  buffer_load_dwordx4 v[104:107], v1, s[4:7], s32 offen offset:0 sc1
  s_waitcnt vmcnt(13)
  v_mfma_f32_16x16x32_bf16 v[20:23], v[240:243], v[108:111], v[20:23]
  v_mfma_f32_16x16x32_bf16 v[28:31], v[244:247], v[108:111], v[28:31]
  v_mfma_f32_16x16x32_bf16 v[36:39], v[248:251], v[108:111], v[36:39]
  v_mfma_f32_16x16x32_bf16 v[44:47], v[252:255], v[108:111], v[44:47]
  buffer_load_dwordx4 v[108:111], v1, s[4:7], s32 offen offset:1024 sc1
  s_waitcnt vmcnt(13)
  s_waitcnt lgkmcnt(3)
  v_mfma_f32_16x16x32_bf16 v[16:19], v[48:51], v[112:115], v[16:19]
  s_waitcnt lgkmcnt(2)
  v_mfma_f32_16x16x32_bf16 v[24:27], v[52:55], v[112:115], v[24:27]
  s_waitcnt lgkmcnt(1)
  v_mfma_f32_16x16x32_bf16 v[32:35], v[56:59], v[112:115], v[32:35]
  s_waitcnt lgkmcnt(0)
  v_mfma_f32_16x16x32_bf16 v[40:43], v[60:63], v[112:115], v[40:43]
  s_add_u32 s32, s40, 49152
  buffer_load_dwordx4 v[112:115], v1, s[4:7], s32 offen offset:0 sc1
  s_waitcnt vmcnt(13)
  v_mfma_f32_16x16x32_bf16 v[20:23], v[48:51], v[116:119], v[20:23]
  v_mfma_f32_16x16x32_bf16 v[28:31], v[52:55], v[116:119], v[28:31]
  v_mfma_f32_16x16x32_bf16 v[36:39], v[56:59], v[116:119], v[36:39]
  v_mfma_f32_16x16x32_bf16 v[44:47], v[60:63], v[116:119], v[44:47]
  buffer_load_dwordx4 v[116:119], v1, s[4:7], s32 offen offset:1024 sc1
  ds_write_b128 v9, v[16:19] offset:0
  s_nop 2
  ds_write_b128 v9, v[20:23] offset:4096
  ds_write_b128 v10, v[24:27] offset:0
  ds_write_b128 v10, v[28:31] offset:4096
  ds_write_b128 v9, v[32:35] offset:128
  ds_write_b128 v9, v[36:39] offset:4224
  ds_write_b128 v10, v[40:43] offset:128
  ds_write_b128 v10, v[44:47] offset:4224
  s_waitcnt lgkmcnt(0)
  s_barrier
  ds_read_b128 v[16:19], v3 offset:0
  ds_read_b128 v[20:23], v4 offset:0
  ds_read_b128 v[24:27], v3 offset:8192
  ds_read_b128 v[28:31], v4 offset:8192
  ds_read_b128 v[32:35], v3 offset:16384
  ds_read_b128 v[36:39], v4 offset:16384
  ds_read_b128 v[40:43], v3 offset:24576
  ds_read_b128 v[44:47], v4 offset:24576
  s_waitcnt lgkmcnt(4)
  v_add_f32 v16, v16, v24
  v_add_f32 v17, v17, v25
  v_add_f32 v18, v18, v26
  v_add_f32 v19, v19, v27
  v_add_f32 v20, v20, v28
  v_add_f32 v21, v21, v29
  v_add_f32 v22, v22, v30
  v_add_f32 v23, v23, v31
  s_waitcnt lgkmcnt(0)
  s_barrier
  v_add_f32 v32, v32, v40
  v_add_f32 v33, v33, v41
  v_add_f32 v34, v34, v42
  v_add_f32 v35, v35, v43
  v_add_f32 v36, v36, v44
  v_add_f32 v37, v37, v45
  v_add_f32 v38, v38, v46
  v_add_f32 v39, v39, v47
  v_add_f32 v16, v16, v32
  v_add_f32 v17, v17, v33
  v_add_f32 v18, v18, v34
  v_add_f32 v19, v19, v35
  v_add_f32 v20, v20, v36
  v_add_f32 v21, v21, v37
  v_add_f32 v22, v22, v38
  v_add_f32 v23, v23, v39
  v_cvt_pk_bf16_f32 v12, v16, v17
  v_cvt_pk_bf16_f32 v13, v18, v19
  v_cvt_pk_bf16_f32 v14, v20, v21
  v_cvt_pk_bf16_f32 v15, v22, v23
  s_add_u32 s31, s46, 0x5800000
  s_mov_b32 s49, s45
  buffer_store_dwordx4 v[12:15], v5, s[4:7], s31 offen sc1
  s_add_u32 s29, s29, s41
  s_cmp_lt_u32 s29, 64
  s_cbranch_scc1 L_G2F_loop
  v_mov_b32 v48, 64
  s_waitcnt vmcnt(0)
  s_mov_b64 exec, 1
  buffer_store_dword v48, off, s[4:7], s42 sc1
  s_mov_b64 exec, -1
  s_branch L_exit
L_roleOP:
  s_sub_u32 s29, s27, 3
  s_lshl_b32 s29, s29, 1
  s_lshr_b32 s31, s26, 4
  s_add_u32 s29, s29, s31
  s_mov_b32 s41, 6
  s_mov_b32 s51, s29
  s_mov_b32 s12, s74
  s_mov_b32 s13, s75
  s_mov_b32 s14, 0x800000
  s_mov_b32 s15, 0x20000
  s_mov_b32 s20, s86
  s_mov_b32 s21, s87
  s_mov_b32 s22, 0x400000
  s_mov_b32 s23, 0x20000
  s_and_b32 s47, s26, 15
  s_mul_i32 s31, s24, 2097152
  s_lshl_b32 s32, s47, 7
  s_add_u32 s31, s31, s32
  v_mov_b32 v12, 0x0
  v_bfe_u32 v15, v0, 3, 3
  v_lshl_add_u32 v12, v15, 11, v12
  v_bfe_u32 v15, v0, 0, 3
  v_lshl_add_u32 v12, v15, 4, v12
  v_add_u32 v12, s31, v12
  v_bfe_u32 v15, v0, 4, 2
  v_lshlrev_b32 v15, 5, v15
  v_xor_b32 v12, v12, v15
  s_lshl_b32 s43, s24, 15
  v_mov_b32 v16, 0x0
  v_bfe_u32 v15, v0, 2, 4
  v_lshl_add_u32 v16, v15, 7, v16
  v_bfe_u32 v15, v0, 3, 2
  v_lshl_add_u32 v16, v15, 5, v16
  v_bfe_u32 v15, v0, 0, 2
  v_lshl_add_u32 v16, v15, 3, v16
  v_add_u32 v16, s43, v16
  v_xor_b32 v17, 32, v16
  v_xor_b32 v18, 64, v16
  v_xor_b32 v19, 96, v16
  v_mov_b32 v8, 0x0
  v_bfe_u32 v15, v0, 0, 6
  v_lshl_add_u32 v8, v15, 4, v8
  v_add_u32 v8, s43, v8
  s_mov_b32 s31, 0x0
  s_add_u32 m0, s43, 0
  s_nop 0
  buffer_load_dwordx4 v12, s[12:15], s31 offen lds
  s_mov_b32 s31, 0x4000
  s_add_u32 m0, s43, 1024
  s_nop 0
  buffer_load_dwordx4 v12, s[12:15], s31 offen lds
  s_mov_b32 s31, 0x8000
  s_add_u32 m0, s43, 2048
  s_nop 0
  buffer_load_dwordx4 v12, s[12:15], s31 offen lds
  s_mov_b32 s31, 0xc000
  s_add_u32 m0, s43, 3072
  s_nop 0
  buffer_load_dwordx4 v12, s[12:15], s31 offen lds
  s_mov_b32 s31, 0x10000
  s_add_u32 m0, s43, 4096
  s_nop 0
  buffer_load_dwordx4 v12, s[12:15], s31 offen lds
  s_mov_b32 s31, 0x14000
  s_add_u32 m0, s43, 5120
  s_nop 0
  buffer_load_dwordx4 v12, s[12:15], s31 offen lds
  s_mov_b32 s31, 0x18000
  s_add_u32 m0, s43, 6144
  s_nop 0
  buffer_load_dwordx4 v12, s[12:15], s31 offen lds
  s_mov_b32 s31, 0x1c000
  s_add_u32 m0, s43, 7168
  s_nop 0
  buffer_load_dwordx4 v12, s[12:15], s31 offen lds
  s_mov_b32 s31, 0x20000
  s_add_u32 m0, s43, 8192
  s_nop 0
  buffer_load_dwordx4 v12, s[12:15], s31 offen lds
  s_mov_b32 s31, 0x24000
  s_add_u32 m0, s43, 9216
  s_nop 0
  buffer_load_dwordx4 v12, s[12:15], s31 offen lds
  s_mov_b32 s31, 0x28000
  s_add_u32 m0, s43, 10240
  s_nop 0
  buffer_load_dwordx4 v12, s[12:15], s31 offen lds
  s_mov_b32 s31, 0x2c000
  s_add_u32 m0, s43, 11264
  s_nop 0
  buffer_load_dwordx4 v12, s[12:15], s31 offen lds
  s_mov_b32 s31, 0x30000
  s_add_u32 m0, s43, 12288
  s_nop 0
  buffer_load_dwordx4 v12, s[12:15], s31 offen lds
  s_mov_b32 s31, 0x34000
  s_add_u32 m0, s43, 13312
  s_nop 0
  buffer_load_dwordx4 v12, s[12:15], s31 offen lds
  s_mov_b32 s31, 0x38000
  s_add_u32 m0, s43, 14336
  s_nop 0
  buffer_load_dwordx4 v12, s[12:15], s31 offen lds
  s_mov_b32 s31, 0x3c000
  s_add_u32 m0, s43, 15360
  s_nop 0
  buffer_load_dwordx4 v12, s[12:15], s31 offen lds
  s_mov_b32 s31, 0x40000
  s_add_u32 m0, s43, 16384
  s_nop 0
  buffer_load_dwordx4 v12, s[12:15], s31 offen lds
  s_mov_b32 s31, 0x44000
  s_add_u32 m0, s43, 17408
  s_nop 0
  buffer_load_dwordx4 v12, s[12:15], s31 offen lds
  s_mov_b32 s31, 0x48000
  s_add_u32 m0, s43, 18432
  s_nop 0
  buffer_load_dwordx4 v12, s[12:15], s31 offen lds
  s_mov_b32 s31, 0x4c000
  s_add_u32 m0, s43, 19456
  s_nop 0
  buffer_load_dwordx4 v12, s[12:15], s31 offen lds
  s_mov_b32 s31, 0x50000
  s_add_u32 m0, s43, 20480
  s_nop 0
  buffer_load_dwordx4 v12, s[12:15], s31 offen lds
  s_mov_b32 s31, 0x54000
  s_add_u32 m0, s43, 21504
  s_nop 0
  buffer_load_dwordx4 v12, s[12:15], s31 offen lds
  s_mov_b32 s31, 0x58000
  s_add_u32 m0, s43, 22528
  s_nop 0
  buffer_load_dwordx4 v12, s[12:15], s31 offen lds
  s_mov_b32 s31, 0x5c000
  s_add_u32 m0, s43, 23552
  s_nop 0
  buffer_load_dwordx4 v12, s[12:15], s31 offen lds
  s_mov_b32 s31, 0x60000
  s_add_u32 m0, s43, 24576
  s_nop 0
  buffer_load_dwordx4 v12, s[12:15], s31 offen lds
  s_mov_b32 s31, 0x64000
  s_add_u32 m0, s43, 25600
  s_nop 0
  buffer_load_dwordx4 v12, s[12:15], s31 offen lds
  s_mov_b32 s31, 0x68000
  s_add_u32 m0, s43, 26624
  s_nop 0
  buffer_load_dwordx4 v12, s[12:15], s31 offen lds
  s_mov_b32 s31, 0x6c000
  s_add_u32 m0, s43, 27648
  s_nop 0
  buffer_load_dwordx4 v12, s[12:15], s31 offen lds
  s_mov_b32 s31, 0x70000
  s_add_u32 m0, s43, 28672
  s_nop 0
  buffer_load_dwordx4 v12, s[12:15], s31 offen lds
  s_mov_b32 s31, 0x74000
  s_add_u32 m0, s43, 29696
  s_nop 0
  buffer_load_dwordx4 v12, s[12:15], s31 offen lds
  s_mov_b32 s31, 0x78000
  s_add_u32 m0, s43, 30720
  s_nop 0
  buffer_load_dwordx4 v12, s[12:15], s31 offen lds
  s_mov_b32 s31, 0x7c000
  s_add_u32 m0, s43, 31744
  s_nop 0
  buffer_load_dwordx4 v12, s[12:15], s31 offen lds
  s_waitcnt vmcnt(28)
  ds_read_b64_tr_b16 a[0:1], v16 offset:0
  ds_read_b64_tr_b16 a[2:3], v16 offset:2048
  ds_read_b64_tr_b16 a[4:5], v17 offset:0
  ds_read_b64_tr_b16 a[6:7], v17 offset:2048
  ds_read_b64_tr_b16 a[8:9], v18 offset:0
  ds_read_b64_tr_b16 a[10:11], v18 offset:2048
  ds_read_b64_tr_b16 a[12:13], v19 offset:0
  ds_read_b64_tr_b16 a[14:15], v19 offset:2048
  s_waitcnt lgkmcnt(0)
  s_mov_b32 s31, 0x80000
  s_add_u32 m0, s43, 0
  s_nop 0
  buffer_load_dwordx4 v12, s[12:15], s31 offen lds
  s_mov_b32 s31, 0x84000
  s_add_u32 m0, s43, 1024
  s_nop 0
  buffer_load_dwordx4 v12, s[12:15], s31 offen lds
  s_mov_b32 s31, 0x88000
  s_add_u32 m0, s43, 2048
  s_nop 0
  buffer_load_dwordx4 v12, s[12:15], s31 offen lds
  s_mov_b32 s31, 0x8c000
  s_add_u32 m0, s43, 3072
  s_nop 0
  buffer_load_dwordx4 v12, s[12:15], s31 offen lds
  s_waitcnt vmcnt(28)
  ds_read_b64_tr_b16 a[16:17], v16 offset:4096
  ds_read_b64_tr_b16 a[18:19], v16 offset:6144
  ds_read_b64_tr_b16 a[20:21], v17 offset:4096
  ds_read_b64_tr_b16 a[22:23], v17 offset:6144
  ds_read_b64_tr_b16 a[24:25], v18 offset:4096
  ds_read_b64_tr_b16 a[26:27], v18 offset:6144
  ds_read_b64_tr_b16 a[28:29], v19 offset:4096
  ds_read_b64_tr_b16 a[30:31], v19 offset:6144
  s_waitcnt lgkmcnt(0)
  s_mov_b32 s31, 0x90000
  s_add_u32 m0, s43, 4096
  s_nop 0
  buffer_load_dwordx4 v12, s[12:15], s31 offen lds
  s_mov_b32 s31, 0x94000
  s_add_u32 m0, s43, 5120
  s_nop 0
  buffer_load_dwordx4 v12, s[12:15], s31 offen lds
  s_mov_b32 s31, 0x98000
  s_add_u32 m0, s43, 6144
  s_nop 0
  buffer_load_dwordx4 v12, s[12:15], s31 offen lds
  s_mov_b32 s31, 0x9c000
  s_add_u32 m0, s43, 7168
  s_nop 0
  buffer_load_dwordx4 v12, s[12:15], s31 offen lds
  s_waitcnt vmcnt(28)
  ds_read_b64_tr_b16 a[32:33], v16 offset:8192
  ds_read_b64_tr_b16 a[34:35], v16 offset:10240
  ds_read_b64_tr_b16 a[36:37], v17 offset:8192
  ds_read_b64_tr_b16 a[38:39], v17 offset:10240
  ds_read_b64_tr_b16 a[40:41], v18 offset:8192
  ds_read_b64_tr_b16 a[42:43], v18 offset:10240
  ds_read_b64_tr_b16 a[44:45], v19 offset:8192
  ds_read_b64_tr_b16 a[46:47], v19 offset:10240
  s_waitcnt lgkmcnt(0)
  s_mov_b32 s31, 0xa0000
  s_add_u32 m0, s43, 8192
  s_nop 0
  buffer_load_dwordx4 v12, s[12:15], s31 offen lds
  s_mov_b32 s31, 0xa4000
  s_add_u32 m0, s43, 9216
  s_nop 0
  buffer_load_dwordx4 v12, s[12:15], s31 offen lds
  s_mov_b32 s31, 0xa8000
  s_add_u32 m0, s43, 10240
  s_nop 0
  buffer_load_dwordx4 v12, s[12:15], s31 offen lds
  s_mov_b32 s31, 0xac000
  s_add_u32 m0, s43, 11264
  s_nop 0
  buffer_load_dwordx4 v12, s[12:15], s31 offen lds
  s_waitcnt vmcnt(28)
  ds_read_b64_tr_b16 a[48:49], v16 offset:12288
  ds_read_b64_tr_b16 a[50:51], v16 offset:14336
  ds_read_b64_tr_b16 a[52:53], v17 offset:12288
  ds_read_b64_tr_b16 a[54:55], v17 offset:14336
  ds_read_b64_tr_b16 a[56:57], v18 offset:12288
  ds_read_b64_tr_b16 a[58:59], v18 offset:14336
  ds_read_b64_tr_b16 a[60:61], v19 offset:12288
  ds_read_b64_tr_b16 a[62:63], v19 offset:14336
  s_waitcnt lgkmcnt(0)
  s_mov_b32 s31, 0xb0000
  s_add_u32 m0, s43, 12288
  s_nop 0
  buffer_load_dwordx4 v12, s[12:15], s31 offen lds
  s_mov_b32 s31, 0xb4000
  s_add_u32 m0, s43, 13312
  s_nop 0
  buffer_load_dwordx4 v12, s[12:15], s31 offen lds
  s_mov_b32 s31, 0xb8000
  s_add_u32 m0, s43, 14336
  s_nop 0
  buffer_load_dwordx4 v12, s[12:15], s31 offen lds
  s_mov_b32 s31, 0xbc000
  s_add_u32 m0, s43, 15360
  s_nop 0
  buffer_load_dwordx4 v12, s[12:15], s31 offen lds
  s_waitcnt vmcnt(28)
  ds_read_b64_tr_b16 a[64:65], v16 offset:16384
  ds_read_b64_tr_b16 a[66:67], v16 offset:18432
  ds_read_b64_tr_b16 a[68:69], v17 offset:16384
  ds_read_b64_tr_b16 a[70:71], v17 offset:18432
  ds_read_b64_tr_b16 a[72:73], v18 offset:16384
  ds_read_b64_tr_b16 a[74:75], v18 offset:18432
  ds_read_b64_tr_b16 a[76:77], v19 offset:16384
  ds_read_b64_tr_b16 a[78:79], v19 offset:18432
  s_waitcnt lgkmcnt(0)
  s_mov_b32 s31, 0xc0000
  s_add_u32 m0, s43, 16384
  s_nop 0
  buffer_load_dwordx4 v12, s[12:15], s31 offen lds
  s_mov_b32 s31, 0xc4000
  s_add_u32 m0, s43, 17408
  s_nop 0
  buffer_load_dwordx4 v12, s[12:15], s31 offen lds
  s_mov_b32 s31, 0xc8000
  s_add_u32 m0, s43, 18432
  s_nop 0
  buffer_load_dwordx4 v12, s[12:15], s31 offen lds
  s_mov_b32 s31, 0xcc000
  s_add_u32 m0, s43, 19456
  s_nop 0
  buffer_load_dwordx4 v12, s[12:15], s31 offen lds
  s_waitcnt vmcnt(28)
  ds_read_b64_tr_b16 a[80:81], v16 offset:20480
  ds_read_b64_tr_b16 a[82:83], v16 offset:22528
  ds_read_b64_tr_b16 a[84:85], v17 offset:20480
  ds_read_b64_tr_b16 a[86:87], v17 offset:22528
  ds_read_b64_tr_b16 a[88:89], v18 offset:20480
  ds_read_b64_tr_b16 a[90:91], v18 offset:22528
  ds_read_b64_tr_b16 a[92:93], v19 offset:20480
  ds_read_b64_tr_b16 a[94:95], v19 offset:22528
  s_waitcnt lgkmcnt(0)
  s_mov_b32 s31, 0xd0000
  s_add_u32 m0, s43, 20480
  s_nop 0
  buffer_load_dwordx4 v12, s[12:15], s31 offen lds
  s_mov_b32 s31, 0xd4000
  s_add_u32 m0, s43, 21504
  s_nop 0
  buffer_load_dwordx4 v12, s[12:15], s31 offen lds
  s_mov_b32 s31, 0xd8000
  s_add_u32 m0, s43, 22528
  s_nop 0
  buffer_load_dwordx4 v12, s[12:15], s31 offen lds
  s_mov_b32 s31, 0xdc000
  s_add_u32 m0, s43, 23552
  s_nop 0
  buffer_load_dwordx4 v12, s[12:15], s31 offen lds
  s_waitcnt vmcnt(28)
  ds_read_b64_tr_b16 a[96:97], v16 offset:24576
  ds_read_b64_tr_b16 a[98:99], v16 offset:26624
  ds_read_b64_tr_b16 a[100:101], v17 offset:24576
  ds_read_b64_tr_b16 a[102:103], v17 offset:26624
  ds_read_b64_tr_b16 a[104:105], v18 offset:24576
  ds_read_b64_tr_b16 a[106:107], v18 offset:26624
  ds_read_b64_tr_b16 a[108:109], v19 offset:24576
  ds_read_b64_tr_b16 a[110:111], v19 offset:26624
  s_waitcnt lgkmcnt(0)
  s_mov_b32 s31, 0xe0000
  s_add_u32 m0, s43, 24576
  s_nop 0
  buffer_load_dwordx4 v12, s[12:15], s31 offen lds
  s_mov_b32 s31, 0xe4000
  s_add_u32 m0, s43, 25600
  s_nop 0
  buffer_load_dwordx4 v12, s[12:15], s31 offen lds
  s_mov_b32 s31, 0xe8000
  s_add_u32 m0, s43, 26624
  s_nop 0
  buffer_load_dwordx4 v12, s[12:15], s31 offen lds
  s_mov_b32 s31, 0xec000
  s_add_u32 m0, s43, 27648
  s_nop 0
  buffer_load_dwordx4 v12, s[12:15], s31 offen lds
  s_waitcnt vmcnt(28)
  ds_read_b64_tr_b16 a[112:113], v16 offset:28672
  ds_read_b64_tr_b16 a[114:115], v16 offset:30720
  ds_read_b64_tr_b16 a[116:117], v17 offset:28672
  ds_read_b64_tr_b16 a[118:119], v17 offset:30720
  ds_read_b64_tr_b16 a[120:121], v18 offset:28672
  ds_read_b64_tr_b16 a[122:123], v18 offset:30720
  ds_read_b64_tr_b16 a[124:125], v19 offset:28672
  ds_read_b64_tr_b16 a[126:127], v19 offset:30720
  s_waitcnt lgkmcnt(0)
  s_mov_b32 s31, 0xf0000
  s_add_u32 m0, s43, 28672
  s_nop 0
  buffer_load_dwordx4 v12, s[12:15], s31 offen lds
  s_mov_b32 s31, 0xf4000
  s_add_u32 m0, s43, 29696
  s_nop 0
  buffer_load_dwordx4 v12, s[12:15], s31 offen lds
  s_mov_b32 s31, 0xf8000
  s_add_u32 m0, s43, 30720
  s_nop 0
  buffer_load_dwordx4 v12, s[12:15], s31 offen lds
  s_mov_b32 s31, 0xfc000
  s_add_u32 m0, s43, 31744
  s_nop 0
  buffer_load_dwordx4 v12, s[12:15], s31 offen lds
  s_waitcnt vmcnt(28)
  ds_read_b64_tr_b16 a[128:129], v16 offset:0
  ds_read_b64_tr_b16 a[130:131], v16 offset:2048
  ds_read_b64_tr_b16 a[132:133], v17 offset:0
  ds_read_b64_tr_b16 a[134:135], v17 offset:2048
  ds_read_b64_tr_b16 a[136:137], v18 offset:0
  ds_read_b64_tr_b16 a[138:139], v18 offset:2048
  ds_read_b64_tr_b16 a[140:141], v19 offset:0
  ds_read_b64_tr_b16 a[142:143], v19 offset:2048
  s_waitcnt lgkmcnt(0)
  s_mov_b32 s31, 0x100000
  s_add_u32 m0, s43, 0
  s_nop 0
  buffer_load_dwordx4 v12, s[12:15], s31 offen lds
  s_mov_b32 s31, 0x104000
  s_add_u32 m0, s43, 1024
  s_nop 0
  buffer_load_dwordx4 v12, s[12:15], s31 offen lds
  s_mov_b32 s31, 0x108000
  s_add_u32 m0, s43, 2048
  s_nop 0
  buffer_load_dwordx4 v12, s[12:15], s31 offen lds
  s_mov_b32 s31, 0x10c000
  s_add_u32 m0, s43, 3072
  s_nop 0
  buffer_load_dwordx4 v12, s[12:15], s31 offen lds
  s_waitcnt vmcnt(28)
  ds_read_b64_tr_b16 a[144:145], v16 offset:4096
  ds_read_b64_tr_b16 a[146:147], v16 offset:6144
  ds_read_b64_tr_b16 a[148:149], v17 offset:4096
  ds_read_b64_tr_b16 a[150:151], v17 offset:6144
  ds_read_b64_tr_b16 a[152:153], v18 offset:4096
  ds_read_b64_tr_b16 a[154:155], v18 offset:6144
  ds_read_b64_tr_b16 a[156:157], v19 offset:4096
  ds_read_b64_tr_b16 a[158:159], v19 offset:6144
  s_waitcnt lgkmcnt(0)
  s_mov_b32 s31, 0x110000
  s_add_u32 m0, s43, 4096
  s_nop 0
  buffer_load_dwordx4 v12, s[12:15], s31 offen lds
  s_mov_b32 s31, 0x114000
  s_add_u32 m0, s43, 5120
  s_nop 0
  buffer_load_dwordx4 v12, s[12:15], s31 offen lds
  s_mov_b32 s31, 0x118000
  s_add_u32 m0, s43, 6144
  s_nop 0
  buffer_load_dwordx4 v12, s[12:15], s31 offen lds
  s_mov_b32 s31, 0x11c000
  s_add_u32 m0, s43, 7168
  s_nop 0
  buffer_load_dwordx4 v12, s[12:15], s31 offen lds
  s_waitcnt vmcnt(28)
  ds_read_b64_tr_b16 a[160:161], v16 offset:8192
  ds_read_b64_tr_b16 a[162:163], v16 offset:10240
  ds_read_b64_tr_b16 a[164:165], v17 offset:8192
  ds_read_b64_tr_b16 a[166:167], v17 offset:10240
  ds_read_b64_tr_b16 a[168:169], v18 offset:8192
  ds_read_b64_tr_b16 a[170:171], v18 offset:10240
  ds_read_b64_tr_b16 a[172:173], v19 offset:8192
  ds_read_b64_tr_b16 a[174:175], v19 offset:10240
  s_waitcnt lgkmcnt(0)
  s_mov_b32 s31, 0x120000
  s_add_u32 m0, s43, 8192
  s_nop 0
  buffer_load_dwordx4 v12, s[12:15], s31 offen lds
  s_mov_b32 s31, 0x124000
  s_add_u32 m0, s43, 9216
  s_nop 0
  buffer_load_dwordx4 v12, s[12:15], s31 offen lds
  s_mov_b32 s31, 0x128000
  s_add_u32 m0, s43, 10240
  s_nop 0
  buffer_load_dwordx4 v12, s[12:15], s31 offen lds
  s_mov_b32 s31, 0x12c000
  s_add_u32 m0, s43, 11264
  s_nop 0
  buffer_load_dwordx4 v12, s[12:15], s31 offen lds
  s_waitcnt vmcnt(28)
  ds_read_b64_tr_b16 a[176:177], v16 offset:12288
  ds_read_b64_tr_b16 a[178:179], v16 offset:14336
  ds_read_b64_tr_b16 a[180:181], v17 offset:12288
  ds_read_b64_tr_b16 a[182:183], v17 offset:14336
  ds_read_b64_tr_b16 a[184:185], v18 offset:12288
  ds_read_b64_tr_b16 a[186:187], v18 offset:14336
  ds_read_b64_tr_b16 a[188:189], v19 offset:12288
  ds_read_b64_tr_b16 a[190:191], v19 offset:14336
  s_waitcnt lgkmcnt(0)
  s_mov_b32 s31, 0x130000
  s_add_u32 m0, s43, 12288
  s_nop 0
  buffer_load_dwordx4 v12, s[12:15], s31 offen lds
  s_mov_b32 s31, 0x134000
  s_add_u32 m0, s43, 13312
  s_nop 0
  buffer_load_dwordx4 v12, s[12:15], s31 offen lds
  s_mov_b32 s31, 0x138000
  s_add_u32 m0, s43, 14336
  s_nop 0
  buffer_load_dwordx4 v12, s[12:15], s31 offen lds
  s_mov_b32 s31, 0x13c000
  s_add_u32 m0, s43, 15360
  s_nop 0
  buffer_load_dwordx4 v12, s[12:15], s31 offen lds
  s_waitcnt vmcnt(28)
  ds_read_b64_tr_b16 a[192:193], v16 offset:16384
  ds_read_b64_tr_b16 a[194:195], v16 offset:18432
  ds_read_b64_tr_b16 a[196:197], v17 offset:16384
  ds_read_b64_tr_b16 a[198:199], v17 offset:18432
  ds_read_b64_tr_b16 a[200:201], v18 offset:16384
  ds_read_b64_tr_b16 a[202:203], v18 offset:18432
  ds_read_b64_tr_b16 a[204:205], v19 offset:16384
  ds_read_b64_tr_b16 a[206:207], v19 offset:18432
  s_waitcnt lgkmcnt(0)
  s_mov_b32 s31, 0x140000
  s_add_u32 m0, s43, 16384
  s_nop 0
  buffer_load_dwordx4 v12, s[12:15], s31 offen lds
  s_mov_b32 s31, 0x144000
  s_add_u32 m0, s43, 17408
  s_nop 0
  buffer_load_dwordx4 v12, s[12:15], s31 offen lds
  s_mov_b32 s31, 0x148000
  s_add_u32 m0, s43, 18432
  s_nop 0
  buffer_load_dwordx4 v12, s[12:15], s31 offen lds
  s_mov_b32 s31, 0x14c000
  s_add_u32 m0, s43, 19456
  s_nop 0
  buffer_load_dwordx4 v12, s[12:15], s31 offen lds
  s_waitcnt vmcnt(28)
  ds_read_b64_tr_b16 a[208:209], v16 offset:20480
  ds_read_b64_tr_b16 a[210:211], v16 offset:22528
  ds_read_b64_tr_b16 a[212:213], v17 offset:20480
  ds_read_b64_tr_b16 a[214:215], v17 offset:22528
  ds_read_b64_tr_b16 a[216:217], v18 offset:20480
  ds_read_b64_tr_b16 a[218:219], v18 offset:22528
  ds_read_b64_tr_b16 a[220:221], v19 offset:20480
  ds_read_b64_tr_b16 a[222:223], v19 offset:22528
  s_waitcnt lgkmcnt(0)
  s_mov_b32 s31, 0x150000
  s_add_u32 m0, s43, 20480
  s_nop 0
  buffer_load_dwordx4 v12, s[12:15], s31 offen lds
  s_mov_b32 s31, 0x154000
  s_add_u32 m0, s43, 21504
  s_nop 0
  buffer_load_dwordx4 v12, s[12:15], s31 offen lds
  s_mov_b32 s31, 0x158000
  s_add_u32 m0, s43, 22528
  s_nop 0
  buffer_load_dwordx4 v12, s[12:15], s31 offen lds
  s_mov_b32 s31, 0x15c000
  s_add_u32 m0, s43, 23552
  s_nop 0
  buffer_load_dwordx4 v12, s[12:15], s31 offen lds
  s_waitcnt vmcnt(28)
  ds_read_b64_tr_b16 a[224:225], v16 offset:24576
  ds_read_b64_tr_b16 a[226:227], v16 offset:26624
  ds_read_b64_tr_b16 a[228:229], v17 offset:24576
  ds_read_b64_tr_b16 a[230:231], v17 offset:26624
  ds_read_b64_tr_b16 a[232:233], v18 offset:24576
  ds_read_b64_tr_b16 a[234:235], v18 offset:26624
  ds_read_b64_tr_b16 a[236:237], v19 offset:24576
  ds_read_b64_tr_b16 a[238:239], v19 offset:26624
  s_waitcnt lgkmcnt(0)
  s_mov_b32 s31, 0x160000
  s_add_u32 m0, s43, 24576
  s_nop 0
  buffer_load_dwordx4 v12, s[12:15], s31 offen lds
  s_mov_b32 s31, 0x164000
  s_add_u32 m0, s43, 25600
  s_nop 0
  buffer_load_dwordx4 v12, s[12:15], s31 offen lds
  s_mov_b32 s31, 0x168000
  s_add_u32 m0, s43, 26624
  s_nop 0
  buffer_load_dwordx4 v12, s[12:15], s31 offen lds
  s_mov_b32 s31, 0x16c000
  s_add_u32 m0, s43, 27648
  s_nop 0
  buffer_load_dwordx4 v12, s[12:15], s31 offen lds
  s_waitcnt vmcnt(28)
  ds_read_b64_tr_b16 a[240:241], v16 offset:28672
  ds_read_b64_tr_b16 a[242:243], v16 offset:30720
  ds_read_b64_tr_b16 a[244:245], v17 offset:28672
  ds_read_b64_tr_b16 a[246:247], v17 offset:30720
  ds_read_b64_tr_b16 a[248:249], v18 offset:28672
  ds_read_b64_tr_b16 a[250:251], v18 offset:30720
  ds_read_b64_tr_b16 a[252:253], v19 offset:28672
  ds_read_b64_tr_b16 a[254:255], v19 offset:30720
  s_waitcnt lgkmcnt(0)
  s_mov_b32 s31, 0x170000
  s_add_u32 m0, s43, 28672
  s_nop 0
  buffer_load_dwordx4 v12, s[12:15], s31 offen lds
  s_mov_b32 s31, 0x174000
  s_add_u32 m0, s43, 29696
  s_nop 0
  buffer_load_dwordx4 v12, s[12:15], s31 offen lds
  s_mov_b32 s31, 0x178000
  s_add_u32 m0, s43, 30720
  s_nop 0
  buffer_load_dwordx4 v12, s[12:15], s31 offen lds
  s_mov_b32 s31, 0x17c000
  s_add_u32 m0, s43, 31744
  s_nop 0
  buffer_load_dwordx4 v12, s[12:15], s31 offen lds
  s_waitcnt vmcnt(28)
  ds_read_b64_tr_b16 v[128:129], v16 offset:0
  ds_read_b64_tr_b16 v[130:131], v16 offset:2048
  ds_read_b64_tr_b16 v[132:133], v17 offset:0
  ds_read_b64_tr_b16 v[134:135], v17 offset:2048
  ds_read_b64_tr_b16 v[136:137], v18 offset:0
  ds_read_b64_tr_b16 v[138:139], v18 offset:2048
  ds_read_b64_tr_b16 v[140:141], v19 offset:0
  ds_read_b64_tr_b16 v[142:143], v19 offset:2048
  s_waitcnt lgkmcnt(0)
  s_mov_b32 s31, 0x180000
  s_add_u32 m0, s43, 0
  s_nop 0
  buffer_load_dwordx4 v12, s[12:15], s31 offen lds
  s_mov_b32 s31, 0x184000
  s_add_u32 m0, s43, 1024
  s_nop 0
  buffer_load_dwordx4 v12, s[12:15], s31 offen lds
  s_mov_b32 s31, 0x188000
  s_add_u32 m0, s43, 2048
  s_nop 0
  buffer_load_dwordx4 v12, s[12:15], s31 offen lds
  s_mov_b32 s31, 0x18c000
  s_add_u32 m0, s43, 3072
  s_nop 0
  buffer_load_dwordx4 v12, s[12:15], s31 offen lds
  s_waitcnt vmcnt(28)
  ds_read_b64_tr_b16 v[144:145], v16 offset:4096
  ds_read_b64_tr_b16 v[146:147], v16 offset:6144
  ds_read_b64_tr_b16 v[148:149], v17 offset:4096
  ds_read_b64_tr_b16 v[150:151], v17 offset:6144
  ds_read_b64_tr_b16 v[152:153], v18 offset:4096
  ds_read_b64_tr_b16 v[154:155], v18 offset:6144
  ds_read_b64_tr_b16 v[156:157], v19 offset:4096
  ds_read_b64_tr_b16 v[158:159], v19 offset:6144
  s_waitcnt lgkmcnt(0)
  s_mov_b32 s31, 0x190000
  s_add_u32 m0, s43, 4096
  s_nop 0
  buffer_load_dwordx4 v12, s[12:15], s31 offen lds
  s_mov_b32 s31, 0x194000
  s_add_u32 m0, s43, 5120
  s_nop 0
  buffer_load_dwordx4 v12, s[12:15], s31 offen lds
  s_mov_b32 s31, 0x198000
  s_add_u32 m0, s43, 6144
  s_nop 0
  buffer_load_dwordx4 v12, s[12:15], s31 offen lds
  s_mov_b32 s31, 0x19c000
  s_add_u32 m0, s43, 7168
  s_nop 0
  buffer_load_dwordx4 v12, s[12:15], s31 offen lds
  s_waitcnt vmcnt(28)
  ds_read_b64_tr_b16 v[160:161], v16 offset:8192
  ds_read_b64_tr_b16 v[162:163], v16 offset:10240
  ds_read_b64_tr_b16 v[164:165], v17 offset:8192
  ds_read_b64_tr_b16 v[166:167], v17 offset:10240
  ds_read_b64_tr_b16 v[168:169], v18 offset:8192
  ds_read_b64_tr_b16 v[170:171], v18 offset:10240
  ds_read_b64_tr_b16 v[172:173], v19 offset:8192
  ds_read_b64_tr_b16 v[174:175], v19 offset:10240
  s_waitcnt lgkmcnt(0)
  s_mov_b32 s31, 0x1a0000
  s_add_u32 m0, s43, 8192
  s_nop 0
  buffer_load_dwordx4 v12, s[12:15], s31 offen lds
  s_mov_b32 s31, 0x1a4000
  s_add_u32 m0, s43, 9216
  s_nop 0
  buffer_load_dwordx4 v12, s[12:15], s31 offen lds
  s_mov_b32 s31, 0x1a8000
  s_add_u32 m0, s43, 10240
  s_nop 0
  buffer_load_dwordx4 v12, s[12:15], s31 offen lds
  s_mov_b32 s31, 0x1ac000
  s_add_u32 m0, s43, 11264
  s_nop 0
  buffer_load_dwordx4 v12, s[12:15], s31 offen lds
  s_waitcnt vmcnt(28)
  ds_read_b64_tr_b16 v[176:177], v16 offset:12288
  ds_read_b64_tr_b16 v[178:179], v16 offset:14336
  ds_read_b64_tr_b16 v[180:181], v17 offset:12288
  ds_read_b64_tr_b16 v[182:183], v17 offset:14336
  ds_read_b64_tr_b16 v[184:185], v18 offset:12288
  ds_read_b64_tr_b16 v[186:187], v18 offset:14336
  ds_read_b64_tr_b16 v[188:189], v19 offset:12288
  ds_read_b64_tr_b16 v[190:191], v19 offset:14336
  s_waitcnt lgkmcnt(0)
  s_mov_b32 s31, 0x1b0000
  s_add_u32 m0, s43, 12288
  s_nop 0
  buffer_load_dwordx4 v12, s[12:15], s31 offen lds
  s_mov_b32 s31, 0x1b4000
  s_add_u32 m0, s43, 13312
  s_nop 0
  buffer_load_dwordx4 v12, s[12:15], s31 offen lds
  s_mov_b32 s31, 0x1b8000
  s_add_u32 m0, s43, 14336
  s_nop 0
  buffer_load_dwordx4 v12, s[12:15], s31 offen lds
  s_mov_b32 s31, 0x1bc000
  s_add_u32 m0, s43, 15360
  s_nop 0
  buffer_load_dwordx4 v12, s[12:15], s31 offen lds
  s_waitcnt vmcnt(28)
  ds_read_b64_tr_b16 v[192:193], v16 offset:16384
  ds_read_b64_tr_b16 v[194:195], v16 offset:18432
  ds_read_b64_tr_b16 v[196:197], v17 offset:16384
  ds_read_b64_tr_b16 v[198:199], v17 offset:18432
  ds_read_b64_tr_b16 v[200:201], v18 offset:16384
  ds_read_b64_tr_b16 v[202:203], v18 offset:18432
  ds_read_b64_tr_b16 v[204:205], v19 offset:16384
  ds_read_b64_tr_b16 v[206:207], v19 offset:18432
  s_waitcnt lgkmcnt(0)
  s_mov_b32 s31, 0x1c0000
  s_add_u32 m0, s43, 16384
  s_nop 0
  buffer_load_dwordx4 v12, s[12:15], s31 offen lds
  s_mov_b32 s31, 0x1c4000
  s_add_u32 m0, s43, 17408
  s_nop 0
  buffer_load_dwordx4 v12, s[12:15], s31 offen lds
  s_mov_b32 s31, 0x1c8000
  s_add_u32 m0, s43, 18432
  s_nop 0
  buffer_load_dwordx4 v12, s[12:15], s31 offen lds
  s_mov_b32 s31, 0x1cc000
  s_add_u32 m0, s43, 19456
  s_nop 0
  buffer_load_dwordx4 v12, s[12:15], s31 offen lds
  s_waitcnt vmcnt(28)
  ds_read_b64_tr_b16 v[208:209], v16 offset:20480
  ds_read_b64_tr_b16 v[210:211], v16 offset:22528
  ds_read_b64_tr_b16 v[212:213], v17 offset:20480
  ds_read_b64_tr_b16 v[214:215], v17 offset:22528
  ds_read_b64_tr_b16 v[216:217], v18 offset:20480
  ds_read_b64_tr_b16 v[218:219], v18 offset:22528
  ds_read_b64_tr_b16 v[220:221], v19 offset:20480
  ds_read_b64_tr_b16 v[222:223], v19 offset:22528
  s_waitcnt lgkmcnt(0)
  s_mov_b32 s31, 0x1d0000
  s_add_u32 m0, s43, 20480
  s_nop 0
  buffer_load_dwordx4 v12, s[12:15], s31 offen lds
  s_mov_b32 s31, 0x1d4000
  s_add_u32 m0, s43, 21504
  s_nop 0
  buffer_load_dwordx4 v12, s[12:15], s31 offen lds
  s_mov_b32 s31, 0x1d8000
  s_add_u32 m0, s43, 22528
  s_nop 0
  buffer_load_dwordx4 v12, s[12:15], s31 offen lds
  s_mov_b32 s31, 0x1dc000
  s_add_u32 m0, s43, 23552
  s_nop 0
  buffer_load_dwordx4 v12, s[12:15], s31 offen lds
  s_waitcnt vmcnt(28)
  ds_read_b64_tr_b16 v[224:225], v16 offset:24576
  ds_read_b64_tr_b16 v[226:227], v16 offset:26624
  ds_read_b64_tr_b16 v[228:229], v17 offset:24576
  ds_read_b64_tr_b16 v[230:231], v17 offset:26624
  ds_read_b64_tr_b16 v[232:233], v18 offset:24576
  ds_read_b64_tr_b16 v[234:235], v18 offset:26624
  ds_read_b64_tr_b16 v[236:237], v19 offset:24576
  ds_read_b64_tr_b16 v[238:239], v19 offset:26624
  s_waitcnt lgkmcnt(0)
  s_mov_b32 s31, 0x1e0000
  s_add_u32 m0, s43, 24576
  s_nop 0
  buffer_load_dwordx4 v12, s[12:15], s31 offen lds
  s_mov_b32 s31, 0x1e4000
  s_add_u32 m0, s43, 25600
  s_nop 0
  buffer_load_dwordx4 v12, s[12:15], s31 offen lds
  s_mov_b32 s31, 0x1e8000
  s_add_u32 m0, s43, 26624
  s_nop 0
  buffer_load_dwordx4 v12, s[12:15], s31 offen lds
  s_mov_b32 s31, 0x1ec000
  s_add_u32 m0, s43, 27648
  s_nop 0
  buffer_load_dwordx4 v12, s[12:15], s31 offen lds
  s_waitcnt vmcnt(28)
  ds_read_b64_tr_b16 v[240:241], v16 offset:28672
  ds_read_b64_tr_b16 v[242:243], v16 offset:30720
  ds_read_b64_tr_b16 v[244:245], v17 offset:28672
  ds_read_b64_tr_b16 v[246:247], v17 offset:30720
  ds_read_b64_tr_b16 v[248:249], v18 offset:28672
  ds_read_b64_tr_b16 v[250:251], v18 offset:30720
  ds_read_b64_tr_b16 v[252:253], v19 offset:28672
  ds_read_b64_tr_b16 v[254:255], v19 offset:30720
  s_waitcnt lgkmcnt(0)
  s_mov_b32 s31, 0x1f0000
  s_add_u32 m0, s43, 28672
  s_nop 0
  buffer_load_dwordx4 v12, s[12:15], s31 offen lds
  s_mov_b32 s31, 0x1f4000
  s_add_u32 m0, s43, 29696
  s_nop 0
  buffer_load_dwordx4 v12, s[12:15], s31 offen lds
  s_mov_b32 s31, 0x1f8000
  s_add_u32 m0, s43, 30720
  s_nop 0
  buffer_load_dwordx4 v12, s[12:15], s31 offen lds
  s_mov_b32 s31, 0x1fc000
  s_add_u32 m0, s43, 31744
  s_nop 0
  buffer_load_dwordx4 v12, s[12:15], s31 offen lds
  s_waitcnt vmcnt(28)
  ds_read_b64_tr_b16 v[48:49], v16 offset:0
  ds_read_b64_tr_b16 v[50:51], v16 offset:2048
  ds_read_b64_tr_b16 v[52:53], v17 offset:0
  ds_read_b64_tr_b16 v[54:55], v17 offset:2048
  ds_read_b64_tr_b16 v[56:57], v18 offset:0
  ds_read_b64_tr_b16 v[58:59], v18 offset:2048
  ds_read_b64_tr_b16 v[60:61], v19 offset:0
  ds_read_b64_tr_b16 v[62:63], v19 offset:2048
  s_waitcnt lgkmcnt(0)
  ds_write_b128 v8, v[48:51] offset:0
  ds_write_b128 v8, v[52:55] offset:1024
  ds_write_b128 v8, v[56:59] offset:2048
  ds_write_b128 v8, v[60:63] offset:3072
  s_waitcnt lgkmcnt(0)
  s_waitcnt vmcnt(24)
  ds_read_b64_tr_b16 v[48:49], v16 offset:4096
  ds_read_b64_tr_b16 v[50:51], v16 offset:6144
  ds_read_b64_tr_b16 v[52:53], v17 offset:4096
  ds_read_b64_tr_b16 v[54:55], v17 offset:6144
  ds_read_b64_tr_b16 v[56:57], v18 offset:4096
  ds_read_b64_tr_b16 v[58:59], v18 offset:6144
  ds_read_b64_tr_b16 v[60:61], v19 offset:4096
  ds_read_b64_tr_b16 v[62:63], v19 offset:6144
  s_waitcnt lgkmcnt(0)
  ds_write_b128 v8, v[48:51] offset:4096
  ds_write_b128 v8, v[52:55] offset:5120
  ds_write_b128 v8, v[56:59] offset:6144
  ds_write_b128 v8, v[60:63] offset:7168
  s_waitcnt lgkmcnt(0)
  s_waitcnt vmcnt(20)
  ds_read_b64_tr_b16 v[48:49], v16 offset:8192
  ds_read_b64_tr_b16 v[50:51], v16 offset:10240
  ds_read_b64_tr_b16 v[52:53], v17 offset:8192
  ds_read_b64_tr_b16 v[54:55], v17 offset:10240
  ds_read_b64_tr_b16 v[56:57], v18 offset:8192
  ds_read_b64_tr_b16 v[58:59], v18 offset:10240
  ds_read_b64_tr_b16 v[60:61], v19 offset:8192
  ds_read_b64_tr_b16 v[62:63], v19 offset:10240
  s_waitcnt lgkmcnt(0)
  ds_write_b128 v8, v[48:51] offset:8192
  ds_write_b128 v8, v[52:55] offset:9216
  ds_write_b128 v8, v[56:59] offset:10240
  ds_write_b128 v8, v[60:63] offset:11264
  s_waitcnt lgkmcnt(0)
  s_waitcnt vmcnt(16)
  ds_read_b64_tr_b16 v[48:49], v16 offset:12288
  ds_read_b64_tr_b16 v[50:51], v16 offset:14336
  ds_read_b64_tr_b16 v[52:53], v17 offset:12288
  ds_read_b64_tr_b16 v[54:55], v17 offset:14336
  ds_read_b64_tr_b16 v[56:57], v18 offset:12288
  ds_read_b64_tr_b16 v[58:59], v18 offset:14336
  ds_read_b64_tr_b16 v[60:61], v19 offset:12288
  ds_read_b64_tr_b16 v[62:63], v19 offset:14336
  s_waitcnt lgkmcnt(0)
  ds_write_b128 v8, v[48:51] offset:12288
  ds_write_b128 v8, v[52:55] offset:13312
  ds_write_b128 v8, v[56:59] offset:14336
  ds_write_b128 v8, v[60:63] offset:15360
  s_waitcnt lgkmcnt(0)
  s_waitcnt vmcnt(12)
  ds_read_b64_tr_b16 v[48:49], v16 offset:16384
  ds_read_b64_tr_b16 v[50:51], v16 offset:18432
  ds_read_b64_tr_b16 v[52:53], v17 offset:16384
  ds_read_b64_tr_b16 v[54:55], v17 offset:18432
  ds_read_b64_tr_b16 v[56:57], v18 offset:16384
  ds_read_b64_tr_b16 v[58:59], v18 offset:18432
  ds_read_b64_tr_b16 v[60:61], v19 offset:16384
  ds_read_b64_tr_b16 v[62:63], v19 offset:18432
  s_waitcnt lgkmcnt(0)
  ds_write_b128 v8, v[48:51] offset:16384
  ds_write_b128 v8, v[52:55] offset:17408
  ds_write_b128 v8, v[56:59] offset:18432
  ds_write_b128 v8, v[60:63] offset:19456
  s_waitcnt lgkmcnt(0)
  s_waitcnt vmcnt(8)
  ds_read_b64_tr_b16 v[48:49], v16 offset:20480
  ds_read_b64_tr_b16 v[50:51], v16 offset:22528
  ds_read_b64_tr_b16 v[52:53], v17 offset:20480
  ds_read_b64_tr_b16 v[54:55], v17 offset:22528
  ds_read_b64_tr_b16 v[56:57], v18 offset:20480
  ds_read_b64_tr_b16 v[58:59], v18 offset:22528
  ds_read_b64_tr_b16 v[60:61], v19 offset:20480
  ds_read_b64_tr_b16 v[62:63], v19 offset:22528
  s_waitcnt lgkmcnt(0)
  ds_write_b128 v8, v[48:51] offset:20480
  ds_write_b128 v8, v[52:55] offset:21504
  ds_write_b128 v8, v[56:59] offset:22528
  ds_write_b128 v8, v[60:63] offset:23552
  s_waitcnt lgkmcnt(0)
  s_waitcnt vmcnt(4)
  ds_read_b64_tr_b16 v[48:49], v16 offset:24576
  ds_read_b64_tr_b16 v[50:51], v16 offset:26624
  ds_read_b64_tr_b16 v[52:53], v17 offset:24576
  ds_read_b64_tr_b16 v[54:55], v17 offset:26624
  ds_read_b64_tr_b16 v[56:57], v18 offset:24576
  ds_read_b64_tr_b16 v[58:59], v18 offset:26624
  ds_read_b64_tr_b16 v[60:61], v19 offset:24576
  ds_read_b64_tr_b16 v[62:63], v19 offset:26624
  s_waitcnt lgkmcnt(0)
  ds_write_b128 v8, v[48:51] offset:24576
  ds_write_b128 v8, v[52:55] offset:25600
  ds_write_b128 v8, v[56:59] offset:26624
  ds_write_b128 v8, v[60:63] offset:27648
  s_waitcnt lgkmcnt(0)
  s_waitcnt vmcnt(0)
  ds_read_b64_tr_b16 v[48:49], v16 offset:28672
  ds_read_b64_tr_b16 v[50:51], v16 offset:30720
  ds_read_b64_tr_b16 v[52:53], v17 offset:28672
  ds_read_b64_tr_b16 v[54:55], v17 offset:30720
  ds_read_b64_tr_b16 v[56:57], v18 offset:28672
  ds_read_b64_tr_b16 v[58:59], v18 offset:30720
  ds_read_b64_tr_b16 v[60:61], v19 offset:28672
  ds_read_b64_tr_b16 v[62:63], v19 offset:30720
  s_waitcnt lgkmcnt(0)
  ds_write_b128 v8, v[48:51] offset:28672
  ds_write_b128 v8, v[52:55] offset:29696
  ds_write_b128 v8, v[56:59] offset:30720
  ds_write_b128 v8, v[60:63] offset:31744
  s_waitcnt lgkmcnt(0)
  s_mul_i32 s31, s24, 4194304
  v_mov_b32 v1, 0x0
  v_bfe_u32 v15, v0, 0, 6
  v_lshl_add_u32 v1, v15, 4, v1
  v_add_u32 v1, s31, v1
  v_lshrrev_b32 v15, 4, v0
  v_and_b32 v9, 7, v0
  v_xor_b32 v15, v15, v9
  v_lshlrev_b32 v15, 4, v15
  v_and_b32 v9, 15, v0
  v_lshl_add_u32 v9, v9, 8, v15
  s_lshl_b32 s31, s24, 13
  s_add_u32 s31, s31, 131072
  v_add_u32 v9, s31, v9
  v_xor_b32 v10, 64, v9
  v_lshrrev_b32 v3, 3, v0
  v_and_b32 v15, 7, v0
  v_lshlrev_b32 v15, 1, v15
  v_xor_b32 v15, v15, v3
  v_lshlrev_b32 v15, 4, v15
  v_lshl_add_u32 v3, v3, 8, v15
  s_lshl_b32 s31, s24, 11
  s_add_u32 s31, s31, 131072
  v_add_u32 v3, s31, v3
  v_xor_b32 v4, 16, v3
  s_lshl_b32 s31, s47, 12
  s_lshl_b32 s32, s24, 10
  s_add_u32 s31, s31, s32
  v_mov_b32 v5, 0x0
  v_bfe_u32 v15, v0, 0, 6
  v_lshl_add_u32 v5, v15, 4, v5
  v_add_u32 v5, s31, v5
  s_lshl_b32 s31, s24, 5
  v_mov_b32 v6, 0x0
  v_bfe_u32 v15, v0, 3, 3
  v_lshl_add_u32 v6, v15, 2, v6
  v_add_u32 v6, s31, v6
  s_lshl_b32 s31, s24, 14
  s_lshl_b32 s32, s47, 7
  s_add_u32 s31, s31, s32
  v_mov_b32 v7, 0x0
  v_bfe_u32 v15, v0, 3, 3
  v_lshl_add_u32 v7, v15, 11, v7
  v_bfe_u32 v15, v0, 0, 3
  v_lshl_add_u32 v7, v15, 4, v7
  v_add_u32 v7, s31, v7
  s_lshl_b32 s31, s24, 3
  s_add_u32 s31, s31, 192
  v_add_u32 v2, s31, v0
  v_add_u32 v15, 216, v0
  v_cmp_gt_u32 vcc, 8, v0
  s_nop 1
  v_cndmask_b32 v2, v15, v2, vcc
  v_lshlrev_b32 v2, 7, v2
  s_add_u32 s31, s26, 128
  s_lshl_b32 s31, s31, 7
  s_lshl_b32 s32, s24, 2
  s_add_u32 s31, s31, s32
  v_writelane_b32 v2, s31, 12
  s_mov_b32 s38, 0x400000
  v_mov_b32 v11, 0
  s_mov_b32 s48, 0
  s_mov_b32 s49, 0
.p2align 6
L_G2O_loop:
  s_add_u32 s45, s29, 1
  s_mul_i32 s44, s29, 8192
  s_add_u32 s44, s44, 0x4800000
  s_lshl_b32 s46, s29, 16
  ds_read_b128 v[48:51], v8 offset:0
  ds_read_b128 v[52:55], v8 offset:1024
  ds_read_b128 v[56:59], v8 offset:2048
  ds_read_b128 v[60:63], v8 offset:3072
  s_cmp_lg_u32 s48, 0
  s_cbranch_scc1 L_G2O_go
  s_mov_b64 exec, 0x1fff
L_G2O_poll:
  buffer_load_dword v11, v2, s[4:7], s38 offen sc1
  s_waitcnt vmcnt(0)
  v_cmp_gt_u32 vcc, s45, v11
  s_cbranch_vccz L_G2O_ready
  s_sleep 1
  s_add_u32 s30, s30, 1
  s_cmp_lt_u32 s30, 0x100000
  s_cbranch_scc1 L_G2O_poll
  s_branch L_abort
L_G2O_ready:
  s_mov_b64 exec, -1
  s_add_u32 s32, s44, 0
  buffer_load_dwordx4 v[64:67], v1, s[4:7], s32 offen offset:0 sc1
  buffer_load_dwordx4 v[68:71], v1, s[4:7], s32 offen offset:1024 sc1
  s_add_u32 s32, s44, 2048
  buffer_load_dwordx4 v[72:75], v1, s[4:7], s32 offen offset:0 sc1
  buffer_load_dwordx4 v[76:79], v1, s[4:7], s32 offen offset:1024 sc1
  s_add_u32 s32, s44, 4096
  buffer_load_dwordx4 v[80:83], v1, s[4:7], s32 offen offset:0 sc1
  buffer_load_dwordx4 v[84:87], v1, s[4:7], s32 offen offset:1024 sc1
  s_add_u32 s32, s44, 3145728
  buffer_load_dwordx4 v[88:91], v1, s[4:7], s32 offen offset:0 sc1
  buffer_load_dwordx4 v[92:95], v1, s[4:7], s32 offen offset:1024 sc1
  s_add_u32 s32, s44, 6144
  buffer_load_dwordx4 v[96:99], v1, s[4:7], s32 offen offset:0 sc1
  buffer_load_dwordx4 v[100:103], v1, s[4:7], s32 offen offset:1024 sc1
  s_add_u32 s32, s44, 524288
  buffer_load_dwordx4 v[104:107], v1, s[4:7], s32 offen offset:0 sc1
  buffer_load_dwordx4 v[108:111], v1, s[4:7], s32 offen offset:1024 sc1
  s_add_u32 s32, s44, 526336
  buffer_load_dwordx4 v[112:115], v1, s[4:7], s32 offen offset:0 sc1
  buffer_load_dwordx4 v[116:119], v1, s[4:7], s32 offen offset:1024 sc1
  s_add_u32 s32, s44, 3147776
  buffer_load_dwordx4 v[120:123], v1, s[4:7], s32 offen offset:0 sc1
  buffer_load_dwordx4 v[124:127], v1, s[4:7], s32 offen offset:1024 sc1
L_G2O_go:
  s_waitcnt vmcnt(15)
  v_mfma_f32_16x16x32_bf16 v[16:19], a[0:3], v[64:67], 0
  v_mfma_f32_16x16x32_bf16 v[24:27], a[4:7], v[64:67], 0
  v_mfma_f32_16x16x32_bf16 v[32:35], a[8:11], v[64:67], 0
  v_mfma_f32_16x16x32_bf16 v[40:43], a[12:15], v[64:67], 0
  s_add_u32 s32, s44, 528384
  buffer_load_dwordx4 v[64:67], v1, s[4:7], s32 offen offset:0 sc1
  s_waitcnt vmcnt(15)
  v_mfma_f32_16x16x32_bf16 v[20:23], a[0:3], v[68:71], 0
  v_mfma_f32_16x16x32_bf16 v[28:31], a[4:7], v[68:71], 0
  v_mfma_f32_16x16x32_bf16 v[36:39], a[8:11], v[68:71], 0
  v_mfma_f32_16x16x32_bf16 v[44:47], a[12:15], v[68:71], 0
  buffer_load_dwordx4 v[68:71], v1, s[4:7], s32 offen offset:1024 sc1
  s_waitcnt vmcnt(15)
  v_mfma_f32_16x16x32_bf16 v[16:19], a[16:19], v[72:75], v[16:19]
  v_mfma_f32_16x16x32_bf16 v[24:27], a[20:23], v[72:75], v[24:27]
  v_mfma_f32_16x16x32_bf16 v[32:35], a[24:27], v[72:75], v[32:35]
  v_mfma_f32_16x16x32_bf16 v[40:43], a[28:31], v[72:75], v[40:43]
  s_add_u32 s32, s44, 530432
  buffer_load_dwordx4 v[72:75], v1, s[4:7], s32 offen offset:0 sc1
  s_waitcnt vmcnt(15)
  v_mfma_f32_16x16x32_bf16 v[20:23], a[16:19], v[76:79], v[20:23]
  v_mfma_f32_16x16x32_bf16 v[28:31], a[20:23], v[76:79], v[28:31]
  v_mfma_f32_16x16x32_bf16 v[36:39], a[24:27], v[76:79], v[36:39]
  v_mfma_f32_16x16x32_bf16 v[44:47], a[28:31], v[76:79], v[44:47]
  buffer_load_dwordx4 v[76:79], v1, s[4:7], s32 offen offset:1024 sc1
  s_waitcnt vmcnt(15)
  v_mfma_f32_16x16x32_bf16 v[16:19], a[32:35], v[80:83], v[16:19]
  v_mfma_f32_16x16x32_bf16 v[24:27], a[36:39], v[80:83], v[24:27]
  v_mfma_f32_16x16x32_bf16 v[32:35], a[40:43], v[80:83], v[32:35]
  v_mfma_f32_16x16x32_bf16 v[40:43], a[44:47], v[80:83], v[40:43]
  s_add_u32 s32, s44, 1048576
  buffer_load_dwordx4 v[80:83], v1, s[4:7], s32 offen offset:0 sc1
  s_waitcnt vmcnt(15)
  v_mfma_f32_16x16x32_bf16 v[20:23], a[32:35], v[84:87], v[20:23]
  v_mfma_f32_16x16x32_bf16 v[28:31], a[36:39], v[84:87], v[28:31]
  v_mfma_f32_16x16x32_bf16 v[36:39], a[40:43], v[84:87], v[36:39]
  v_mfma_f32_16x16x32_bf16 v[44:47], a[44:47], v[84:87], v[44:47]
  buffer_load_dwordx4 v[84:87], v1, s[4:7], s32 offen offset:1024 sc1
  s_waitcnt vmcnt(15)
  s_waitcnt lgkmcnt(3)
  v_mfma_f32_16x16x32_bf16 v[16:19], v[48:51], v[88:91], v[16:19]
  s_waitcnt lgkmcnt(2)
  v_mfma_f32_16x16x32_bf16 v[24:27], v[52:55], v[88:91], v[24:27]
  s_waitcnt lgkmcnt(1)
  v_mfma_f32_16x16x32_bf16 v[32:35], v[56:59], v[88:91], v[32:35]
  s_waitcnt lgkmcnt(0)
  v_mfma_f32_16x16x32_bf16 v[40:43], v[60:63], v[88:91], v[40:43]
  s_add_u32 s32, s44, 3149824
  buffer_load_dwordx4 v[88:91], v1, s[4:7], s32 offen offset:0 sc1
  s_waitcnt vmcnt(15)
  v_mfma_f32_16x16x32_bf16 v[20:23], v[48:51], v[92:95], v[20:23]
  v_mfma_f32_16x16x32_bf16 v[28:31], v[52:55], v[92:95], v[28:31]
  v_mfma_f32_16x16x32_bf16 v[36:39], v[56:59], v[92:95], v[36:39]
  v_mfma_f32_16x16x32_bf16 v[44:47], v[60:63], v[92:95], v[44:47]
  buffer_load_dwordx4 v[92:95], v1, s[4:7], s32 offen offset:1024 sc1
  ds_read_b128 v[48:51], v8 offset:4096
  ds_read_b128 v[52:55], v8 offset:5120
  ds_read_b128 v[56:59], v8 offset:6144
  ds_read_b128 v[60:63], v8 offset:7168
  s_waitcnt vmcnt(15)
  v_mfma_f32_16x16x32_bf16 v[16:19], a[48:51], v[96:99], v[16:19]
  v_mfma_f32_16x16x32_bf16 v[24:27], a[52:55], v[96:99], v[24:27]
  v_mfma_f32_16x16x32_bf16 v[32:35], a[56:59], v[96:99], v[32:35]
  v_mfma_f32_16x16x32_bf16 v[40:43], a[60:63], v[96:99], v[40:43]
  s_add_u32 s32, s44, 1050624
  buffer_load_dwordx4 v[96:99], v1, s[4:7], s32 offen offset:0 sc1
  s_waitcnt vmcnt(15)
  v_mfma_f32_16x16x32_bf16 v[20:23], a[48:51], v[100:103], v[20:23]
  v_mfma_f32_16x16x32_bf16 v[28:31], a[52:55], v[100:103], v[28:31]
  v_mfma_f32_16x16x32_bf16 v[36:39], a[56:59], v[100:103], v[36:39]
  v_mfma_f32_16x16x32_bf16 v[44:47], a[60:63], v[100:103], v[44:47]
  buffer_load_dwordx4 v[100:103], v1, s[4:7], s32 offen offset:1024 sc1
  s_waitcnt vmcnt(15)
  v_mfma_f32_16x16x32_bf16 v[16:19], a[64:67], v[104:107], v[16:19]
  v_mfma_f32_16x16x32_bf16 v[24:27], a[68:71], v[104:107], v[24:27]
  v_mfma_f32_16x16x32_bf16 v[32:35], a[72:75], v[104:107], v[32:35]
  v_mfma_f32_16x16x32_bf16 v[40:43], a[76:79], v[104:107], v[40:43]
  s_add_u32 s32, s44, 1052672
  buffer_load_dwordx4 v[104:107], v1, s[4:7], s32 offen offset:0 sc1
  s_waitcnt vmcnt(15)
  v_mfma_f32_16x16x32_bf16 v[20:23], a[64:67], v[108:111], v[20:23]
  v_mfma_f32_16x16x32_bf16 v[28:31], a[68:71], v[108:111], v[28:31]
  v_mfma_f32_16x16x32_bf16 v[36:39], a[72:75], v[108:111], v[36:39]
  v_mfma_f32_16x16x32_bf16 v[44:47], a[76:79], v[108:111], v[44:47]
  buffer_load_dwordx4 v[108:111], v1, s[4:7], s32 offen offset:1024 sc1
  s_waitcnt vmcnt(15)
  v_mfma_f32_16x16x32_bf16 v[16:19], a[80:83], v[112:115], v[16:19]
  v_mfma_f32_16x16x32_bf16 v[24:27], a[84:87], v[112:115], v[24:27]
  v_mfma_f32_16x16x32_bf16 v[32:35], a[88:91], v[112:115], v[32:35]
  v_mfma_f32_16x16x32_bf16 v[40:43], a[92:95], v[112:115], v[40:43]
  s_add_u32 s32, s44, 1054720
  buffer_load_dwordx4 v[112:115], v1, s[4:7], s32 offen offset:0 sc1
  s_waitcnt vmcnt(15)
  v_mfma_f32_16x16x32_bf16 v[20:23], a[80:83], v[116:119], v[20:23]
  v_mfma_f32_16x16x32_bf16 v[28:31], a[84:87], v[116:119], v[28:31]
  v_mfma_f32_16x16x32_bf16 v[36:39], a[88:91], v[116:119], v[36:39]
  v_mfma_f32_16x16x32_bf16 v[44:47], a[92:95], v[116:119], v[44:47]
  buffer_load_dwordx4 v[116:119], v1, s[4:7], s32 offen offset:1024 sc1
  s_waitcnt vmcnt(15)
  s_waitcnt lgkmcnt(3)
  v_mfma_f32_16x16x32_bf16 v[16:19], v[48:51], v[120:123], v[16:19]
  s_waitcnt lgkmcnt(2)
  v_mfma_f32_16x16x32_bf16 v[24:27], v[52:55], v[120:123], v[24:27]
  s_waitcnt lgkmcnt(1)
  v_mfma_f32_16x16x32_bf16 v[32:35], v[56:59], v[120:123], v[32:35]
  s_waitcnt lgkmcnt(0)
  v_mfma_f32_16x16x32_bf16 v[40:43], v[60:63], v[120:123], v[40:43]
  s_add_u32 s32, s44, 3151872
  buffer_load_dwordx4 v[120:123], v1, s[4:7], s32 offen offset:0 sc1
  s_waitcnt vmcnt(15)
  v_mfma_f32_16x16x32_bf16 v[20:23], v[48:51], v[124:127], v[20:23]
  v_mfma_f32_16x16x32_bf16 v[28:31], v[52:55], v[124:127], v[28:31]
  v_mfma_f32_16x16x32_bf16 v[36:39], v[56:59], v[124:127], v[36:39]
  v_mfma_f32_16x16x32_bf16 v[44:47], v[60:63], v[124:127], v[44:47]
  buffer_load_dwordx4 v[124:127], v1, s[4:7], s32 offen offset:1024 sc1
  ds_read_b128 v[48:51], v8 offset:8192
  ds_read_b128 v[52:55], v8 offset:9216
  ds_read_b128 v[56:59], v8 offset:10240
  ds_read_b128 v[60:63], v8 offset:11264
  s_waitcnt vmcnt(15)
  v_mfma_f32_16x16x32_bf16 v[16:19], a[96:99], v[64:67], v[16:19]
  v_mfma_f32_16x16x32_bf16 v[24:27], a[100:103], v[64:67], v[24:27]
  v_mfma_f32_16x16x32_bf16 v[32:35], a[104:107], v[64:67], v[32:35]
  v_mfma_f32_16x16x32_bf16 v[40:43], a[108:111], v[64:67], v[40:43]
  s_mov_b64 exec, 0x1fff
  buffer_load_dword v11, v2, s[4:7], s38 offen sc1
  s_mov_b64 exec, -1
  s_add_u32 s32, s44, 1572864
  buffer_load_dwordx4 v[64:67], v1, s[4:7], s32 offen offset:0 sc1
  s_waitcnt vmcnt(16)
  v_mfma_f32_16x16x32_bf16 v[20:23], a[96:99], v[68:71], v[20:23]
  v_mfma_f32_16x16x32_bf16 v[28:31], a[100:103], v[68:71], v[28:31]
  v_mfma_f32_16x16x32_bf16 v[36:39], a[104:107], v[68:71], v[36:39]
  v_mfma_f32_16x16x32_bf16 v[44:47], a[108:111], v[68:71], v[44:47]
  buffer_load_dwordx4 v[68:71], v1, s[4:7], s32 offen offset:1024 sc1
  s_waitcnt vmcnt(16)
  v_mfma_f32_16x16x32_bf16 v[16:19], a[112:115], v[72:75], v[16:19]
  v_mfma_f32_16x16x32_bf16 v[24:27], a[116:119], v[72:75], v[24:27]
  v_mfma_f32_16x16x32_bf16 v[32:35], a[120:123], v[72:75], v[32:35]
  v_mfma_f32_16x16x32_bf16 v[40:43], a[124:127], v[72:75], v[40:43]
  s_add_u32 s32, s44, 1574912
  buffer_load_dwordx4 v[72:75], v1, s[4:7], s32 offen offset:0 sc1
  s_waitcnt vmcnt(16)
  v_mfma_f32_16x16x32_bf16 v[20:23], a[112:115], v[76:79], v[20:23]
  v_mfma_f32_16x16x32_bf16 v[28:31], a[116:119], v[76:79], v[28:31]
  v_mfma_f32_16x16x32_bf16 v[36:39], a[120:123], v[76:79], v[36:39]
  v_mfma_f32_16x16x32_bf16 v[44:47], a[124:127], v[76:79], v[44:47]
  buffer_load_dwordx4 v[76:79], v1, s[4:7], s32 offen offset:1024 sc1
  s_waitcnt vmcnt(16)
  v_mfma_f32_16x16x32_bf16 v[16:19], a[128:131], v[80:83], v[16:19]
  v_mfma_f32_16x16x32_bf16 v[24:27], a[132:135], v[80:83], v[24:27]
  v_mfma_f32_16x16x32_bf16 v[32:35], a[136:139], v[80:83], v[32:35]
  v_mfma_f32_16x16x32_bf16 v[40:43], a[140:143], v[80:83], v[40:43]
  s_add_u32 s32, s44, 1576960
  buffer_load_dwordx4 v[80:83], v1, s[4:7], s32 offen offset:0 sc1
  s_waitcnt vmcnt(16)
  v_mfma_f32_16x16x32_bf16 v[20:23], a[128:131], v[84:87], v[20:23]
  v_mfma_f32_16x16x32_bf16 v[28:31], a[132:135], v[84:87], v[28:31]
  v_mfma_f32_16x16x32_bf16 v[36:39], a[136:139], v[84:87], v[36:39]
  v_mfma_f32_16x16x32_bf16 v[44:47], a[140:143], v[84:87], v[44:47]
  buffer_load_dwordx4 v[84:87], v1, s[4:7], s32 offen offset:1024 sc1
  s_waitcnt vmcnt(16)
  s_waitcnt lgkmcnt(3)
  v_mfma_f32_16x16x32_bf16 v[16:19], v[48:51], v[88:91], v[16:19]
  s_waitcnt lgkmcnt(2)
  v_mfma_f32_16x16x32_bf16 v[24:27], v[52:55], v[88:91], v[24:27]
  s_waitcnt lgkmcnt(1)
  v_mfma_f32_16x16x32_bf16 v[32:35], v[56:59], v[88:91], v[32:35]
  s_waitcnt lgkmcnt(0)
  v_mfma_f32_16x16x32_bf16 v[40:43], v[60:63], v[88:91], v[40:43]
  s_add_u32 s32, s44, 3670016
  buffer_load_dwordx4 v[88:91], v1, s[4:7], s32 offen offset:0 sc1
  s_waitcnt vmcnt(16)
  v_mfma_f32_16x16x32_bf16 v[20:23], v[48:51], v[92:95], v[20:23]
  v_mfma_f32_16x16x32_bf16 v[28:31], v[52:55], v[92:95], v[28:31]
  v_mfma_f32_16x16x32_bf16 v[36:39], v[56:59], v[92:95], v[36:39]
  v_mfma_f32_16x16x32_bf16 v[44:47], v[60:63], v[92:95], v[44:47]
  buffer_load_dwordx4 v[92:95], v1, s[4:7], s32 offen offset:1024 sc1
  ds_read_b128 v[48:51], v8 offset:12288
  ds_read_b128 v[52:55], v8 offset:13312
  ds_read_b128 v[56:59], v8 offset:14336
  ds_read_b128 v[60:63], v8 offset:15360
  s_waitcnt vmcnt(16)
  v_mfma_f32_16x16x32_bf16 v[16:19], a[144:147], v[96:99], v[16:19]
  v_mfma_f32_16x16x32_bf16 v[24:27], a[148:151], v[96:99], v[24:27]
  v_mfma_f32_16x16x32_bf16 v[32:35], a[152:155], v[96:99], v[32:35]
  v_mfma_f32_16x16x32_bf16 v[40:43], a[156:159], v[96:99], v[40:43]
  s_add_u32 s32, s44, 1579008
  buffer_load_dwordx4 v[96:99], v1, s[4:7], s32 offen offset:0 sc1
  s_waitcnt vmcnt(16)
  v_mfma_f32_16x16x32_bf16 v[20:23], a[144:147], v[100:103], v[20:23]
  v_mfma_f32_16x16x32_bf16 v[28:31], a[148:151], v[100:103], v[28:31]
  v_mfma_f32_16x16x32_bf16 v[36:39], a[152:155], v[100:103], v[36:39]
  v_mfma_f32_16x16x32_bf16 v[44:47], a[156:159], v[100:103], v[44:47]
  buffer_load_dwordx4 v[100:103], v1, s[4:7], s32 offen offset:1024 sc1
  s_waitcnt vmcnt(16)
  v_mfma_f32_16x16x32_bf16 v[16:19], a[160:163], v[104:107], v[16:19]
  v_mfma_f32_16x16x32_bf16 v[24:27], a[164:167], v[104:107], v[24:27]
  v_mfma_f32_16x16x32_bf16 v[32:35], a[168:171], v[104:107], v[32:35]
  v_mfma_f32_16x16x32_bf16 v[40:43], a[172:175], v[104:107], v[40:43]
  s_add_u32 s32, s44, 2097152
  buffer_load_dwordx4 v[104:107], v1, s[4:7], s32 offen offset:0 sc1
  s_waitcnt vmcnt(16)
  v_mfma_f32_16x16x32_bf16 v[20:23], a[160:163], v[108:111], v[20:23]
  v_mfma_f32_16x16x32_bf16 v[28:31], a[164:167], v[108:111], v[28:31]
  v_mfma_f32_16x16x32_bf16 v[36:39], a[168:171], v[108:111], v[36:39]
  v_mfma_f32_16x16x32_bf16 v[44:47], a[172:175], v[108:111], v[44:47]
  buffer_load_dwordx4 v[108:111], v1, s[4:7], s32 offen offset:1024 sc1
  s_waitcnt vmcnt(16)
  v_mfma_f32_16x16x32_bf16 v[16:19], a[176:179], v[112:115], v[16:19]
  v_mfma_f32_16x16x32_bf16 v[24:27], a[180:183], v[112:115], v[24:27]
  v_mfma_f32_16x16x32_bf16 v[32:35], a[184:187], v[112:115], v[32:35]
  v_mfma_f32_16x16x32_bf16 v[40:43], a[188:191], v[112:115], v[40:43]
  s_add_u32 s32, s44, 2099200
  buffer_load_dwordx4 v[112:115], v1, s[4:7], s32 offen offset:0 sc1
  s_waitcnt vmcnt(16)
  v_mfma_f32_16x16x32_bf16 v[20:23], a[176:179], v[116:119], v[20:23]
  v_mfma_f32_16x16x32_bf16 v[28:31], a[180:183], v[116:119], v[28:31]
  v_mfma_f32_16x16x32_bf16 v[36:39], a[184:187], v[116:119], v[36:39]
  v_mfma_f32_16x16x32_bf16 v[44:47], a[188:191], v[116:119], v[44:47]
  buffer_load_dwordx4 v[116:119], v1, s[4:7], s32 offen offset:1024 sc1
  s_waitcnt vmcnt(16)
  s_waitcnt lgkmcnt(3)
  v_mfma_f32_16x16x32_bf16 v[16:19], v[48:51], v[120:123], v[16:19]
  s_waitcnt lgkmcnt(2)
  v_mfma_f32_16x16x32_bf16 v[24:27], v[52:55], v[120:123], v[24:27]
  s_waitcnt lgkmcnt(1)
  v_mfma_f32_16x16x32_bf16 v[32:35], v[56:59], v[120:123], v[32:35]
  s_waitcnt lgkmcnt(0)
  v_mfma_f32_16x16x32_bf16 v[40:43], v[60:63], v[120:123], v[40:43]
  s_add_u32 s32, s44, 3672064
  buffer_load_dwordx4 v[120:123], v1, s[4:7], s32 offen offset:0 sc1
  s_waitcnt vmcnt(16)
  v_mfma_f32_16x16x32_bf16 v[20:23], v[48:51], v[124:127], v[20:23]
  v_mfma_f32_16x16x32_bf16 v[28:31], v[52:55], v[124:127], v[28:31]
  v_mfma_f32_16x16x32_bf16 v[36:39], v[56:59], v[124:127], v[36:39]
  v_mfma_f32_16x16x32_bf16 v[44:47], v[60:63], v[124:127], v[44:47]
  buffer_load_dwordx4 v[124:127], v1, s[4:7], s32 offen offset:1024 sc1
  ds_read_b128 v[48:51], v8 offset:16384
  ds_read_b128 v[52:55], v8 offset:17408
  ds_read_b128 v[56:59], v8 offset:18432
  ds_read_b128 v[60:63], v8 offset:19456
  s_waitcnt vmcnt(15)
  v_mfma_f32_16x16x32_bf16 v[16:19], a[192:195], v[64:67], v[16:19]
  v_mfma_f32_16x16x32_bf16 v[24:27], a[196:199], v[64:67], v[24:27]
  v_mfma_f32_16x16x32_bf16 v[32:35], a[200:203], v[64:67], v[32:35]
  v_mfma_f32_16x16x32_bf16 v[40:43], a[204:207], v[64:67], v[40:43]
  s_add_u32 s32, s44, 2101248
  buffer_load_dwordx4 v[64:67], v1, s[4:7], s32 offen offset:0 sc1
  s_waitcnt vmcnt(15)
  v_mfma_f32_16x16x32_bf16 v[20:23], a[192:195], v[68:71], v[20:23]
  v_mfma_f32_16x16x32_bf16 v[28:31], a[196:199], v[68:71], v[28:31]
  v_mfma_f32_16x16x32_bf16 v[36:39], a[200:203], v[68:71], v[36:39]
  v_mfma_f32_16x16x32_bf16 v[44:47], a[204:207], v[68:71], v[44:47]
  buffer_load_dwordx4 v[68:71], v1, s[4:7], s32 offen offset:1024 sc1
  s_waitcnt vmcnt(15)
  v_mfma_f32_16x16x32_bf16 v[16:19], a[208:211], v[72:75], v[16:19]
  v_mfma_f32_16x16x32_bf16 v[24:27], a[212:215], v[72:75], v[24:27]
  v_mfma_f32_16x16x32_bf16 v[32:35], a[216:219], v[72:75], v[32:35]
  v_mfma_f32_16x16x32_bf16 v[40:43], a[220:223], v[72:75], v[40:43]
  s_add_u32 s32, s44, 2103296
  buffer_load_dwordx4 v[72:75], v1, s[4:7], s32 offen offset:0 sc1
  s_waitcnt vmcnt(15)
  v_mfma_f32_16x16x32_bf16 v[20:23], a[208:211], v[76:79], v[20:23]
  v_mfma_f32_16x16x32_bf16 v[28:31], a[212:215], v[76:79], v[28:31]
  v_mfma_f32_16x16x32_bf16 v[36:39], a[216:219], v[76:79], v[36:39]
  v_mfma_f32_16x16x32_bf16 v[44:47], a[220:223], v[76:79], v[44:47]
  buffer_load_dwordx4 v[76:79], v1, s[4:7], s32 offen offset:1024 sc1
  s_waitcnt vmcnt(15)
  v_mfma_f32_16x16x32_bf16 v[16:19], a[224:227], v[80:83], v[16:19]
  v_mfma_f32_16x16x32_bf16 v[24:27], a[228:231], v[80:83], v[24:27]
  v_mfma_f32_16x16x32_bf16 v[32:35], a[232:235], v[80:83], v[32:35]
  v_mfma_f32_16x16x32_bf16 v[40:43], a[236:239], v[80:83], v[40:43]
  s_add_u32 s32, s44, 2621440
  buffer_load_dwordx4 v[80:83], v1, s[4:7], s32 offen offset:0 sc1
  s_waitcnt vmcnt(15)
  v_mfma_f32_16x16x32_bf16 v[20:23], a[224:227], v[84:87], v[20:23]
  v_mfma_f32_16x16x32_bf16 v[28:31], a[228:231], v[84:87], v[28:31]
  v_mfma_f32_16x16x32_bf16 v[36:39], a[232:235], v[84:87], v[36:39]
  v_mfma_f32_16x16x32_bf16 v[44:47], a[236:239], v[84:87], v[44:47]
  buffer_load_dwordx4 v[84:87], v1, s[4:7], s32 offen offset:1024 sc1
  s_waitcnt vmcnt(15)
  s_waitcnt lgkmcnt(3)
  v_mfma_f32_16x16x32_bf16 v[16:19], v[48:51], v[88:91], v[16:19]
  s_waitcnt lgkmcnt(2)
  v_mfma_f32_16x16x32_bf16 v[24:27], v[52:55], v[88:91], v[24:27]
  s_waitcnt lgkmcnt(1)
  v_mfma_f32_16x16x32_bf16 v[32:35], v[56:59], v[88:91], v[32:35]
  s_waitcnt lgkmcnt(0)
  v_mfma_f32_16x16x32_bf16 v[40:43], v[60:63], v[88:91], v[40:43]
  s_add_u32 s32, s44, 3674112
  buffer_load_dwordx4 v[88:91], v1, s[4:7], s32 offen offset:0 sc1
  s_waitcnt vmcnt(15)
  v_mfma_f32_16x16x32_bf16 v[20:23], v[48:51], v[92:95], v[20:23]
  v_mfma_f32_16x16x32_bf16 v[28:31], v[52:55], v[92:95], v[28:31]
  v_mfma_f32_16x16x32_bf16 v[36:39], v[56:59], v[92:95], v[36:39]
  v_mfma_f32_16x16x32_bf16 v[44:47], v[60:63], v[92:95], v[44:47]
  buffer_load_dwordx4 v[92:95], v1, s[4:7], s32 offen offset:1024 sc1
  ds_read_b128 v[48:51], v8 offset:20480
  ds_read_b128 v[52:55], v8 offset:21504
  ds_read_b128 v[56:59], v8 offset:22528
  ds_read_b128 v[60:63], v8 offset:23552
  s_waitcnt vmcnt(15)
  v_mfma_f32_16x16x32_bf16 v[16:19], a[240:243], v[96:99], v[16:19]
  v_mfma_f32_16x16x32_bf16 v[24:27], a[244:247], v[96:99], v[24:27]
  v_mfma_f32_16x16x32_bf16 v[32:35], a[248:251], v[96:99], v[32:35]
  v_mfma_f32_16x16x32_bf16 v[40:43], a[252:255], v[96:99], v[40:43]
  s_add_u32 s32, s44, 2623488
  buffer_load_dwordx4 v[96:99], v1, s[4:7], s32 offen offset:0 sc1
  s_waitcnt vmcnt(15)
  v_mfma_f32_16x16x32_bf16 v[20:23], a[240:243], v[100:103], v[20:23]
  v_mfma_f32_16x16x32_bf16 v[28:31], a[244:247], v[100:103], v[28:31]
  v_mfma_f32_16x16x32_bf16 v[36:39], a[248:251], v[100:103], v[36:39]
  v_mfma_f32_16x16x32_bf16 v[44:47], a[252:255], v[100:103], v[44:47]
  buffer_load_dwordx4 v[100:103], v1, s[4:7], s32 offen offset:1024 sc1
  s_waitcnt vmcnt(15)
  v_mfma_f32_16x16x32_bf16 v[16:19], v[128:131], v[104:107], v[16:19]
  v_mfma_f32_16x16x32_bf16 v[24:27], v[132:135], v[104:107], v[24:27]
  v_mfma_f32_16x16x32_bf16 v[32:35], v[136:139], v[104:107], v[32:35]
  v_mfma_f32_16x16x32_bf16 v[40:43], v[140:143], v[104:107], v[40:43]
  s_add_u32 s32, s44, 2625536
  buffer_load_dwordx4 v[104:107], v1, s[4:7], s32 offen offset:0 sc1
  s_waitcnt vmcnt(15)
  v_mfma_f32_16x16x32_bf16 v[20:23], v[128:131], v[108:111], v[20:23]
  v_mfma_f32_16x16x32_bf16 v[28:31], v[132:135], v[108:111], v[28:31]
  v_mfma_f32_16x16x32_bf16 v[36:39], v[136:139], v[108:111], v[36:39]
  v_mfma_f32_16x16x32_bf16 v[44:47], v[140:143], v[108:111], v[44:47]
  buffer_load_dwordx4 v[108:111], v1, s[4:7], s32 offen offset:1024 sc1
  s_waitcnt vmcnt(15)
  v_mfma_f32_16x16x32_bf16 v[16:19], v[144:147], v[112:115], v[16:19]
  v_mfma_f32_16x16x32_bf16 v[24:27], v[148:151], v[112:115], v[24:27]
  v_mfma_f32_16x16x32_bf16 v[32:35], v[152:155], v[112:115], v[32:35]
  v_mfma_f32_16x16x32_bf16 v[40:43], v[156:159], v[112:115], v[40:43]
  s_add_u32 s32, s44, 2627584
  buffer_load_dwordx4 v[112:115], v1, s[4:7], s32 offen offset:0 sc1
  s_waitcnt vmcnt(15)
  v_mfma_f32_16x16x32_bf16 v[20:23], v[144:147], v[116:119], v[20:23]
  v_mfma_f32_16x16x32_bf16 v[28:31], v[148:151], v[116:119], v[28:31]
  v_mfma_f32_16x16x32_bf16 v[36:39], v[152:155], v[116:119], v[36:39]
  v_mfma_f32_16x16x32_bf16 v[44:47], v[156:159], v[116:119], v[44:47]
  buffer_load_dwordx4 v[116:119], v1, s[4:7], s32 offen offset:1024 sc1
  s_waitcnt vmcnt(15)
  s_waitcnt lgkmcnt(3)
  v_mfma_f32_16x16x32_bf16 v[16:19], v[48:51], v[120:123], v[16:19]
  s_waitcnt lgkmcnt(2)
  v_mfma_f32_16x16x32_bf16 v[24:27], v[52:55], v[120:123], v[24:27]
  s_waitcnt lgkmcnt(1)
  v_mfma_f32_16x16x32_bf16 v[32:35], v[56:59], v[120:123], v[32:35]
  s_waitcnt lgkmcnt(0)
  v_mfma_f32_16x16x32_bf16 v[40:43], v[60:63], v[120:123], v[40:43]
  s_add_u32 s33, s45, s41
  s_mov_b64 exec, 0x1fff
  v_cmp_gt_u32 vcc, s33, v11
  s_mov_b64 exec, -1
  s_mul_i32 s40, s41, 8192
  s_add_u32 s40, s40, s44
  s_cmp_gt_u32 s33, 62
  s_cselect_b64 vcc, -1, vcc
  s_cmp_eq_u64 vcc, 0
  s_cselect_b32 s48, 1, 0
  s_cselect_b32 s40, s40, 0x40000000
  s_add_u32 s32, s44, 3676160
  buffer_load_dwordx4 v[120:123], v1, s[4:7], s32 offen offset:0 sc1
  s_waitcnt vmcnt(15)
  v_mfma_f32_16x16x32_bf16 v[20:23], v[48:51], v[124:127], v[20:23]
  v_mfma_f32_16x16x32_bf16 v[28:31], v[52:55], v[124:127], v[28:31]
  v_mfma_f32_16x16x32_bf16 v[36:39], v[56:59], v[124:127], v[36:39]
  v_mfma_f32_16x16x32_bf16 v[44:47], v[60:63], v[124:127], v[44:47]
  s_add_u32 s31, s46, 0x5800000
  s_lshl_b32 s33, s29, 7
  s_add_u32 s33, s33, 0x410000
  buffer_load_dwordx4 v[12:15], v5, s[4:7], s31 offen sc1
  buffer_load_dword v0, v6, s[4:7], s33 offen sc1
  buffer_load_dwordx4 v[124:127], v1, s[4:7], s32 offen offset:1024 sc1
  ds_read_b128 v[48:51], v8 offset:24576
  ds_read_b128 v[52:55], v8 offset:25600
  ds_read_b128 v[56:59], v8 offset:26624
  ds_read_b128 v[60:63], v8 offset:27648
  s_waitcnt vmcnt(17)
  v_mfma_f32_16x16x32_bf16 v[16:19], v[160:163], v[64:67], v[16:19]
  v_mfma_f32_16x16x32_bf16 v[24:27], v[164:167], v[64:67], v[24:27]
  v_mfma_f32_16x16x32_bf16 v[32:35], v[168:171], v[64:67], v[32:35]
  v_mfma_f32_16x16x32_bf16 v[40:43], v[172:175], v[64:67], v[40:43]
  s_add_u32 s32, s40, 0
  buffer_load_dwordx4 v[64:67], v1, s[4:7], s32 offen offset:0 sc1
  s_waitcnt vmcnt(17)
  v_mfma_f32_16x16x32_bf16 v[20:23], v[160:163], v[68:71], v[20:23]
  v_mfma_f32_16x16x32_bf16 v[28:31], v[164:167], v[68:71], v[28:31]
  v_mfma_f32_16x16x32_bf16 v[36:39], v[168:171], v[68:71], v[36:39]
  v_mfma_f32_16x16x32_bf16 v[44:47], v[172:175], v[68:71], v[44:47]
  buffer_load_dwordx4 v[68:71], v1, s[4:7], s32 offen offset:1024 sc1
  s_waitcnt vmcnt(17)
  v_mfma_f32_16x16x32_bf16 v[16:19], v[176:179], v[72:75], v[16:19]
  v_mfma_f32_16x16x32_bf16 v[24:27], v[180:183], v[72:75], v[24:27]
  v_mfma_f32_16x16x32_bf16 v[32:35], v[184:187], v[72:75], v[32:35]
  v_mfma_f32_16x16x32_bf16 v[40:43], v[188:191], v[72:75], v[40:43]
  s_add_u32 s32, s40, 2048
  buffer_load_dwordx4 v[72:75], v1, s[4:7], s32 offen offset:0 sc1
  s_waitcnt vmcnt(17)
  v_mfma_f32_16x16x32_bf16 v[20:23], v[176:179], v[76:79], v[20:23]
  v_mfma_f32_16x16x32_bf16 v[28:31], v[180:183], v[76:79], v[28:31]
  v_mfma_f32_16x16x32_bf16 v[36:39], v[184:187], v[76:79], v[36:39]
  v_mfma_f32_16x16x32_bf16 v[44:47], v[188:191], v[76:79], v[44:47]
  buffer_load_dwordx4 v[76:79], v1, s[4:7], s32 offen offset:1024 sc1
  s_waitcnt vmcnt(17)
  v_mfma_f32_16x16x32_bf16 v[16:19], v[192:195], v[80:83], v[16:19]
  v_mfma_f32_16x16x32_bf16 v[24:27], v[196:199], v[80:83], v[24:27]
  v_mfma_f32_16x16x32_bf16 v[32:35], v[200:203], v[80:83], v[32:35]
  v_mfma_f32_16x16x32_bf16 v[40:43], v[204:207], v[80:83], v[40:43]
  s_add_u32 s32, s40, 4096
  buffer_load_dwordx4 v[80:83], v1, s[4:7], s32 offen offset:0 sc1
  s_waitcnt vmcnt(17)
  v_mfma_f32_16x16x32_bf16 v[20:23], v[192:195], v[84:87], v[20:23]
  v_mfma_f32_16x16x32_bf16 v[28:31], v[196:199], v[84:87], v[28:31]
  v_mfma_f32_16x16x32_bf16 v[36:39], v[200:203], v[84:87], v[36:39]
  v_mfma_f32_16x16x32_bf16 v[44:47], v[204:207], v[84:87], v[44:47]
  buffer_load_dwordx4 v[84:87], v1, s[4:7], s32 offen offset:1024 sc1
  s_waitcnt vmcnt(17)
  s_waitcnt lgkmcnt(3)
  v_mfma_f32_16x16x32_bf16 v[16:19], v[48:51], v[88:91], v[16:19]
  s_waitcnt lgkmcnt(2)
  v_mfma_f32_16x16x32_bf16 v[24:27], v[52:55], v[88:91], v[24:27]
  s_waitcnt lgkmcnt(1)
  v_mfma_f32_16x16x32_bf16 v[32:35], v[56:59], v[88:91], v[32:35]
  s_waitcnt lgkmcnt(0)
  v_mfma_f32_16x16x32_bf16 v[40:43], v[60:63], v[88:91], v[40:43]
  s_add_u32 s32, s40, 3145728
  buffer_load_dwordx4 v[88:91], v1, s[4:7], s32 offen offset:0 sc1
  s_waitcnt vmcnt(17)
  v_mfma_f32_16x16x32_bf16 v[20:23], v[48:51], v[92:95], v[20:23]
  v_mfma_f32_16x16x32_bf16 v[28:31], v[52:55], v[92:95], v[28:31]
  v_mfma_f32_16x16x32_bf16 v[36:39], v[56:59], v[92:95], v[36:39]
  v_mfma_f32_16x16x32_bf16 v[44:47], v[60:63], v[92:95], v[44:47]
  buffer_load_dwordx4 v[92:95], v1, s[4:7], s32 offen offset:1024 sc1
  ds_read_b128 v[48:51], v8 offset:28672
  ds_read_b128 v[52:55], v8 offset:29696
  ds_read_b128 v[56:59], v8 offset:30720
  ds_read_b128 v[60:63], v8 offset:31744
  s_waitcnt vmcnt(17)
  v_mfma_f32_16x16x32_bf16 v[16:19], v[208:211], v[96:99], v[16:19]
  v_mfma_f32_16x16x32_bf16 v[24:27], v[212:215], v[96:99], v[24:27]
  v_mfma_f32_16x16x32_bf16 v[32:35], v[216:219], v[96:99], v[32:35]
  v_mfma_f32_16x16x32_bf16 v[40:43], v[220:223], v[96:99], v[40:43]
  s_add_u32 s32, s40, 6144
  buffer_load_dwordx4 v[96:99], v1, s[4:7], s32 offen offset:0 sc1
  s_waitcnt vmcnt(17)
  v_mfma_f32_16x16x32_bf16 v[20:23], v[208:211], v[100:103], v[20:23]
  v_mfma_f32_16x16x32_bf16 v[28:31], v[212:215], v[100:103], v[28:31]
  v_mfma_f32_16x16x32_bf16 v[36:39], v[216:219], v[100:103], v[36:39]
  v_mfma_f32_16x16x32_bf16 v[44:47], v[220:223], v[100:103], v[44:47]
  buffer_load_dwordx4 v[100:103], v1, s[4:7], s32 offen offset:1024 sc1
  s_waitcnt vmcnt(17)
  v_mfma_f32_16x16x32_bf16 v[16:19], v[224:227], v[104:107], v[16:19]
  v_mfma_f32_16x16x32_bf16 v[24:27], v[228:231], v[104:107], v[24:27]
  v_mfma_f32_16x16x32_bf16 v[32:35], v[232:235], v[104:107], v[32:35]
  v_mfma_f32_16x16x32_bf16 v[40:43], v[236:239], v[104:107], v[40:43]
  s_add_u32 s32, s40, 524288
  buffer_load_dwordx4 v[104:107], v1, s[4:7], s32 offen offset:0 sc1
  s_waitcnt vmcnt(17)
  v_mfma_f32_16x16x32_bf16 v[20:23], v[224:227], v[108:111], v[20:23]
  v_mfma_f32_16x16x32_bf16 v[28:31], v[228:231], v[108:111], v[28:31]
  v_mfma_f32_16x16x32_bf16 v[36:39], v[232:235], v[108:111], v[36:39]
  v_mfma_f32_16x16x32_bf16 v[44:47], v[236:239], v[108:111], v[44:47]
  buffer_load_dwordx4 v[108:111], v1, s[4:7], s32 offen offset:1024 sc1
  s_waitcnt vmcnt(17)
  v_mfma_f32_16x16x32_bf16 v[16:19], v[240:243], v[112:115], v[16:19]
  v_mfma_f32_16x16x32_bf16 v[24:27], v[244:247], v[112:115], v[24:27]
  v_mfma_f32_16x16x32_bf16 v[32:35], v[248:251], v[112:115], v[32:35]
  v_mfma_f32_16x16x32_bf16 v[40:43], v[252:255], v[112:115], v[40:43]
  s_add_u32 s32, s40, 526336
  buffer_load_dwordx4 v[112:115], v1, s[4:7], s32 offen offset:0 sc1
  s_waitcnt vmcnt(17)
  v_mfma_f32_16x16x32_bf16 v[20:23], v[240:243], v[116:119], v[20:23]
  v_mfma_f32_16x16x32_bf16 v[28:31], v[244:247], v[116:119], v[28:31]
  v_mfma_f32_16x16x32_bf16 v[36:39], v[248:251], v[116:119], v[36:39]
  v_mfma_f32_16x16x32_bf16 v[44:47], v[252:255], v[116:119], v[44:47]
  buffer_load_dwordx4 v[116:119], v1, s[4:7], s32 offen offset:1024 sc1
  s_waitcnt vmcnt(17)
  s_waitcnt lgkmcnt(3)
  v_mfma_f32_16x16x32_bf16 v[16:19], v[48:51], v[120:123], v[16:19]
  s_waitcnt lgkmcnt(2)
  v_mfma_f32_16x16x32_bf16 v[24:27], v[52:55], v[120:123], v[24:27]
  s_waitcnt lgkmcnt(1)
  v_mfma_f32_16x16x32_bf16 v[32:35], v[56:59], v[120:123], v[32:35]
  s_waitcnt lgkmcnt(0)
  v_mfma_f32_16x16x32_bf16 v[40:43], v[60:63], v[120:123], v[40:43]
  s_add_u32 s32, s40, 3147776
  buffer_load_dwordx4 v[120:123], v1, s[4:7], s32 offen offset:0 sc1
  s_waitcnt vmcnt(15)
  v_mfma_f32_16x16x32_bf16 v[20:23], v[48:51], v[124:127], v[20:23]
  v_mfma_f32_16x16x32_bf16 v[28:31], v[52:55], v[124:127], v[28:31]
  v_mfma_f32_16x16x32_bf16 v[36:39], v[56:59], v[124:127], v[36:39]
  v_mfma_f32_16x16x32_bf16 v[44:47], v[60:63], v[124:127], v[44:47]
  buffer_load_dwordx4 v[124:127], v1, s[4:7], s32 offen offset:1024 sc1
  ds_write_b128 v9, v[16:19] offset:0
  s_nop 2
  ds_write_b128 v9, v[20:23] offset:4096
  ds_write_b128 v10, v[24:27] offset:0
  ds_write_b128 v10, v[28:31] offset:4096
  ds_write_b128 v9, v[32:35] offset:128
  ds_write_b128 v9, v[36:39] offset:4224
  ds_write_b128 v10, v[40:43] offset:128
  ds_write_b128 v10, v[44:47] offset:4224
  s_waitcnt lgkmcnt(0)
  s_barrier
  ds_read_b128 v[16:19], v3 offset:0
  ds_read_b128 v[20:23], v4 offset:0
  ds_read_b128 v[24:27], v3 offset:8192
  ds_read_b128 v[28:31], v4 offset:8192
  ds_read_b128 v[32:35], v3 offset:16384
  ds_read_b128 v[36:39], v4 offset:16384
  ds_read_b128 v[40:43], v3 offset:24576
  ds_read_b128 v[44:47], v4 offset:24576
  s_waitcnt lgkmcnt(4)
  v_add_f32 v16, v16, v24
  v_add_f32 v17, v17, v25
  v_add_f32 v18, v18, v26
  v_add_f32 v19, v19, v27
  v_add_f32 v20, v20, v28
  v_add_f32 v21, v21, v29
  v_add_f32 v22, v22, v30
  v_add_f32 v23, v23, v31
  s_waitcnt lgkmcnt(0)
  s_barrier
  v_add_f32 v32, v32, v40
  v_add_f32 v33, v33, v41
  v_add_f32 v34, v34, v42
  v_add_f32 v35, v35, v43
  v_add_f32 v36, v36, v44
  v_add_f32 v37, v37, v45
  v_add_f32 v38, v38, v46
  v_add_f32 v39, v39, v47
  v_add_f32 v16, v16, v32
  v_add_f32 v17, v17, v33
  v_add_f32 v18, v18, v34
  v_add_f32 v19, v19, v35
  v_add_f32 v20, v20, v36
  v_add_f32 v21, v21, v37
  v_add_f32 v22, v22, v38
  v_add_f32 v23, v23, v39
  v_cvt_pk_bf16_f32 v24, v16, v17
  v_cvt_pk_bf16_f32 v25, v18, v19
  v_cvt_pk_bf16_f32 v26, v20, v21
  v_cvt_pk_bf16_f32 v27, v22, v23
  v_and_b32 v17, 0xffff0000, v24
  v_lshlrev_b32 v16, 16, v24
  v_and_b32 v19, 0xffff0000, v25
  v_lshlrev_b32 v18, 16, v25
  v_and_b32 v21, 0xffff0000, v26
  v_lshlrev_b32 v20, 16, v26
  v_and_b32 v23, 0xffff0000, v27
  v_lshlrev_b32 v22, 16, v27
  v_sub_f32 v40, 1.0, v0
  v_cvt_pk_bf16_f32 v40, v40, v40
  v_lshlrev_b32 v40, 16, v40
  v_and_b32 v33, 0xffff0000, v12
  v_lshlrev_b32 v32, 16, v12
  v_and_b32 v35, 0xffff0000, v13
  v_lshlrev_b32 v34, 16, v13
  v_and_b32 v37, 0xffff0000, v14
  v_lshlrev_b32 v36, 16, v14
  v_and_b32 v39, 0xffff0000, v15
  v_lshlrev_b32 v38, 16, v15
  v_mul_f32 v16, v0, v16
  v_mul_f32 v32, v40, v32
  v_mul_f32 v17, v0, v17
  v_mul_f32 v33, v40, v33
  v_mul_f32 v18, v0, v18
  v_mul_f32 v34, v40, v34
  v_mul_f32 v19, v0, v19
  v_mul_f32 v35, v40, v35
  v_mul_f32 v20, v0, v20
  v_mul_f32 v36, v40, v36
  v_mul_f32 v21, v0, v21
  v_mul_f32 v37, v40, v37
  v_mul_f32 v22, v0, v22
  v_mul_f32 v38, v40, v38
  v_mul_f32 v23, v0, v23
  v_mul_f32 v39, v40, v39
  v_cvt_pk_bf16_f32 v24, v16, v17
  v_cvt_pk_bf16_f32 v25, v18, v19
  v_cvt_pk_bf16_f32 v26, v20, v21
  v_cvt_pk_bf16_f32 v27, v22, v23
  v_cvt_pk_bf16_f32 v28, v32, v33
  v_cvt_pk_bf16_f32 v29, v34, v35
  v_cvt_pk_bf16_f32 v30, v36, v37
  v_cvt_pk_bf16_f32 v31, v38, v39
  v_and_b32 v17, 0xffff0000, v24
  v_lshlrev_b32 v16, 16, v24
  v_and_b32 v19, 0xffff0000, v25
  v_lshlrev_b32 v18, 16, v25
  v_and_b32 v21, 0xffff0000, v26
  v_lshlrev_b32 v20, 16, v26
  v_and_b32 v23, 0xffff0000, v27
  v_lshlrev_b32 v22, 16, v27
  v_and_b32 v33, 0xffff0000, v28
  v_lshlrev_b32 v32, 16, v28
  v_and_b32 v35, 0xffff0000, v29
  v_lshlrev_b32 v34, 16, v29
  v_and_b32 v37, 0xffff0000, v30
  v_lshlrev_b32 v36, 16, v30
  v_and_b32 v39, 0xffff0000, v31
  v_lshlrev_b32 v38, 16, v31
  v_add_f32 v16, v16, v32
  v_add_f32 v17, v17, v33
  v_add_f32 v18, v18, v34
  v_add_f32 v19, v19, v35
  v_add_f32 v20, v20, v36
  v_add_f32 v21, v21, v37
  v_add_f32 v22, v22, v38
  v_add_f32 v23, v23, v39
  v_cvt_pk_bf16_f32 v12, v16, v17
  v_cvt_pk_bf16_f32 v13, v18, v19
  v_cvt_pk_bf16_f32 v14, v20, v21
  v_cvt_pk_bf16_f32 v15, v22, v23
  buffer_store_dwordx4 v[12:15], v7, s[20:23], s46 offen sc1
  s_add_u32 s29, s29, s41
  s_cmp_lt_u32 s29, 62
  s_cbranch_scc1 L_G2O_loop
  s_cmp_lt_u32 s51, 2
  s_cbranch_scc1 L_G2O_end
  s_sub_u32 s31, s51, 2
  s_and_b32 s50, s31, 1
  s_lshr_b32 s31, s31, 1
  s_add_u32 s29, s31, 62
  s_waitcnt vmcnt(0)
  v_mbcnt_lo_u32_b32 v0, -1, 0
  v_mbcnt_hi_u32_b32 v0, -1, v0
  s_mul_i32 s31, s24, 4194304
  s_lshl_b32 s32, s50, 10
  s_add_u32 s31, s31, s32
  v_mov_b32 v1, 0x0
  v_bfe_u32 v15, v0, 0, 6
  v_lshl_add_u32 v1, v15, 4, v1
  v_add_u32 v1, s31, v1
  v_lshrrev_b32 v15, 4, v0
  v_and_b32 v9, 7, v0
  v_xor_b32 v15, v15, v9
  v_lshlrev_b32 v15, 4, v15
  v_and_b32 v9, 15, v0
  v_lshl_add_u32 v9, v9, 8, v15
  s_lshl_b32 s31, s24, 13
  s_add_u32 s31, s31, 131072
  v_add_u32 v9, s31, v9
  v_xor_b32 v10, 64, v9
  s_lshl_b32 s31, s24, 2
  v_lshrrev_b32 v3, 4, v0
  v_add_u32 v3, s31, v3
  v_and_b32 v15, 7, v3
  v_and_b32 v4, 15, v0
  v_xor_b32 v15, v15, v4
  v_lshlrev_b32 v15, 4, v15
  v_lshl_add_u32 v3, v3, 8, v15
  v_add_u32 v3, 131072, v3
  s_lshl_b32 s31, s47, 12
  s_lshl_b32 s32, s50, 11
  s_add_u32 s31, s31, s32
  s_lshl_b32 s32, s24, 9
  s_add_u32 s31, s31, s32
  v_mov_b32 v5, 0x0
  v_bfe_u32 v15, v0, 0, 6
  v_lshl_add_u32 v5, v15, 3, v5
  v_add_u32 v5, s31, v5
  s_lshl_b32 s33, s50, 2
  s_add_u32 s33, s33, s24
  s_lshl_b32 s31, s33, 4
  v_mov_b32 v6, 0x0
  v_bfe_u32 v15, v0, 4, 2
  v_lshl_add_u32 v6, v15, 2, v6
  v_add_u32 v6, s31, v6
  s_lshl_b32 s31, s33, 13
  s_lshl_b32 s32, s47, 7
  s_add_u32 s31, s31, s32
  v_mov_b32 v7, 0x0
  v_bfe_u32 v15, v0, 4, 2
  v_lshl_add_u32 v7, v15, 11, v7
  v_bfe_u32 v15, v0, 0, 4
  v_lshl_add_u32 v7, v15, 3, v7
  v_add_u32 v7, s31, v7
  s_lshl_b32 s31, s24, 3
  s_add_u32 s31, s31, 192
  v_add_u32 v2, s31, v0
  v_add_u32 v15, 216, v0
  v_cmp_gt_u32 vcc, 8, v0
  s_nop 1
  v_cndmask_b32 v2, v15, v2, vcc
  v_lshlrev_b32 v2, 7, v2
  s_add_u32 s31, s47, 128
  s_lshl_b32 s31, s31, 7
  s_lshr_b32 s32, s33, 1
  s_lshl_b32 s32, s32, 2
  s_add_u32 s31, s31, s32
  v_writelane_b32 v2, s31, 12
  s_add_u32 s31, s31, 2048
  v_writelane_b32 v2, s31, 13
  s_mov_b32 s38, 0x400000
  v_mov_b32 v11, 0
  s_mov_b32 s48, 0
  s_mov_b32 s49, 0
.p2align 6
L_G2Oh_loop:
  s_add_u32 s45, s29, 1
  s_mul_i32 s44, s29, 8192
  s_add_u32 s44, s44, 0x4800000
  s_lshl_b32 s46, s29, 16
  ds_read_b128 v[48:51], v8 offset:0
  ds_read_b128 v[52:55], v8 offset:1024
  ds_read_b128 v[56:59], v8 offset:2048
  ds_read_b128 v[60:63], v8 offset:3072
  s_cmp_lg_u32 s48, 0
  s_cbranch_scc1 L_G2Oh_go
  s_mov_b64 exec, 0x3fff
L_G2Oh_poll:
  buffer_load_dword v11, v2, s[4:7], s38 offen sc1
  s_waitcnt vmcnt(0)
  v_cmp_gt_u32 vcc, s45, v11
  s_cbranch_vccz L_G2Oh_ready
  s_sleep 1
  s_add_u32 s30, s30, 1
  s_cmp_lt_u32 s30, 0x100000
  s_cbranch_scc1 L_G2Oh_poll
  s_branch L_abort
L_G2Oh_ready:
  s_mov_b64 exec, -1
  s_add_u32 s32, s44, 0
  buffer_load_dwordx4 v[64:67], v1, s[4:7], s32 offen offset:0 sc1
  s_add_u32 s32, s44, 2048
  buffer_load_dwordx4 v[68:71], v1, s[4:7], s32 offen offset:0 sc1
  s_add_u32 s32, s44, 4096
  buffer_load_dwordx4 v[72:75], v1, s[4:7], s32 offen offset:0 sc1
  s_add_u32 s32, s44, 3145728
  buffer_load_dwordx4 v[76:79], v1, s[4:7], s32 offen offset:0 sc1
  s_add_u32 s32, s44, 6144
  buffer_load_dwordx4 v[80:83], v1, s[4:7], s32 offen offset:0 sc1
  s_add_u32 s32, s44, 524288
  buffer_load_dwordx4 v[84:87], v1, s[4:7], s32 offen offset:0 sc1
  s_add_u32 s32, s44, 526336
  buffer_load_dwordx4 v[88:91], v1, s[4:7], s32 offen offset:0 sc1
  s_add_u32 s32, s44, 3147776
  buffer_load_dwordx4 v[92:95], v1, s[4:7], s32 offen offset:0 sc1
  s_add_u32 s32, s44, 528384
  buffer_load_dwordx4 v[96:99], v1, s[4:7], s32 offen offset:0 sc1
  s_add_u32 s32, s44, 530432
  buffer_load_dwordx4 v[100:103], v1, s[4:7], s32 offen offset:0 sc1
  s_add_u32 s32, s44, 1048576
  buffer_load_dwordx4 v[104:107], v1, s[4:7], s32 offen offset:0 sc1
  s_add_u32 s32, s44, 3149824
  buffer_load_dwordx4 v[108:111], v1, s[4:7], s32 offen offset:0 sc1
  s_add_u32 s32, s44, 1050624
  buffer_load_dwordx4 v[112:115], v1, s[4:7], s32 offen offset:0 sc1
  s_add_u32 s32, s44, 1052672
  buffer_load_dwordx4 v[116:119], v1, s[4:7], s32 offen offset:0 sc1
  s_add_u32 s32, s44, 1054720
  buffer_load_dwordx4 v[120:123], v1, s[4:7], s32 offen offset:0 sc1
  s_add_u32 s32, s44, 3151872
  buffer_load_dwordx4 v[124:127], v1, s[4:7], s32 offen offset:0 sc1
L_G2Oh_go:
  s_waitcnt vmcnt(15)
  v_mfma_f32_16x16x32_bf16 v[16:19], a[0:3], v[64:67], 0
  v_mfma_f32_16x16x32_bf16 v[24:27], a[4:7], v[64:67], 0
  v_mfma_f32_16x16x32_bf16 v[32:35], a[8:11], v[64:67], 0
  v_mfma_f32_16x16x32_bf16 v[40:43], a[12:15], v[64:67], 0
  s_add_u32 s32, s44, 1572864
  buffer_load_dwordx4 v[64:67], v1, s[4:7], s32 offen offset:0 sc1
  s_waitcnt vmcnt(15)
  v_mfma_f32_16x16x32_bf16 v[16:19], a[16:19], v[68:71], v[16:19]
  v_mfma_f32_16x16x32_bf16 v[24:27], a[20:23], v[68:71], v[24:27]
  v_mfma_f32_16x16x32_bf16 v[32:35], a[24:27], v[68:71], v[32:35]
  v_mfma_f32_16x16x32_bf16 v[40:43], a[28:31], v[68:71], v[40:43]
  s_add_u32 s32, s44, 1574912
  buffer_load_dwordx4 v[68:71], v1, s[4:7], s32 offen offset:0 sc1
  s_waitcnt vmcnt(15)
  v_mfma_f32_16x16x32_bf16 v[16:19], a[32:35], v[72:75], v[16:19]
  v_mfma_f32_16x16x32_bf16 v[24:27], a[36:39], v[72:75], v[24:27]
  v_mfma_f32_16x16x32_bf16 v[32:35], a[40:43], v[72:75], v[32:35]
  v_mfma_f32_16x16x32_bf16 v[40:43], a[44:47], v[72:75], v[40:43]
  s_mov_b64 exec, 0x3fff
  buffer_load_dword v11, v2, s[4:7], s38 offen sc1
  s_mov_b64 exec, -1
  s_add_u32 s32, s44, 1576960
  buffer_load_dwordx4 v[72:75], v1, s[4:7], s32 offen offset:0 sc1
  s_waitcnt vmcnt(16)
  s_waitcnt lgkmcnt(3)
  v_mfma_f32_16x16x32_bf16 v[16:19], v[48:51], v[76:79], v[16:19]
  s_waitcnt lgkmcnt(2)
  v_mfma_f32_16x16x32_bf16 v[24:27], v[52:55], v[76:79], v[24:27]
  s_waitcnt lgkmcnt(1)
  v_mfma_f32_16x16x32_bf16 v[32:35], v[56:59], v[76:79], v[32:35]
  s_waitcnt lgkmcnt(0)
  v_mfma_f32_16x16x32_bf16 v[40:43], v[60:63], v[76:79], v[40:43]
  s_add_u32 s32, s44, 3670016
  buffer_load_dwordx4 v[76:79], v1, s[4:7], s32 offen offset:0 sc1
  ds_read_b128 v[48:51], v8 offset:4096
  ds_read_b128 v[52:55], v8 offset:5120
  ds_read_b128 v[56:59], v8 offset:6144
  ds_read_b128 v[60:63], v8 offset:7168
  s_waitcnt vmcnt(16)
  v_mfma_f32_16x16x32_bf16 v[16:19], a[48:51], v[80:83], v[16:19]
  v_mfma_f32_16x16x32_bf16 v[24:27], a[52:55], v[80:83], v[24:27]
  v_mfma_f32_16x16x32_bf16 v[32:35], a[56:59], v[80:83], v[32:35]
  v_mfma_f32_16x16x32_bf16 v[40:43], a[60:63], v[80:83], v[40:43]
  s_add_u32 s32, s44, 1579008
  buffer_load_dwordx4 v[80:83], v1, s[4:7], s32 offen offset:0 sc1
  s_waitcnt vmcnt(16)
  v_mfma_f32_16x16x32_bf16 v[16:19], a[64:67], v[84:87], v[16:19]
  v_mfma_f32_16x16x32_bf16 v[24:27], a[68:71], v[84:87], v[24:27]
  v_mfma_f32_16x16x32_bf16 v[32:35], a[72:75], v[84:87], v[32:35]
  v_mfma_f32_16x16x32_bf16 v[40:43], a[76:79], v[84:87], v[40:43]
  s_add_u32 s32, s44, 2097152
  buffer_load_dwordx4 v[84:87], v1, s[4:7], s32 offen offset:0 sc1
  s_waitcnt vmcnt(16)
  v_mfma_f32_16x16x32_bf16 v[16:19], a[80:83], v[88:91], v[16:19]
  v_mfma_f32_16x16x32_bf16 v[24:27], a[84:87], v[88:91], v[24:27]
  v_mfma_f32_16x16x32_bf16 v[32:35], a[88:91], v[88:91], v[32:35]
  v_mfma_f32_16x16x32_bf16 v[40:43], a[92:95], v[88:91], v[40:43]
  s_add_u32 s32, s44, 2099200
  buffer_load_dwordx4 v[88:91], v1, s[4:7], s32 offen offset:0 sc1
  s_waitcnt vmcnt(16)
  s_waitcnt lgkmcnt(3)
  v_mfma_f32_16x16x32_bf16 v[16:19], v[48:51], v[92:95], v[16:19]
  s_waitcnt lgkmcnt(2)
  v_mfma_f32_16x16x32_bf16 v[24:27], v[52:55], v[92:95], v[24:27]
  s_waitcnt lgkmcnt(1)
  v_mfma_f32_16x16x32_bf16 v[32:35], v[56:59], v[92:95], v[32:35]
  s_waitcnt lgkmcnt(0)
  v_mfma_f32_16x16x32_bf16 v[40:43], v[60:63], v[92:95], v[40:43]
  s_add_u32 s32, s44, 3672064
  buffer_load_dwordx4 v[92:95], v1, s[4:7], s32 offen offset:0 sc1
  ds_read_b128 v[48:51], v8 offset:8192
  ds_read_b128 v[52:55], v8 offset:9216
  ds_read_b128 v[56:59], v8 offset:10240
  ds_read_b128 v[60:63], v8 offset:11264
  s_waitcnt vmcnt(16)
  v_mfma_f32_16x16x32_bf16 v[16:19], a[96:99], v[96:99], v[16:19]
  v_mfma_f32_16x16x32_bf16 v[24:27], a[100:103], v[96:99], v[24:27]
  v_mfma_f32_16x16x32_bf16 v[32:35], a[104:107], v[96:99], v[32:35]
  v_mfma_f32_16x16x32_bf16 v[40:43], a[108:111], v[96:99], v[40:43]
  s_add_u32 s32, s44, 2101248
  buffer_load_dwordx4 v[96:99], v1, s[4:7], s32 offen offset:0 sc1
  s_waitcnt vmcnt(16)
  v_mfma_f32_16x16x32_bf16 v[16:19], a[112:115], v[100:103], v[16:19]
  v_mfma_f32_16x16x32_bf16 v[24:27], a[116:119], v[100:103], v[24:27]
  v_mfma_f32_16x16x32_bf16 v[32:35], a[120:123], v[100:103], v[32:35]
  v_mfma_f32_16x16x32_bf16 v[40:43], a[124:127], v[100:103], v[40:43]
  s_add_u32 s32, s44, 2103296
  buffer_load_dwordx4 v[100:103], v1, s[4:7], s32 offen offset:0 sc1
  s_waitcnt vmcnt(16)
  v_mfma_f32_16x16x32_bf16 v[16:19], a[128:131], v[104:107], v[16:19]
  v_mfma_f32_16x16x32_bf16 v[24:27], a[132:135], v[104:107], v[24:27]
  v_mfma_f32_16x16x32_bf16 v[32:35], a[136:139], v[104:107], v[32:35]
  v_mfma_f32_16x16x32_bf16 v[40:43], a[140:143], v[104:107], v[40:43]
  s_add_u32 s32, s44, 2621440
  buffer_load_dwordx4 v[104:107], v1, s[4:7], s32 offen offset:0 sc1
  s_waitcnt vmcnt(16)
  s_waitcnt lgkmcnt(3)
  v_mfma_f32_16x16x32_bf16 v[16:19], v[48:51], v[108:111], v[16:19]
  s_waitcnt lgkmcnt(2)
  v_mfma_f32_16x16x32_bf16 v[24:27], v[52:55], v[108:111], v[24:27]
  s_waitcnt lgkmcnt(1)
  v_mfma_f32_16x16x32_bf16 v[32:35], v[56:59], v[108:111], v[32:35]
  s_waitcnt lgkmcnt(0)
  v_mfma_f32_16x16x32_bf16 v[40:43], v[60:63], v[108:111], v[40:43]
  s_add_u32 s32, s44, 3674112
  buffer_load_dwordx4 v[108:111], v1, s[4:7], s32 offen offset:0 sc1
  ds_read_b128 v[48:51], v8 offset:12288
  ds_read_b128 v[52:55], v8 offset:13312
  ds_read_b128 v[56:59], v8 offset:14336
  ds_read_b128 v[60:63], v8 offset:15360
  s_waitcnt vmcnt(16)
  v_mfma_f32_16x16x32_bf16 v[16:19], a[144:147], v[112:115], v[16:19]
  v_mfma_f32_16x16x32_bf16 v[24:27], a[148:151], v[112:115], v[24:27]
  v_mfma_f32_16x16x32_bf16 v[32:35], a[152:155], v[112:115], v[32:35]
  v_mfma_f32_16x16x32_bf16 v[40:43], a[156:159], v[112:115], v[40:43]
  s_add_u32 s32, s44, 2623488
  buffer_load_dwordx4 v[112:115], v1, s[4:7], s32 offen offset:0 sc1
  s_waitcnt vmcnt(16)
  v_mfma_f32_16x16x32_bf16 v[16:19], a[160:163], v[116:119], v[16:19]
  v_mfma_f32_16x16x32_bf16 v[24:27], a[164:167], v[116:119], v[24:27]
  v_mfma_f32_16x16x32_bf16 v[32:35], a[168:171], v[116:119], v[32:35]
  v_mfma_f32_16x16x32_bf16 v[40:43], a[172:175], v[116:119], v[40:43]
  s_add_u32 s32, s44, 2625536
  buffer_load_dwordx4 v[116:119], v1, s[4:7], s32 offen offset:0 sc1
  s_waitcnt vmcnt(16)
  v_mfma_f32_16x16x32_bf16 v[16:19], a[176:179], v[120:123], v[16:19]
  v_mfma_f32_16x16x32_bf16 v[24:27], a[180:183], v[120:123], v[24:27]
  v_mfma_f32_16x16x32_bf16 v[32:35], a[184:187], v[120:123], v[32:35]
  v_mfma_f32_16x16x32_bf16 v[40:43], a[188:191], v[120:123], v[40:43]
  s_waitcnt vmcnt(12)
  s_add_u32 s33, s45, s41
  s_mov_b64 exec, 0x3fff
  v_cmp_gt_u32 vcc, s33, v11
  s_mov_b64 exec, -1
  s_mul_i32 s40, s41, 8192
  s_add_u32 s40, s40, s44
  s_cmp_eq_u64 vcc, 0
  s_cselect_b32 s48, 1, 0
  s_cselect_b32 s40, s40, 0x40000000
  s_add_u32 s32, s44, 2627584
  buffer_load_dwordx4 v[120:123], v1, s[4:7], s32 offen offset:0 sc1
  s_waitcnt lgkmcnt(3)
  v_mfma_f32_16x16x32_bf16 v[16:19], v[48:51], v[124:127], v[16:19]
  s_waitcnt lgkmcnt(2)
  v_mfma_f32_16x16x32_bf16 v[24:27], v[52:55], v[124:127], v[24:27]
  s_waitcnt lgkmcnt(1)
  v_mfma_f32_16x16x32_bf16 v[32:35], v[56:59], v[124:127], v[32:35]
  s_waitcnt lgkmcnt(0)
  v_mfma_f32_16x16x32_bf16 v[40:43], v[60:63], v[124:127], v[40:43]
  s_add_u32 s31, s46, 0x5800000
  s_lshl_b32 s33, s29, 7
  s_add_u32 s33, s33, 0x410000
  buffer_load_dwordx2 v[12:13], v5, s[4:7], s31 offen sc1
  buffer_load_dword v0, v6, s[4:7], s33 offen sc1
  s_add_u32 s32, s44, 3676160
  buffer_load_dwordx4 v[124:127], v1, s[4:7], s32 offen offset:0 sc1
  ds_read_b128 v[48:51], v8 offset:16384
  ds_read_b128 v[52:55], v8 offset:17408
  ds_read_b128 v[56:59], v8 offset:18432
  ds_read_b128 v[60:63], v8 offset:19456
  v_mfma_f32_16x16x32_bf16 v[16:19], a[192:195], v[64:67], v[16:19]
  v_mfma_f32_16x16x32_bf16 v[24:27], a[196:199], v[64:67], v[24:27]
  v_mfma_f32_16x16x32_bf16 v[32:35], a[200:203], v[64:67], v[32:35]
  v_mfma_f32_16x16x32_bf16 v[40:43], a[204:207], v[64:67], v[40:43]
  s_add_u32 s32, s40, 0
  buffer_load_dwordx4 v[64:67], v1, s[4:7], s32 offen offset:0 sc1
  v_mfma_f32_16x16x32_bf16 v[16:19], a[208:211], v[68:71], v[16:19]
  v_mfma_f32_16x16x32_bf16 v[24:27], a[212:215], v[68:71], v[24:27]
  v_mfma_f32_16x16x32_bf16 v[32:35], a[216:219], v[68:71], v[32:35]
  v_mfma_f32_16x16x32_bf16 v[40:43], a[220:223], v[68:71], v[40:43]
  s_add_u32 s32, s40, 2048
  buffer_load_dwordx4 v[68:71], v1, s[4:7], s32 offen offset:0 sc1
  s_waitcnt vmcnt(17)
  v_mfma_f32_16x16x32_bf16 v[16:19], a[224:227], v[72:75], v[16:19]
  v_mfma_f32_16x16x32_bf16 v[24:27], a[228:231], v[72:75], v[24:27]
  v_mfma_f32_16x16x32_bf16 v[32:35], a[232:235], v[72:75], v[32:35]
  v_mfma_f32_16x16x32_bf16 v[40:43], a[236:239], v[72:75], v[40:43]
  s_add_u32 s32, s40, 4096
  buffer_load_dwordx4 v[72:75], v1, s[4:7], s32 offen offset:0 sc1
  s_waitcnt vmcnt(17)
  s_waitcnt lgkmcnt(3)
  v_mfma_f32_16x16x32_bf16 v[16:19], v[48:51], v[76:79], v[16:19]
  s_waitcnt lgkmcnt(2)
  v_mfma_f32_16x16x32_bf16 v[24:27], v[52:55], v[76:79], v[24:27]
  s_waitcnt lgkmcnt(1)
  v_mfma_f32_16x16x32_bf16 v[32:35], v[56:59], v[76:79], v[32:35]
  s_waitcnt lgkmcnt(0)
  v_mfma_f32_16x16x32_bf16 v[40:43], v[60:63], v[76:79], v[40:43]
  s_add_u32 s32, s40, 3145728
  buffer_load_dwordx4 v[76:79], v1, s[4:7], s32 offen offset:0 sc1
  ds_read_b128 v[48:51], v8 offset:20480
  ds_read_b128 v[52:55], v8 offset:21504
  ds_read_b128 v[56:59], v8 offset:22528
  ds_read_b128 v[60:63], v8 offset:23552
  s_waitcnt vmcnt(17)
  v_mfma_f32_16x16x32_bf16 v[16:19], a[240:243], v[80:83], v[16:19]
  v_mfma_f32_16x16x32_bf16 v[24:27], a[244:247], v[80:83], v[24:27]
  v_mfma_f32_16x16x32_bf16 v[32:35], a[248:251], v[80:83], v[32:35]
  v_mfma_f32_16x16x32_bf16 v[40:43], a[252:255], v[80:83], v[40:43]
  s_add_u32 s32, s40, 6144
  buffer_load_dwordx4 v[80:83], v1, s[4:7], s32 offen offset:0 sc1
  s_waitcnt vmcnt(17)
  v_mfma_f32_16x16x32_bf16 v[16:19], v[128:131], v[84:87], v[16:19]
  v_mfma_f32_16x16x32_bf16 v[24:27], v[132:135], v[84:87], v[24:27]
  v_mfma_f32_16x16x32_bf16 v[32:35], v[136:139], v[84:87], v[32:35]
  v_mfma_f32_16x16x32_bf16 v[40:43], v[140:143], v[84:87], v[40:43]
  s_add_u32 s32, s40, 524288
  buffer_load_dwordx4 v[84:87], v1, s[4:7], s32 offen offset:0 sc1
  s_waitcnt vmcnt(17)
  v_mfma_f32_16x16x32_bf16 v[16:19], v[144:147], v[88:91], v[16:19]
  v_mfma_f32_16x16x32_bf16 v[24:27], v[148:151], v[88:91], v[24:27]
  v_mfma_f32_16x16x32_bf16 v[32:35], v[152:155], v[88:91], v[32:35]
  v_mfma_f32_16x16x32_bf16 v[40:43], v[156:159], v[88:91], v[40:43]
  s_add_u32 s32, s40, 526336
  buffer_load_dwordx4 v[88:91], v1, s[4:7], s32 offen offset:0 sc1
  s_waitcnt vmcnt(17)
  s_waitcnt lgkmcnt(3)
  v_mfma_f32_16x16x32_bf16 v[16:19], v[48:51], v[92:95], v[16:19]
  s_waitcnt lgkmcnt(2)
  v_mfma_f32_16x16x32_bf16 v[24:27], v[52:55], v[92:95], v[24:27]
  s_waitcnt lgkmcnt(1)
  v_mfma_f32_16x16x32_bf16 v[32:35], v[56:59], v[92:95], v[32:35]
  s_waitcnt lgkmcnt(0)
  v_mfma_f32_16x16x32_bf16 v[40:43], v[60:63], v[92:95], v[40:43]
  s_add_u32 s32, s40, 3147776
  buffer_load_dwordx4 v[92:95], v1, s[4:7], s32 offen offset:0 sc1
  ds_read_b128 v[48:51], v8 offset:24576
  ds_read_b128 v[52:55], v8 offset:25600
  ds_read_b128 v[56:59], v8 offset:26624
  ds_read_b128 v[60:63], v8 offset:27648
  s_waitcnt vmcnt(17)
  v_mfma_f32_16x16x32_bf16 v[16:19], v[160:163], v[96:99], v[16:19]
  v_mfma_f32_16x16x32_bf16 v[24:27], v[164:167], v[96:99], v[24:27]
  v_mfma_f32_16x16x32_bf16 v[32:35], v[168:171], v[96:99], v[32:35]
  v_mfma_f32_16x16x32_bf16 v[40:43], v[172:175], v[96:99], v[40:43]
  s_add_u32 s32, s40, 528384
  buffer_load_dwordx4 v[96:99], v1, s[4:7], s32 offen offset:0 sc1
  s_waitcnt vmcnt(17)
  v_mfma_f32_16x16x32_bf16 v[16:19], v[176:179], v[100:103], v[16:19]
  v_mfma_f32_16x16x32_bf16 v[24:27], v[180:183], v[100:103], v[24:27]
  v_mfma_f32_16x16x32_bf16 v[32:35], v[184:187], v[100:103], v[32:35]
  v_mfma_f32_16x16x32_bf16 v[40:43], v[188:191], v[100:103], v[40:43]
  s_add_u32 s32, s40, 530432
  buffer_load_dwordx4 v[100:103], v1, s[4:7], s32 offen offset:0 sc1
  s_waitcnt vmcnt(17)
  v_mfma_f32_16x16x32_bf16 v[16:19], v[192:195], v[104:107], v[16:19]
  v_mfma_f32_16x16x32_bf16 v[24:27], v[196:199], v[104:107], v[24:27]
  v_mfma_f32_16x16x32_bf16 v[32:35], v[200:203], v[104:107], v[32:35]
  v_mfma_f32_16x16x32_bf16 v[40:43], v[204:207], v[104:107], v[40:43]
  s_add_u32 s32, s40, 1048576
  buffer_load_dwordx4 v[104:107], v1, s[4:7], s32 offen offset:0 sc1
  s_waitcnt vmcnt(17)
  s_waitcnt lgkmcnt(3)
  v_mfma_f32_16x16x32_bf16 v[16:19], v[48:51], v[108:111], v[16:19]
  s_waitcnt lgkmcnt(2)
  v_mfma_f32_16x16x32_bf16 v[24:27], v[52:55], v[108:111], v[24:27]
  s_waitcnt lgkmcnt(1)
  v_mfma_f32_16x16x32_bf16 v[32:35], v[56:59], v[108:111], v[32:35]
  s_waitcnt lgkmcnt(0)
  v_mfma_f32_16x16x32_bf16 v[40:43], v[60:63], v[108:111], v[40:43]
  s_add_u32 s32, s40, 3149824
  buffer_load_dwordx4 v[108:111], v1, s[4:7], s32 offen offset:0 sc1
  ds_read_b128 v[48:51], v8 offset:28672
  ds_read_b128 v[52:55], v8 offset:29696
  ds_read_b128 v[56:59], v8 offset:30720
  ds_read_b128 v[60:63], v8 offset:31744
  s_waitcnt vmcnt(17)
  v_mfma_f32_16x16x32_bf16 v[16:19], v[208:211], v[112:115], v[16:19]
  v_mfma_f32_16x16x32_bf16 v[24:27], v[212:215], v[112:115], v[24:27]
  v_mfma_f32_16x16x32_bf16 v[32:35], v[216:219], v[112:115], v[32:35]
  v_mfma_f32_16x16x32_bf16 v[40:43], v[220:223], v[112:115], v[40:43]
  s_add_u32 s32, s40, 1050624
  buffer_load_dwordx4 v[112:115], v1, s[4:7], s32 offen offset:0 sc1
  s_waitcnt vmcnt(17)
  v_mfma_f32_16x16x32_bf16 v[16:19], v[224:227], v[116:119], v[16:19]
  v_mfma_f32_16x16x32_bf16 v[24:27], v[228:231], v[116:119], v[24:27]
  v_mfma_f32_16x16x32_bf16 v[32:35], v[232:235], v[116:119], v[32:35]
  v_mfma_f32_16x16x32_bf16 v[40:43], v[236:239], v[116:119], v[40:43]
  s_add_u32 s32, s40, 1052672
  buffer_load_dwordx4 v[116:119], v1, s[4:7], s32 offen offset:0 sc1
  s_waitcnt vmcnt(17)
  v_mfma_f32_16x16x32_bf16 v[16:19], v[240:243], v[120:123], v[16:19]
  v_mfma_f32_16x16x32_bf16 v[24:27], v[244:247], v[120:123], v[24:27]
  v_mfma_f32_16x16x32_bf16 v[32:35], v[248:251], v[120:123], v[32:35]
  v_mfma_f32_16x16x32_bf16 v[40:43], v[252:255], v[120:123], v[40:43]
  s_add_u32 s32, s40, 1054720
  buffer_load_dwordx4 v[120:123], v1, s[4:7], s32 offen offset:0 sc1
  s_waitcnt vmcnt(15)
  s_waitcnt lgkmcnt(3)
  v_mfma_f32_16x16x32_bf16 v[16:19], v[48:51], v[124:127], v[16:19]
  s_waitcnt lgkmcnt(2)
  v_mfma_f32_16x16x32_bf16 v[24:27], v[52:55], v[124:127], v[24:27]
  s_waitcnt lgkmcnt(1)
  v_mfma_f32_16x16x32_bf16 v[32:35], v[56:59], v[124:127], v[32:35]
  s_waitcnt lgkmcnt(0)
  v_mfma_f32_16x16x32_bf16 v[40:43], v[60:63], v[124:127], v[40:43]
  s_add_u32 s32, s40, 3151872
  buffer_load_dwordx4 v[124:127], v1, s[4:7], s32 offen offset:0 sc1
  v_cmp_u_f32 vcc, v16, v16
  s_cbranch_vccz L_G2Oh_valid
  s_cmp_lg_u32 s49, 0
  s_cbranch_scc1 L_G2Oh_valid
  s_mov_b32 s49, 1
  s_mov_b32 s48, 0
  s_add_u32 s33, s45, 1
  s_mov_b64 exec, 0xff
L_G2Oh_conf:
  buffer_load_dword v11, v2, s[4:7], s38 offen sc1
  s_waitcnt vmcnt(0)
  v_cmp_gt_u32 vcc, s33, v11
  s_cbranch_vccnz L_G2Oh_more
  s_mov_b64 exec, -1
  s_branch L_G2Oh_loop
L_G2Oh_more:
  s_sleep 1
  s_add_u32 s30, s30, 1
  s_cmp_lt_u32 s30, 0x100000
  s_cbranch_scc1 L_G2Oh_conf
  s_branch L_abort
L_G2Oh_valid:
  s_nop 7
  ds_write_b128 v9, v[16:19] offset:0
  ds_write_b128 v10, v[24:27] offset:0
  ds_write_b128 v9, v[32:35] offset:128
  ds_write_b128 v10, v[40:43] offset:128
  s_waitcnt lgkmcnt(0)
  s_barrier
  ds_read_b128 v[16:19], v3 offset:0
  ds_read_b128 v[24:27], v3 offset:8192
  ds_read_b128 v[32:35], v3 offset:16384
  ds_read_b128 v[40:43], v3 offset:24576
  s_waitcnt lgkmcnt(2)
  v_add_f32 v16, v16, v24
  v_add_f32 v17, v17, v25
  v_add_f32 v18, v18, v26
  v_add_f32 v19, v19, v27
  s_waitcnt lgkmcnt(0)
  s_barrier
  v_add_f32 v32, v32, v40
  v_add_f32 v33, v33, v41
  v_add_f32 v34, v34, v42
  v_add_f32 v35, v35, v43
  v_add_f32 v16, v16, v32
  v_add_f32 v17, v17, v33
  v_add_f32 v18, v18, v34
  v_add_f32 v19, v19, v35
  v_cvt_pk_bf16_f32 v24, v16, v17
  v_cvt_pk_bf16_f32 v25, v18, v19
  v_and_b32 v17, 0xffff0000, v24
  v_lshlrev_b32 v16, 16, v24
  v_and_b32 v19, 0xffff0000, v25
  v_lshlrev_b32 v18, 16, v25
  v_sub_f32 v40, 1.0, v0
  v_cvt_pk_bf16_f32 v40, v40, v40
  v_lshlrev_b32 v40, 16, v40
  v_and_b32 v33, 0xffff0000, v12
  v_lshlrev_b32 v32, 16, v12
  v_and_b32 v35, 0xffff0000, v13
  v_lshlrev_b32 v34, 16, v13
  v_mul_f32 v16, v0, v16
  v_mul_f32 v32, v40, v32
  v_mul_f32 v17, v0, v17
  v_mul_f32 v33, v40, v33
  v_mul_f32 v18, v0, v18
  v_mul_f32 v34, v40, v34
  v_mul_f32 v19, v0, v19
  v_mul_f32 v35, v40, v35
  v_cvt_pk_bf16_f32 v24, v16, v17
  v_cvt_pk_bf16_f32 v25, v18, v19
  v_cvt_pk_bf16_f32 v28, v32, v33
  v_cvt_pk_bf16_f32 v29, v34, v35
  v_and_b32 v17, 0xffff0000, v24
  v_lshlrev_b32 v16, 16, v24
  v_and_b32 v19, 0xffff0000, v25
  v_lshlrev_b32 v18, 16, v25
  v_and_b32 v33, 0xffff0000, v28
  v_lshlrev_b32 v32, 16, v28
  v_and_b32 v35, 0xffff0000, v29
  v_lshlrev_b32 v34, 16, v29
  v_add_f32 v16, v16, v32
  v_add_f32 v17, v17, v33
  v_add_f32 v18, v18, v34
  v_add_f32 v19, v19, v35
  v_cvt_pk_bf16_f32 v12, v16, v17
  v_cvt_pk_bf16_f32 v13, v18, v19
  buffer_store_dwordx2 v[12:13], v7, s[20:23], s46 offen sc1
  s_add_u32 s29, s29, s41
  s_cmp_lt_u32 s29, 64
  s_cbranch_scc1 L_G2Oh_loop
L_G2O_end:
  s_branch L_exit
L_abort:
  v_mov_b32 v2, s25
  v_mov_b32 v3, s29
  v_add_u32 v2, 0x1000, v2
  s_mov_b64 exec, 1
  buffer_store_dwordx2 v[2:3], off, s[8:11], 0 offset:160
  s_waitcnt vmcnt(0)
L_exit:
  s_endpgm
L_code_end:
.section .rodata,"a"
.p2align 6
.amdhsa_kernel gated_mix__memory_aug_recurrent_mem_tr__dense_activation_relu__prompt_kernel
  .amdhsa_next_free_vgpr 512
  .amdhsa_next_free_sgpr 102
  .amdhsa_accum_offset 256
  .amdhsa_group_segment_fixed_size 0
  .amdhsa_kernarg_size 112
  .amdhsa_user_sgpr_count 2
  .amdhsa_user_sgpr_kernarg_segment_ptr 1
  .amdhsa_system_sgpr_workgroup_id_x 1
  .amdhsa_float_denorm_mode_32 3
.end_amdhsa_kernel
```
